```python
import torch

def _softmax(x, axis=-1):
    return torch.softmax(x, dim=axis)

def _gelu(x):
    return torch.nn.functional.gelu(x, approximate='tanh')

def _silu(x):
    return torch.nn.functional.silu(x)

def _sigmoid(x):
    return torch.sigmoid(x)

def _layernorm(x, axis=-1, eps=1e-05):
    m = x.mean(dim=axis, keepdim=True)
    v = x.var(dim=axis, keepdim=True, unbiased=False)
    return (x - m) / torch.sqrt(v + eps)

def _scatter_add(tgt, idx, src, axis=0):
    return tgt.clone().index_add_(axis, idx, src)

def _segment_sum(src, seg, n):
    out = torch.zeros((n,) + src.shape[1:], dtype=src.dtype)
    return out.index_add_(0, seg, src)

def _pad(x, pw):
    flat = tuple((v for pair in reversed(pw) for v in pair))
    return torch.nn.functional.pad(x, flat)
kernel_name = 'parallel_sum__memory_aug_recurrent_mem_tr__mixer_channel_mlp__prompt'

def setup_inputs():

    _w = lambda a: (lambda t: t.to(torch.bfloat16) if t.is_floating_point() else t)(torch.as_tensor(a))

    def _A_setup():
        B, S, Dm = (1, 2048, 640)
        H, Dh = (32, 128)
        M, seg = (8, 32)
        seg = min(seg, S)
        S = S // seg * seg
        return {'x': _w((lambda *s: torch.randn(*s, dtype=torch.bfloat16) * 0.05)(B, S, Dm)), 'mem0': _w((lambda *s: torch.randn(*s, dtype=torch.bfloat16) * 0.2)(B, M, Dm)), 'Wq': _w((lambda *s: torch.randn(*s, dtype=torch.bfloat16) * 1.6)(Dm, H, Dh) * Dm ** (-0.5)), 'Wk': _w((lambda *s: torch.randn(*s, dtype=torch.bfloat16) * 1.6)(Dm, H, Dh) * Dm ** (-0.5)), 'Wv': _w((lambda *s: torch.randn(*s, dtype=torch.bfloat16) * 0.2)(Dm, H, Dh) * Dm ** (-0.5)), 'Wo': _w((lambda *s: torch.randn(*s, dtype=torch.bfloat16) * 0.2)(H, Dh, Dm) * (H * Dh) ** (-0.5)), 'seg_len': seg}
    _A_in = _A_setup()

    def _B_setup():
        B, S, D, F = (1, 2048, 640, 1728)
        return {'x': _w((lambda *s: torch.randn(*s, dtype=torch.bfloat16) * 0.05)(B, S, D)), 'w1': _w((lambda *s: torch.randn(*s, dtype=torch.bfloat16) * 0.8)(D, F) * D ** (-0.5)), 'b1': _w((lambda *s: torch.randn(*s, dtype=torch.bfloat16) * 0.4)(F)), 'w2': _w((lambda *s: torch.randn(*s, dtype=torch.bfloat16) * 0.05)(F, D) * F ** (-0.5)), 'b2': _w((lambda *s: torch.randn(*s, dtype=torch.bfloat16) * 0.05)(D))}
    _B_in = _B_setup()
    return {'A_x': _A_in['x'], 'A_mem0': _A_in['mem0'], 'A_Wq': _A_in['Wq'], 'A_Wk': _A_in['Wk'], 'A_Wv': _A_in['Wv'], 'A_Wo': _A_in['Wo'], 'A_seg_len': _A_in['seg_len'], 'B_x': _B_in['x'], 'B_w1': _B_in['w1'], 'B_b1': _B_in['b1'], 'B_w2': _B_in['w2'], 'B_b2': _B_in['b2']}

def reference(A_x, A_mem0, A_Wq, A_Wk, A_Wv, A_Wo, A_seg_len, B_x, B_w1, B_b1, B_w2, B_b2):

    def _A_ref(x, mem0, Wq, Wk, Wv, Wo, seg_len):
        B, S, Dm = x.shape
        H, Dh = (Wq.shape[1], Wq.shape[2])
        M = mem0.shape[1]
        scale = Dh ** (-0.5)
        n_seg = S // seg_len
        L = M + seg_len
        idx = torch.arange(L)
        mask = (idx[:, None] < M) | (idx[:, None] >= idx[None, :])
        mem = mem0
        outs = []
        for s in range(n_seg):
            xs = x[:, s * seg_len:(s + 1) * seg_len, :].clone()
            h = torch.concatenate([mem, xs], axis=1)
            q = torch.einsum('btd,dhe->bhte', h, Wq)
            k = torch.einsum('btd,dhe->bhte', h, Wk)
            v = torch.einsum('btd,dhe->bhte', h, Wv)
            scores = torch.einsum('bhqe,bhke->bhqk', q, k) * scale
            scores = torch.where(mask[None, None], scores, -1000000000.0)
            p = _softmax(scores, axis=-1)
            o = torch.einsum('bhqk,bhke->bhqe', p, v)
            o = torch.einsum('bhte,hed->btd', o, Wo)
            mem = o[:, :M, :].clone()
            outs.append(o[:, M:, :])
        return torch.concatenate(outs, axis=1)

    def _B_ref(x, w1, b1, w2, b2):
        y = _layernorm(x, axis=-1)
        h = _gelu(torch.einsum('bsd,df->bsf', y, w1) + b1)
        return torch.einsum('bsf,fd->bsd', h, w2) + b2
    x = A_x
    xn = _layernorm(x, axis=-1)
    return x + _A_ref(xn, A_mem0, A_Wq, A_Wk, A_Wv, A_Wo, A_seg_len) + _B_ref(xn, B_w1, B_b1, B_w2, B_b2)
```

```asm
; @launch grid=(256,1,1) block=(256,1,1) lds=163840
.amdgcn_target "amdgcn-amd-amdhsa--gfx950"
.text
.globl parallel_sum__memory_aug_recurrent_mem_tr__mixer_channel_mlp__prompt_kernel
.p2align 8
.type parallel_sum__memory_aug_recurrent_mem_tr__mixer_channel_mlp__prompt_kernel,@function
parallel_sum__memory_aug_recurrent_mem_tr__mixer_channel_mlp__prompt_kernel:
  s_cmp_ge_u32 s2, 0x100
  s_cbranch_scc1 L_end
  s_load_dwordx16 s[64:79], s[0:1], 0
  s_load_dwordx8 s[80:87], s[0:1], 64
  s_load_dwordx4 s[88:91], s[0:1], 96
  s_load_dwordx2 s[92:93], s[0:1], 112
  s_getreg_b32 s30, hwreg(HW_REG_XCC_ID, 0, 3)
  v_lshrrev_b32 v2, 6, v0
  v_and_b32 v1, 63, v0
  s_mov_b32 s29, 131072
  v_readfirstlane_b32 s28, v2
  s_mov_b32 s33, 0
  s_mov_b32 s34, 0
  s_mov_b32 s101, 0
  s_and_b32 s30, s30, 7
  s_waitcnt lgkmcnt(0)
  s_mov_b32 s4, s92
  s_mov_b32 s5, s93
  s_mov_b32 s6, 268435456
  s_mov_b32 s7, 0x20000
  s_mov_b32 s8, s90
  s_mov_b32 s9, s91
  s_mov_b32 s10, 256
  s_mov_b32 s11, 0x20000
  s_cmp_eq_u32 s28, 0
  s_cbranch_scc1 L_rank
  s_cmp_eq_u32 s28, 3
  s_cbranch_scc0 L_ranked
  s_cmp_ge_u32 s2, 32
  s_cbranch_scc1 L_ranked
  v_lshlrev_b32 v2, 4, v1
  s_lshl_b32 s35, s2, 14
  s_cmp_lt_u32 s35, 180224
  s_cselect_b32 s3, -1, 0
  v_mov_b32 v4, s3
  v_mov_b32 v5, s3
  v_mov_b32 v6, s3
  v_mov_b32 v7, s3
  buffer_store_dwordx4 v[4:7], v2, s[4:7], s35 offen offset:0 sc1
  buffer_store_dwordx4 v[4:7], v2, s[4:7], s35 offen offset:1024 sc1
  buffer_store_dwordx4 v[4:7], v2, s[4:7], s35 offen offset:2048 sc1
  buffer_store_dwordx4 v[4:7], v2, s[4:7], s35 offen offset:3072 sc1
  s_add_u32 s35, s35, 4096
  buffer_store_dwordx4 v[4:7], v2, s[4:7], s35 offen offset:0 sc1
  buffer_store_dwordx4 v[4:7], v2, s[4:7], s35 offen offset:1024 sc1
  buffer_store_dwordx4 v[4:7], v2, s[4:7], s35 offen offset:2048 sc1
  buffer_store_dwordx4 v[4:7], v2, s[4:7], s35 offen offset:3072 sc1
  s_add_u32 s35, s35, 4096
  s_cmp_lt_u32 s35, 180224
  s_cselect_b32 s3, -1, 0
  v_mov_b32 v8, s3
  v_mov_b32 v9, s3
  v_mov_b32 v10, s3
  v_mov_b32 v11, s3
  buffer_store_dwordx4 v[8:11], v2, s[4:7], s35 offen offset:0 sc1
  buffer_store_dwordx4 v[8:11], v2, s[4:7], s35 offen offset:1024 sc1
  buffer_store_dwordx4 v[8:11], v2, s[4:7], s35 offen offset:2048 sc1
  buffer_store_dwordx4 v[8:11], v2, s[4:7], s35 offen offset:3072 sc1
  s_add_u32 s35, s35, 4096
  buffer_store_dwordx4 v[8:11], v2, s[4:7], s35 offen offset:0 sc1
  buffer_store_dwordx4 v[8:11], v2, s[4:7], s35 offen offset:1024 sc1
  buffer_store_dwordx4 v[8:11], v2, s[4:7], s35 offen offset:2048 sc1
  buffer_store_dwordx4 v[8:11], v2, s[4:7], s35 offen offset:3072 sc1
  s_add_u32 s35, s35, 4096
  s_mov_b32 s101, 1
  s_branch L_ranked
L_rank:
  s_cmp_lt_u32 s30, 2
  s_cselect_b32 s3, 0, 128
  s_lshl2_add_u32 s3, s30, s3
  s_mov_b64 exec, 1
  v_mov_b32 v3, 1
  buffer_atomic_add v3, off, s[8:11], s3 sc0
  v_mov_b32 v4, 0
  s_waitcnt vmcnt(0)
  ds_write_b32 v4, v3
  s_waitcnt lgkmcnt(0)
  s_mov_b64 exec, -1
L_ranked:
  s_barrier
  v_mov_b32 v4, 0
  ds_read_b32 v3, v4
  s_waitcnt lgkmcnt(0)
  v_readfirstlane_b32 s31, v3
  s_barrier
  s_lshl_b32 s32, s30, 5
  s_add_u32 s32, s32, s31
  s_cmp_lt_u32 s31, 32
  s_cbranch_scc1 L_dispatch
  s_cmp_lg_u32 s34, 0
  s_cbranch_scc1 L_verd_2
  s_cmp_eq_u32 s101, 0
  s_cbranch_scc1 L_sig_5
  s_mov_b32 s101, 0
  s_waitcnt vmcnt(0)
  s_mov_b64 exec, 1
  v_mov_b32 v0, 1
  buffer_atomic_add v0, off, s[8:11], 0 offset:32
  s_mov_b64 exec, -1
L_sig_5:
  v_lshlrev_b32 v2, 2, v1
L_ver_1:
  buffer_load_dword v3, v2, s[8:11], 0 offen sc1
  s_waitcnt vmcnt(0)
  v_readlane_b32 s3, v3, 8
  s_nop 0
  s_cmp_eq_u32 s3, 32
  s_cbranch_scc0 L_verf_4
  v_readlane_b32 s3, v3, 0
  v_readlane_b32 vcc_lo, v3, 1
  s_nop 0
  s_add_u32 s3, s3, vcc_lo
  v_readlane_b32 vcc_lo, v3, 34
  s_nop 0
  s_add_u32 s3, s3, vcc_lo
  v_readlane_b32 vcc_lo, v3, 35
  s_nop 0
  s_add_u32 s3, s3, vcc_lo
  v_readlane_b32 vcc_lo, v3, 36
  s_nop 0
  s_add_u32 s3, s3, vcc_lo
  v_readlane_b32 vcc_lo, v3, 37
  s_nop 0
  s_add_u32 s3, s3, vcc_lo
  v_readlane_b32 vcc_lo, v3, 38
  s_nop 0
  s_add_u32 s3, s3, vcc_lo
  v_readlane_b32 vcc_lo, v3, 39
  s_nop 0
  s_add_u32 s3, s3, vcc_lo
  s_cmp_eq_u32 s3, 0x100
  s_cbranch_scc1 L_verr_3
L_verf_4:
  s_sleep 2
  s_sub_u32 s29, s29, 1
  s_cbranch_scc0 L_ver_1
  s_branch L_end
L_verr_3:
  s_mov_b32 s34, 1
  v_cmp_ne_u32 vcc, 32, v3
  s_nop 4
  s_and_b32 vcc_lo, vcc_lo, 3
  s_and_b32 vcc_hi, vcc_hi, 0xfc
  s_cbranch_vccz L_verd_2
  s_mov_b32 s32, s31
  s_mov_b32 s33, 1
  v_readlane_b32 s3, v3, 0
  s_nop 0
  s_cmp_gt_u32 s30, 0
  s_cselect_b32 s3, s3, 0
  s_add_u32 s32, s32, s3
  v_readlane_b32 s3, v3, 1
  s_nop 0
  s_cmp_gt_u32 s30, 1
  s_cselect_b32 s3, s3, 0
  s_add_u32 s32, s32, s3
  v_readlane_b32 s3, v3, 34
  s_nop 0
  s_cmp_gt_u32 s30, 2
  s_cselect_b32 s3, s3, 0
  s_add_u32 s32, s32, s3
  v_readlane_b32 s3, v3, 35
  s_nop 0
  s_cmp_gt_u32 s30, 3
  s_cselect_b32 s3, s3, 0
  s_add_u32 s32, s32, s3
  v_readlane_b32 s3, v3, 36
  s_nop 0
  s_cmp_gt_u32 s30, 4
  s_cselect_b32 s3, s3, 0
  s_add_u32 s32, s32, s3
  v_readlane_b32 s3, v3, 37
  s_nop 0
  s_cmp_gt_u32 s30, 5
  s_cselect_b32 s3, s3, 0
  s_add_u32 s32, s32, s3
  v_readlane_b32 s3, v3, 38
  s_nop 0
  s_cmp_gt_u32 s30, 6
  s_cselect_b32 s3, s3, 0
  s_add_u32 s32, s32, s3
  s_branch L_restart
L_verd_2:
  s_branch L_end
L_restart:
  s_waitcnt vmcnt(0) lgkmcnt(0)
  s_barrier
L_dispatch:
  s_cmp_ge_u32 s32, 0x100
  s_cbranch_scc1 L_end
  s_cmp_lt_u32 s32, 64
  s_cbranch_scc1 L_rec
  s_and_b32 s3, s32, 31
  s_cmp_ge_u32 s32, 192
  s_cbranch_scc1 L_hi
  s_cmp_lt_u32 s3, 20
  s_cbranch_scc1 L_wo
  s_cmp_lt_u32 s3, 28
  s_cbranch_scc1 L_kv
  s_branch L_mlp
L_hi:
  s_cmp_lt_u32 s3, 16
  s_cbranch_scc1 L_kv
  s_branch L_qa
L_rec:
  s_lshr_b32 s41, s32, 5
  s_and_b32 s40, s32, 31
  s_and_b32 s43, s28, 1
  s_mov_b32 s12, s68
  s_mov_b32 s13, s69
  s_mov_b32 s14, 5242880
  s_mov_b32 s15, 0x20000
  s_mov_b32 s16, s70
  s_mov_b32 s17, s71
  s_mov_b32 s18, 5242880
  s_mov_b32 s19, 0x20000
  s_mov_b32 s20, s72
  s_mov_b32 s21, s73
  s_mov_b32 s22, 5242880
  s_mov_b32 s23, 0x20000
  s_mov_b32 s24, s74
  s_mov_b32 s25, s75
  s_mov_b32 s26, 5242880
  s_mov_b32 s27, 0x20000
  v_bfe_u32 v21, v1, 4, 1
  v_lshlrev_b32 v22, 1, v21
  v_and_b32 v23, 3, v1
  v_xor_b32 v23, v23, v22
  v_lshlrev_b32 v23, 4, v23
  v_bfe_u32 v22, v1, 3, 1
  v_lshlrev_b32 v16, 4, v22
  v_lshl_add_u32 v16, v21, 3, v16
  v_mul_u32_u24 v17, 80, v21
  v_add_u32 v17, v17, v22
  v_lshlrev_b32 v18, 5, v22
  v_lshl_add_u32 v18, v21, 4, v18
  v_lshrrev_b32 v22, 5, v1
  v_add_u32 v16, v16, v22
  v_lshl_add_u32 v18, v22, 2, v18
  v_lshl_add_u32 v17, v22, 1, v17
  v_bfe_u32 v22, v1, 2, 1
  v_lshl_add_u32 v16, v22, 1, v16
  v_lshl_add_u32 v17, v22, 2, v17
  v_add_u32 v18, v18, v22
  v_lshl_add_u32 v16, v16, 13, v23
  v_lshl_add_u32 v17, v17, 13, v23
  v_mul_u32_u24 v18, 1280, v18
  v_add_u32 v18, v18, v23
  s_mul_i32 s62, s28, 34816
  s_add_u32 s62, s62, 24576
  v_lshrrev_b32 v19, 2, v1
  v_lshlrev_b32 v19, 6, v19
  v_lshl_add_u32 v19, v21, 5, v19
  v_and_b32 v22, 3, v1
  v_lshl_add_u32 v19, v22, 3, v19
  v_add_u32 v19, s62, v19
  v_xor_b32 v20, 32, v19
  v_lshlrev_b32 v3, 4, v1
  v_add_u32 v2, s62, v3
  s_lshl_b32 s3, s40, 8
  s_lshl_b32 s35, s28, 6
  s_add_u32 s3, s3, s35
  s_mul_i32 s37, s41, 2621440
  s_add_u32 s37, s37, s3
  s_xor_b32 s38, s41, 1
  s_mul_i32 s38, s38, 2621440
  s_add_u32 s38, s38, s3
  s_mul_i32 s39, s40, 163840
  s_mul_i32 s3, s41, 640
  s_add_u32 s39, s39, s3
  s_mul_i32 s3, s28, 160
  s_add_u32 s39, s39, s3
  s_lshl_b32 s44, s28, 5
  s_add_u32 s44, s44, s40
  s_mov_b32 s96, s66
  s_mov_b32 s97, s67
  s_mov_b32 s98, 10240
  s_mov_b32 s99, 0x20000
  v_bfe_u32 v24, v1, 2, 1
  v_bfe_u32 v27, v1, 1, 1
  v_bfe_u32 v25, v1, 4, 1
  v_lshrrev_b32 v26, 5, v1
  s_and_b32 s54, s44, 3
  s_bfe_u32 s3, s44, 0x10002
  s_cmp_lt_u32 s44, 32
  s_cbranch_scc0 L_rec_m1
  v_lshl_add_u32 v24, v27, 4, v24
  v_lshl_add_u32 v24, v25, 3, v24
  v_lshl_add_u32 v24, v26, 2, v24
  s_mov_b32 s56, 4
  s_lshl_b32 s55, s3, 5
  s_lshr_b32 s3, s44, 3
  s_mul_i32 s3, s3, 80
  s_add_u32 s55, s55, s3
  s_branch L_rec_m2
L_rec_m1:
  v_lshl_add_u32 v24, v24, 1, v27
  v_mul_u32_u24 v25, 80, v25
  v_add_u32 v24, v24, v25
  v_lshl_add_u32 v24, v26, 3, v24
  s_mov_b32 s56, 8
  s_mul_i32 s55, s3, 160
  s_add_u32 s55, s55, 64
L_rec_m2:
  s_mul_i32 s3, s41, 320
  s_add_u32 s55, s55, s3
  s_lshl_b32 s55, s55, 1
  s_mul_i32 s54, s54, 2560
  s_add_u32 s55, s55, s54
  v_and_b32 v26, 1, v1
  v_mul_u32_u24 v26, 1280, v26
  v_lshl_add_u32 v24, v24, 1, v26
  s_add_u32 s56, s56, s55
  buffer_load_ushort v74, v24, s[96:99], s55 offen
  buffer_load_ushort v75, v24, s[96:99], s56 offen
  v_lshrrev_b32 v34, 4, v1
  v_bfe_u32 v35, v1, 1, 2
  v_xor_b32 v34, v34, v35
  v_and_b32 v35, 1, v1
  v_lshl_add_u32 v34, v34, 1, v35
  v_lshlrev_b32 v34, 4, v34
  v_bfe_u32 v35, v1, 4, 1
  v_lshlrev_b32 v28, 4, v35
  v_mov_b32 v29, v35
  v_lshrrev_b32 v35, 5, v1
  v_lshl_add_u32 v28, v35, 3, v28
  v_mul_u32_u24 v35, 80, v35
  v_add_u32 v29, v29, v35
  v_bfe_u32 v35, v1, 3, 1
  v_lshl_add_u32 v28, v35, 1, v28
  v_lshl_add_u32 v29, v35, 2, v29
  s_mul_i32 s3, s43, 262080
  v_lshl_add_u32 v28, v28, 13, v34
  v_add_u32 v28, s3, v28
  s_mul_i32 s3, s43, 1310656
  v_lshl_add_u32 v29, v29, 13, v34
  v_add_u32 v29, s3, v29
  v_bfe_u32 v34, v1, 3, 2
  s_lshl_b32 s3, s43, 1
  v_xor_b32 v34, s3, v34
  v_lshlrev_b32 v30, 5, v34
  v_bfe_u32 v34, v1, 2, 3
  v_lshl_add_u32 v30, v34, 7, v30
  v_lshrrev_b32 v34, 5, v1
  v_lshl_add_u32 v30, v34, 10, v30
  v_and_b32 v34, 3, v1
  v_lshl_add_u32 v30, v34, 3, v30
  s_and_b32 s3, s28, 2
  s_mul_i32 s3, s3, 34816
  s_add_u32 s3, s3, 24576
  v_add_u32 v30, s3, v30
  v_xor_b32 v31, 32, v30
  v_add_u32 v32, 34816, v30
  v_add_u32 v33, 34816, v31
  s_add_u32 s36, s37, 0
  s_add_u32 m0, s62, 2048
  s_nop 0
  buffer_load_dwordx4 v28, s[12:15], s36 offen lds
  s_add_u32 s36, s37, 8192
  s_add_u32 m0, s62, 3072
  s_nop 0
  buffer_load_dwordx4 v28, s[12:15], s36 offen lds
  s_add_u32 s36, s37, 32768
  s_add_u32 m0, s62, 4096
  s_nop 0
  buffer_load_dwordx4 v28, s[12:15], s36 offen lds
  s_add_u32 s36, s37, 40960
  s_add_u32 m0, s62, 5120
  s_nop 0
  buffer_load_dwordx4 v28, s[12:15], s36 offen lds
  s_add_u32 s36, s37, 655360
  s_add_u32 m0, s62, 6144
  s_nop 0
  buffer_load_dwordx4 v28, s[12:15], s36 offen lds
  s_add_u32 s36, s37, 663552
  s_add_u32 m0, s62, 7168
  s_nop 0
  buffer_load_dwordx4 v28, s[12:15], s36 offen lds
  s_add_u32 s36, s37, 688128
  s_add_u32 m0, s62, 8192
  s_nop 0
  buffer_load_dwordx4 v28, s[12:15], s36 offen lds
  s_add_u32 s36, s37, 696320
  s_add_u32 m0, s62, 9216
  s_nop 0
  buffer_load_dwordx4 v28, s[12:15], s36 offen lds
  s_add_u32 s36, s37, 1310720
  s_add_u32 m0, s62, 10240
  s_nop 0
  buffer_load_dwordx4 v28, s[12:15], s36 offen lds
  s_add_u32 s36, s37, 1318912
  s_add_u32 m0, s62, 11264
  s_nop 0
  buffer_load_dwordx4 v28, s[12:15], s36 offen lds
  s_add_u32 s36, s37, 1343488
  s_add_u32 m0, s62, 12288
  s_nop 0
  buffer_load_dwordx4 v28, s[12:15], s36 offen lds
  s_add_u32 s36, s37, 1351680
  s_add_u32 m0, s62, 13312
  s_nop 0
  buffer_load_dwordx4 v28, s[12:15], s36 offen lds
  s_add_u32 s36, s37, 1966080
  s_add_u32 m0, s62, 14336
  s_nop 0
  buffer_load_dwordx4 v28, s[12:15], s36 offen lds
  s_add_u32 s36, s37, 1974272
  s_add_u32 m0, s62, 15360
  s_nop 0
  buffer_load_dwordx4 v28, s[12:15], s36 offen lds
  s_add_u32 s36, s37, 1998848
  s_add_u32 m0, s62, 16384
  s_nop 0
  buffer_load_dwordx4 v28, s[12:15], s36 offen lds
  s_add_u32 s36, s37, 2007040
  s_add_u32 m0, s62, 17408
  s_nop 0
  buffer_load_dwordx4 v28, s[12:15], s36 offen lds
  s_add_u32 s36, s37, 524288
  s_add_u32 m0, s62, 18432
  s_nop 0
  buffer_load_dwordx4 v29, s[12:15], s36 offen lds
  s_add_u32 s36, s37, 540672
  s_add_u32 m0, s62, 19456
  s_nop 0
  buffer_load_dwordx4 v29, s[12:15], s36 offen lds
  s_add_u32 s36, s37, 589824
  s_add_u32 m0, s62, 20480
  s_nop 0
  buffer_load_dwordx4 v29, s[12:15], s36 offen lds
  s_add_u32 s36, s37, 606208
  s_add_u32 m0, s62, 21504
  s_nop 0
  buffer_load_dwordx4 v29, s[12:15], s36 offen lds
  s_add_u32 s36, s38, 0
  s_add_u32 m0, s62, 22528
  s_nop 0
  buffer_load_dwordx4 v28, s[12:15], s36 offen lds
  s_add_u32 s36, s38, 8192
  s_add_u32 m0, s62, 23552
  s_nop 0
  buffer_load_dwordx4 v28, s[12:15], s36 offen lds
  s_add_u32 s36, s38, 32768
  s_add_u32 m0, s62, 24576
  s_nop 0
  buffer_load_dwordx4 v28, s[12:15], s36 offen lds
  s_add_u32 s36, s38, 40960
  s_add_u32 m0, s62, 25600
  s_nop 0
  buffer_load_dwordx4 v28, s[12:15], s36 offen lds
  s_add_u32 s36, s38, 655360
  s_add_u32 m0, s62, 26624
  s_nop 0
  buffer_load_dwordx4 v28, s[12:15], s36 offen lds
  s_add_u32 s36, s38, 663552
  s_add_u32 m0, s62, 27648
  s_nop 0
  buffer_load_dwordx4 v28, s[12:15], s36 offen lds
  s_add_u32 s36, s38, 688128
  s_add_u32 m0, s62, 28672
  s_nop 0
  buffer_load_dwordx4 v28, s[12:15], s36 offen lds
  s_add_u32 s36, s38, 696320
  s_add_u32 m0, s62, 29696
  s_nop 0
  buffer_load_dwordx4 v28, s[12:15], s36 offen lds
  s_waitcnt vmcnt(24) lgkmcnt(0)
  s_cmp_eq_u32 s101, 0
  s_cbranch_scc1 L_sig_6
  s_mov_b32 s101, 0
  s_mov_b64 exec, 1
  v_mov_b32 v0, 1
  buffer_atomic_add v0, off, s[8:11], 0 offset:32
  s_mov_b64 exec, -1
L_sig_6:
  s_barrier
  s_add_u32 s36, s38, 1310720
  s_add_u32 m0, s62, 30720
  s_nop 0
  buffer_load_dwordx4 v28, s[12:15], s36 offen lds
  s_add_u32 s36, s38, 1318912
  s_add_u32 m0, s62, 31744
  s_nop 0
  buffer_load_dwordx4 v28, s[12:15], s36 offen lds
  s_add_u32 s36, s38, 1343488
  s_add_u32 m0, s62, 32768
  s_nop 0
  buffer_load_dwordx4 v28, s[12:15], s36 offen lds
  s_add_u32 s36, s38, 1351680
  s_add_u32 m0, s62, 33792
  s_nop 0
  buffer_load_dwordx4 v28, s[12:15], s36 offen lds
  ds_read_b64_tr_b16 v[80:81], v30 offset:2048
  ds_read_b64_tr_b16 v[82:83], v30 offset:4096
  ds_read_b64_tr_b16 v[84:85], v32 offset:2048
  ds_read_b64_tr_b16 v[86:87], v32 offset:4096
  ds_read_b64_tr_b16 v[88:89], v31 offset:2048
  ds_read_b64_tr_b16 v[90:91], v31 offset:4096
  ds_read_b64_tr_b16 v[92:93], v33 offset:2048
  ds_read_b64_tr_b16 v[94:95], v33 offset:4096
  s_waitcnt vmcnt(24) lgkmcnt(0)
  s_barrier
  s_add_u32 s36, s38, 1966080
  s_add_u32 m0, s62, 2048
  s_nop 0
  buffer_load_dwordx4 v28, s[12:15], s36 offen lds
  s_add_u32 s36, s38, 1974272
  s_add_u32 m0, s62, 3072
  s_nop 0
  buffer_load_dwordx4 v28, s[12:15], s36 offen lds
  s_add_u32 s36, s38, 1998848
  s_add_u32 m0, s62, 4096
  s_nop 0
  buffer_load_dwordx4 v28, s[12:15], s36 offen lds
  s_add_u32 s36, s38, 2007040
  s_add_u32 m0, s62, 5120
  s_nop 0
  buffer_load_dwordx4 v28, s[12:15], s36 offen lds
  ds_read_b64_tr_b16 v[96:97], v30 offset:6144
  ds_read_b64_tr_b16 v[98:99], v30 offset:8192
  ds_read_b64_tr_b16 v[100:101], v32 offset:6144
  ds_read_b64_tr_b16 v[102:103], v32 offset:8192
  ds_read_b64_tr_b16 v[104:105], v31 offset:6144
  ds_read_b64_tr_b16 v[106:107], v31 offset:8192
  ds_read_b64_tr_b16 v[108:109], v33 offset:6144
  ds_read_b64_tr_b16 v[110:111], v33 offset:8192
  s_waitcnt vmcnt(24) lgkmcnt(0)
  s_barrier
  s_add_u32 s36, s38, 524288
  s_add_u32 m0, s62, 6144
  s_nop 0
  buffer_load_dwordx4 v29, s[12:15], s36 offen lds
  s_add_u32 s36, s38, 540672
  s_add_u32 m0, s62, 7168
  s_nop 0
  buffer_load_dwordx4 v29, s[12:15], s36 offen lds
  s_add_u32 s36, s38, 589824
  s_add_u32 m0, s62, 8192
  s_nop 0
  buffer_load_dwordx4 v29, s[12:15], s36 offen lds
  s_add_u32 s36, s38, 606208
  s_add_u32 m0, s62, 9216
  s_nop 0
  buffer_load_dwordx4 v29, s[12:15], s36 offen lds
  ds_read_b64_tr_b16 v[112:113], v30 offset:10240
  ds_read_b64_tr_b16 v[114:115], v30 offset:12288
  ds_read_b64_tr_b16 v[116:117], v32 offset:10240
  ds_read_b64_tr_b16 v[118:119], v32 offset:12288
  ds_read_b64_tr_b16 v[120:121], v31 offset:10240
  ds_read_b64_tr_b16 v[122:123], v31 offset:12288
  ds_read_b64_tr_b16 v[124:125], v33 offset:10240
  ds_read_b64_tr_b16 v[126:127], v33 offset:12288
  s_waitcnt vmcnt(24) lgkmcnt(0)
  s_barrier
  s_add_u32 s36, s37, 0
  s_add_u32 m0, s62, 10240
  s_nop 0
  buffer_load_dwordx4 v28, s[16:19], s36 offen lds
  s_add_u32 s36, s37, 8192
  s_add_u32 m0, s62, 11264
  s_nop 0
  buffer_load_dwordx4 v28, s[16:19], s36 offen lds
  s_add_u32 s36, s37, 32768
  s_add_u32 m0, s62, 12288
  s_nop 0
  buffer_load_dwordx4 v28, s[16:19], s36 offen lds
  s_add_u32 s36, s37, 40960
  s_add_u32 m0, s62, 13312
  s_nop 0
  buffer_load_dwordx4 v28, s[16:19], s36 offen lds
  ds_read_b64_tr_b16 v[128:129], v30 offset:14336
  ds_read_b64_tr_b16 v[130:131], v30 offset:16384
  ds_read_b64_tr_b16 v[132:133], v32 offset:14336
  ds_read_b64_tr_b16 v[134:135], v32 offset:16384
  ds_read_b64_tr_b16 v[136:137], v31 offset:14336
  ds_read_b64_tr_b16 v[138:139], v31 offset:16384
  ds_read_b64_tr_b16 v[140:141], v33 offset:14336
  ds_read_b64_tr_b16 v[142:143], v33 offset:16384
  s_waitcnt vmcnt(24) lgkmcnt(0)
  s_barrier
  s_add_u32 s36, s37, 655360
  s_add_u32 m0, s62, 14336
  s_nop 0
  buffer_load_dwordx4 v28, s[16:19], s36 offen lds
  s_add_u32 s36, s37, 663552
  s_add_u32 m0, s62, 15360
  s_nop 0
  buffer_load_dwordx4 v28, s[16:19], s36 offen lds
  s_add_u32 s36, s37, 688128
  s_add_u32 m0, s62, 16384
  s_nop 0
  buffer_load_dwordx4 v28, s[16:19], s36 offen lds
  s_add_u32 s36, s37, 696320
  s_add_u32 m0, s62, 17408
  s_nop 0
  buffer_load_dwordx4 v28, s[16:19], s36 offen lds
  ds_read_b64_tr_b16 v[144:145], v30 offset:18432
  ds_read_b64_tr_b16 v[146:147], v30 offset:20480
  ds_read_b64_tr_b16 v[148:149], v32 offset:18432
  ds_read_b64_tr_b16 v[150:151], v32 offset:20480
  ds_read_b64_tr_b16 v[152:153], v31 offset:18432
  ds_read_b64_tr_b16 v[154:155], v31 offset:20480
  ds_read_b64_tr_b16 v[156:157], v33 offset:18432
  ds_read_b64_tr_b16 v[158:159], v33 offset:20480
  s_waitcnt vmcnt(24) lgkmcnt(0)
  s_barrier
  s_add_u32 s36, s37, 1310720
  s_add_u32 m0, s62, 18432
  s_nop 0
  buffer_load_dwordx4 v28, s[16:19], s36 offen lds
  s_add_u32 s36, s37, 1318912
  s_add_u32 m0, s62, 19456
  s_nop 0
  buffer_load_dwordx4 v28, s[16:19], s36 offen lds
  s_add_u32 s36, s37, 1343488
  s_add_u32 m0, s62, 20480
  s_nop 0
  buffer_load_dwordx4 v28, s[16:19], s36 offen lds
  s_add_u32 s36, s37, 1351680
  s_add_u32 m0, s62, 21504
  s_nop 0
  buffer_load_dwordx4 v28, s[16:19], s36 offen lds
  ds_read_b64_tr_b16 v[160:161], v30 offset:22528
  ds_read_b64_tr_b16 v[162:163], v30 offset:24576
  ds_read_b64_tr_b16 v[164:165], v32 offset:22528
  ds_read_b64_tr_b16 v[166:167], v32 offset:24576
  ds_read_b64_tr_b16 v[168:169], v31 offset:22528
  ds_read_b64_tr_b16 v[170:171], v31 offset:24576
  ds_read_b64_tr_b16 v[172:173], v33 offset:22528
  ds_read_b64_tr_b16 v[174:175], v33 offset:24576
  s_waitcnt vmcnt(24) lgkmcnt(0)
  s_barrier
  s_add_u32 s36, s37, 1966080
  s_add_u32 m0, s62, 22528
  s_nop 0
  buffer_load_dwordx4 v28, s[16:19], s36 offen lds
  s_add_u32 s36, s37, 1974272
  s_add_u32 m0, s62, 23552
  s_nop 0
  buffer_load_dwordx4 v28, s[16:19], s36 offen lds
  s_add_u32 s36, s37, 1998848
  s_add_u32 m0, s62, 24576
  s_nop 0
  buffer_load_dwordx4 v28, s[16:19], s36 offen lds
  s_add_u32 s36, s37, 2007040
  s_add_u32 m0, s62, 25600
  s_nop 0
  buffer_load_dwordx4 v28, s[16:19], s36 offen lds
  ds_read_b64_tr_b16 v[176:177], v30 offset:26624
  ds_read_b64_tr_b16 v[178:179], v30 offset:28672
  ds_read_b64_tr_b16 v[180:181], v32 offset:26624
  ds_read_b64_tr_b16 v[182:183], v32 offset:28672
  ds_read_b64_tr_b16 v[184:185], v31 offset:26624
  ds_read_b64_tr_b16 v[186:187], v31 offset:28672
  ds_read_b64_tr_b16 v[188:189], v33 offset:26624
  ds_read_b64_tr_b16 v[190:191], v33 offset:28672
  s_waitcnt vmcnt(24) lgkmcnt(0)
  s_barrier
  s_add_u32 s36, s37, 524288
  s_add_u32 m0, s62, 26624
  s_nop 0
  buffer_load_dwordx4 v29, s[16:19], s36 offen lds
  s_add_u32 s36, s37, 540672
  s_add_u32 m0, s62, 27648
  s_nop 0
  buffer_load_dwordx4 v29, s[16:19], s36 offen lds
  s_add_u32 s36, s37, 589824
  s_add_u32 m0, s62, 28672
  s_nop 0
  buffer_load_dwordx4 v29, s[16:19], s36 offen lds
  s_add_u32 s36, s37, 606208
  s_add_u32 m0, s62, 29696
  s_nop 0
  buffer_load_dwordx4 v29, s[16:19], s36 offen lds
  ds_read_b64_tr_b16 v[192:193], v30 offset:30720
  ds_read_b64_tr_b16 v[194:195], v30 offset:32768
  ds_read_b64_tr_b16 v[196:197], v32 offset:30720
  ds_read_b64_tr_b16 v[198:199], v32 offset:32768
  ds_read_b64_tr_b16 v[200:201], v31 offset:30720
  ds_read_b64_tr_b16 v[202:203], v31 offset:32768
  ds_read_b64_tr_b16 v[204:205], v33 offset:30720
  ds_read_b64_tr_b16 v[206:207], v33 offset:32768
  s_waitcnt vmcnt(24) lgkmcnt(0)
  s_barrier
  s_add_u32 s36, s38, 0
  s_add_u32 m0, s62, 30720
  s_nop 0
  buffer_load_dwordx4 v28, s[16:19], s36 offen lds
  s_add_u32 s36, s38, 8192
  s_add_u32 m0, s62, 31744
  s_nop 0
  buffer_load_dwordx4 v28, s[16:19], s36 offen lds
  s_add_u32 s36, s38, 32768
  s_add_u32 m0, s62, 32768
  s_nop 0
  buffer_load_dwordx4 v28, s[16:19], s36 offen lds
  s_add_u32 s36, s38, 40960
  s_add_u32 m0, s62, 33792
  s_nop 0
  buffer_load_dwordx4 v28, s[16:19], s36 offen lds
  ds_read_b64_tr_b16 v[208:209], v30 offset:2048
  ds_read_b64_tr_b16 v[210:211], v30 offset:4096
  ds_read_b64_tr_b16 v[212:213], v32 offset:2048
  ds_read_b64_tr_b16 v[214:215], v32 offset:4096
  ds_read_b64_tr_b16 v[216:217], v31 offset:2048
  ds_read_b64_tr_b16 v[218:219], v31 offset:4096
  ds_read_b64_tr_b16 v[220:221], v33 offset:2048
  ds_read_b64_tr_b16 v[222:223], v33 offset:4096
  s_waitcnt vmcnt(24) lgkmcnt(0)
  s_barrier
  s_add_u32 s36, s38, 655360
  s_add_u32 m0, s62, 2048
  s_nop 0
  buffer_load_dwordx4 v28, s[16:19], s36 offen lds
  s_add_u32 s36, s38, 663552
  s_add_u32 m0, s62, 3072
  s_nop 0
  buffer_load_dwordx4 v28, s[16:19], s36 offen lds
  s_add_u32 s36, s38, 688128
  s_add_u32 m0, s62, 4096
  s_nop 0
  buffer_load_dwordx4 v28, s[16:19], s36 offen lds
  s_add_u32 s36, s38, 696320
  s_add_u32 m0, s62, 5120
  s_nop 0
  buffer_load_dwordx4 v28, s[16:19], s36 offen lds
  ds_read_b64_tr_b16 v[224:225], v30 offset:6144
  ds_read_b64_tr_b16 v[226:227], v30 offset:8192
  ds_read_b64_tr_b16 v[228:229], v32 offset:6144
  ds_read_b64_tr_b16 v[230:231], v32 offset:8192
  ds_read_b64_tr_b16 v[232:233], v31 offset:6144
  ds_read_b64_tr_b16 v[234:235], v31 offset:8192
  ds_read_b64_tr_b16 v[236:237], v33 offset:6144
  ds_read_b64_tr_b16 v[238:239], v33 offset:8192
  s_waitcnt vmcnt(24) lgkmcnt(0)
  s_barrier
  s_add_u32 s36, s38, 1310720
  s_add_u32 m0, s62, 6144
  s_nop 0
  buffer_load_dwordx4 v28, s[16:19], s36 offen lds
  s_add_u32 s36, s38, 1318912
  s_add_u32 m0, s62, 7168
  s_nop 0
  buffer_load_dwordx4 v28, s[16:19], s36 offen lds
  s_add_u32 s36, s38, 1343488
  s_add_u32 m0, s62, 8192
  s_nop 0
  buffer_load_dwordx4 v28, s[16:19], s36 offen lds
  s_add_u32 s36, s38, 1351680
  s_add_u32 m0, s62, 9216
  s_nop 0
  buffer_load_dwordx4 v28, s[16:19], s36 offen lds
  ds_read_b64_tr_b16 v[240:241], v30 offset:10240
  ds_read_b64_tr_b16 v[242:243], v30 offset:12288
  ds_read_b64_tr_b16 v[244:245], v32 offset:10240
  ds_read_b64_tr_b16 v[246:247], v32 offset:12288
  ds_read_b64_tr_b16 v[248:249], v31 offset:10240
  ds_read_b64_tr_b16 v[250:251], v31 offset:12288
  ds_read_b64_tr_b16 v[252:253], v33 offset:10240
  ds_read_b64_tr_b16 v[254:255], v33 offset:12288
  s_waitcnt vmcnt(24) lgkmcnt(0)
  s_barrier
  s_add_u32 s36, s38, 1966080
  s_add_u32 m0, s62, 10240
  s_nop 0
  buffer_load_dwordx4 v28, s[16:19], s36 offen lds
  s_add_u32 s36, s38, 1974272
  s_add_u32 m0, s62, 11264
  s_nop 0
  buffer_load_dwordx4 v28, s[16:19], s36 offen lds
  s_add_u32 s36, s38, 1998848
  s_add_u32 m0, s62, 12288
  s_nop 0
  buffer_load_dwordx4 v28, s[16:19], s36 offen lds
  s_add_u32 s36, s38, 2007040
  s_add_u32 m0, s62, 13312
  s_nop 0
  buffer_load_dwordx4 v28, s[16:19], s36 offen lds
  ds_read_b64_tr_b16 a[0:1], v30 offset:14336
  ds_read_b64_tr_b16 a[2:3], v30 offset:16384
  ds_read_b64_tr_b16 a[4:5], v32 offset:14336
  ds_read_b64_tr_b16 a[6:7], v32 offset:16384
  ds_read_b64_tr_b16 a[8:9], v31 offset:14336
  ds_read_b64_tr_b16 a[10:11], v31 offset:16384
  ds_read_b64_tr_b16 a[12:13], v33 offset:14336
  ds_read_b64_tr_b16 a[14:15], v33 offset:16384
  s_waitcnt vmcnt(24) lgkmcnt(0)
  s_barrier
  s_add_u32 s36, s38, 524288
  s_add_u32 m0, s62, 14336
  s_nop 0
  buffer_load_dwordx4 v29, s[16:19], s36 offen lds
  s_add_u32 s36, s38, 540672
  s_add_u32 m0, s62, 15360
  s_nop 0
  buffer_load_dwordx4 v29, s[16:19], s36 offen lds
  s_add_u32 s36, s38, 589824
  s_add_u32 m0, s62, 16384
  s_nop 0
  buffer_load_dwordx4 v29, s[16:19], s36 offen lds
  s_add_u32 s36, s38, 606208
  s_add_u32 m0, s62, 17408
  s_nop 0
  buffer_load_dwordx4 v29, s[16:19], s36 offen lds
  ds_read_b64_tr_b16 a[16:17], v30 offset:18432
  ds_read_b64_tr_b16 a[18:19], v30 offset:20480
  ds_read_b64_tr_b16 a[20:21], v32 offset:18432
  ds_read_b64_tr_b16 a[22:23], v32 offset:20480
  ds_read_b64_tr_b16 a[24:25], v31 offset:18432
  ds_read_b64_tr_b16 a[26:27], v31 offset:20480
  ds_read_b64_tr_b16 a[28:29], v33 offset:18432
  ds_read_b64_tr_b16 a[30:31], v33 offset:20480
  s_waitcnt vmcnt(24) lgkmcnt(0)
  s_barrier
  s_add_u32 s36, s38, 0
  s_add_u32 m0, s62, 18432
  s_nop 0
  buffer_load_dwordx4 v28, s[20:23], s36 offen lds
  s_add_u32 s36, s38, 8192
  s_add_u32 m0, s62, 19456
  s_nop 0
  buffer_load_dwordx4 v28, s[20:23], s36 offen lds
  s_add_u32 s36, s38, 32768
  s_add_u32 m0, s62, 20480
  s_nop 0
  buffer_load_dwordx4 v28, s[20:23], s36 offen lds
  s_add_u32 s36, s38, 40960
  s_add_u32 m0, s62, 21504
  s_nop 0
  buffer_load_dwordx4 v28, s[20:23], s36 offen lds
  ds_read_b64_tr_b16 a[32:33], v30 offset:22528
  ds_read_b64_tr_b16 a[34:35], v30 offset:24576
  ds_read_b64_tr_b16 a[36:37], v32 offset:22528
  ds_read_b64_tr_b16 a[38:39], v32 offset:24576
  ds_read_b64_tr_b16 a[40:41], v31 offset:22528
  ds_read_b64_tr_b16 a[42:43], v31 offset:24576
  ds_read_b64_tr_b16 a[44:45], v33 offset:22528
  ds_read_b64_tr_b16 a[46:47], v33 offset:24576
  s_waitcnt vmcnt(24) lgkmcnt(0)
  s_barrier
  s_add_u32 s36, s38, 655360
  s_add_u32 m0, s62, 22528
  s_nop 0
  buffer_load_dwordx4 v28, s[20:23], s36 offen lds
  s_add_u32 s36, s38, 663552
  s_add_u32 m0, s62, 23552
  s_nop 0
  buffer_load_dwordx4 v28, s[20:23], s36 offen lds
  s_add_u32 s36, s38, 688128
  s_add_u32 m0, s62, 24576
  s_nop 0
  buffer_load_dwordx4 v28, s[20:23], s36 offen lds
  s_add_u32 s36, s38, 696320
  s_add_u32 m0, s62, 25600
  s_nop 0
  buffer_load_dwordx4 v28, s[20:23], s36 offen lds
  ds_read_b64_tr_b16 a[48:49], v30 offset:26624
  ds_read_b64_tr_b16 a[50:51], v30 offset:28672
  ds_read_b64_tr_b16 a[52:53], v32 offset:26624
  ds_read_b64_tr_b16 a[54:55], v32 offset:28672
  ds_read_b64_tr_b16 a[56:57], v31 offset:26624
  ds_read_b64_tr_b16 a[58:59], v31 offset:28672
  ds_read_b64_tr_b16 a[60:61], v33 offset:26624
  ds_read_b64_tr_b16 a[62:63], v33 offset:28672
  s_waitcnt vmcnt(24) lgkmcnt(0)
  s_barrier
  s_add_u32 s36, s38, 1310720
  s_add_u32 m0, s62, 26624
  s_nop 0
  buffer_load_dwordx4 v28, s[20:23], s36 offen lds
  s_add_u32 s36, s38, 1318912
  s_add_u32 m0, s62, 27648
  s_nop 0
  buffer_load_dwordx4 v28, s[20:23], s36 offen lds
  s_add_u32 s36, s38, 1343488
  s_add_u32 m0, s62, 28672
  s_nop 0
  buffer_load_dwordx4 v28, s[20:23], s36 offen lds
  s_add_u32 s36, s38, 1351680
  s_add_u32 m0, s62, 29696
  s_nop 0
  buffer_load_dwordx4 v28, s[20:23], s36 offen lds
  ds_read_b64_tr_b16 a[64:65], v30 offset:30720
  ds_read_b64_tr_b16 a[66:67], v30 offset:32768
  ds_read_b64_tr_b16 a[68:69], v32 offset:30720
  ds_read_b64_tr_b16 a[70:71], v32 offset:32768
  ds_read_b64_tr_b16 a[72:73], v31 offset:30720
  ds_read_b64_tr_b16 a[74:75], v31 offset:32768
  ds_read_b64_tr_b16 a[76:77], v33 offset:30720
  ds_read_b64_tr_b16 a[78:79], v33 offset:32768
  s_waitcnt vmcnt(24) lgkmcnt(0)
  s_barrier
  s_add_u32 s36, s38, 1966080
  s_add_u32 m0, s62, 30720
  s_nop 0
  buffer_load_dwordx4 v28, s[20:23], s36 offen lds
  s_add_u32 s36, s38, 1974272
  s_add_u32 m0, s62, 31744
  s_nop 0
  buffer_load_dwordx4 v28, s[20:23], s36 offen lds
  s_add_u32 s36, s38, 1998848
  s_add_u32 m0, s62, 32768
  s_nop 0
  buffer_load_dwordx4 v28, s[20:23], s36 offen lds
  s_add_u32 s36, s38, 2007040
  s_add_u32 m0, s62, 33792
  s_nop 0
  buffer_load_dwordx4 v28, s[20:23], s36 offen lds
  s_cmp_lg_u32 s34, 0
  s_cbranch_scc1 L_verd_8
  s_cmp_eq_u32 s101, 0
  s_cbranch_scc1 L_sig_11
  s_mov_b32 s101, 0
  s_waitcnt vmcnt(0)
  s_mov_b64 exec, 1
  v_mov_b32 v0, 1
  buffer_atomic_add v0, off, s[8:11], 0 offset:32
  s_mov_b64 exec, -1
L_sig_11:
  v_lshlrev_b32 v24, 2, v1
L_ver_7:
  buffer_load_dword v25, v24, s[8:11], 0 offen sc1
  s_waitcnt vmcnt(0)
  v_readlane_b32 s3, v25, 8
  s_nop 0
  s_cmp_eq_u32 s3, 32
  s_cbranch_scc0 L_verf_10
  v_readlane_b32 s3, v25, 0
  v_readlane_b32 vcc_lo, v25, 1
  s_nop 0
  s_add_u32 s3, s3, vcc_lo
  v_readlane_b32 vcc_lo, v25, 34
  s_nop 0
  s_add_u32 s3, s3, vcc_lo
  v_readlane_b32 vcc_lo, v25, 35
  s_nop 0
  s_add_u32 s3, s3, vcc_lo
  v_readlane_b32 vcc_lo, v25, 36
  s_nop 0
  s_add_u32 s3, s3, vcc_lo
  v_readlane_b32 vcc_lo, v25, 37
  s_nop 0
  s_add_u32 s3, s3, vcc_lo
  v_readlane_b32 vcc_lo, v25, 38
  s_nop 0
  s_add_u32 s3, s3, vcc_lo
  v_readlane_b32 vcc_lo, v25, 39
  s_nop 0
  s_add_u32 s3, s3, vcc_lo
  s_cmp_eq_u32 s3, 0x100
  s_cbranch_scc1 L_verr_9
L_verf_10:
  s_sleep 2
  s_sub_u32 s29, s29, 1
  s_cbranch_scc0 L_ver_7
  s_branch L_end
L_verr_9:
  s_mov_b32 s34, 1
  v_cmp_ne_u32 vcc, 32, v25
  s_nop 4
  s_and_b32 vcc_lo, vcc_lo, 3
  s_and_b32 vcc_hi, vcc_hi, 0xfc
  s_cbranch_vccz L_verd_8
  s_mov_b32 s32, s31
  s_mov_b32 s33, 1
  v_readlane_b32 s3, v25, 0
  s_nop 0
  s_cmp_gt_u32 s30, 0
  s_cselect_b32 s3, s3, 0
  s_add_u32 s32, s32, s3
  v_readlane_b32 s3, v25, 1
  s_nop 0
  s_cmp_gt_u32 s30, 1
  s_cselect_b32 s3, s3, 0
  s_add_u32 s32, s32, s3
  v_readlane_b32 s3, v25, 34
  s_nop 0
  s_cmp_gt_u32 s30, 2
  s_cselect_b32 s3, s3, 0
  s_add_u32 s32, s32, s3
  v_readlane_b32 s3, v25, 35
  s_nop 0
  s_cmp_gt_u32 s30, 3
  s_cselect_b32 s3, s3, 0
  s_add_u32 s32, s32, s3
  v_readlane_b32 s3, v25, 36
  s_nop 0
  s_cmp_gt_u32 s30, 4
  s_cselect_b32 s3, s3, 0
  s_add_u32 s32, s32, s3
  v_readlane_b32 s3, v25, 37
  s_nop 0
  s_cmp_gt_u32 s30, 5
  s_cselect_b32 s3, s3, 0
  s_add_u32 s32, s32, s3
  v_readlane_b32 s3, v25, 38
  s_nop 0
  s_cmp_gt_u32 s30, 6
  s_cselect_b32 s3, s3, 0
  s_add_u32 s32, s32, s3
  s_branch L_restart
L_verd_8:
  v_bfe_u32 v24, v1, 2, 2
  v_lshlrev_b32 v4, 7, v24
  v_bfe_u32 v24, v1, 4, 1
  v_lshl_add_u32 v4, v24, 6, v4
  v_lshrrev_b32 v24, 5, v1
  v_lshl_add_u32 v4, v24, 9, v4
  v_and_b32 v24, 3, v1
  v_lshl_add_u32 v4, v24, 4, v4
  v_lshrrev_b32 v24, 5, v1
  v_lshlrev_b32 v6, 9, v24
  v_and_b32 v24, 3, v1
  v_lshl_add_u32 v6, v24, 6, v6
  v_bfe_u32 v24, v1, 2, 3
  v_lshl_add_u32 v6, v24, 3, v6
  v_add_u32 v6, 10240, v6
  v_bfe_u32 v24, v1, 3, 1
  v_lshlrev_b32 v25, 8, v24
  v_lshrrev_b32 v24, 4, v1
  v_lshl_add_u32 v25, v24, 6, v25
  v_and_b32 v24, 7, v1
  v_lshl_add_u32 v5, v24, 3, v25
  s_lshl_b32 s3, s28, 10
  s_add_u32 s3, s3, 10240
  v_add_u32 v5, s3, v5
  v_lshrrev_b32 v25, 4, v1
  v_lshlrev_b32 v25, 7, v25
  v_bfe_u32 v24, v1, 2, 2
  v_lshl_add_u32 v25, v24, 5, v25
  v_and_b32 v24, 1, v1
  v_lshl_add_u32 v25, v24, 4, v25
  v_bfe_u32 v24, v1, 1, 1
  v_lshl_add_u32 v25, v24, 9, v25
  v_add_u32 v7, 14336, v25
  s_mul_i32 s51, s41, 163840
  s_add_u32 s51, s51, 196608
  s_lshl_b32 s3, s28, 15
  s_lshl_b32 s35, s40, 7
  s_add_u32 s3, s3, s35
  v_lshrrev_b32 v24, 4, v1
  v_lshlrev_b32 v25, 12, v24
  v_and_b32 v24, 15, v1
  v_lshl_add_u32 v8, v24, 3, v25
  v_add_u32 v8, s3, v8
  s_lshr_b32 s3, s28, 1
  s_lshl_b32 s3, s3, 14
  s_add_u32 s3, s3, s35
  s_lshl_b32 s36, s43, 6
  s_add_u32 s3, s3, s36
  s_add_u32 s3, s3, 131072
  v_lshl_add_u32 v9, v24, 2, v25
  v_add_u32 v9, s3, v9
  v_and_b32 v24, 7, v1
  v_lshlrev_b32 v10, 4, v24
  v_bfe_u32 v24, v1, 4, 1
  v_lshl_add_u32 v10, v24, 3, v10
  v_lshrrev_b32 v24, 5, v1
  v_lshl_add_u32 v10, v24, 2, v10
  s_mov_b32 s46, 0x3e0293ee
  s_mov_b32 s47, s46
  s_lshl_b32 s3, s40, 7
  s_add_u32 s63, s3, 180480
  s_add_u32 s48, s3, 184576
  s_lshl2_add_u32 s48, s41, s48
  s_lshl_b32 s49, s40, 13
  s_lshl_b32 s3, s43, 12
  s_add_u32 s49, s49, s3
  s_lshl_b32 s50, s40, 12
  s_lshl_b32 s3, s28, 9
  s_add_u32 s50, s50, s3
  s_mul_i32 s3, s41, 8388608
  s_add_u32 s50, s50, s3
  s_add_u32 s50, s50, 41943040
  s_mov_b32 s42, 0
  s_mov_b32 s45, 1
  s_mov_b32 s52, 0
  ds_read_b64_tr_b16 a[80:81], v30 offset:2048
  ds_read_b64_tr_b16 a[82:83], v30 offset:4096
  ds_read_b64_tr_b16 a[84:85], v32 offset:2048
  ds_read_b64_tr_b16 a[86:87], v32 offset:4096
  ds_read_b64_tr_b16 a[88:89], v31 offset:2048
  ds_read_b64_tr_b16 a[90:91], v31 offset:4096
  ds_read_b64_tr_b16 a[92:93], v33 offset:2048
  ds_read_b64_tr_b16 a[94:95], v33 offset:4096
  s_waitcnt vmcnt(24) lgkmcnt(0)
  s_barrier
  s_add_u32 s36, s38, 524288
  s_add_u32 m0, s62, 2048
  s_nop 0
  buffer_load_dwordx4 v29, s[20:23], s36 offen lds
  s_add_u32 s36, s38, 540672
  s_add_u32 m0, s62, 3072
  s_nop 0
  buffer_load_dwordx4 v29, s[20:23], s36 offen lds
  s_add_u32 s36, s38, 589824
  s_add_u32 m0, s62, 4096
  s_nop 0
  buffer_load_dwordx4 v29, s[20:23], s36 offen lds
  s_add_u32 s36, s38, 606208
  s_add_u32 m0, s62, 5120
  s_nop 0
  buffer_load_dwordx4 v29, s[20:23], s36 offen lds
  ds_read_b64_tr_b16 a[96:97], v30 offset:6144
  ds_read_b64_tr_b16 a[98:99], v30 offset:8192
  ds_read_b64_tr_b16 a[100:101], v32 offset:6144
  ds_read_b64_tr_b16 a[102:103], v32 offset:8192
  ds_read_b64_tr_b16 a[104:105], v31 offset:6144
  ds_read_b64_tr_b16 a[106:107], v31 offset:8192
  ds_read_b64_tr_b16 a[108:109], v33 offset:6144
  ds_read_b64_tr_b16 a[110:111], v33 offset:8192
  s_waitcnt vmcnt(24) lgkmcnt(0)
  s_barrier
  s_add_u32 s36, s39, 64
  s_add_u32 m0, s62, 6144
  s_nop 0
  buffer_load_dwordx4 v18, s[24:27], s36 offen lds
  s_add_u32 s36, s39, 2624
  s_add_u32 m0, s62, 7168
  s_nop 0
  buffer_load_dwordx4 v18, s[24:27], s36 offen lds
  s_add_u32 s36, s39, 10304
  s_add_u32 m0, s62, 8192
  s_nop 0
  buffer_load_dwordx4 v18, s[24:27], s36 offen lds
  s_add_u32 s36, s39, 12864
  s_add_u32 m0, s62, 9216
  s_nop 0
  buffer_load_dwordx4 v18, s[24:27], s36 offen lds
  ds_read_b64_tr_b16 a[112:113], v30 offset:10240
  ds_read_b64_tr_b16 a[114:115], v30 offset:12288
  ds_read_b64_tr_b16 a[116:117], v32 offset:10240
  ds_read_b64_tr_b16 a[118:119], v32 offset:12288
  ds_read_b64_tr_b16 a[120:121], v31 offset:10240
  ds_read_b64_tr_b16 a[122:123], v31 offset:12288
  ds_read_b64_tr_b16 a[124:125], v33 offset:10240
  ds_read_b64_tr_b16 a[126:127], v33 offset:12288
  s_waitcnt vmcnt(24) lgkmcnt(0)
  s_barrier
  s_add_u32 s36, s39, 96
  s_add_u32 m0, s62, 10240
  s_nop 0
  buffer_load_dwordx4 v18, s[24:27], s36 offen lds
  s_add_u32 s36, s39, 2656
  s_add_u32 m0, s62, 11264
  s_nop 0
  buffer_load_dwordx4 v18, s[24:27], s36 offen lds
  s_add_u32 s36, s39, 10336
  s_add_u32 m0, s62, 12288
  s_nop 0
  buffer_load_dwordx4 v18, s[24:27], s36 offen lds
  s_add_u32 s36, s39, 12896
  s_add_u32 m0, s62, 13312
  s_nop 0
  buffer_load_dwordx4 v18, s[24:27], s36 offen lds
  ds_read_b64_tr_b16 a[128:129], v30 offset:14336
  ds_read_b64_tr_b16 a[130:131], v30 offset:16384
  ds_read_b64_tr_b16 a[132:133], v32 offset:14336
  ds_read_b64_tr_b16 a[134:135], v32 offset:16384
  ds_read_b64_tr_b16 a[136:137], v31 offset:14336
  ds_read_b64_tr_b16 a[138:139], v31 offset:16384
  ds_read_b64_tr_b16 a[140:141], v33 offset:14336
  ds_read_b64_tr_b16 a[142:143], v33 offset:16384
  s_waitcnt vmcnt(24) lgkmcnt(0)
  s_barrier
  s_add_u32 s36, s39, 81984
  s_add_u32 m0, s62, 14336
  s_nop 0
  buffer_load_dwordx4 v18, s[24:27], s36 offen lds
  s_add_u32 s36, s39, 84544
  s_add_u32 m0, s62, 15360
  s_nop 0
  buffer_load_dwordx4 v18, s[24:27], s36 offen lds
  s_add_u32 s36, s39, 92224
  s_add_u32 m0, s62, 16384
  s_nop 0
  buffer_load_dwordx4 v18, s[24:27], s36 offen lds
  s_add_u32 s36, s39, 94784
  s_add_u32 m0, s62, 17408
  s_nop 0
  buffer_load_dwordx4 v18, s[24:27], s36 offen lds
  ds_read_b64_tr_b16 a[144:145], v30 offset:18432
  ds_read_b64_tr_b16 a[146:147], v30 offset:20480
  ds_read_b64_tr_b16 a[148:149], v32 offset:18432
  ds_read_b64_tr_b16 a[150:151], v32 offset:20480
  ds_read_b64_tr_b16 a[152:153], v31 offset:18432
  ds_read_b64_tr_b16 a[154:155], v31 offset:20480
  ds_read_b64_tr_b16 a[156:157], v33 offset:18432
  ds_read_b64_tr_b16 a[158:159], v33 offset:20480
  s_waitcnt vmcnt(24) lgkmcnt(0)
  s_barrier
  s_add_u32 s36, s39, 0
  s_add_u32 m0, s62, 18432
  s_nop 0
  buffer_load_dwordx4 v18, s[24:27], s36 offen lds
  s_add_u32 s36, s39, 2560
  s_add_u32 m0, s62, 19456
  s_nop 0
  buffer_load_dwordx4 v18, s[24:27], s36 offen lds
  s_add_u32 s36, s39, 10240
  s_add_u32 m0, s62, 20480
  s_nop 0
  buffer_load_dwordx4 v18, s[24:27], s36 offen lds
  s_add_u32 s36, s39, 12800
  s_add_u32 m0, s62, 21504
  s_nop 0
  buffer_load_dwordx4 v18, s[24:27], s36 offen lds
  ds_read_b64_tr_b16 a[160:161], v30 offset:22528
  ds_read_b64_tr_b16 a[162:163], v30 offset:24576
  ds_read_b64_tr_b16 a[164:165], v32 offset:22528
  ds_read_b64_tr_b16 a[166:167], v32 offset:24576
  ds_read_b64_tr_b16 a[168:169], v31 offset:22528
  ds_read_b64_tr_b16 a[170:171], v31 offset:24576
  ds_read_b64_tr_b16 a[172:173], v33 offset:22528
  ds_read_b64_tr_b16 a[174:175], v33 offset:24576
  s_waitcnt vmcnt(24) lgkmcnt(0)
  s_barrier
  s_add_u32 s36, s39, 81920
  s_add_u32 m0, s62, 22528
  s_nop 0
  buffer_load_dwordx4 v18, s[24:27], s36 offen lds
  s_add_u32 s36, s39, 84480
  s_add_u32 m0, s62, 23552
  s_nop 0
  buffer_load_dwordx4 v18, s[24:27], s36 offen lds
  s_add_u32 s36, s39, 92160
  s_add_u32 m0, s62, 24576
  s_nop 0
  buffer_load_dwordx4 v18, s[24:27], s36 offen lds
  s_add_u32 s36, s39, 94720
  s_add_u32 m0, s62, 25600
  s_nop 0
  buffer_load_dwordx4 v18, s[24:27], s36 offen lds
  ds_read_b64_tr_b16 a[176:177], v30 offset:26624
  ds_read_b64_tr_b16 a[178:179], v30 offset:28672
  ds_read_b64_tr_b16 a[180:181], v32 offset:26624
  ds_read_b64_tr_b16 a[182:183], v32 offset:28672
  ds_read_b64_tr_b16 a[184:185], v31 offset:26624
  ds_read_b64_tr_b16 a[186:187], v31 offset:28672
  ds_read_b64_tr_b16 a[188:189], v33 offset:26624
  ds_read_b64_tr_b16 a[190:191], v33 offset:28672
  s_waitcnt vmcnt(24) lgkmcnt(0)
  s_barrier
  s_add_u32 s36, s39, 82016
  s_add_u32 m0, s62, 26624
  s_nop 0
  buffer_load_dwordx4 v18, s[24:27], s36 offen lds
  s_add_u32 s36, s39, 84576
  s_add_u32 m0, s62, 27648
  s_nop 0
  buffer_load_dwordx4 v18, s[24:27], s36 offen lds
  s_add_u32 s36, s39, 92256
  s_add_u32 m0, s62, 28672
  s_nop 0
  buffer_load_dwordx4 v18, s[24:27], s36 offen lds
  s_add_u32 s36, s39, 94816
  s_add_u32 m0, s62, 29696
  s_nop 0
  buffer_load_dwordx4 v18, s[24:27], s36 offen lds
  buffer_load_dwordx2 v[72:73], off, s[4:7], s63 sc1
  s_mov_b32 s3, 189952
  buffer_load_dword v25, off, s[4:7], s3 sc1
  ds_read_b64_tr_b16 a[192:193], v30 offset:30720
  ds_read_b64_tr_b16 a[194:195], v30 offset:32768
  ds_read_b64_tr_b16 a[196:197], v32 offset:30720
  ds_read_b64_tr_b16 a[198:199], v32 offset:32768
  ds_read_b64_tr_b16 a[200:201], v31 offset:30720
  ds_read_b64_tr_b16 a[202:203], v31 offset:32768
  ds_read_b64_tr_b16 a[204:205], v33 offset:30720
  ds_read_b64_tr_b16 a[206:207], v33 offset:32768
  s_waitcnt vmcnt(24) lgkmcnt(0)
  s_barrier
  s_add_u32 s36, s37, 0
  s_add_u32 m0, s62, 30720
  s_nop 0
  buffer_load_dwordx4 v28, s[20:23], s36 offen lds
  s_add_u32 s36, s37, 8192
  s_add_u32 m0, s62, 31744
  s_nop 0
  buffer_load_dwordx4 v28, s[20:23], s36 offen lds
  s_add_u32 s36, s37, 32768
  s_add_u32 m0, s62, 32768
  s_nop 0
  buffer_load_dwordx4 v28, s[20:23], s36 offen lds
  s_add_u32 s36, s37, 40960
  s_add_u32 m0, s62, 33792
  s_nop 0
  buffer_load_dwordx4 v28, s[20:23], s36 offen lds
  ds_read_b64_tr_b16 a[208:209], v30 offset:2048
  ds_read_b64_tr_b16 a[210:211], v30 offset:4096
  ds_read_b64_tr_b16 a[212:213], v32 offset:2048
  ds_read_b64_tr_b16 a[214:215], v32 offset:4096
  ds_read_b64_tr_b16 a[216:217], v31 offset:2048
  ds_read_b64_tr_b16 a[218:219], v31 offset:4096
  ds_read_b64_tr_b16 a[220:221], v33 offset:2048
  ds_read_b64_tr_b16 a[222:223], v33 offset:4096
  s_waitcnt vmcnt(24) lgkmcnt(0)
  s_barrier
  s_add_u32 s36, s37, 655360
  s_add_u32 m0, s62, 2048
  s_nop 0
  buffer_load_dwordx4 v28, s[20:23], s36 offen lds
  s_add_u32 s36, s37, 663552
  s_add_u32 m0, s62, 3072
  s_nop 0
  buffer_load_dwordx4 v28, s[20:23], s36 offen lds
  s_add_u32 s36, s37, 688128
  s_add_u32 m0, s62, 4096
  s_nop 0
  buffer_load_dwordx4 v28, s[20:23], s36 offen lds
  s_add_u32 s36, s37, 696320
  s_add_u32 m0, s62, 5120
  s_nop 0
  buffer_load_dwordx4 v28, s[20:23], s36 offen lds
  ds_read_b64_tr_b16 v[60:61], v19 offset:6144
  ds_read_b64_tr_b16 v[62:63], v19 offset:7168
  ds_read_b64_tr_b16 v[64:65], v19 offset:8192
  ds_read_b64_tr_b16 v[66:67], v19 offset:9216
  ds_read_b64_tr_b16 a[224:225], v20 offset:6144
  ds_read_b64_tr_b16 a[226:227], v20 offset:7168
  ds_read_b64_tr_b16 a[228:229], v20 offset:8192
  ds_read_b64_tr_b16 a[230:231], v20 offset:9216
  s_waitcnt vmcnt(24) lgkmcnt(0)
  s_barrier
  s_add_u32 s36, s37, 1310720
  s_add_u32 m0, s62, 6144
  s_nop 0
  buffer_load_dwordx4 v28, s[20:23], s36 offen lds
  s_add_u32 s36, s37, 1318912
  s_add_u32 m0, s62, 7168
  s_nop 0
  buffer_load_dwordx4 v28, s[20:23], s36 offen lds
  s_add_u32 s36, s37, 1343488
  s_add_u32 m0, s62, 8192
  s_nop 0
  buffer_load_dwordx4 v28, s[20:23], s36 offen lds
  s_add_u32 s36, s37, 1351680
  s_add_u32 m0, s62, 9216
  s_nop 0
  buffer_load_dwordx4 v28, s[20:23], s36 offen lds
  ds_read_b64_tr_b16 a[232:233], v20 offset:10240
  ds_read_b64_tr_b16 a[234:235], v20 offset:11264
  ds_read_b64_tr_b16 a[236:237], v20 offset:12288
  ds_read_b64_tr_b16 a[238:239], v20 offset:13312
  s_waitcnt vmcnt(24) lgkmcnt(0)
  s_barrier
  s_add_u32 s36, s37, 1966080
  s_add_u32 m0, s62, 10240
  s_nop 0
  buffer_load_dwordx4 v28, s[20:23], s36 offen lds
  s_add_u32 s36, s37, 1974272
  s_add_u32 m0, s62, 11264
  s_nop 0
  buffer_load_dwordx4 v28, s[20:23], s36 offen lds
  s_add_u32 s36, s37, 1998848
  s_add_u32 m0, s62, 12288
  s_nop 0
  buffer_load_dwordx4 v28, s[20:23], s36 offen lds
  s_add_u32 s36, s37, 2007040
  s_add_u32 m0, s62, 13312
  s_nop 0
  buffer_load_dwordx4 v28, s[20:23], s36 offen lds
  ds_read_b64_tr_b16 a[240:241], v19 offset:14336
  ds_read_b64_tr_b16 a[242:243], v19 offset:15360
  ds_read_b64_tr_b16 a[244:245], v19 offset:16384
  ds_read_b64_tr_b16 a[246:247], v19 offset:17408
  ds_read_b64_tr_b16 a[248:249], v20 offset:14336
  ds_read_b64_tr_b16 a[250:251], v20 offset:15360
  ds_read_b64_tr_b16 a[252:253], v20 offset:16384
  ds_read_b64_tr_b16 a[254:255], v20 offset:17408
  s_waitcnt vmcnt(24) lgkmcnt(0)
  s_barrier
  s_add_u32 s36, s37, 524288
  s_add_u32 m0, s62, 14336
  s_nop 0
  buffer_load_dwordx4 v29, s[20:23], s36 offen lds
  s_add_u32 s36, s37, 540672
  s_add_u32 m0, s62, 15360
  s_nop 0
  buffer_load_dwordx4 v29, s[20:23], s36 offen lds
  s_add_u32 s36, s37, 589824
  s_add_u32 m0, s62, 16384
  s_nop 0
  buffer_load_dwordx4 v29, s[20:23], s36 offen lds
  s_add_u32 s36, s37, 606208
  s_add_u32 m0, s62, 17408
  s_nop 0
  buffer_load_dwordx4 v29, s[20:23], s36 offen lds
  ds_read_b64_tr_b16 v[40:41], v19 offset:18432
  ds_read_b64_tr_b16 v[42:43], v19 offset:19456
  ds_read_b64_tr_b16 v[44:45], v19 offset:20480
  ds_read_b64_tr_b16 v[46:47], v19 offset:21504
  ds_read_b64_tr_b16 v[48:49], v20 offset:18432
  ds_read_b64_tr_b16 v[50:51], v20 offset:19456
  ds_read_b64_tr_b16 v[52:53], v20 offset:20480
  ds_read_b64_tr_b16 v[54:55], v20 offset:21504
  s_waitcnt lgkmcnt(0)
  ds_write_b128 v2, v[40:43] offset:18432
  ds_write_b128 v2, v[44:47] offset:19456
  ds_write_b128 v2, v[48:51] offset:20480
  ds_write_b128 v2, v[52:55] offset:21504
  s_waitcnt lgkmcnt(0)
  s_waitcnt vmcnt(24) lgkmcnt(0)
  s_barrier
  ds_read_b64_tr_b16 v[40:41], v19 offset:22528
  ds_read_b64_tr_b16 v[42:43], v19 offset:23552
  ds_read_b64_tr_b16 v[44:45], v19 offset:24576
  ds_read_b64_tr_b16 v[46:47], v19 offset:25600
  ds_read_b64_tr_b16 v[48:49], v20 offset:22528
  ds_read_b64_tr_b16 v[50:51], v20 offset:23552
  ds_read_b64_tr_b16 v[52:53], v20 offset:24576
  ds_read_b64_tr_b16 v[54:55], v20 offset:25600
  s_waitcnt lgkmcnt(0)
  ds_write_b128 v2, v[40:43] offset:22528
  ds_write_b128 v2, v[44:47] offset:23552
  ds_write_b128 v2, v[48:51] offset:24576
  ds_write_b128 v2, v[52:55] offset:25600
  s_waitcnt lgkmcnt(0)
  s_waitcnt vmcnt(20) lgkmcnt(0)
  s_barrier
  ds_read_b64_tr_b16 v[48:49], v20 offset:26624
  ds_read_b64_tr_b16 v[50:51], v20 offset:27648
  ds_read_b64_tr_b16 v[52:53], v20 offset:28672
  ds_read_b64_tr_b16 v[54:55], v20 offset:29696
  s_waitcnt lgkmcnt(0)
  ds_write_b128 v2, v[48:51] offset:28672
  ds_write_b128 v2, v[52:55] offset:29696
  ds_write_b128 v2, v[60:63] offset:26624
  ds_write_b128 v2, v[64:67] offset:27648
  s_waitcnt lgkmcnt(0)
  s_waitcnt vmcnt(16) lgkmcnt(0)
  s_barrier
  ds_read_b64_tr_b16 v[56:57], v30 offset:30720
  ds_read_b64_tr_b16 v[58:59], v30 offset:32768
  ds_read_b64_tr_b16 v[60:61], v32 offset:30720
  ds_read_b64_tr_b16 v[62:63], v32 offset:32768
  ds_read_b64_tr_b16 v[64:65], v31 offset:30720
  ds_read_b64_tr_b16 v[66:67], v31 offset:32768
  ds_read_b64_tr_b16 v[68:69], v33 offset:30720
  ds_read_b64_tr_b16 v[70:71], v33 offset:32768
  s_waitcnt vmcnt(12) lgkmcnt(0)
  s_barrier
  ds_write_b128 v2, v[56:59] offset:30720
  ds_write_b128 v2, v[60:63] offset:31744
  ds_write_b128 v2, v[64:67] offset:32768
  ds_write_b128 v2, v[68:71] offset:33792
  v_cmp_eq_u32 vcc, 0, v25
  s_cbranch_vccz L_rec_pg
  s_mov_b32 s54, 189952
  s_mov_b32 s55, 1
  v_min_u32 v24, 0, v1
  v_mul_u32_u24 v24, 4, v24
L_wf_12:
  buffer_load_dword v25, v24, s[4:7], s54 offen sc1
  s_waitcnt vmcnt(0)
  v_cmp_gt_u32 vcc, s55, v25
  s_cbranch_vccz L_wfd_13
  s_sleep 1
  s_sub_u32 s29, s29, 1
  s_cbranch_scc0 L_wf_12
  s_branch L_end
L_wfd_13:
L_rec_pg:
  v_readfirstlane_b32 s52, v25
  s_nop 0
  s_and_b32 s52, s52, 0x2000
  s_cmp_lt_u32 s28, 2
  s_cbranch_scc1 L_rec_m0
  v_min_u32 v72, v72, v73
  v_cmp_eq_u32 vcc, 0, v72
  s_cbranch_vccz L_rec_kv
  s_mov_b32 s54, 1
  v_min_u32 v24, 1, v1
  v_mul_u32_u24 v24, 4, v24
L_wf_14:
  buffer_load_dword v25, v24, s[4:7], s63 offen sc1
  s_waitcnt vmcnt(0)
  v_cmp_gt_u32 vcc, s54, v25
  s_cbranch_vccz L_wfd_15
  s_sleep 1
  s_sub_u32 s29, s29, 1
  s_cbranch_scc0 L_wf_14
  s_branch L_end
L_wfd_15:
L_rec_kv:
  s_add_u32 s35, s49, 8388608
  s_lshl_b32 s3, s43, 12
  s_add_u32 m0, s3, 16384
  s_nop 0
  buffer_load_dwordx4 v3, s[4:7], s35 offen offset:0 sc1 lds
  buffer_load_dwordx4 v3, s[4:7], s35 offen offset:1024 sc1 lds
  buffer_load_dwordx4 v3, s[4:7], s35 offen offset:2048 sc1 lds
  v_lshlrev_b32 v24, 3, v3
  v_and_b32 v24, 0xf80, v24
  v_add_u32 v26, 16777216, v24
  v_cmp_gt_u32 vcc, 512, v3
  s_movk_i32 m0, 0x1800
  s_nop 0
  v_cndmask_b32 v24, v26, v24, vcc
  buffer_load_dword v24, s[4:7], s35 offen sc1 lds
  s_cmp_lg_u32 s32, 5
  s_cbranch_scc1 L_rec_go
  s_mov_b32 s3, 190080
  v_mov_b32 v24, 1
  s_mov_b64 exec, 1
  buffer_store_dword v24, off, s[4:7], s3 sc1
  s_mov_b64 exec, -1
  s_branch L_rec_go
L_rec_m0:
  s_cmp_ge_u32 s44, 40
  s_cbranch_scc1 L_rec_go
  s_lshl_b32 s54, s44, 7
  s_and_b32 s3, 0, 3
  s_lshl1_add_u32 s3, s3, s41
  s_mul_i32 s35, s3, 6144
  s_add_u32 s35, s35, s54
  s_add_u32 s35, s35, 131072
  s_and_b32 s3, 0, 3
  s_lshl1_add_u32 s3, s3, s41
  s_lshl_b32 s36, s3, 14
  s_add_u32 s36, s36, s54
  s_add_u32 s36, s36, s52
  s_add_u32 s36, s36, 0
  v_lshl_or_b32 v24, v75, 16, v74
  v_min_u32 v24, -2, v24
  s_cmp_lg_u32 s33, 0
  s_cbranch_scc1 L_rec_m3
  buffer_store_dword v24, v10, s[4:7], s35 offen
  buffer_store_dword v24, v10, s[4:7], s36 offen sc1
  s_branch L_rec_go
L_rec_m3:
  buffer_store_dword v24, v10, s[4:7], s35 offen sc1
  buffer_store_dword v24, v10, s[4:7], s36 offen sc1
L_rec_go:
  ds_read_b64_tr_b16 v[40:41], v30 offset:2048
  ds_read_b64_tr_b16 v[42:43], v30 offset:4096
  ds_read_b64_tr_b16 v[44:45], v32 offset:2048
  ds_read_b64_tr_b16 v[46:47], v32 offset:4096
  ds_read_b64_tr_b16 v[48:49], v31 offset:2048
  ds_read_b64_tr_b16 v[50:51], v31 offset:4096
  ds_read_b64_tr_b16 v[52:53], v33 offset:2048
  ds_read_b64_tr_b16 v[54:55], v33 offset:4096
  s_waitcnt vmcnt(8) lgkmcnt(0)
  s_barrier
  ds_write_b128 v2, v[40:43] offset:2048
  ds_write_b128 v2, v[44:47] offset:3072
  ds_write_b128 v2, v[48:51] offset:4096
  ds_write_b128 v2, v[52:55] offset:5120
  ds_read_b64_tr_b16 v[56:57], v30 offset:6144
  ds_read_b64_tr_b16 v[58:59], v30 offset:8192
  ds_read_b64_tr_b16 v[60:61], v32 offset:6144
  ds_read_b64_tr_b16 v[62:63], v32 offset:8192
  ds_read_b64_tr_b16 v[64:65], v31 offset:6144
  ds_read_b64_tr_b16 v[66:67], v31 offset:8192
  ds_read_b64_tr_b16 v[68:69], v33 offset:6144
  ds_read_b64_tr_b16 v[70:71], v33 offset:8192
  s_waitcnt vmcnt(4) lgkmcnt(0)
  s_barrier
  ds_write_b128 v2, v[56:59] offset:6144
  ds_write_b128 v2, v[60:63] offset:7168
  ds_write_b128 v2, v[64:67] offset:8192
  ds_write_b128 v2, v[68:71] offset:9216
  ds_read_b64_tr_b16 v[40:41], v30 offset:10240
  ds_read_b64_tr_b16 v[42:43], v30 offset:12288
  ds_read_b64_tr_b16 v[44:45], v32 offset:10240
  ds_read_b64_tr_b16 v[46:47], v32 offset:12288
  ds_read_b64_tr_b16 v[48:49], v31 offset:10240
  ds_read_b64_tr_b16 v[50:51], v31 offset:12288
  ds_read_b64_tr_b16 v[52:53], v33 offset:10240
  ds_read_b64_tr_b16 v[54:55], v33 offset:12288
  s_waitcnt vmcnt(0) lgkmcnt(0)
  s_barrier
  ds_write_b128 v2, v[40:43] offset:10240
  ds_write_b128 v2, v[44:47] offset:11264
  ds_write_b128 v2, v[48:51] offset:12288
  ds_write_b128 v2, v[52:55] offset:13312
  ds_read_b64_tr_b16 v[56:57], v30 offset:14336
  ds_read_b64_tr_b16 v[58:59], v30 offset:16384
  ds_read_b64_tr_b16 v[60:61], v32 offset:14336
  ds_read_b64_tr_b16 v[62:63], v32 offset:16384
  ds_read_b64_tr_b16 v[64:65], v31 offset:14336
  ds_read_b64_tr_b16 v[66:67], v31 offset:16384
  ds_read_b64_tr_b16 v[68:69], v33 offset:14336
  ds_read_b64_tr_b16 v[70:71], v33 offset:16384
  s_waitcnt lgkmcnt(0)
  s_barrier
  ds_write_b128 v2, v[56:59] offset:14336
  ds_write_b128 v2, v[60:63] offset:15360
  ds_write_b128 v2, v[64:67] offset:16384
  ds_write_b128 v2, v[68:71] offset:17408
  s_waitcnt lgkmcnt(0)
  s_mov_b32 s24, 0x3f803f80
  s_mov_b32 s25, 0x3f803f80
  s_mov_b32 s26, 0xcccccccc
  s_mov_b32 s27, 0xcccccccc
  s_lshl_b32 s14, s28, 9
  s_sub_u32 s14, s14, 512
  s_mov_b32 s54, 0x3030303
  s_mov_b32 s55, 0x3030303
  s_mov_b32 s56, 0xc0c0c0c
  s_mov_b32 s57, 0xc0c0c0c
  s_mov_b32 s58, 0x30303030
  s_mov_b32 s59, 0x30303030
  s_mov_b32 s60, 0xc0c0c0c0
  s_mov_b32 s61, 0xc0c0c0c0
  v_and_b32 v16, 2, v1
  v_mov_b32 v17, 0x4444
  v_mov_b32 v1, 0xeeee
  v_cmp_eq_u32 vcc, 0, v16
  s_nop 1
  v_cndmask_b32 v1, v1, v17, vcc
  v_mov_b32 v12, 0
  v_mov_b32 v13, 0
  v_mov_b32 v14, 0
  v_mov_b32 v15, 0
  v_mov_b32 v16, 0
  v_mov_b32 v17, 0
  v_mov_b32 v18, 0
  v_mov_b32 v19, 0
  v_mov_b32 v20, 0
  v_mov_b32 v21, 0
  v_mov_b32 v22, 0
  v_mov_b32 v23, 0
  v_mov_b32 v24, 0
  v_mov_b32 v25, 0
  v_mov_b32 v26, 0
  v_mov_b32 v27, 0
  v_mov_b32 v28, 0
  v_mov_b32 v29, 0
  v_mov_b32 v30, 0
  v_mov_b32 v31, 0
  v_mov_b32 v32, 0
  v_mov_b32 v33, 0
  v_mov_b32 v34, 0
  v_mov_b32 v35, 0
  ds_read_b128 v[36:39], v2 offset:30720
  ds_read_b128 v[40:43], v2 offset:31744
  ds_read_b128 v[44:47], v2 offset:32768
  ds_read_b128 v[48:51], v2 offset:33792
  s_waitcnt lgkmcnt(0)
  s_lshr_b32 s3, s28, 1
  s_lshl1_add_u32 s3, s41, s3
  s_lshl2_add_u32 s3, s33, s3
  s_cmp_eq_u32 s3, 1
  s_cbranch_scc1 L_loop1
  s_cmp_eq_u32 s3, 2
  s_cbranch_scc1 L_loop2
  s_cmp_eq_u32 s3, 3
  s_cbranch_scc1 L_loop3
  s_cmp_eq_u32 s3, 4
  s_cbranch_scc1 L_loop4
  s_cmp_eq_u32 s3, 5
  s_cbranch_scc1 L_loop5
  s_cmp_eq_u32 s3, 6
  s_cbranch_scc1 L_loop6
  s_cmp_eq_u32 s3, 7
  s_cbranch_scc1 L_loop7
L_loop0:
  s_lshl_b32 s16, s44, 7
  s_lshl_b32 s3, s40, 7
  s_add_u32 s3, s3, 589824
  s_cmp_ge_u32 s44, 40
  s_cselect_b32 s16, s3, s16
  s_add_u32 s18, s49, 8388608
  s_lshl_b32 s3, s40, 13
  s_lshl_b32 s19, s28, 11
  s_add_u32 s19, s19, s3
  s_add_u32 s19, s19, 25165824
  s_lshl_b32 s94, s43, 12
  s_add_u32 s94, s94, 16384
  s_mov_b32 s92, 62
  s_add_u32 s90, s51, 16384
  s_add_u32 s93, s18, 262144
  s_add_u32 s3, s42, 0
  s_and_b32 s38, s3, 3
  s_lshl_b32 s38, s38, 15
  s_add_u32 s38, s38, s52
  s_add_u32 s38, s38, 16384
  s_add_u32 s17, s38, 4096
  s_add_u32 s3, s3, 2
  s_and_b32 s21, s3, 3
  s_and_b32 s3, s3, 3
  s_mul_i32 s20, s3, 12288
  s_lshl_b32 s21, s21, 15
  s_add_u32 s20, s20, s16
  s_add_u32 s21, s21, s16
  s_add_u32 s20, s20, 131072
  s_add_u32 s21, s21, 0
  s_add_u32 s21, s21, s52
L_loop0_top:
  s_barrier
  ds_read_b128 v[52:55], v3 offset:0
  ds_read_b128 v[56:59], v3 offset:1024
  buffer_load_dwordx4 v[60:63], v4, s[4:7], s38 offen offset:0 sc1
  buffer_load_dwordx4 v[64:67], v4, s[4:7], s38 offen offset:1024 sc1
  buffer_load_dwordx4 v[68:71], v4, s[4:7], s38 offen offset:2048 sc1
  s_waitcnt lgkmcnt(1)
  v_smfmac_f32_16x16x64_bf16 v[28:31], v[52:55], v[36:43], v1
  ds_read_b128 v[36:39], v2 offset:2048
  v_smfmac_f32_16x16x64_bf16 v[12:15], v[52:55], v[80:87], v1
  ds_read_b128 v[40:43], v2 offset:3072
  v_smfmac_f32_16x16x64_bf16 v[16:19], v[52:55], v[88:95], v1
  buffer_load_dwordx4 v[72:75], v4, s[4:7], s38 offen offset:3072 sc1
  v_smfmac_f32_16x16x64_bf16 v[32:35], v[52:55], v[44:51], v1
  ds_read_b128 v[44:47], v2 offset:4096
  v_smfmac_f32_16x16x64_bf16 v[20:23], v[52:55], v[240:247], v1
  ds_read_b128 v[48:51], v2 offset:5120
  buffer_load_dwordx4 v[76:79], v4, s[4:7], s17 offen sc1
  s_mov_b32 m0, s62
  v_smfmac_f32_16x16x64_bf16 v[24:27], v[52:55], v[248:255], v1
  ds_read_b128 v[52:55], v3 offset:2048
  s_waitcnt lgkmcnt(3)
  v_smfmac_f32_16x16x64_bf16 v[28:31], v[56:59], v[36:43], v1
  ds_read_b128 v[36:39], v2 offset:6144
  v_smfmac_f32_16x16x64_bf16 v[12:15], v[56:59], v[96:103], v1
  ds_read_b128 v[40:43], v2 offset:7168
  v_smfmac_f32_16x16x64_bf16 v[16:19], v[56:59], v[104:111], v1
  s_waitcnt lgkmcnt(3)
  v_smfmac_f32_16x16x64_bf16 v[32:35], v[56:59], v[44:51], v1
  ds_read_b128 v[44:47], v2 offset:8192
  v_smfmac_f32_16x16x64_bf16 v[20:23], v[56:59], a[0:7], v1
  ds_read_b128 v[48:51], v2 offset:9216
  buffer_load_dwordx4 v3, s[4:7], s19 offen offset:0 sc1 lds
  v_smfmac_f32_16x16x64_bf16 v[24:27], v[56:59], a[8:15], v1
  ds_read_b128 v[56:59], v3 offset:3072
  s_waitcnt lgkmcnt(3)
  v_smfmac_f32_16x16x64_bf16 v[28:31], v[52:55], v[36:43], v1
  ds_read_b128 v[36:39], v2 offset:10240
  v_smfmac_f32_16x16x64_bf16 v[12:15], v[52:55], v[112:119], v1
  ds_read_b128 v[40:43], v2 offset:11264
  v_smfmac_f32_16x16x64_bf16 v[16:19], v[52:55], v[120:127], v1
  s_waitcnt lgkmcnt(3)
  v_smfmac_f32_16x16x64_bf16 v[32:35], v[52:55], v[44:51], v1
  ds_read_b128 v[44:47], v2 offset:12288
  v_smfmac_f32_16x16x64_bf16 v[20:23], v[52:55], a[16:23], v1
  ds_read_b128 v[48:51], v2 offset:13312
  buffer_load_dwordx4 v3, s[4:7], s19 offen offset:1024 sc1 lds
  s_mov_b32 m0, s94
  s_nop 0
  v_smfmac_f32_16x16x64_bf16 v[24:27], v[52:55], a[24:31], v1
  ds_read_b128 v[52:55], v3 offset:4096
  s_waitcnt lgkmcnt(3)
  v_smfmac_f32_16x16x64_bf16 v[28:31], v[56:59], v[36:43], v1
  ds_read_b128 v[36:39], v2 offset:14336
  v_smfmac_f32_16x16x64_bf16 v[12:15], v[56:59], v[128:135], v1
  ds_read_b128 v[40:43], v2 offset:15360
  v_smfmac_f32_16x16x64_bf16 v[16:19], v[56:59], v[136:143], v1
  s_waitcnt lgkmcnt(3)
  v_smfmac_f32_16x16x64_bf16 v[32:35], v[56:59], v[44:51], v1
  ds_read_b128 v[44:47], v2 offset:16384
  v_smfmac_f32_16x16x64_bf16 v[20:23], v[56:59], a[32:39], v1
  ds_read_b128 v[48:51], v2 offset:17408
  buffer_load_dwordx4 v3, s[4:7], s18 offen offset:3072 sc1 lds
  v_smfmac_f32_16x16x64_bf16 v[24:27], v[56:59], a[40:47], v1
  s_waitcnt lgkmcnt(2)
  v_smfmac_f32_16x16x64_bf16 v[28:31], v[52:55], v[36:43], v1
  v_smfmac_f32_16x16x64_bf16 v[12:15], v[52:55], v[144:151], v1
  v_smfmac_f32_16x16x64_bf16 v[16:19], v[52:55], v[152:159], v1
  s_waitcnt lgkmcnt(0)
  v_smfmac_f32_16x16x64_bf16 v[32:35], v[52:55], v[44:51], v1
  s_waitcnt vmcnt(7)
  v_smfmac_f32_16x16x64_bf16 v[20:23], v[52:55], a[48:55], v1
  v_cmp_eq_u32 vcc, -1, v60
  v_smfmac_f32_16x16x64_bf16 v[24:27], v[52:55], a[56:63], v1
  s_cbranch_vccnz L_loop0_rr0
L_loop0_rok0:
  v_smfmac_f32_16x16x64_bf16 v[12:15], v[60:63], v[160:167], v1
  s_waitcnt vmcnt(6)
  v_smfmac_f32_16x16x64_bf16 v[16:19], v[60:63], v[168:175], v1
  v_cmp_eq_u32 vcc, -1, v64
  v_smfmac_f32_16x16x64_bf16 v[20:23], v[60:63], a[64:71], v1
  ds_read_b128 v[36:39], v3 offset:16384
  v_smfmac_f32_16x16x64_bf16 v[24:27], v[60:63], a[72:79], v1
  ds_read_b128 v[40:43], v3 offset:20480
  s_cbranch_vccnz L_loop0_rr1
L_loop0_rok1:
  v_smfmac_f32_16x16x64_bf16 v[12:15], v[64:67], v[176:183], v1
  s_waitcnt vmcnt(5)
  v_smfmac_f32_16x16x64_bf16 v[16:19], v[64:67], v[184:191], v1
  v_cmp_eq_u32 vcc, -1, v68
  v_smfmac_f32_16x16x64_bf16 v[20:23], v[64:67], a[80:87], v1
  ds_read_b128 v[44:47], v3 offset:17408
  v_smfmac_f32_16x16x64_bf16 v[24:27], v[64:67], a[88:95], v1
  ds_read_b128 v[48:51], v3 offset:21504
  s_cbranch_vccnz L_loop0_rr2
L_loop0_rok2:
  v_smfmac_f32_16x16x64_bf16 v[12:15], v[68:71], v[192:199], v1
  s_waitcnt vmcnt(4)
  v_smfmac_f32_16x16x64_bf16 v[16:19], v[68:71], v[200:207], v1
  v_cmp_eq_u32 vcc, -1, v72
  v_smfmac_f32_16x16x64_bf16 v[20:23], v[68:71], a[96:103], v1
  ds_read_b128 v[52:55], v3 offset:18432
  v_smfmac_f32_16x16x64_bf16 v[24:27], v[68:71], a[104:111], v1
  ds_read_b128 v[56:59], v3 offset:22528
  s_cbranch_vccnz L_loop0_rr3
L_loop0_rok3:
  v_smfmac_f32_16x16x64_bf16 v[12:15], v[72:75], v[208:215], v1
  s_waitcnt vmcnt(3)
  v_smfmac_f32_16x16x64_bf16 v[16:19], v[72:75], v[216:223], v1
  v_cmp_eq_u32 vcc, -1, v76
  v_smfmac_f32_16x16x64_bf16 v[20:23], v[72:75], a[112:119], v1
  v_smfmac_f32_16x16x64_bf16 v[24:27], v[72:75], a[120:127], v1
  s_cbranch_vccnz L_loop0_rr4
L_loop0_rok4:
  v_smfmac_f32_16x16x64_bf16 v[12:15], v[76:79], v[224:231], v1
  v_mov_b32 v11, -1
  v_smfmac_f32_16x16x64_bf16 v[16:19], v[76:79], v[232:239], v1
  v_smfmac_f32_16x16x64_bf16 v[20:23], v[76:79], a[128:135], v1
  v_smfmac_f32_16x16x64_bf16 v[24:27], v[76:79], a[136:143], v1
  v_smfmac_f32_16x16x64_bf16 v[28:31], v[60:63], a[144:151], v1
  s_nop 0
  v_smfmac_f32_16x16x64_bf16 v[32:35], v[60:63], a[152:159], v1
  s_nop 0
  v_add_f32 v12, v12, v14
  v_add_f32 v13, v13, v15
  v_add_f32 v16, v16, v18
  v_add_f32 v17, v17, v19
  v_add_f32 v20, v20, v22
  v_add_f32 v21, v21, v23
  v_add_f32 v24, v24, v26
  v_add_f32 v25, v25, v27
  v_cvt_pk_bf16_f32 v20, v20, v21
  v_cvt_pk_bf16_f32 v21, v12, v13
  v_cvt_pk_bf16_f32 v22, v24, v25
  v_cvt_pk_bf16_f32 v23, v16, v17
  ds_write2_b64 v5, v[20:21], v[22:23] offset0:0 offset1:64
  v_mov_b32 v12, v20
  v_mov_b32 v13, v22
  v_smfmac_f32_16x16x64_bf16 v[28:31], v[64:67], a[160:167], v1
  v_lshrrev_b32 v0, 1, v3
  v_smfmac_f32_16x16x64_bf16 v[32:35], v[64:67], a[168:175], v1
  buffer_store_dwordx2 v[12:13], v0, s[4:7], s50 offen sc1
  s_waitcnt vmcnt(1)
  s_waitcnt lgkmcnt(0)
  s_barrier
  ds_read_b64_tr_b16 v[12:13], v6 offset:0
  ds_read_b64_tr_b16 v[14:15], v6 offset:256
  v_smfmac_f32_16x16x64_bf16 v[28:31], v[68:71], a[176:183], v1
  ds_read_b64_tr_b16 v[16:17], v6 offset:1024
  v_smfmac_f32_16x16x64_bf16 v[32:35], v[68:71], a[184:191], v1
  ds_read_b64_tr_b16 v[18:19], v6 offset:1280
  buffer_store_dword v11, v10, s[4:7], s20 offen
  v_smfmac_f32_16x16x64_bf16 v[28:31], v[72:75], a[192:199], v1
  ds_read_b64_tr_b16 v[20:21], v6 offset:2048
  buffer_store_dword v11, v10, s[4:7], s21 offen sc1
  v_smfmac_f32_16x16x64_bf16 v[32:35], v[72:75], a[200:207], v1
  ds_read_b64_tr_b16 v[22:23], v6 offset:2304
  v_smfmac_f32_16x16x64_bf16 v[28:31], v[76:79], a[208:215], v1
  ds_read_b64_tr_b16 v[24:25], v6 offset:3072
  v_smfmac_f32_16x16x64_bf16 v[32:35], v[76:79], a[216:223], v1
  ds_read_b64_tr_b16 v[26:27], v6 offset:3328
  s_waitcnt lgkmcnt(6)
  v_mfma_f32_16x16x32_bf16 v[68:71], v[36:39], v[12:15], 0
  ds_read_b128 v[60:63], v3 offset:19456
  ds_read_b128 v[64:67], v3 offset:23552
  v_mfma_f32_16x16x32_bf16 v[72:75], v[40:43], v[12:15], 0
  s_nop 0
  s_nop 0
  s_waitcnt lgkmcnt(6)
  v_mfma_f32_16x16x32_bf16 v[68:71], v[44:47], v[16:19], v[68:71]
  v_add_f32 v28, v28, v30
  v_add_f32 v29, v29, v31
  v_mfma_f32_16x16x32_bf16 v[72:75], v[48:51], v[16:19], v[72:75]
  v_add_f32 v32, v32, v34
  s_waitcnt lgkmcnt(4)
  v_mfma_f32_16x16x32_bf16 v[68:71], v[52:55], v[20:23], v[68:71]
  v_add_f32 v33, v33, v35
  v_cvt_pk_bf16_f32 v33, v32, v33
  v_mfma_f32_16x16x32_bf16 v[72:75], v[56:59], v[20:23], v[72:75]
  v_cvt_pk_bf16_f32 v32, v28, v29
  ds_read_b128 v[52:55], v2 offset:0
  ds_read_b128 v[56:59], v2 offset:1024
  s_waitcnt lgkmcnt(3)
  v_mfma_f32_16x16x32_bf16 v[68:71], v[60:63], v[24:27], v[68:71]
  v_mov_b64 v[44:45], s[24:25]
  s_waitcnt lgkmcnt(2)
  v_mfma_f32_16x16x32_bf16 v[72:75], v[64:67], v[24:27], v[72:75]
  v_mov_b64 v[46:47], s[24:25]
  v_mov_b32 v41, 0
  v_mfma_f32_16x16x32_bf16 v[76:79], v[12:15], v[12:15], 0
  v_mov_b32 v42, 0
  s_nop 0
  v_mfma_f32_16x16x32_bf16 v[76:79], v[16:19], v[16:19], v[76:79]
  s_nop 1
  v_mfma_f32_16x16x32_bf16 v[76:79], v[20:23], v[20:23], v[76:79]
  v_max3_f32 v28, v68, v69, v70
  s_cmp_eq_u32 s42, s92
  v_mfma_f32_16x16x32_bf16 v[76:79], v[24:27], v[24:27], v[76:79]
  v_max3_f32 v28, v28, v71, v72
  v_max3_f32 v28, v28, v73, v74
  s_cbranch_scc1 L_loop0_last
L_loop0_back:
  v_max_f32 v28, v28, v75
  ds_read_b128 v[60:63], v2 offset:18432
  ds_read_b128 v[64:67], v2 offset:19456
  s_nop 1
  v_max3_f32 v28, v28, v76, v77
  v_mov_b32 v29, v28
  s_nop 1
  v_permlane16_swap_b32 v29, v28
  v_max_f32 v28, v28, v29
  v_mov_b32 v29, v28
  s_nop 1
  v_permlane32_swap_b32 v29, v28
  v_max_f32 v28, v28, v29
  v_mul_f32 v28, s46, v28
  v_pk_fma_f32 v[68:69], v[68:69], s[46:47], v[28:29] op_sel_hi:[1,0,0] neg_lo:[0,0,1] neg_hi:[0,0,1]
  v_pk_fma_f32 v[70:71], v[70:71], s[46:47], v[28:29] op_sel_hi:[1,0,0] neg_lo:[0,0,1] neg_hi:[0,0,1]
  v_pk_fma_f32 v[72:73], v[72:73], s[46:47], v[28:29] op_sel_hi:[1,0,0] neg_lo:[0,0,1] neg_hi:[0,0,1]
  v_pk_fma_f32 v[74:75], v[74:75], s[46:47], v[28:29] op_sel_hi:[1,0,0] neg_lo:[0,0,1] neg_hi:[0,0,1]
  v_pk_fma_f32 v[76:77], v[76:77], s[46:47], v[28:29] op_sel_hi:[1,0,0] neg_lo:[0,0,1] neg_hi:[0,0,1]
  v_exp_f32 v68, v68
  v_exp_f32 v69, v69
  v_exp_f32 v70, v70
  v_cvt_pk_bf16_f32 v36, v68, v69
  v_exp_f32 v71, v71
  v_exp_f32 v72, v72
  v_cvt_pk_bf16_f32 v37, v70, v71
  v_exp_f32 v73, v73
  v_exp_f32 v74, v74
  v_cvt_pk_bf16_f32 v38, v72, v73
  v_exp_f32 v75, v75
  v_exp_f32 v76, v76
  v_cvt_pk_bf16_f32 v39, v74, v75
  v_exp_f32 v77, v77
  s_waitcnt lgkmcnt(2)
  v_mfma_f32_16x16x32_bf16 v[20:23], v[44:47], v[36:39], 0
  v_cvt_pk_bf16_f32 v40, v76, v77
  v_cvt_pk_bf16_f32 v43, v76, v77
  v_mfma_f32_16x16x32_bf16 v[12:15], v[52:55], v[36:39], 0
  ds_read_b128 v[68:71], v2 offset:20480
  ds_read_b128 v[72:75], v2 offset:21504
  v_mfma_f32_16x16x32_bf16 v[16:19], v[56:59], v[36:39], 0
  ds_read_b128 v[52:55], v2 offset:22528
  ds_read_b128 v[56:59], v2 offset:23552
  v_mfma_f32_16x16x16_bf16 v[20:23], v[44:45], v[40:41], v[20:23]
  v_add_u32 v0, s14, v7
  v_mov_b64 v[24:25], 0
  v_mfma_f32_16x16x16_bf16 v[12:15], v[32:33], v[40:41], v[12:15]
  v_mov_b64 v[26:27], 0
  v_mov_b64 v[76:77], 0
  v_mfma_f32_16x16x16_bf16 v[16:19], v[32:33], v[42:43], v[16:19]
  v_mov_b64 v[78:79], 0
  s_nop 0
  v_rcp_f32 v30, v20
  s_nop 0
  s_mov_b64 exec, s[26:27]
  v_pk_mul_f32 v[12:13], v[12:13], v[30:31] op_sel_hi:[1,0]
  v_pk_mul_f32 v[14:15], v[14:15], v[30:31] op_sel_hi:[1,0]
  v_cvt_pk_bf16_f32 v12, v12, v13
  v_pk_mul_f32 v[16:17], v[16:17], v[30:31] op_sel_hi:[1,0]
  v_pk_mul_f32 v[18:19], v[18:19], v[30:31] op_sel_hi:[1,0]
  v_cvt_pk_bf16_f32 v13, v14, v15
  v_cvt_pk_bf16_f32 v14, v16, v17
  v_cvt_pk_bf16_f32 v15, v18, v19
  ds_write_b128 v0, v[12:15]
  s_mov_b64 exec, -1
  ds_read_b128 v[36:39], v2 offset:24576
  ds_read_b128 v[40:43], v2 offset:25600
  v_mov_b64 v[20:21], 0
  v_mov_b64 v[22:23], 0
  v_mov_b64 v[44:45], 0
  v_mov_b64 v[46:47], 0
  v_mov_b64 v[48:49], 0
  v_mov_b64 v[50:51], 0
  s_waitcnt lgkmcnt(2)
  s_barrier
  ds_read_b128 v[16:19], v7 offset:0
  ds_read_b128 v[12:15], v7 offset:1024
  ds_read_b128 v[28:31], v2 offset:26624
  ds_read_b128 v[32:35], v2 offset:27648
  s_add_u32 s50, s50, 131072
  s_cmp_ge_u32 s44, 40
  s_waitcnt lgkmcnt(3)
  v_smfmac_f32_16x16x64_bf16 v[20:23], v[16:19], v[60:67], v1
  ds_read_b128 v[60:63], v2 offset:28672
  v_smfmac_f32_16x16x64_bf16 v[24:27], v[16:19], v[68:75], v1
  s_waitcnt lgkmcnt(3)
  v_smfmac_f32_16x16x64_bf16 v[20:23], v[12:15], v[52:59], v1
  ds_read_b128 v[64:67], v2 offset:29696
  v_smfmac_f32_16x16x64_bf16 v[24:27], v[12:15], v[36:43], v1
  s_waitcnt lgkmcnt(2)
  v_smfmac_f32_16x16x64_bf16 v[44:47], v[16:19], v[28:35], v1
  s_nop 0
  v_smfmac_f32_16x16x64_bf16 v[48:51], v[16:19], a[224:231], v1
  s_nop 0
  v_smfmac_f32_16x16x64_bf16 v[44:47], v[12:15], a[240:247], v1
  v_add_f32 v20, v20, v22
  v_smfmac_f32_16x16x64_bf16 v[48:51], v[12:15], a[248:255], v1
  v_add_f32 v21, v21, v23
  v_smfmac_f32_16x16x64_bf16 v[76:79], v[16:19], a[232:239], v1
  v_add_f32 v24, v24, v26
  s_waitcnt lgkmcnt(0)
  v_smfmac_f32_16x16x64_bf16 v[76:79], v[12:15], v[60:67], v1
  v_add_f32 v25, v25, v27
  v_cvt_pk_bf16_f32 v20, v20, v21
  v_cvt_pk_bf16_f32 v21, v24, v25
  v_and_or_b32 v20, v20, -2, s45
  buffer_store_dwordx2 v[20:21], v8, s[4:7], s51 offen
  v_pk_add_f32 v[44:45], v[44:45], v[46:47]
  v_pk_add_f32 v[48:49], v[48:49], v[50:51]
  v_cvt_pk_bf16_f32 v44, v44, v45
  v_cvt_pk_bf16_f32 v45, v48, v49
  v_and_or_b32 v44, v44, -2, s45
  buffer_store_dwordx2 v[44:45], v8, s[4:7], s90 offen
  v_pk_add_f32 v[76:77], v[76:77], v[78:79]
  v_cvt_pk_bf16_f32 v76, v76, v77
  v_and_or_b32 v76, v76, -2, s45
  buffer_store_dword v76, v9, s[4:7], s51 offen
  s_cbranch_scc1 L_loop0_nored
  v_and_b32 v0, 16, v3
  v_mov_b32 v56, 0x3f80
  v_lshlrev_b32 v0, v0, v56
  v_cndmask_b32 v52, 0, v0, s[54:55]
  v_cndmask_b32 v53, 0, v0, s[56:57]
  v_cndmask_b32 v54, 0, v0, s[58:59]
  v_cndmask_b32 v55, 0, v0, s[60:61]
  v_mov_b32 v79, s45
  v_mov_b32 v28, 0
  v_mov_b32 v29, 0
  v_mov_b32 v30, 0
  v_mov_b32 v31, 0
  v_mov_b32 v32, 0
  v_mov_b32 v33, 0
  v_mov_b32 v34, 0
  v_mov_b32 v35, 0
  s_lshl_b32 s37, s44, 12
  s_add_u32 s37, s37, s51
  s_lshl_b32 s39, s44, 7
  s_add_u32 s53, s42, 1
  s_and_b32 s3, s53, 3
  s_lshl1_add_u32 s3, s3, 0
  s_mul_i32 s35, s3, 6144
  s_add_u32 s35, s35, s39
  s_add_u32 s35, s35, 131072
  s_and_b32 s3, s53, 3
  s_lshl1_add_u32 s3, s3, 0
  s_lshl_b32 s36, s3, 14
  s_add_u32 s36, s36, s39
  s_add_u32 s36, s36, s52
  s_add_u32 s36, s36, 0
  s_add_u32 s18, s18, 262144
  s_add_u32 s19, s19, 262144
  s_add_u32 s93, s18, 262144
  s_add_u32 s3, s42, 1
  s_and_b32 s38, s3, 3
  s_lshl_b32 s38, s38, 15
  s_add_u32 s38, s38, s52
  s_add_u32 s38, s38, 16384
  s_add_u32 s17, s38, 4096
  s_add_u32 s3, s3, 2
  s_and_b32 s21, s3, 3
  s_and_b32 s3, s3, 3
  s_mul_i32 s20, s3, 12288
  s_lshl_b32 s21, s21, 15
  s_add_u32 s20, s20, s16
  s_add_u32 s21, s21, s16
  s_add_u32 s20, s20, 131072
  s_add_u32 s21, s21, 0
  s_add_u32 s21, s21, s52
  buffer_load_dwordx4 v[60:63], v3, s[4:7], s37 offen offset:0 sc1
  buffer_load_dwordx4 v[64:67], v3, s[4:7], s37 offen offset:1024 sc1
  buffer_load_dwordx4 v[68:71], v3, s[4:7], s37 offen offset:2048 sc1
  buffer_load_dwordx4 v[72:75], v3, s[4:7], s37 offen offset:3072 sc1
  ds_read_b128 v[36:39], v2 offset:30720
  ds_read_b128 v[40:43], v2 offset:31744
  ds_read_b128 v[44:47], v2 offset:32768
  ds_read_b128 v[48:51], v2 offset:33792
  s_waitcnt lgkmcnt(0)
  buffer_load_dwordx4 v[12:15], v3, s[4:7], s37 offen offset:0 sc1
  buffer_load_dwordx4 v[16:19], v3, s[4:7], s37 offen offset:1024 sc1
  buffer_load_dwordx4 v[20:23], v3, s[4:7], s37 offen offset:2048 sc1
  buffer_load_dwordx4 v[24:27], v3, s[4:7], s37 offen offset:3072 sc1
L_loop0_rp:
  s_waitcnt vmcnt(7)
  v_mfma_f32_16x16x32_bf16 v[56:59], v[60:63], v[52:55], 0
  v_bitop3_b32 v0, v60, v62, v79 bitop3:0x7e
  s_waitcnt vmcnt(6)
  v_mfma_f32_16x16x32_bf16 v[56:59], v[64:67], v[52:55], v[56:59]
  v_bitop3_b32 v76, v64, v66, v79 bitop3:0x7e
  s_waitcnt vmcnt(5)
  v_mfma_f32_16x16x32_bf16 v[56:59], v[68:71], v[52:55], v[56:59]
  v_bitop3_b32 v77, v68, v70, v79 bitop3:0x7e
  v_or3_b32 v0, v0, v76, v77
  s_waitcnt vmcnt(4)
  v_mfma_f32_16x16x32_bf16 v[56:59], v[72:75], v[52:55], v[56:59]
  v_bitop3_b32 v78, v72, v74, v79 bitop3:0x7e
  v_bitop3_b32 v0, v0, v78, 1 bitop3:0xa8
  v_cmp_ne_u32 vcc, 0, v0
  s_nop 4
  v_permlane32_swap_b32 v56, v58
  v_permlane32_swap_b32 v57, v59
  v_pk_add_f32 v[56:57], v[56:57], v[58:59]
  v_cvt_pk_bf16_f32 v56, v56, v57
  v_min_u32 v56, -2, v56
  s_cbranch_vccnz L_loop0_rpr
L_loop0_rpok:
  buffer_store_dword v56, v10, s[4:7], s35 offen
  buffer_store_dword v56, v10, s[4:7], s36 offen sc1
L_loop0_next:
  s_barrier
  s_waitcnt vmcnt(2)
  v_mov_b64 v[12:13], 0
  v_mov_b64 v[14:15], 0
  v_mov_b64 v[16:17], 0
  v_mov_b64 v[18:19], 0
  v_mov_b64 v[20:21], 0
  v_mov_b64 v[22:23], 0
  v_mov_b64 v[24:25], 0
  v_mov_b64 v[26:27], 0
  s_add_u32 s42, s42, 1
  s_xor_b32 s45, s45, 1
  s_waitcnt lgkmcnt(0)
  s_branch L_loop0_top
L_loop0_rpr:
  buffer_load_dwordx4 v[60:63], v3, s[4:7], s37 offen offset:0 sc1
  buffer_load_dwordx4 v[64:67], v3, s[4:7], s37 offen offset:1024 sc1
  buffer_load_dwordx4 v[68:71], v3, s[4:7], s37 offen offset:2048 sc1
  buffer_load_dwordx4 v[72:75], v3, s[4:7], s37 offen offset:3072 sc1
  s_waitcnt vmcnt(7)
  v_mfma_f32_16x16x32_bf16 v[56:59], v[12:15], v[52:55], 0
  v_bitop3_b32 v0, v12, v14, v79 bitop3:0x7e
  s_waitcnt vmcnt(6)
  v_mfma_f32_16x16x32_bf16 v[56:59], v[16:19], v[52:55], v[56:59]
  v_bitop3_b32 v76, v16, v18, v79 bitop3:0x7e
  s_waitcnt vmcnt(5)
  v_mfma_f32_16x16x32_bf16 v[56:59], v[20:23], v[52:55], v[56:59]
  v_bitop3_b32 v77, v20, v22, v79 bitop3:0x7e
  v_or3_b32 v0, v0, v76, v77
  s_waitcnt vmcnt(4)
  v_mfma_f32_16x16x32_bf16 v[56:59], v[24:27], v[52:55], v[56:59]
  v_bitop3_b32 v78, v24, v26, v79 bitop3:0x7e
  v_bitop3_b32 v0, v0, v78, 1 bitop3:0xa8
  v_cmp_ne_u32 vcc, 0, v0
  s_nop 4
  v_permlane32_swap_b32 v56, v58
  v_permlane32_swap_b32 v57, v59
  v_pk_add_f32 v[56:57], v[56:57], v[58:59]
  v_cvt_pk_bf16_f32 v56, v56, v57
  v_min_u32 v56, -2, v56
  s_cbranch_vccz L_loop0_rpok
  buffer_load_dwordx4 v[12:15], v3, s[4:7], s37 offen offset:0 sc1
  buffer_load_dwordx4 v[16:19], v3, s[4:7], s37 offen offset:1024 sc1
  buffer_load_dwordx4 v[20:23], v3, s[4:7], s37 offen offset:2048 sc1
  buffer_load_dwordx4 v[24:27], v3, s[4:7], s37 offen offset:3072 sc1
  s_sub_u32 s29, s29, 1
  s_cbranch_scc0 L_loop0_rp
  s_branch L_end
L_loop0_nored:
  ds_read_b128 v[36:39], v2 offset:30720
  ds_read_b128 v[40:43], v2 offset:31744
  ds_read_b128 v[44:47], v2 offset:32768
  ds_read_b128 v[48:51], v2 offset:33792
  v_mov_b64 v[12:13], 0
  v_mov_b64 v[14:15], 0
  v_mov_b64 v[16:17], 0
  v_mov_b64 v[18:19], 0
  v_mov_b64 v[20:21], 0
  v_mov_b64 v[22:23], 0
  v_mov_b64 v[24:25], 0
  v_mov_b64 v[26:27], 0
  v_mov_b64 v[28:29], 0
  v_mov_b64 v[30:31], 0
  v_mov_b64 v[32:33], 0
  v_mov_b64 v[34:35], 0
  s_add_u32 s18, s18, 262144
  s_add_u32 s19, s19, 262144
  s_add_u32 s93, s18, 262144
  s_add_u32 s3, s42, 1
  s_and_b32 s38, s3, 3
  s_lshl_b32 s38, s38, 15
  s_add_u32 s38, s38, s52
  s_add_u32 s38, s38, 16384
  s_add_u32 s17, s38, 4096
  s_add_u32 s3, s3, 2
  s_and_b32 s21, s3, 3
  s_and_b32 s3, s3, 3
  s_mul_i32 s20, s3, 12288
  s_lshl_b32 s21, s21, 15
  s_add_u32 s20, s20, s16
  s_add_u32 s21, s21, s16
  s_add_u32 s20, s20, 131072
  s_add_u32 s21, s21, 0
  s_add_u32 s21, s21, s52
  s_waitcnt vmcnt(0)
  s_mov_b32 s36, s16
  v_mov_b32 v56, 0
  s_branch L_loop0_next
L_loop0_rr0:
  buffer_load_dwordx4 v[60:63], v4, s[4:7], s38 offen offset:0 sc1
  buffer_load_dwordx4 v[64:67], v4, s[4:7], s38 offen offset:1024 sc1
  buffer_load_dwordx4 v[68:71], v4, s[4:7], s38 offen offset:2048 sc1
  buffer_load_dwordx4 v[72:75], v4, s[4:7], s38 offen offset:3072 sc1
  buffer_load_dwordx4 v[76:79], v4, s[4:7], s17 offen sc1
  s_mov_b32 m0, s62
  s_nop 0
  buffer_load_dwordx4 v3, s[4:7], s19 offen offset:0 sc1 lds
  buffer_load_dwordx4 v3, s[4:7], s19 offen offset:1024 sc1 lds
  s_mov_b32 m0, s94
  s_nop 0
  s_nop 0
  buffer_load_dwordx4 v3, s[4:7], s18 offen offset:3072 sc1 lds
  s_waitcnt vmcnt(7)
  v_cmp_eq_u32 vcc, -1, v60
  s_cbranch_vccz L_loop0_rok0
  s_sub_u32 s29, s29, 1
  s_cbranch_scc0 L_loop0_rr0
  s_branch L_end
L_loop0_rr1:
  buffer_load_dwordx4 v[64:67], v4, s[4:7], s38 offen offset:1024 sc1
  buffer_load_dwordx4 v[68:71], v4, s[4:7], s38 offen offset:2048 sc1
  buffer_load_dwordx4 v[72:75], v4, s[4:7], s38 offen offset:3072 sc1
  buffer_load_dwordx4 v[76:79], v4, s[4:7], s17 offen sc1
  s_mov_b32 m0, s62
  s_nop 0
  buffer_load_dwordx4 v3, s[4:7], s19 offen offset:0 sc1 lds
  buffer_load_dwordx4 v3, s[4:7], s19 offen offset:1024 sc1 lds
  s_mov_b32 m0, s94
  s_nop 0
  s_nop 0
  buffer_load_dwordx4 v3, s[4:7], s18 offen offset:3072 sc1 lds
  s_waitcnt vmcnt(6)
  v_cmp_eq_u32 vcc, -1, v64
  s_cbranch_vccz L_loop0_rok1
  s_sub_u32 s29, s29, 1
  s_cbranch_scc0 L_loop0_rr1
  s_branch L_end
L_loop0_rr2:
  buffer_load_dwordx4 v[68:71], v4, s[4:7], s38 offen offset:2048 sc1
  buffer_load_dwordx4 v[72:75], v4, s[4:7], s38 offen offset:3072 sc1
  buffer_load_dwordx4 v[76:79], v4, s[4:7], s17 offen sc1
  s_mov_b32 m0, s62
  s_nop 0
  buffer_load_dwordx4 v3, s[4:7], s19 offen offset:0 sc1 lds
  buffer_load_dwordx4 v3, s[4:7], s19 offen offset:1024 sc1 lds
  s_mov_b32 m0, s94
  s_nop 0
  s_nop 0
  buffer_load_dwordx4 v3, s[4:7], s18 offen offset:3072 sc1 lds
  s_waitcnt vmcnt(5)
  v_cmp_eq_u32 vcc, -1, v68
  s_cbranch_vccz L_loop0_rok2
  s_sub_u32 s29, s29, 1
  s_cbranch_scc0 L_loop0_rr2
  s_branch L_end
L_loop0_rr3:
  buffer_load_dwordx4 v[72:75], v4, s[4:7], s38 offen offset:3072 sc1
  buffer_load_dwordx4 v[76:79], v4, s[4:7], s17 offen sc1
  s_mov_b32 m0, s62
  s_nop 0
  buffer_load_dwordx4 v3, s[4:7], s19 offen offset:0 sc1 lds
  buffer_load_dwordx4 v3, s[4:7], s19 offen offset:1024 sc1 lds
  s_mov_b32 m0, s94
  s_nop 0
  s_nop 0
  buffer_load_dwordx4 v3, s[4:7], s18 offen offset:3072 sc1 lds
  s_waitcnt vmcnt(4)
  v_cmp_eq_u32 vcc, -1, v72
  s_cbranch_vccz L_loop0_rok3
  s_sub_u32 s29, s29, 1
  s_cbranch_scc0 L_loop0_rr3
  s_branch L_end
L_loop0_rr4:
  buffer_load_dwordx4 v[76:79], v4, s[4:7], s17 offen sc1
  s_mov_b32 m0, s62
  s_nop 0
  buffer_load_dwordx4 v3, s[4:7], s19 offen offset:0 sc1 lds
  buffer_load_dwordx4 v3, s[4:7], s19 offen offset:1024 sc1 lds
  s_mov_b32 m0, s94
  s_nop 0
  s_nop 0
  buffer_load_dwordx4 v3, s[4:7], s18 offen offset:3072 sc1 lds
  s_waitcnt vmcnt(3)
  v_cmp_eq_u32 vcc, -1, v76
  s_cbranch_vccz L_loop0_rok4
  s_sub_u32 s29, s29, 1
  s_cbranch_scc0 L_loop0_rr4
  s_branch L_end
L_loop0_last:
  s_waitcnt vmcnt(0) lgkmcnt(0)
  s_barrier
  s_add_u32 s3, s42, 1
  s_mov_b32 s92, s3
  s_cmp_lt_u32 s42, 63
  s_cbranch_scc1 L_loop0_back
  s_branch L_fin
L_loop1:
  s_add_u32 s18, s49, 8388608
  s_lshl_b32 s3, s40, 13
  s_lshl_b32 s19, s28, 11
  s_add_u32 s19, s19, s3
  s_add_u32 s19, s19, 25165824
  s_lshl_b32 s94, s43, 12
  s_add_u32 s94, s94, 16384
  v_lshlrev_b32 v0, 3, v3
  v_and_b32 v0, 0xf80, v0
  v_add_u32 v10, 16777216, v0
  v_cmp_gt_u32 vcc, 512, v3
  s_nop 1
  v_cndmask_b32 v10, v10, v0, vcc
  s_mov_b32 s92, 62
  s_add_u32 s90, s51, 16384
  s_lshl_b32 s3, s32, 7
  s_add_u32 s3, s3, 819200
  s_cmp_eq_u32 s43, 0
  s_cselect_b32 s48, s48, s3
L_loop1_top:
  s_add_u32 s93, s18, 262144
  s_add_u32 s3, s42, 0
  s_and_b32 s38, s3, 3
  s_lshl_b32 s38, s38, 15
  s_add_u32 s38, s38, s52
  s_add_u32 s38, s38, 16384
  s_add_u32 s17, s38, 4096
  s_and_b32 s3, s3, 3
  s_mul_i32 s3, s3, 12288
  s_add_u32 s15, s3, 135168
  s_lshl_b32 s37, s43, 11
  s_add_u32 s37, s37, s3
  s_add_u32 s37, s37, 131072
  s_add_u32 s3, s42, 2
  s_and_b32 s95, s3, 1
  s_lshl2_add_u32 s95, s95, s63
  s_lshr_b32 s96, s3, 1
  s_min_u32 s96, s96, 31
  s_lshl_b32 s3, s43, 11
  v_add_u32 v11, s3, v3
  s_lshl_b32 s3, s43, 9
  v_lshrrev_b32 v53, 1, v3
  v_and_b32 v0, 56, v53
  v_add_u32 v53, s3, v53
  v_bfe_u32 v52, v3, 7, 2
  v_lshl_add_u32 v0, v52, 7, v0
  v_lshrrev_b32 v52, 9, v3
  v_lshl_add_u32 v0, v52, 6, v0
  v_add_u32 v52, s3, v0
  buffer_load_dwordx4 v[60:63], v4, s[4:7], s37 offen sc1
  buffer_load_dwordx4 v[64:67], v4, s[4:7], s37 offen offset:1024 sc1
  buffer_load_dwordx2 v[76:77], v52, s[4:7], s15 offen sc1
  v_mov_b64 v[12:13], 0
  v_mov_b64 v[14:15], 0
  v_mov_b64 v[16:17], 0
  v_mov_b64 v[18:19], 0
  v_mov_b64 v[20:21], 0
  v_mov_b64 v[22:23], 0
  v_mov_b64 v[24:25], 0
  v_mov_b64 v[26:27], 0
  v_mov_b64 v[28:29], 0
  v_mov_b64 v[30:31], 0
  v_mov_b64 v[32:33], 0
  v_mov_b64 v[34:35], 0
  ds_read_b128 v[36:39], v2 offset:30720
  ds_read_b128 v[40:43], v2 offset:31744
  ds_read_b128 v[44:47], v2 offset:32768
  ds_read_b128 v[48:51], v2 offset:33792
  s_waitcnt lgkmcnt(0)
  buffer_load_dwordx4 v[68:71], v4, s[4:7], s37 offen sc1
  buffer_load_dwordx4 v[72:75], v4, s[4:7], s37 offen offset:1024 sc1
  buffer_load_dwordx2 v[78:79], v52, s[4:7], s15 offen sc1
L_loop1_pl:
  s_waitcnt vmcnt(5)
  ds_write_b128 v11, v[60:63]
  s_waitcnt vmcnt(4)
  ds_write_b128 v11, v[64:67] offset:1024
  s_waitcnt vmcnt(3)
  ds_write_b64 v53, v[76:77] offset:4096
  v_max3_u32 v0, v60, v64, v76
  v_cmp_eq_u32 vcc, -1, v0
  s_cbranch_vccnz L_loop1_plr
L_loop1_plok:
  s_waitcnt lgkmcnt(0)
  s_barrier
  ds_read_b128 v[52:55], v3 offset:0
  ds_read_b128 v[56:59], v3 offset:1024
  buffer_load_dwordx4 v[60:63], v4, s[4:7], s38 offen offset:0 sc1
  buffer_load_dwordx4 v[64:67], v4, s[4:7], s38 offen offset:1024 sc1
  buffer_load_dwordx4 v[68:71], v4, s[4:7], s38 offen offset:2048 sc1
  s_waitcnt lgkmcnt(1)
  v_smfmac_f32_16x16x64_bf16 v[28:31], v[52:55], v[36:43], v1
  ds_read_b128 v[36:39], v2 offset:2048
  v_smfmac_f32_16x16x64_bf16 v[12:15], v[52:55], v[80:87], v1
  ds_read_b128 v[40:43], v2 offset:3072
  v_smfmac_f32_16x16x64_bf16 v[16:19], v[52:55], v[88:95], v1
  buffer_load_dwordx4 v[72:75], v4, s[4:7], s38 offen offset:3072 sc1
  v_smfmac_f32_16x16x64_bf16 v[32:35], v[52:55], v[44:51], v1
  ds_read_b128 v[44:47], v2 offset:4096
  v_smfmac_f32_16x16x64_bf16 v[20:23], v[52:55], v[240:247], v1
  ds_read_b128 v[48:51], v2 offset:5120
  buffer_load_dwordx4 v[76:79], v4, s[4:7], s17 offen sc1
  s_mov_b32 m0, s62
  v_smfmac_f32_16x16x64_bf16 v[24:27], v[52:55], v[248:255], v1
  ds_read_b128 v[52:55], v3 offset:2048
  s_waitcnt lgkmcnt(3)
  v_smfmac_f32_16x16x64_bf16 v[28:31], v[56:59], v[36:43], v1
  ds_read_b128 v[36:39], v2 offset:6144
  v_smfmac_f32_16x16x64_bf16 v[12:15], v[56:59], v[96:103], v1
  ds_read_b128 v[40:43], v2 offset:7168
  v_smfmac_f32_16x16x64_bf16 v[16:19], v[56:59], v[104:111], v1
  s_waitcnt lgkmcnt(3)
  v_smfmac_f32_16x16x64_bf16 v[32:35], v[56:59], v[44:51], v1
  ds_read_b128 v[44:47], v2 offset:8192
  v_smfmac_f32_16x16x64_bf16 v[20:23], v[56:59], a[0:7], v1
  ds_read_b128 v[48:51], v2 offset:9216
  buffer_load_dwordx4 v3, s[4:7], s19 offen offset:0 sc1 lds
  v_smfmac_f32_16x16x64_bf16 v[24:27], v[56:59], a[8:15], v1
  ds_read_b128 v[56:59], v3 offset:3072
  s_waitcnt lgkmcnt(3)
  v_smfmac_f32_16x16x64_bf16 v[28:31], v[52:55], v[36:43], v1
  ds_read_b128 v[36:39], v2 offset:10240
  v_smfmac_f32_16x16x64_bf16 v[12:15], v[52:55], v[112:119], v1
  ds_read_b128 v[40:43], v2 offset:11264
  v_smfmac_f32_16x16x64_bf16 v[16:19], v[52:55], v[120:127], v1
  s_waitcnt lgkmcnt(3)
  v_smfmac_f32_16x16x64_bf16 v[32:35], v[52:55], v[44:51], v1
  ds_read_b128 v[44:47], v2 offset:12288
  v_smfmac_f32_16x16x64_bf16 v[20:23], v[52:55], a[16:23], v1
  ds_read_b128 v[48:51], v2 offset:13312
  buffer_load_dwordx4 v3, s[4:7], s19 offen offset:1024 sc1 lds
  v_smfmac_f32_16x16x64_bf16 v[24:27], v[52:55], a[24:31], v1
  ds_read_b128 v[52:55], v3 offset:4096
  s_waitcnt lgkmcnt(3)
  v_smfmac_f32_16x16x64_bf16 v[28:31], v[56:59], v[36:43], v1
  ds_read_b128 v[36:39], v2 offset:14336
  v_smfmac_f32_16x16x64_bf16 v[12:15], v[56:59], v[128:135], v1
  ds_read_b128 v[40:43], v2 offset:15360
  v_smfmac_f32_16x16x64_bf16 v[16:19], v[56:59], v[136:143], v1
  s_waitcnt lgkmcnt(3)
  v_smfmac_f32_16x16x64_bf16 v[32:35], v[56:59], v[44:51], v1
  ds_read_b128 v[44:47], v2 offset:16384
  v_smfmac_f32_16x16x64_bf16 v[20:23], v[56:59], a[32:39], v1
  ds_read_b128 v[48:51], v2 offset:17408
  v_smfmac_f32_16x16x64_bf16 v[24:27], v[56:59], a[40:47], v1
  s_waitcnt lgkmcnt(2)
  v_smfmac_f32_16x16x64_bf16 v[28:31], v[52:55], v[36:43], v1
  v_smfmac_f32_16x16x64_bf16 v[12:15], v[52:55], v[144:151], v1
  v_smfmac_f32_16x16x64_bf16 v[16:19], v[52:55], v[152:159], v1
  s_waitcnt lgkmcnt(0)
  v_smfmac_f32_16x16x64_bf16 v[32:35], v[52:55], v[44:51], v1
  s_waitcnt vmcnt(6)
  v_smfmac_f32_16x16x64_bf16 v[20:23], v[52:55], a[48:55], v1
  v_cmp_eq_u32 vcc, -1, v60
  v_smfmac_f32_16x16x64_bf16 v[24:27], v[52:55], a[56:63], v1
  s_cbranch_vccnz L_loop1_rr0
L_loop1_rok0:
  v_smfmac_f32_16x16x64_bf16 v[12:15], v[60:63], v[160:167], v1
  s_waitcnt vmcnt(5)
  v_smfmac_f32_16x16x64_bf16 v[16:19], v[60:63], v[168:175], v1
  v_cmp_eq_u32 vcc, -1, v64
  v_smfmac_f32_16x16x64_bf16 v[20:23], v[60:63], a[64:71], v1
  ds_read_b128 v[36:39], v3 offset:16384
  v_smfmac_f32_16x16x64_bf16 v[24:27], v[60:63], a[72:79], v1
  ds_read_b128 v[40:43], v3 offset:20480
  s_cbranch_vccnz L_loop1_rr1
L_loop1_rok1:
  v_smfmac_f32_16x16x64_bf16 v[12:15], v[64:67], v[176:183], v1
  s_waitcnt vmcnt(4)
  v_smfmac_f32_16x16x64_bf16 v[16:19], v[64:67], v[184:191], v1
  v_cmp_eq_u32 vcc, -1, v68
  v_smfmac_f32_16x16x64_bf16 v[20:23], v[64:67], a[80:87], v1
  ds_read_b128 v[44:47], v3 offset:17408
  v_smfmac_f32_16x16x64_bf16 v[24:27], v[64:67], a[88:95], v1
  ds_read_b128 v[48:51], v3 offset:21504
  s_cbranch_vccnz L_loop1_rr2
L_loop1_rok2:
  v_smfmac_f32_16x16x64_bf16 v[12:15], v[68:71], v[192:199], v1
  s_waitcnt vmcnt(3)
  v_smfmac_f32_16x16x64_bf16 v[16:19], v[68:71], v[200:207], v1
  v_cmp_eq_u32 vcc, -1, v72
  v_smfmac_f32_16x16x64_bf16 v[20:23], v[68:71], a[96:103], v1
  ds_read_b128 v[52:55], v3 offset:18432
  v_smfmac_f32_16x16x64_bf16 v[24:27], v[68:71], a[104:111], v1
  ds_read_b128 v[56:59], v3 offset:22528
  s_cbranch_vccnz L_loop1_rr3
L_loop1_rok3:
  v_smfmac_f32_16x16x64_bf16 v[12:15], v[72:75], v[208:215], v1
  s_waitcnt vmcnt(2)
  v_smfmac_f32_16x16x64_bf16 v[16:19], v[72:75], v[216:223], v1
  v_cmp_eq_u32 vcc, -1, v76
  v_smfmac_f32_16x16x64_bf16 v[20:23], v[72:75], a[112:119], v1
  v_smfmac_f32_16x16x64_bf16 v[24:27], v[72:75], a[120:127], v1
  s_cbranch_vccnz L_loop1_rr4
L_loop1_rok4:
  v_smfmac_f32_16x16x64_bf16 v[12:15], v[76:79], v[224:231], v1
  s_movk_i32 m0, 0x1800
  v_smfmac_f32_16x16x64_bf16 v[16:19], v[76:79], v[232:239], v1
  buffer_load_dword v10, s[4:7], s93 offen sc1 lds
  v_smfmac_f32_16x16x64_bf16 v[20:23], v[76:79], a[128:135], v1
  buffer_load_dword v11, off, s[4:7], s95 sc1
  v_smfmac_f32_16x16x64_bf16 v[24:27], v[76:79], a[136:143], v1
  v_smfmac_f32_16x16x64_bf16 v[28:31], v[60:63], a[144:151], v1
  s_nop 0
  v_smfmac_f32_16x16x64_bf16 v[32:35], v[60:63], a[152:159], v1
  s_nop 0
  v_add_f32 v12, v12, v14
  v_add_f32 v13, v13, v15
  v_add_f32 v16, v16, v18
  v_add_f32 v17, v17, v19
  v_add_f32 v20, v20, v22
  v_add_f32 v21, v21, v23
  v_add_f32 v24, v24, v26
  v_add_f32 v25, v25, v27
  v_cvt_pk_bf16_f32 v20, v20, v21
  v_cvt_pk_bf16_f32 v21, v12, v13
  v_cvt_pk_bf16_f32 v22, v24, v25
  v_cvt_pk_bf16_f32 v23, v16, v17
  ds_write2_b64 v5, v[20:21], v[22:23] offset0:0 offset1:64
  v_mov_b32 v12, v20
  v_mov_b32 v13, v22
  v_smfmac_f32_16x16x64_bf16 v[28:31], v[64:67], a[160:167], v1
  v_lshrrev_b32 v0, 1, v3
  v_smfmac_f32_16x16x64_bf16 v[32:35], v[64:67], a[168:175], v1
  buffer_store_dwordx2 v[12:13], v0, s[4:7], s50 offen sc1
  s_waitcnt lgkmcnt(0)
  s_barrier
  ds_read_b64_tr_b16 v[12:13], v6 offset:0
  ds_read_b64_tr_b16 v[14:15], v6 offset:256
  v_smfmac_f32_16x16x64_bf16 v[28:31], v[68:71], a[176:183], v1
  ds_read_b64_tr_b16 v[16:17], v6 offset:1024
  v_smfmac_f32_16x16x64_bf16 v[32:35], v[68:71], a[184:191], v1
  ds_read_b64_tr_b16 v[18:19], v6 offset:1280
  v_mov_b32 v60, s42
  v_smfmac_f32_16x16x64_bf16 v[28:31], v[72:75], a[192:199], v1
  ds_read_b64_tr_b16 v[20:21], v6 offset:2048
  buffer_store_dword v60, off, s[4:7], s48 sc1
  v_smfmac_f32_16x16x64_bf16 v[32:35], v[72:75], a[200:207], v1
  ds_read_b64_tr_b16 v[22:23], v6 offset:2304
  v_smfmac_f32_16x16x64_bf16 v[28:31], v[76:79], a[208:215], v1
  ds_read_b64_tr_b16 v[24:25], v6 offset:3072
  v_smfmac_f32_16x16x64_bf16 v[32:35], v[76:79], a[216:223], v1
  ds_read_b64_tr_b16 v[26:27], v6 offset:3328
  s_waitcnt lgkmcnt(6)
  v_mfma_f32_16x16x32_bf16 v[68:71], v[36:39], v[12:15], 0
  ds_read_b128 v[60:63], v3 offset:19456
  ds_read_b128 v[64:67], v3 offset:23552
  v_mfma_f32_16x16x32_bf16 v[72:75], v[40:43], v[12:15], 0
  s_nop 0
  s_nop 0
  s_waitcnt lgkmcnt(6)
  v_mfma_f32_16x16x32_bf16 v[68:71], v[44:47], v[16:19], v[68:71]
  v_add_f32 v28, v28, v30
  v_add_f32 v29, v29, v31
  v_mfma_f32_16x16x32_bf16 v[72:75], v[48:51], v[16:19], v[72:75]
  v_add_f32 v32, v32, v34
  s_waitcnt lgkmcnt(4)
  v_mfma_f32_16x16x32_bf16 v[68:71], v[52:55], v[20:23], v[68:71]
  v_add_f32 v33, v33, v35
  v_cvt_pk_bf16_f32 v33, v32, v33
  v_mfma_f32_16x16x32_bf16 v[72:75], v[56:59], v[20:23], v[72:75]
  v_cvt_pk_bf16_f32 v32, v28, v29
  s_waitcnt vmcnt(4)
  ds_read_b128 v[52:55], v2 offset:0
  ds_read_b128 v[56:59], v2 offset:1024
  s_waitcnt lgkmcnt(3)
  v_mfma_f32_16x16x32_bf16 v[68:71], v[60:63], v[24:27], v[68:71]
  v_mov_b64 v[44:45], s[24:25]
  s_waitcnt lgkmcnt(2)
  v_mfma_f32_16x16x32_bf16 v[72:75], v[64:67], v[24:27], v[72:75]
  v_mov_b64 v[46:47], s[24:25]
  v_mov_b32 v41, 0
  v_mfma_f32_16x16x32_bf16 v[76:79], v[12:15], v[12:15], 0
  v_mov_b32 v42, 0
  s_nop 0
  v_mfma_f32_16x16x32_bf16 v[76:79], v[16:19], v[16:19], v[76:79]
  s_nop 1
  v_mfma_f32_16x16x32_bf16 v[76:79], v[20:23], v[20:23], v[76:79]
  v_max3_f32 v28, v68, v69, v70
  s_cmp_eq_u32 s42, s92
  v_mfma_f32_16x16x32_bf16 v[76:79], v[24:27], v[24:27], v[76:79]
  v_max3_f32 v28, v28, v71, v72
  v_max3_f32 v28, v28, v73, v74
  s_cbranch_scc1 L_loop1_last
L_loop1_back:
  v_max_f32 v28, v28, v75
  ds_read_b128 v[60:63], v2 offset:18432
  ds_read_b128 v[64:67], v2 offset:19456
  s_nop 1
  v_max3_f32 v28, v28, v76, v77
  v_mov_b32 v29, v28
  s_nop 1
  v_permlane16_swap_b32 v29, v28
  v_max_f32 v28, v28, v29
  v_mov_b32 v29, v28
  s_nop 1
  v_permlane32_swap_b32 v29, v28
  v_max_f32 v28, v28, v29
  v_mul_f32 v28, s46, v28
  v_pk_fma_f32 v[68:69], v[68:69], s[46:47], v[28:29] op_sel_hi:[1,0,0] neg_lo:[0,0,1] neg_hi:[0,0,1]
  v_pk_fma_f32 v[70:71], v[70:71], s[46:47], v[28:29] op_sel_hi:[1,0,0] neg_lo:[0,0,1] neg_hi:[0,0,1]
  v_pk_fma_f32 v[72:73], v[72:73], s[46:47], v[28:29] op_sel_hi:[1,0,0] neg_lo:[0,0,1] neg_hi:[0,0,1]
  v_pk_fma_f32 v[74:75], v[74:75], s[46:47], v[28:29] op_sel_hi:[1,0,0] neg_lo:[0,0,1] neg_hi:[0,0,1]
  v_pk_fma_f32 v[76:77], v[76:77], s[46:47], v[28:29] op_sel_hi:[1,0,0] neg_lo:[0,0,1] neg_hi:[0,0,1]
  v_exp_f32 v68, v68
  v_exp_f32 v69, v69
  v_exp_f32 v70, v70
  v_cvt_pk_bf16_f32 v36, v68, v69
  v_exp_f32 v71, v71
  v_exp_f32 v72, v72
  v_cvt_pk_bf16_f32 v37, v70, v71
  v_exp_f32 v73, v73
  v_exp_f32 v74, v74
  v_cvt_pk_bf16_f32 v38, v72, v73
  v_exp_f32 v75, v75
  v_exp_f32 v76, v76
  v_cvt_pk_bf16_f32 v39, v74, v75
  v_exp_f32 v77, v77
  s_waitcnt lgkmcnt(2)
  v_mfma_f32_16x16x32_bf16 v[20:23], v[44:47], v[36:39], 0
  v_cvt_pk_bf16_f32 v40, v76, v77
  v_cvt_pk_bf16_f32 v43, v76, v77
  v_mfma_f32_16x16x32_bf16 v[12:15], v[52:55], v[36:39], 0
  ds_read_b128 v[68:71], v2 offset:20480
  ds_read_b128 v[72:75], v2 offset:21504
  v_mfma_f32_16x16x32_bf16 v[16:19], v[56:59], v[36:39], 0
  ds_read_b128 v[52:55], v2 offset:22528
  ds_read_b128 v[56:59], v2 offset:23552
  v_mfma_f32_16x16x16_bf16 v[20:23], v[44:45], v[40:41], v[20:23]
  v_add_u32 v0, s14, v7
  v_mov_b64 v[24:25], 0
  v_mfma_f32_16x16x16_bf16 v[12:15], v[32:33], v[40:41], v[12:15]
  v_mov_b64 v[26:27], 0
  v_mov_b64 v[76:77], 0
  v_mfma_f32_16x16x16_bf16 v[16:19], v[32:33], v[42:43], v[16:19]
  v_mov_b64 v[78:79], 0
  s_nop 0
  v_rcp_f32 v30, v20
  s_mov_b32 m0, s94
  s_mov_b64 exec, s[26:27]
  v_pk_mul_f32 v[12:13], v[12:13], v[30:31] op_sel_hi:[1,0]
  v_pk_mul_f32 v[14:15], v[14:15], v[30:31] op_sel_hi:[1,0]
  v_cvt_pk_bf16_f32 v12, v12, v13
  v_pk_mul_f32 v[16:17], v[16:17], v[30:31] op_sel_hi:[1,0]
  v_pk_mul_f32 v[18:19], v[18:19], v[30:31] op_sel_hi:[1,0]
  v_cvt_pk_bf16_f32 v13, v14, v15
  v_cvt_pk_bf16_f32 v14, v16, v17
  v_cvt_pk_bf16_f32 v15, v18, v19
  ds_write_b128 v0, v[12:15]
  s_mov_b64 exec, -1
  ds_read_b128 v[36:39], v2 offset:24576
  ds_read_b128 v[40:43], v2 offset:25600
  v_mov_b64 v[20:21], 0
  v_mov_b64 v[22:23], 0
  v_mov_b64 v[44:45], 0
  v_mov_b64 v[46:47], 0
  v_mov_b64 v[48:49], 0
  v_mov_b64 v[50:51], 0
  buffer_load_dwordx4 v3, s[4:7], s93 offen offset:0 sc1 lds
  buffer_load_dwordx4 v3, s[4:7], s93 offen offset:1024 sc1 lds
  buffer_load_dwordx4 v3, s[4:7], s93 offen offset:2048 sc1 lds
  s_waitcnt lgkmcnt(2)
  s_barrier
  ds_read_b128 v[16:19], v7 offset:0
  ds_read_b128 v[12:15], v7 offset:1024
  ds_read_b128 v[28:31], v2 offset:26624
  ds_read_b128 v[32:35], v2 offset:27648
  s_add_u32 s50, s50, 131072
  s_waitcnt lgkmcnt(3)
  v_smfmac_f32_16x16x64_bf16 v[20:23], v[16:19], v[60:67], v1
  ds_read_b128 v[60:63], v2 offset:28672
  v_smfmac_f32_16x16x64_bf16 v[24:27], v[16:19], v[68:75], v1
  s_waitcnt lgkmcnt(3)
  v_smfmac_f32_16x16x64_bf16 v[20:23], v[12:15], v[52:59], v1
  ds_read_b128 v[64:67], v2 offset:29696
  v_smfmac_f32_16x16x64_bf16 v[24:27], v[12:15], v[36:43], v1
  s_waitcnt lgkmcnt(2)
  v_smfmac_f32_16x16x64_bf16 v[44:47], v[16:19], v[28:35], v1
  s_nop 0
  v_smfmac_f32_16x16x64_bf16 v[48:51], v[16:19], a[224:231], v1
  s_nop 0
  v_smfmac_f32_16x16x64_bf16 v[44:47], v[12:15], a[240:247], v1
  v_add_f32 v20, v20, v22
  v_smfmac_f32_16x16x64_bf16 v[48:51], v[12:15], a[248:255], v1
  v_add_f32 v21, v21, v23
  v_smfmac_f32_16x16x64_bf16 v[76:79], v[16:19], a[232:239], v1
  v_add_f32 v24, v24, v26
  s_waitcnt lgkmcnt(0)
  v_smfmac_f32_16x16x64_bf16 v[76:79], v[12:15], v[60:67], v1
  v_add_f32 v25, v25, v27
  v_cvt_pk_bf16_f32 v20, v20, v21
  v_cvt_pk_bf16_f32 v21, v24, v25
  v_and_or_b32 v20, v20, -2, s45
  buffer_store_dwordx2 v[20:21], v8, s[4:7], s51 offen
  v_pk_add_f32 v[44:45], v[44:45], v[46:47]
  v_pk_add_f32 v[48:49], v[48:49], v[50:51]
  v_cvt_pk_bf16_f32 v44, v44, v45
  v_cvt_pk_bf16_f32 v45, v48, v49
  v_and_or_b32 v44, v44, -2, s45
  buffer_store_dwordx2 v[44:45], v8, s[4:7], s90 offen
  v_pk_add_f32 v[76:77], v[76:77], v[78:79]
  v_cvt_pk_bf16_f32 v76, v76, v77
  v_and_or_b32 v76, v76, -2, s45
  buffer_store_dword v76, v9, s[4:7], s51 offen
  s_waitcnt vmcnt(0)
  s_barrier
  v_readfirstlane_b32 s3, v11
  s_add_u32 s42, s42, 1
  s_xor_b32 s45, s45, 1
  s_cmp_gt_u32 s3, s96
  s_cbranch_scc0 L_loop1_kvw
L_loop1_kvok:
  s_add_u32 s18, s18, 262144
  s_add_u32 s19, s19, 262144
  s_branch L_loop1_top
L_loop1_plr:
  s_waitcnt lgkmcnt(0)
  buffer_load_dwordx4 v[60:63], v4, s[4:7], s37 offen sc1
  buffer_load_dwordx4 v[64:67], v4, s[4:7], s37 offen offset:1024 sc1
  buffer_load_dwordx2 v[76:77], v52, s[4:7], s15 offen sc1
  s_waitcnt vmcnt(5)
  ds_write_b128 v11, v[68:71]
  s_waitcnt vmcnt(4)
  ds_write_b128 v11, v[72:75] offset:1024
  s_waitcnt vmcnt(3)
  ds_write_b64 v53, v[78:79] offset:4096
  v_max3_u32 v0, v68, v72, v78
  v_cmp_eq_u32 vcc, -1, v0
  s_cbranch_vccz L_loop1_plok
  s_waitcnt lgkmcnt(0)
  buffer_load_dwordx4 v[68:71], v4, s[4:7], s37 offen sc1
  buffer_load_dwordx4 v[72:75], v4, s[4:7], s37 offen offset:1024 sc1
  buffer_load_dwordx2 v[78:79], v52, s[4:7], s15 offen sc1
  s_sub_u32 s29, s29, 1
  s_cbranch_scc0 L_loop1_pl
  s_branch L_end
L_loop1_kvw:
  buffer_load_dword v11, off, s[4:7], s95 sc1
  s_waitcnt vmcnt(0)
  v_readfirstlane_b32 s3, v11
  s_nop 0
  s_cmp_gt_u32 s3, s96
  s_cbranch_scc1 L_loop1_kvok
  s_sleep 1
  s_sub_u32 s29, s29, 1
  s_cbranch_scc0 L_loop1_kvw
  s_branch L_end
L_loop1_rr0:
  buffer_load_dwordx4 v[60:63], v4, s[4:7], s38 offen offset:0 sc1
  buffer_load_dwordx4 v[64:67], v4, s[4:7], s38 offen offset:1024 sc1
  buffer_load_dwordx4 v[68:71], v4, s[4:7], s38 offen offset:2048 sc1
  buffer_load_dwordx4 v[72:75], v4, s[4:7], s38 offen offset:3072 sc1
  buffer_load_dwordx4 v[76:79], v4, s[4:7], s17 offen sc1
  s_mov_b32 m0, s62
  s_nop 0
  buffer_load_dwordx4 v3, s[4:7], s19 offen offset:0 sc1 lds
  buffer_load_dwordx4 v3, s[4:7], s19 offen offset:1024 sc1 lds
  s_waitcnt vmcnt(6)
  v_cmp_eq_u32 vcc, -1, v60
  s_cbranch_vccz L_loop1_rok0
  s_sub_u32 s29, s29, 1
  s_cbranch_scc0 L_loop1_rr0
  s_branch L_end
L_loop1_rr1:
  buffer_load_dwordx4 v[64:67], v4, s[4:7], s38 offen offset:1024 sc1
  buffer_load_dwordx4 v[68:71], v4, s[4:7], s38 offen offset:2048 sc1
  buffer_load_dwordx4 v[72:75], v4, s[4:7], s38 offen offset:3072 sc1
  buffer_load_dwordx4 v[76:79], v4, s[4:7], s17 offen sc1
  s_mov_b32 m0, s62
  s_nop 0
  buffer_load_dwordx4 v3, s[4:7], s19 offen offset:0 sc1 lds
  buffer_load_dwordx4 v3, s[4:7], s19 offen offset:1024 sc1 lds
  s_waitcnt vmcnt(5)
  v_cmp_eq_u32 vcc, -1, v64
  s_cbranch_vccz L_loop1_rok1
  s_sub_u32 s29, s29, 1
  s_cbranch_scc0 L_loop1_rr1
  s_branch L_end
L_loop1_rr2:
  buffer_load_dwordx4 v[68:71], v4, s[4:7], s38 offen offset:2048 sc1
  buffer_load_dwordx4 v[72:75], v4, s[4:7], s38 offen offset:3072 sc1
  buffer_load_dwordx4 v[76:79], v4, s[4:7], s17 offen sc1
  s_mov_b32 m0, s62
  s_nop 0
  buffer_load_dwordx4 v3, s[4:7], s19 offen offset:0 sc1 lds
  buffer_load_dwordx4 v3, s[4:7], s19 offen offset:1024 sc1 lds
  s_waitcnt vmcnt(4)
  v_cmp_eq_u32 vcc, -1, v68
  s_cbranch_vccz L_loop1_rok2
  s_sub_u32 s29, s29, 1
  s_cbranch_scc0 L_loop1_rr2
  s_branch L_end
L_loop1_rr3:
  buffer_load_dwordx4 v[72:75], v4, s[4:7], s38 offen offset:3072 sc1
  buffer_load_dwordx4 v[76:79], v4, s[4:7], s17 offen sc1
  s_mov_b32 m0, s62
  s_nop 0
  buffer_load_dwordx4 v3, s[4:7], s19 offen offset:0 sc1 lds
  buffer_load_dwordx4 v3, s[4:7], s19 offen offset:1024 sc1 lds
  s_waitcnt vmcnt(3)
  v_cmp_eq_u32 vcc, -1, v72
  s_cbranch_vccz L_loop1_rok3
  s_sub_u32 s29, s29, 1
  s_cbranch_scc0 L_loop1_rr3
  s_branch L_end
L_loop1_rr4:
  buffer_load_dwordx4 v[76:79], v4, s[4:7], s17 offen sc1
  s_mov_b32 m0, s62
  s_nop 0
  buffer_load_dwordx4 v3, s[4:7], s19 offen offset:0 sc1 lds
  buffer_load_dwordx4 v3, s[4:7], s19 offen offset:1024 sc1 lds
  s_waitcnt vmcnt(2)
  v_cmp_eq_u32 vcc, -1, v76
  s_cbranch_vccz L_loop1_rok4
  s_sub_u32 s29, s29, 1
  s_cbranch_scc0 L_loop1_rr4
  s_branch L_end
L_loop1_last:
  s_waitcnt vmcnt(0) lgkmcnt(0)
  s_barrier
  s_add_u32 s3, s42, 1
  v_mov_b32 v0, s3
  s_mov_b64 exec, 1
  buffer_store_dword v0, off, s[4:7], s48 sc1
  s_mov_b64 exec, -1
  s_mov_b32 s92, s3
  s_cmp_lt_u32 s42, 63
  s_cbranch_scc1 L_loop1_back
  s_branch L_fin
L_loop2:
  s_lshl_b32 s16, s44, 7
  s_lshl_b32 s3, s40, 7
  s_add_u32 s3, s3, 589824
  s_cmp_ge_u32 s44, 40
  s_cselect_b32 s16, s3, s16
  s_add_u32 s18, s49, 8388608
  s_lshl_b32 s3, s40, 13
  s_lshl_b32 s19, s28, 11
  s_add_u32 s19, s19, s3
  s_add_u32 s19, s19, 25165824
  s_lshl_b32 s94, s43, 12
  s_add_u32 s94, s94, 16384
  s_mov_b32 s92, 62
  s_add_u32 s90, s51, 16384
  s_add_u32 s93, s18, 262144
  s_add_u32 s3, s42, 0
  s_and_b32 s38, s3, 3
  s_lshl_b32 s38, s38, 15
  s_add_u32 s38, s38, s52
  s_add_u32 s38, s38, 0
  s_add_u32 s17, s38, 4096
  s_add_u32 s3, s3, 2
  s_and_b32 s21, s3, 3
  s_and_b32 s3, s3, 3
  s_mul_i32 s20, s3, 12288
  s_lshl_b32 s21, s21, 15
  s_add_u32 s20, s20, s16
  s_add_u32 s21, s21, s16
  s_add_u32 s20, s20, 137216
  s_add_u32 s21, s21, 16384
  s_add_u32 s21, s21, s52
L_loop2_top:
  s_barrier
  ds_read_b128 v[52:55], v3 offset:0
  ds_read_b128 v[56:59], v3 offset:1024
  buffer_load_dwordx4 v[60:63], v4, s[4:7], s38 offen offset:0 sc1
  buffer_load_dwordx4 v[64:67], v4, s[4:7], s38 offen offset:1024 sc1
  buffer_load_dwordx4 v[68:71], v4, s[4:7], s38 offen offset:2048 sc1
  s_waitcnt lgkmcnt(1)
  v_smfmac_f32_16x16x64_bf16 v[28:31], v[52:55], v[36:43], v1
  ds_read_b128 v[36:39], v2 offset:2048
  v_smfmac_f32_16x16x64_bf16 v[12:15], v[52:55], v[80:87], v1
  ds_read_b128 v[40:43], v2 offset:3072
  v_smfmac_f32_16x16x64_bf16 v[16:19], v[52:55], v[88:95], v1
  buffer_load_dwordx4 v[72:75], v4, s[4:7], s38 offen offset:3072 sc1
  v_smfmac_f32_16x16x64_bf16 v[32:35], v[52:55], v[44:51], v1
  ds_read_b128 v[44:47], v2 offset:4096
  v_smfmac_f32_16x16x64_bf16 v[20:23], v[52:55], v[240:247], v1
  ds_read_b128 v[48:51], v2 offset:5120
  buffer_load_dwordx4 v[76:79], v4, s[4:7], s17 offen sc1
  s_mov_b32 m0, s62
  v_smfmac_f32_16x16x64_bf16 v[24:27], v[52:55], v[248:255], v1
  ds_read_b128 v[52:55], v3 offset:2048
  s_waitcnt lgkmcnt(3)
  v_smfmac_f32_16x16x64_bf16 v[28:31], v[56:59], v[36:43], v1
  ds_read_b128 v[36:39], v2 offset:6144
  v_smfmac_f32_16x16x64_bf16 v[12:15], v[56:59], v[96:103], v1
  ds_read_b128 v[40:43], v2 offset:7168
  v_smfmac_f32_16x16x64_bf16 v[16:19], v[56:59], v[104:111], v1
  s_waitcnt lgkmcnt(3)
  v_smfmac_f32_16x16x64_bf16 v[32:35], v[56:59], v[44:51], v1
  ds_read_b128 v[44:47], v2 offset:8192
  v_smfmac_f32_16x16x64_bf16 v[20:23], v[56:59], a[0:7], v1
  ds_read_b128 v[48:51], v2 offset:9216
  buffer_load_dwordx4 v3, s[4:7], s19 offen offset:0 sc1 lds
  v_smfmac_f32_16x16x64_bf16 v[24:27], v[56:59], a[8:15], v1
  ds_read_b128 v[56:59], v3 offset:3072
  s_waitcnt lgkmcnt(3)
  v_smfmac_f32_16x16x64_bf16 v[28:31], v[52:55], v[36:43], v1
  ds_read_b128 v[36:39], v2 offset:10240
  v_smfmac_f32_16x16x64_bf16 v[12:15], v[52:55], v[112:119], v1
  ds_read_b128 v[40:43], v2 offset:11264
  v_smfmac_f32_16x16x64_bf16 v[16:19], v[52:55], v[120:127], v1
  s_waitcnt lgkmcnt(3)
  v_smfmac_f32_16x16x64_bf16 v[32:35], v[52:55], v[44:51], v1
  ds_read_b128 v[44:47], v2 offset:12288
  v_smfmac_f32_16x16x64_bf16 v[20:23], v[52:55], a[16:23], v1
  ds_read_b128 v[48:51], v2 offset:13312
  buffer_load_dwordx4 v3, s[4:7], s19 offen offset:1024 sc1 lds
  s_mov_b32 m0, s94
  s_nop 0
  v_smfmac_f32_16x16x64_bf16 v[24:27], v[52:55], a[24:31], v1
  ds_read_b128 v[52:55], v3 offset:4096
  s_waitcnt lgkmcnt(3)
  v_smfmac_f32_16x16x64_bf16 v[28:31], v[56:59], v[36:43], v1
  ds_read_b128 v[36:39], v2 offset:14336
  v_smfmac_f32_16x16x64_bf16 v[12:15], v[56:59], v[128:135], v1
  ds_read_b128 v[40:43], v2 offset:15360
  v_smfmac_f32_16x16x64_bf16 v[16:19], v[56:59], v[136:143], v1
  s_waitcnt lgkmcnt(3)
  v_smfmac_f32_16x16x64_bf16 v[32:35], v[56:59], v[44:51], v1
  ds_read_b128 v[44:47], v2 offset:16384
  v_smfmac_f32_16x16x64_bf16 v[20:23], v[56:59], a[32:39], v1
  ds_read_b128 v[48:51], v2 offset:17408
  buffer_load_dwordx4 v3, s[4:7], s18 offen offset:3072 sc1 lds
  v_smfmac_f32_16x16x64_bf16 v[24:27], v[56:59], a[40:47], v1
  s_waitcnt lgkmcnt(2)
  v_smfmac_f32_16x16x64_bf16 v[28:31], v[52:55], v[36:43], v1
  v_smfmac_f32_16x16x64_bf16 v[12:15], v[52:55], v[144:151], v1
  v_smfmac_f32_16x16x64_bf16 v[16:19], v[52:55], v[152:159], v1
  s_waitcnt lgkmcnt(0)
  v_smfmac_f32_16x16x64_bf16 v[32:35], v[52:55], v[44:51], v1
  s_waitcnt vmcnt(7)
  v_smfmac_f32_16x16x64_bf16 v[20:23], v[52:55], a[48:55], v1
  v_cmp_eq_u32 vcc, -1, v60
  v_smfmac_f32_16x16x64_bf16 v[24:27], v[52:55], a[56:63], v1
  s_cbranch_vccnz L_loop2_rr0
L_loop2_rok0:
  v_smfmac_f32_16x16x64_bf16 v[12:15], v[60:63], v[160:167], v1
  s_waitcnt vmcnt(6)
  v_smfmac_f32_16x16x64_bf16 v[16:19], v[60:63], v[168:175], v1
  v_cmp_eq_u32 vcc, -1, v64
  v_smfmac_f32_16x16x64_bf16 v[20:23], v[60:63], a[64:71], v1
  ds_read_b128 v[36:39], v3 offset:16384
  v_smfmac_f32_16x16x64_bf16 v[24:27], v[60:63], a[72:79], v1
  ds_read_b128 v[40:43], v3 offset:20480
  s_cbranch_vccnz L_loop2_rr1
L_loop2_rok1:
  v_smfmac_f32_16x16x64_bf16 v[12:15], v[64:67], v[176:183], v1
  s_waitcnt vmcnt(5)
  v_smfmac_f32_16x16x64_bf16 v[16:19], v[64:67], v[184:191], v1
  v_cmp_eq_u32 vcc, -1, v68
  v_smfmac_f32_16x16x64_bf16 v[20:23], v[64:67], a[80:87], v1
  ds_read_b128 v[44:47], v3 offset:17408
  v_smfmac_f32_16x16x64_bf16 v[24:27], v[64:67], a[88:95], v1
  ds_read_b128 v[48:51], v3 offset:21504
  s_cbranch_vccnz L_loop2_rr2
L_loop2_rok2:
  v_smfmac_f32_16x16x64_bf16 v[12:15], v[68:71], v[192:199], v1
  s_waitcnt vmcnt(4)
  v_smfmac_f32_16x16x64_bf16 v[16:19], v[68:71], v[200:207], v1
  v_cmp_eq_u32 vcc, -1, v72
  v_smfmac_f32_16x16x64_bf16 v[20:23], v[68:71], a[96:103], v1
  ds_read_b128 v[52:55], v3 offset:18432
  v_smfmac_f32_16x16x64_bf16 v[24:27], v[68:71], a[104:111], v1
  ds_read_b128 v[56:59], v3 offset:22528
  s_cbranch_vccnz L_loop2_rr3
L_loop2_rok3:
  v_smfmac_f32_16x16x64_bf16 v[12:15], v[72:75], v[208:215], v1
  s_waitcnt vmcnt(3)
  v_smfmac_f32_16x16x64_bf16 v[16:19], v[72:75], v[216:223], v1
  v_cmp_eq_u32 vcc, -1, v76
  v_smfmac_f32_16x16x64_bf16 v[20:23], v[72:75], a[112:119], v1
  v_smfmac_f32_16x16x64_bf16 v[24:27], v[72:75], a[120:127], v1
  s_cbranch_vccnz L_loop2_rr4
L_loop2_rok4:
  v_smfmac_f32_16x16x64_bf16 v[12:15], v[76:79], v[224:231], v1
  v_mov_b32 v11, -1
  v_smfmac_f32_16x16x64_bf16 v[16:19], v[76:79], v[232:239], v1
  v_smfmac_f32_16x16x64_bf16 v[20:23], v[76:79], a[128:135], v1
  v_smfmac_f32_16x16x64_bf16 v[24:27], v[76:79], a[136:143], v1
  v_smfmac_f32_16x16x64_bf16 v[28:31], v[60:63], a[144:151], v1
  s_nop 0
  v_smfmac_f32_16x16x64_bf16 v[32:35], v[60:63], a[152:159], v1
  s_nop 0
  v_add_f32 v12, v12, v14
  v_add_f32 v13, v13, v15
  v_add_f32 v16, v16, v18
  v_add_f32 v17, v17, v19
  v_add_f32 v20, v20, v22
  v_add_f32 v21, v21, v23
  v_add_f32 v24, v24, v26
  v_add_f32 v25, v25, v27
  v_cvt_pk_bf16_f32 v20, v20, v21
  v_cvt_pk_bf16_f32 v21, v12, v13
  v_cvt_pk_bf16_f32 v22, v24, v25
  v_cvt_pk_bf16_f32 v23, v16, v17
  ds_write2_b64 v5, v[20:21], v[22:23] offset0:0 offset1:64
  v_smfmac_f32_16x16x64_bf16 v[28:31], v[64:67], a[160:167], v1
  v_lshrrev_b32 v0, 1, v3
  v_smfmac_f32_16x16x64_bf16 v[32:35], v[64:67], a[168:175], v1
  s_waitcnt vmcnt(0)
  s_waitcnt lgkmcnt(0)
  s_barrier
  ds_read_b64_tr_b16 v[12:13], v6 offset:0
  ds_read_b64_tr_b16 v[14:15], v6 offset:256
  v_smfmac_f32_16x16x64_bf16 v[28:31], v[68:71], a[176:183], v1
  ds_read_b64_tr_b16 v[16:17], v6 offset:1024
  v_smfmac_f32_16x16x64_bf16 v[32:35], v[68:71], a[184:191], v1
  ds_read_b64_tr_b16 v[18:19], v6 offset:1280
  buffer_store_dword v11, v10, s[4:7], s20 offen
  v_smfmac_f32_16x16x64_bf16 v[28:31], v[72:75], a[192:199], v1
  ds_read_b64_tr_b16 v[20:21], v6 offset:2048
  buffer_store_dword v11, v10, s[4:7], s21 offen sc1
  v_smfmac_f32_16x16x64_bf16 v[32:35], v[72:75], a[200:207], v1
  ds_read_b64_tr_b16 v[22:23], v6 offset:2304
  v_smfmac_f32_16x16x64_bf16 v[28:31], v[76:79], a[208:215], v1
  ds_read_b64_tr_b16 v[24:25], v6 offset:3072
  v_smfmac_f32_16x16x64_bf16 v[32:35], v[76:79], a[216:223], v1
  ds_read_b64_tr_b16 v[26:27], v6 offset:3328
  s_waitcnt lgkmcnt(6)
  v_mfma_f32_16x16x32_bf16 v[68:71], v[36:39], v[12:15], 0
  ds_read_b128 v[60:63], v3 offset:19456
  ds_read_b128 v[64:67], v3 offset:23552
  v_mfma_f32_16x16x32_bf16 v[72:75], v[40:43], v[12:15], 0
  s_nop 0
  s_nop 0
  s_waitcnt lgkmcnt(6)
  v_mfma_f32_16x16x32_bf16 v[68:71], v[44:47], v[16:19], v[68:71]
  v_add_f32 v28, v28, v30
  v_add_f32 v29, v29, v31
  v_mfma_f32_16x16x32_bf16 v[72:75], v[48:51], v[16:19], v[72:75]
  v_add_f32 v32, v32, v34
  s_waitcnt lgkmcnt(4)
  v_mfma_f32_16x16x32_bf16 v[68:71], v[52:55], v[20:23], v[68:71]
  v_add_f32 v33, v33, v35
  v_cvt_pk_bf16_f32 v33, v32, v33
  v_mfma_f32_16x16x32_bf16 v[72:75], v[56:59], v[20:23], v[72:75]
  v_cvt_pk_bf16_f32 v32, v28, v29
  ds_read_b128 v[52:55], v2 offset:0
  ds_read_b128 v[56:59], v2 offset:1024
  s_waitcnt lgkmcnt(3)
  v_mfma_f32_16x16x32_bf16 v[68:71], v[60:63], v[24:27], v[68:71]
  v_mov_b64 v[44:45], s[24:25]
  s_waitcnt lgkmcnt(2)
  v_mfma_f32_16x16x32_bf16 v[72:75], v[64:67], v[24:27], v[72:75]
  v_mov_b64 v[46:47], s[24:25]
  v_mov_b32 v41, 0
  v_mfma_f32_16x16x32_bf16 v[76:79], v[12:15], v[12:15], 0
  v_mov_b32 v42, 0
  s_nop 0
  v_mfma_f32_16x16x32_bf16 v[76:79], v[16:19], v[16:19], v[76:79]
  buffer_store_dwordx2 v[32:33], v0, s[4:7], s50 offen sc1
  s_nop 0
  v_mfma_f32_16x16x32_bf16 v[76:79], v[20:23], v[20:23], v[76:79]
  v_max3_f32 v28, v68, v69, v70
  s_cmp_eq_u32 s42, s92
  v_mfma_f32_16x16x32_bf16 v[76:79], v[24:27], v[24:27], v[76:79]
  v_max3_f32 v28, v28, v71, v72
  v_max3_f32 v28, v28, v73, v74
  s_cbranch_scc1 L_loop2_last
L_loop2_back:
  v_max_f32 v28, v28, v75
  ds_read_b128 v[60:63], v2 offset:18432
  ds_read_b128 v[64:67], v2 offset:19456
  s_nop 1
  v_max3_f32 v28, v28, v76, v77
  v_mov_b32 v29, v28
  s_nop 1
  v_permlane16_swap_b32 v29, v28
  v_max_f32 v28, v28, v29
  v_mov_b32 v29, v28
  s_nop 1
  v_permlane32_swap_b32 v29, v28
  v_max_f32 v28, v28, v29
  v_mul_f32 v28, s46, v28
  v_pk_fma_f32 v[68:69], v[68:69], s[46:47], v[28:29] op_sel_hi:[1,0,0] neg_lo:[0,0,1] neg_hi:[0,0,1]
  v_pk_fma_f32 v[70:71], v[70:71], s[46:47], v[28:29] op_sel_hi:[1,0,0] neg_lo:[0,0,1] neg_hi:[0,0,1]
  v_pk_fma_f32 v[72:73], v[72:73], s[46:47], v[28:29] op_sel_hi:[1,0,0] neg_lo:[0,0,1] neg_hi:[0,0,1]
  v_pk_fma_f32 v[74:75], v[74:75], s[46:47], v[28:29] op_sel_hi:[1,0,0] neg_lo:[0,0,1] neg_hi:[0,0,1]
  v_pk_fma_f32 v[76:77], v[76:77], s[46:47], v[28:29] op_sel_hi:[1,0,0] neg_lo:[0,0,1] neg_hi:[0,0,1]
  v_exp_f32 v68, v68
  v_exp_f32 v69, v69
  v_exp_f32 v70, v70
  v_cvt_pk_bf16_f32 v36, v68, v69
  v_exp_f32 v71, v71
  v_exp_f32 v72, v72
  v_cvt_pk_bf16_f32 v37, v70, v71
  v_exp_f32 v73, v73
  v_exp_f32 v74, v74
  v_cvt_pk_bf16_f32 v38, v72, v73
  v_exp_f32 v75, v75
  v_exp_f32 v76, v76
  v_cvt_pk_bf16_f32 v39, v74, v75
  v_exp_f32 v77, v77
  s_waitcnt lgkmcnt(2)
  v_mfma_f32_16x16x32_bf16 v[20:23], v[44:47], v[36:39], 0
  v_cvt_pk_bf16_f32 v40, v76, v77
  v_cvt_pk_bf16_f32 v43, v76, v77
  v_mfma_f32_16x16x32_bf16 v[12:15], v[52:55], v[36:39], 0
  ds_read_b128 v[68:71], v2 offset:20480
  ds_read_b128 v[72:75], v2 offset:21504
  v_mfma_f32_16x16x32_bf16 v[16:19], v[56:59], v[36:39], 0
  ds_read_b128 v[52:55], v2 offset:22528
  ds_read_b128 v[56:59], v2 offset:23552
  v_mfma_f32_16x16x16_bf16 v[20:23], v[44:45], v[40:41], v[20:23]
  v_add_u32 v0, s14, v7
  v_mov_b64 v[24:25], 0
  v_mfma_f32_16x16x16_bf16 v[12:15], v[32:33], v[40:41], v[12:15]
  v_mov_b64 v[26:27], 0
  v_mov_b64 v[76:77], 0
  v_mfma_f32_16x16x16_bf16 v[16:19], v[32:33], v[42:43], v[16:19]
  v_mov_b64 v[78:79], 0
  s_nop 0
  v_rcp_f32 v30, v20
  s_nop 0
  s_mov_b64 exec, s[26:27]
  v_pk_mul_f32 v[12:13], v[12:13], v[30:31] op_sel_hi:[1,0]
  v_pk_mul_f32 v[14:15], v[14:15], v[30:31] op_sel_hi:[1,0]
  v_cvt_pk_bf16_f32 v12, v12, v13
  v_pk_mul_f32 v[16:17], v[16:17], v[30:31] op_sel_hi:[1,0]
  v_pk_mul_f32 v[18:19], v[18:19], v[30:31] op_sel_hi:[1,0]
  v_cvt_pk_bf16_f32 v13, v14, v15
  v_cvt_pk_bf16_f32 v14, v16, v17
  v_cvt_pk_bf16_f32 v15, v18, v19
  ds_write_b128 v0, v[12:15]
  s_mov_b64 exec, -1
  ds_read_b128 v[36:39], v2 offset:24576
  ds_read_b128 v[40:43], v2 offset:25600
  v_mov_b64 v[20:21], 0
  v_mov_b64 v[22:23], 0
  v_mov_b64 v[44:45], 0
  v_mov_b64 v[46:47], 0
  v_mov_b64 v[48:49], 0
  v_mov_b64 v[50:51], 0
  s_waitcnt lgkmcnt(2)
  s_barrier
  ds_read_b128 v[16:19], v7 offset:0
  ds_read_b128 v[12:15], v7 offset:1024
  ds_read_b128 v[28:31], v2 offset:26624
  ds_read_b128 v[32:35], v2 offset:27648
  s_add_u32 s50, s50, 131072
  s_cmp_ge_u32 s44, 40
  s_waitcnt lgkmcnt(3)
  v_smfmac_f32_16x16x64_bf16 v[20:23], v[16:19], v[60:67], v1
  ds_read_b128 v[60:63], v2 offset:28672
  v_smfmac_f32_16x16x64_bf16 v[24:27], v[16:19], v[68:75], v1
  s_waitcnt lgkmcnt(3)
  v_smfmac_f32_16x16x64_bf16 v[20:23], v[12:15], v[52:59], v1
  ds_read_b128 v[64:67], v2 offset:29696
  v_smfmac_f32_16x16x64_bf16 v[24:27], v[12:15], v[36:43], v1
  s_waitcnt lgkmcnt(2)
  v_smfmac_f32_16x16x64_bf16 v[44:47], v[16:19], v[28:35], v1
  s_nop 0
  v_smfmac_f32_16x16x64_bf16 v[48:51], v[16:19], a[224:231], v1
  s_nop 0
  v_smfmac_f32_16x16x64_bf16 v[44:47], v[12:15], a[240:247], v1
  v_add_f32 v20, v20, v22
  v_smfmac_f32_16x16x64_bf16 v[48:51], v[12:15], a[248:255], v1
  v_add_f32 v21, v21, v23
  v_smfmac_f32_16x16x64_bf16 v[76:79], v[16:19], a[232:239], v1
  v_add_f32 v24, v24, v26
  s_waitcnt lgkmcnt(0)
  v_smfmac_f32_16x16x64_bf16 v[76:79], v[12:15], v[60:67], v1
  v_add_f32 v25, v25, v27
  v_cvt_pk_bf16_f32 v20, v20, v21
  v_cvt_pk_bf16_f32 v21, v24, v25
  v_and_or_b32 v20, v20, -2, s45
  buffer_store_dwordx2 v[20:21], v8, s[4:7], s51 offen
  v_pk_add_f32 v[44:45], v[44:45], v[46:47]
  v_pk_add_f32 v[48:49], v[48:49], v[50:51]
  v_cvt_pk_bf16_f32 v44, v44, v45
  v_cvt_pk_bf16_f32 v45, v48, v49
  v_and_or_b32 v44, v44, -2, s45
  buffer_store_dwordx2 v[44:45], v8, s[4:7], s90 offen
  v_pk_add_f32 v[76:77], v[76:77], v[78:79]
  v_cvt_pk_bf16_f32 v76, v76, v77
  v_and_or_b32 v76, v76, -2, s45
  buffer_store_dword v76, v9, s[4:7], s51 offen
  s_cbranch_scc1 L_loop2_nored
  v_and_b32 v0, 16, v3
  v_mov_b32 v56, 0x3f80
  v_lshlrev_b32 v0, v0, v56
  v_cndmask_b32 v52, 0, v0, s[54:55]
  v_cndmask_b32 v53, 0, v0, s[56:57]
  v_cndmask_b32 v54, 0, v0, s[58:59]
  v_cndmask_b32 v55, 0, v0, s[60:61]
  v_mov_b32 v79, s45
  v_mov_b32 v28, 0
  v_mov_b32 v29, 0
  v_mov_b32 v30, 0
  v_mov_b32 v31, 0
  v_mov_b32 v32, 0
  v_mov_b32 v33, 0
  v_mov_b32 v34, 0
  v_mov_b32 v35, 0
  s_lshl_b32 s37, s44, 12
  s_add_u32 s37, s37, s51
  s_lshl_b32 s39, s44, 7
  s_add_u32 s53, s42, 1
  s_and_b32 s3, s53, 3
  s_lshl1_add_u32 s3, s3, 1
  s_mul_i32 s35, s3, 6144
  s_add_u32 s35, s35, s39
  s_add_u32 s35, s35, 131072
  s_and_b32 s3, s53, 3
  s_lshl1_add_u32 s3, s3, 1
  s_lshl_b32 s36, s3, 14
  s_add_u32 s36, s36, s39
  s_add_u32 s36, s36, s52
  s_add_u32 s36, s36, 0
  s_add_u32 s18, s18, 262144
  s_add_u32 s19, s19, 262144
  s_add_u32 s93, s18, 262144
  s_add_u32 s3, s42, 1
  s_and_b32 s38, s3, 3
  s_lshl_b32 s38, s38, 15
  s_add_u32 s38, s38, s52
  s_add_u32 s38, s38, 0
  s_add_u32 s17, s38, 4096
  s_add_u32 s3, s3, 2
  s_and_b32 s21, s3, 3
  s_and_b32 s3, s3, 3
  s_mul_i32 s20, s3, 12288
  s_lshl_b32 s21, s21, 15
  s_add_u32 s20, s20, s16
  s_add_u32 s21, s21, s16
  s_add_u32 s20, s20, 137216
  s_add_u32 s21, s21, 16384
  s_add_u32 s21, s21, s52
  buffer_load_dwordx4 v[60:63], v3, s[4:7], s37 offen offset:0 sc1
  buffer_load_dwordx4 v[64:67], v3, s[4:7], s37 offen offset:1024 sc1
  buffer_load_dwordx4 v[68:71], v3, s[4:7], s37 offen offset:2048 sc1
  buffer_load_dwordx4 v[72:75], v3, s[4:7], s37 offen offset:3072 sc1
  ds_read_b128 v[36:39], v2 offset:30720
  ds_read_b128 v[40:43], v2 offset:31744
  ds_read_b128 v[44:47], v2 offset:32768
  ds_read_b128 v[48:51], v2 offset:33792
  s_waitcnt lgkmcnt(0)
  buffer_load_dwordx4 v[12:15], v3, s[4:7], s37 offen offset:0 sc1
  buffer_load_dwordx4 v[16:19], v3, s[4:7], s37 offen offset:1024 sc1
  buffer_load_dwordx4 v[20:23], v3, s[4:7], s37 offen offset:2048 sc1
  buffer_load_dwordx4 v[24:27], v3, s[4:7], s37 offen offset:3072 sc1
L_loop2_rp:
  s_waitcnt vmcnt(7)
  v_mfma_f32_16x16x32_bf16 v[56:59], v[60:63], v[52:55], 0
  v_bitop3_b32 v0, v60, v62, v79 bitop3:0x7e
  s_waitcnt vmcnt(6)
  v_mfma_f32_16x16x32_bf16 v[56:59], v[64:67], v[52:55], v[56:59]
  v_bitop3_b32 v76, v64, v66, v79 bitop3:0x7e
  s_waitcnt vmcnt(5)
  v_mfma_f32_16x16x32_bf16 v[56:59], v[68:71], v[52:55], v[56:59]
  v_bitop3_b32 v77, v68, v70, v79 bitop3:0x7e
  v_or3_b32 v0, v0, v76, v77
  s_waitcnt vmcnt(4)
  v_mfma_f32_16x16x32_bf16 v[56:59], v[72:75], v[52:55], v[56:59]
  v_bitop3_b32 v78, v72, v74, v79 bitop3:0x7e
  v_bitop3_b32 v0, v0, v78, 1 bitop3:0xa8
  v_cmp_ne_u32 vcc, 0, v0
  s_nop 4
  v_permlane32_swap_b32 v56, v58
  v_permlane32_swap_b32 v57, v59
  v_pk_add_f32 v[56:57], v[56:57], v[58:59]
  v_cvt_pk_bf16_f32 v56, v56, v57
  v_min_u32 v56, -2, v56
  s_cbranch_vccnz L_loop2_rpr
L_loop2_rpok:
  buffer_store_dword v56, v10, s[4:7], s35 offen
  buffer_store_dword v56, v10, s[4:7], s36 offen sc1
L_loop2_next:
  s_barrier
  s_waitcnt vmcnt(2)
  v_mov_b64 v[12:13], 0
  v_mov_b64 v[14:15], 0
  v_mov_b64 v[16:17], 0
  v_mov_b64 v[18:19], 0
  v_mov_b64 v[20:21], 0
  v_mov_b64 v[22:23], 0
  v_mov_b64 v[24:25], 0
  v_mov_b64 v[26:27], 0
  s_add_u32 s42, s42, 1
  s_xor_b32 s45, s45, 1
  s_waitcnt lgkmcnt(0)
  s_branch L_loop2_top
L_loop2_rpr:
  buffer_load_dwordx4 v[60:63], v3, s[4:7], s37 offen offset:0 sc1
  buffer_load_dwordx4 v[64:67], v3, s[4:7], s37 offen offset:1024 sc1
  buffer_load_dwordx4 v[68:71], v3, s[4:7], s37 offen offset:2048 sc1
  buffer_load_dwordx4 v[72:75], v3, s[4:7], s37 offen offset:3072 sc1
  s_waitcnt vmcnt(7)
  v_mfma_f32_16x16x32_bf16 v[56:59], v[12:15], v[52:55], 0
  v_bitop3_b32 v0, v12, v14, v79 bitop3:0x7e
  s_waitcnt vmcnt(6)
  v_mfma_f32_16x16x32_bf16 v[56:59], v[16:19], v[52:55], v[56:59]
  v_bitop3_b32 v76, v16, v18, v79 bitop3:0x7e
  s_waitcnt vmcnt(5)
  v_mfma_f32_16x16x32_bf16 v[56:59], v[20:23], v[52:55], v[56:59]
  v_bitop3_b32 v77, v20, v22, v79 bitop3:0x7e
  v_or3_b32 v0, v0, v76, v77
  s_waitcnt vmcnt(4)
  v_mfma_f32_16x16x32_bf16 v[56:59], v[24:27], v[52:55], v[56:59]
  v_bitop3_b32 v78, v24, v26, v79 bitop3:0x7e
  v_bitop3_b32 v0, v0, v78, 1 bitop3:0xa8
  v_cmp_ne_u32 vcc, 0, v0
  s_nop 4
  v_permlane32_swap_b32 v56, v58
  v_permlane32_swap_b32 v57, v59
  v_pk_add_f32 v[56:57], v[56:57], v[58:59]
  v_cvt_pk_bf16_f32 v56, v56, v57
  v_min_u32 v56, -2, v56
  s_cbranch_vccz L_loop2_rpok
  buffer_load_dwordx4 v[12:15], v3, s[4:7], s37 offen offset:0 sc1
  buffer_load_dwordx4 v[16:19], v3, s[4:7], s37 offen offset:1024 sc1
  buffer_load_dwordx4 v[20:23], v3, s[4:7], s37 offen offset:2048 sc1
  buffer_load_dwordx4 v[24:27], v3, s[4:7], s37 offen offset:3072 sc1
  s_sub_u32 s29, s29, 1
  s_cbranch_scc0 L_loop2_rp
  s_branch L_end
L_loop2_nored:
  ds_read_b128 v[36:39], v2 offset:30720
  ds_read_b128 v[40:43], v2 offset:31744
  ds_read_b128 v[44:47], v2 offset:32768
  ds_read_b128 v[48:51], v2 offset:33792
  v_mov_b64 v[12:13], 0
  v_mov_b64 v[14:15], 0
  v_mov_b64 v[16:17], 0
  v_mov_b64 v[18:19], 0
  v_mov_b64 v[20:21], 0
  v_mov_b64 v[22:23], 0
  v_mov_b64 v[24:25], 0
  v_mov_b64 v[26:27], 0
  v_mov_b64 v[28:29], 0
  v_mov_b64 v[30:31], 0
  v_mov_b64 v[32:33], 0
  v_mov_b64 v[34:35], 0
  s_add_u32 s18, s18, 262144
  s_add_u32 s19, s19, 262144
  s_add_u32 s93, s18, 262144
  s_add_u32 s3, s42, 1
  s_and_b32 s38, s3, 3
  s_lshl_b32 s38, s38, 15
  s_add_u32 s38, s38, s52
  s_add_u32 s38, s38, 0
  s_add_u32 s17, s38, 4096
  s_add_u32 s3, s3, 2
  s_and_b32 s21, s3, 3
  s_and_b32 s3, s3, 3
  s_mul_i32 s20, s3, 12288
  s_lshl_b32 s21, s21, 15
  s_add_u32 s20, s20, s16
  s_add_u32 s21, s21, s16
  s_add_u32 s20, s20, 137216
  s_add_u32 s21, s21, 16384
  s_add_u32 s21, s21, s52
  s_waitcnt vmcnt(0)
  s_mov_b32 s36, s16
  v_mov_b32 v56, 0
  s_branch L_loop2_next
L_loop2_rr0:
  buffer_load_dwordx4 v[60:63], v4, s[4:7], s38 offen offset:0 sc1
  buffer_load_dwordx4 v[64:67], v4, s[4:7], s38 offen offset:1024 sc1
  buffer_load_dwordx4 v[68:71], v4, s[4:7], s38 offen offset:2048 sc1
  buffer_load_dwordx4 v[72:75], v4, s[4:7], s38 offen offset:3072 sc1
  buffer_load_dwordx4 v[76:79], v4, s[4:7], s17 offen sc1
  s_mov_b32 m0, s62
  s_nop 0
  buffer_load_dwordx4 v3, s[4:7], s19 offen offset:0 sc1 lds
  buffer_load_dwordx4 v3, s[4:7], s19 offen offset:1024 sc1 lds
  s_mov_b32 m0, s94
  s_nop 0
  s_nop 0
  buffer_load_dwordx4 v3, s[4:7], s18 offen offset:3072 sc1 lds
  s_waitcnt vmcnt(7)
  v_cmp_eq_u32 vcc, -1, v60
  s_cbranch_vccz L_loop2_rok0
  s_sub_u32 s29, s29, 1
  s_cbranch_scc0 L_loop2_rr0
  s_branch L_end
L_loop2_rr1:
  buffer_load_dwordx4 v[64:67], v4, s[4:7], s38 offen offset:1024 sc1
  buffer_load_dwordx4 v[68:71], v4, s[4:7], s38 offen offset:2048 sc1
  buffer_load_dwordx4 v[72:75], v4, s[4:7], s38 offen offset:3072 sc1
  buffer_load_dwordx4 v[76:79], v4, s[4:7], s17 offen sc1
  s_mov_b32 m0, s62
  s_nop 0
  buffer_load_dwordx4 v3, s[4:7], s19 offen offset:0 sc1 lds
  buffer_load_dwordx4 v3, s[4:7], s19 offen offset:1024 sc1 lds
  s_mov_b32 m0, s94
  s_nop 0
  s_nop 0
  buffer_load_dwordx4 v3, s[4:7], s18 offen offset:3072 sc1 lds
  s_waitcnt vmcnt(6)
  v_cmp_eq_u32 vcc, -1, v64
  s_cbranch_vccz L_loop2_rok1
  s_sub_u32 s29, s29, 1
  s_cbranch_scc0 L_loop2_rr1
  s_branch L_end
L_loop2_rr2:
  buffer_load_dwordx4 v[68:71], v4, s[4:7], s38 offen offset:2048 sc1
  buffer_load_dwordx4 v[72:75], v4, s[4:7], s38 offen offset:3072 sc1
  buffer_load_dwordx4 v[76:79], v4, s[4:7], s17 offen sc1
  s_mov_b32 m0, s62
  s_nop 0
  buffer_load_dwordx4 v3, s[4:7], s19 offen offset:0 sc1 lds
  buffer_load_dwordx4 v3, s[4:7], s19 offen offset:1024 sc1 lds
  s_mov_b32 m0, s94
  s_nop 0
  s_nop 0
  buffer_load_dwordx4 v3, s[4:7], s18 offen offset:3072 sc1 lds
  s_waitcnt vmcnt(5)
  v_cmp_eq_u32 vcc, -1, v68
  s_cbranch_vccz L_loop2_rok2
  s_sub_u32 s29, s29, 1
  s_cbranch_scc0 L_loop2_rr2
  s_branch L_end
L_loop2_rr3:
  buffer_load_dwordx4 v[72:75], v4, s[4:7], s38 offen offset:3072 sc1
  buffer_load_dwordx4 v[76:79], v4, s[4:7], s17 offen sc1
  s_mov_b32 m0, s62
  s_nop 0
  buffer_load_dwordx4 v3, s[4:7], s19 offen offset:0 sc1 lds
  buffer_load_dwordx4 v3, s[4:7], s19 offen offset:1024 sc1 lds
  s_mov_b32 m0, s94
  s_nop 0
  s_nop 0
  buffer_load_dwordx4 v3, s[4:7], s18 offen offset:3072 sc1 lds
  s_waitcnt vmcnt(4)
  v_cmp_eq_u32 vcc, -1, v72
  s_cbranch_vccz L_loop2_rok3
  s_sub_u32 s29, s29, 1
  s_cbranch_scc0 L_loop2_rr3
  s_branch L_end
L_loop2_rr4:
  buffer_load_dwordx4 v[76:79], v4, s[4:7], s17 offen sc1
  s_mov_b32 m0, s62
  s_nop 0
  buffer_load_dwordx4 v3, s[4:7], s19 offen offset:0 sc1 lds
  buffer_load_dwordx4 v3, s[4:7], s19 offen offset:1024 sc1 lds
  s_mov_b32 m0, s94
  s_nop 0
  s_nop 0
  buffer_load_dwordx4 v3, s[4:7], s18 offen offset:3072 sc1 lds
  s_waitcnt vmcnt(3)
  v_cmp_eq_u32 vcc, -1, v76
  s_cbranch_vccz L_loop2_rok4
  s_sub_u32 s29, s29, 1
  s_cbranch_scc0 L_loop2_rr4
  s_branch L_end
L_loop2_last:
  s_waitcnt vmcnt(0) lgkmcnt(0)
  s_barrier
  s_add_u32 s3, s42, 1
  s_mov_b32 s92, s3
  s_cmp_lt_u32 s42, 63
  s_cbranch_scc1 L_loop2_back
  s_branch L_fin
L_loop3:
  s_add_u32 s18, s49, 8388608
  s_lshl_b32 s3, s40, 13
  s_lshl_b32 s19, s28, 11
  s_add_u32 s19, s19, s3
  s_add_u32 s19, s19, 25165824
  s_lshl_b32 s94, s43, 12
  s_add_u32 s94, s94, 16384
  v_lshlrev_b32 v0, 3, v3
  v_and_b32 v0, 0xf80, v0
  v_add_u32 v10, 16777216, v0
  v_cmp_gt_u32 vcc, 512, v3
  s_nop 1
  v_cndmask_b32 v10, v10, v0, vcc
  s_mov_b32 s92, 62
  s_add_u32 s90, s51, 16384
  s_lshl_b32 s3, s32, 7
  s_add_u32 s3, s3, 819200
  s_cmp_eq_u32 s43, 0
  s_cselect_b32 s48, s48, s3
L_loop3_top:
  s_add_u32 s93, s18, 262144
  s_add_u32 s3, s42, 0
  s_and_b32 s38, s3, 3
  s_lshl_b32 s38, s38, 15
  s_add_u32 s38, s38, s52
  s_add_u32 s38, s38, 0
  s_add_u32 s17, s38, 4096
  s_and_b32 s3, s3, 3
  s_mul_i32 s3, s3, 12288
  s_add_u32 s15, s3, 141312
  s_lshl_b32 s37, s43, 11
  s_add_u32 s37, s37, s3
  s_add_u32 s37, s37, 137216
  s_add_u32 s3, s42, 2
  s_and_b32 s95, s3, 1
  s_lshl2_add_u32 s95, s95, s63
  s_lshr_b32 s96, s3, 1
  s_min_u32 s96, s96, 31
  s_lshl_b32 s3, s43, 11
  v_add_u32 v11, s3, v3
  s_lshl_b32 s3, s43, 9
  v_lshrrev_b32 v53, 1, v3
  v_and_b32 v0, 56, v53
  v_add_u32 v53, s3, v53
  v_bfe_u32 v52, v3, 7, 2
  v_lshl_add_u32 v0, v52, 7, v0
  v_lshrrev_b32 v52, 9, v3
  v_lshl_add_u32 v0, v52, 6, v0
  v_add_u32 v52, s3, v0
  buffer_load_dwordx4 v[60:63], v4, s[4:7], s37 offen sc1
  buffer_load_dwordx4 v[64:67], v4, s[4:7], s37 offen offset:1024 sc1
  buffer_load_dwordx2 v[76:77], v52, s[4:7], s15 offen sc1
  v_mov_b64 v[12:13], 0
  v_mov_b64 v[14:15], 0
  v_mov_b64 v[16:17], 0
  v_mov_b64 v[18:19], 0
  v_mov_b64 v[20:21], 0
  v_mov_b64 v[22:23], 0
  v_mov_b64 v[24:25], 0
  v_mov_b64 v[26:27], 0
  v_mov_b64 v[28:29], 0
  v_mov_b64 v[30:31], 0
  v_mov_b64 v[32:33], 0
  v_mov_b64 v[34:35], 0
  ds_read_b128 v[36:39], v2 offset:30720
  ds_read_b128 v[40:43], v2 offset:31744
  ds_read_b128 v[44:47], v2 offset:32768
  ds_read_b128 v[48:51], v2 offset:33792
  s_waitcnt lgkmcnt(0)
  buffer_load_dwordx4 v[68:71], v4, s[4:7], s37 offen sc1
  buffer_load_dwordx4 v[72:75], v4, s[4:7], s37 offen offset:1024 sc1
  buffer_load_dwordx2 v[78:79], v52, s[4:7], s15 offen sc1
L_loop3_pl:
  s_waitcnt vmcnt(5)
  ds_write_b128 v11, v[60:63]
  s_waitcnt vmcnt(4)
  ds_write_b128 v11, v[64:67] offset:1024
  s_waitcnt vmcnt(3)
  ds_write_b64 v53, v[76:77] offset:4096
  v_max3_u32 v0, v60, v64, v76
  v_cmp_eq_u32 vcc, -1, v0
  s_cbranch_vccnz L_loop3_plr
L_loop3_plok:
  s_waitcnt lgkmcnt(0)
  s_barrier
  ds_read_b128 v[52:55], v3 offset:0
  ds_read_b128 v[56:59], v3 offset:1024
  buffer_load_dwordx4 v[60:63], v4, s[4:7], s38 offen offset:0 sc1
  buffer_load_dwordx4 v[64:67], v4, s[4:7], s38 offen offset:1024 sc1
  buffer_load_dwordx4 v[68:71], v4, s[4:7], s38 offen offset:2048 sc1
  s_waitcnt lgkmcnt(1)
  v_smfmac_f32_16x16x64_bf16 v[28:31], v[52:55], v[36:43], v1
  ds_read_b128 v[36:39], v2 offset:2048
  v_smfmac_f32_16x16x64_bf16 v[12:15], v[52:55], v[80:87], v1
  ds_read_b128 v[40:43], v2 offset:3072
  v_smfmac_f32_16x16x64_bf16 v[16:19], v[52:55], v[88:95], v1
  buffer_load_dwordx4 v[72:75], v4, s[4:7], s38 offen offset:3072 sc1
  v_smfmac_f32_16x16x64_bf16 v[32:35], v[52:55], v[44:51], v1
  ds_read_b128 v[44:47], v2 offset:4096
  v_smfmac_f32_16x16x64_bf16 v[20:23], v[52:55], v[240:247], v1
  ds_read_b128 v[48:51], v2 offset:5120
  buffer_load_dwordx4 v[76:79], v4, s[4:7], s17 offen sc1
  s_mov_b32 m0, s62
  v_smfmac_f32_16x16x64_bf16 v[24:27], v[52:55], v[248:255], v1
  ds_read_b128 v[52:55], v3 offset:2048
  s_waitcnt lgkmcnt(3)
  v_smfmac_f32_16x16x64_bf16 v[28:31], v[56:59], v[36:43], v1
  ds_read_b128 v[36:39], v2 offset:6144
  v_smfmac_f32_16x16x64_bf16 v[12:15], v[56:59], v[96:103], v1
  ds_read_b128 v[40:43], v2 offset:7168
  v_smfmac_f32_16x16x64_bf16 v[16:19], v[56:59], v[104:111], v1
  s_waitcnt lgkmcnt(3)
  v_smfmac_f32_16x16x64_bf16 v[32:35], v[56:59], v[44:51], v1
  ds_read_b128 v[44:47], v2 offset:8192
  v_smfmac_f32_16x16x64_bf16 v[20:23], v[56:59], a[0:7], v1
  ds_read_b128 v[48:51], v2 offset:9216
  buffer_load_dwordx4 v3, s[4:7], s19 offen offset:0 sc1 lds
  v_smfmac_f32_16x16x64_bf16 v[24:27], v[56:59], a[8:15], v1
  ds_read_b128 v[56:59], v3 offset:3072
  s_waitcnt lgkmcnt(3)
  v_smfmac_f32_16x16x64_bf16 v[28:31], v[52:55], v[36:43], v1
  ds_read_b128 v[36:39], v2 offset:10240
  v_smfmac_f32_16x16x64_bf16 v[12:15], v[52:55], v[112:119], v1
  ds_read_b128 v[40:43], v2 offset:11264
  v_smfmac_f32_16x16x64_bf16 v[16:19], v[52:55], v[120:127], v1
  s_waitcnt lgkmcnt(3)
  v_smfmac_f32_16x16x64_bf16 v[32:35], v[52:55], v[44:51], v1
  ds_read_b128 v[44:47], v2 offset:12288
  v_smfmac_f32_16x16x64_bf16 v[20:23], v[52:55], a[16:23], v1
  ds_read_b128 v[48:51], v2 offset:13312
  buffer_load_dwordx4 v3, s[4:7], s19 offen offset:1024 sc1 lds
  v_smfmac_f32_16x16x64_bf16 v[24:27], v[52:55], a[24:31], v1
  ds_read_b128 v[52:55], v3 offset:4096
  s_waitcnt lgkmcnt(3)
  v_smfmac_f32_16x16x64_bf16 v[28:31], v[56:59], v[36:43], v1
  ds_read_b128 v[36:39], v2 offset:14336
  v_smfmac_f32_16x16x64_bf16 v[12:15], v[56:59], v[128:135], v1
  ds_read_b128 v[40:43], v2 offset:15360
  v_smfmac_f32_16x16x64_bf16 v[16:19], v[56:59], v[136:143], v1
  s_waitcnt lgkmcnt(3)
  v_smfmac_f32_16x16x64_bf16 v[32:35], v[56:59], v[44:51], v1
  ds_read_b128 v[44:47], v2 offset:16384
  v_smfmac_f32_16x16x64_bf16 v[20:23], v[56:59], a[32:39], v1
  ds_read_b128 v[48:51], v2 offset:17408
  v_smfmac_f32_16x16x64_bf16 v[24:27], v[56:59], a[40:47], v1
  s_waitcnt lgkmcnt(2)
  v_smfmac_f32_16x16x64_bf16 v[28:31], v[52:55], v[36:43], v1
  v_smfmac_f32_16x16x64_bf16 v[12:15], v[52:55], v[144:151], v1
  v_smfmac_f32_16x16x64_bf16 v[16:19], v[52:55], v[152:159], v1
  s_waitcnt lgkmcnt(0)
  v_smfmac_f32_16x16x64_bf16 v[32:35], v[52:55], v[44:51], v1
  s_waitcnt vmcnt(6)
  v_smfmac_f32_16x16x64_bf16 v[20:23], v[52:55], a[48:55], v1
  v_cmp_eq_u32 vcc, -1, v60
  v_smfmac_f32_16x16x64_bf16 v[24:27], v[52:55], a[56:63], v1
  s_cbranch_vccnz L_loop3_rr0
L_loop3_rok0:
  v_smfmac_f32_16x16x64_bf16 v[12:15], v[60:63], v[160:167], v1
  s_waitcnt vmcnt(5)
  v_smfmac_f32_16x16x64_bf16 v[16:19], v[60:63], v[168:175], v1
  v_cmp_eq_u32 vcc, -1, v64
  v_smfmac_f32_16x16x64_bf16 v[20:23], v[60:63], a[64:71], v1
  ds_read_b128 v[36:39], v3 offset:16384
  v_smfmac_f32_16x16x64_bf16 v[24:27], v[60:63], a[72:79], v1
  ds_read_b128 v[40:43], v3 offset:20480
  s_cbranch_vccnz L_loop3_rr1
L_loop3_rok1:
  v_smfmac_f32_16x16x64_bf16 v[12:15], v[64:67], v[176:183], v1
  s_waitcnt vmcnt(4)
  v_smfmac_f32_16x16x64_bf16 v[16:19], v[64:67], v[184:191], v1
  v_cmp_eq_u32 vcc, -1, v68
  v_smfmac_f32_16x16x64_bf16 v[20:23], v[64:67], a[80:87], v1
  ds_read_b128 v[44:47], v3 offset:17408
  v_smfmac_f32_16x16x64_bf16 v[24:27], v[64:67], a[88:95], v1
  ds_read_b128 v[48:51], v3 offset:21504
  s_cbranch_vccnz L_loop3_rr2
L_loop3_rok2:
  v_smfmac_f32_16x16x64_bf16 v[12:15], v[68:71], v[192:199], v1
  s_waitcnt vmcnt(3)
  v_smfmac_f32_16x16x64_bf16 v[16:19], v[68:71], v[200:207], v1
  v_cmp_eq_u32 vcc, -1, v72
  v_smfmac_f32_16x16x64_bf16 v[20:23], v[68:71], a[96:103], v1
  ds_read_b128 v[52:55], v3 offset:18432
  v_smfmac_f32_16x16x64_bf16 v[24:27], v[68:71], a[104:111], v1
  ds_read_b128 v[56:59], v3 offset:22528
  s_cbranch_vccnz L_loop3_rr3
L_loop3_rok3:
  v_smfmac_f32_16x16x64_bf16 v[12:15], v[72:75], v[208:215], v1
  s_waitcnt vmcnt(2)
  v_smfmac_f32_16x16x64_bf16 v[16:19], v[72:75], v[216:223], v1
  v_cmp_eq_u32 vcc, -1, v76
  v_smfmac_f32_16x16x64_bf16 v[20:23], v[72:75], a[112:119], v1
  v_smfmac_f32_16x16x64_bf16 v[24:27], v[72:75], a[120:127], v1
  s_cbranch_vccnz L_loop3_rr4
L_loop3_rok4:
  v_smfmac_f32_16x16x64_bf16 v[12:15], v[76:79], v[224:231], v1
  s_movk_i32 m0, 0x1800
  v_smfmac_f32_16x16x64_bf16 v[16:19], v[76:79], v[232:239], v1
  buffer_load_dword v10, s[4:7], s93 offen sc1 lds
  v_smfmac_f32_16x16x64_bf16 v[20:23], v[76:79], a[128:135], v1
  buffer_load_dword v11, off, s[4:7], s95 sc1
  v_smfmac_f32_16x16x64_bf16 v[24:27], v[76:79], a[136:143], v1
  v_smfmac_f32_16x16x64_bf16 v[28:31], v[60:63], a[144:151], v1
  s_nop 0
  v_smfmac_f32_16x16x64_bf16 v[32:35], v[60:63], a[152:159], v1
  s_nop 0
  v_add_f32 v12, v12, v14
  v_add_f32 v13, v13, v15
  v_add_f32 v16, v16, v18
  v_add_f32 v17, v17, v19
  v_add_f32 v20, v20, v22
  v_add_f32 v21, v21, v23
  v_add_f32 v24, v24, v26
  v_add_f32 v25, v25, v27
  v_cvt_pk_bf16_f32 v20, v20, v21
  v_cvt_pk_bf16_f32 v21, v12, v13
  v_cvt_pk_bf16_f32 v22, v24, v25
  v_cvt_pk_bf16_f32 v23, v16, v17
  ds_write2_b64 v5, v[20:21], v[22:23] offset0:0 offset1:64
  v_smfmac_f32_16x16x64_bf16 v[28:31], v[64:67], a[160:167], v1
  v_lshrrev_b32 v0, 1, v3
  v_smfmac_f32_16x16x64_bf16 v[32:35], v[64:67], a[168:175], v1
  s_waitcnt lgkmcnt(0)
  s_barrier
  ds_read_b64_tr_b16 v[12:13], v6 offset:0
  ds_read_b64_tr_b16 v[14:15], v6 offset:256
  v_smfmac_f32_16x16x64_bf16 v[28:31], v[68:71], a[176:183], v1
  ds_read_b64_tr_b16 v[16:17], v6 offset:1024
  v_smfmac_f32_16x16x64_bf16 v[32:35], v[68:71], a[184:191], v1
  ds_read_b64_tr_b16 v[18:19], v6 offset:1280
  v_mov_b32 v60, s42
  v_smfmac_f32_16x16x64_bf16 v[28:31], v[72:75], a[192:199], v1
  ds_read_b64_tr_b16 v[20:21], v6 offset:2048
  buffer_store_dword v60, off, s[4:7], s48 sc1
  v_smfmac_f32_16x16x64_bf16 v[32:35], v[72:75], a[200:207], v1
  ds_read_b64_tr_b16 v[22:23], v6 offset:2304
  v_smfmac_f32_16x16x64_bf16 v[28:31], v[76:79], a[208:215], v1
  ds_read_b64_tr_b16 v[24:25], v6 offset:3072
  v_smfmac_f32_16x16x64_bf16 v[32:35], v[76:79], a[216:223], v1
  ds_read_b64_tr_b16 v[26:27], v6 offset:3328
  s_waitcnt lgkmcnt(6)
  v_mfma_f32_16x16x32_bf16 v[68:71], v[36:39], v[12:15], 0
  ds_read_b128 v[60:63], v3 offset:19456
  ds_read_b128 v[64:67], v3 offset:23552
  v_mfma_f32_16x16x32_bf16 v[72:75], v[40:43], v[12:15], 0
  s_nop 0
  s_nop 0
  s_waitcnt lgkmcnt(6)
  v_mfma_f32_16x16x32_bf16 v[68:71], v[44:47], v[16:19], v[68:71]
  v_add_f32 v28, v28, v30
  v_add_f32 v29, v29, v31
  v_mfma_f32_16x16x32_bf16 v[72:75], v[48:51], v[16:19], v[72:75]
  v_add_f32 v32, v32, v34
  s_waitcnt lgkmcnt(4)
  v_mfma_f32_16x16x32_bf16 v[68:71], v[52:55], v[20:23], v[68:71]
  v_add_f32 v33, v33, v35
  v_cvt_pk_bf16_f32 v33, v32, v33
  v_mfma_f32_16x16x32_bf16 v[72:75], v[56:59], v[20:23], v[72:75]
  v_cvt_pk_bf16_f32 v32, v28, v29
  s_waitcnt vmcnt(3)
  ds_read_b128 v[52:55], v2 offset:0
  ds_read_b128 v[56:59], v2 offset:1024
  s_waitcnt lgkmcnt(3)
  v_mfma_f32_16x16x32_bf16 v[68:71], v[60:63], v[24:27], v[68:71]
  v_mov_b64 v[44:45], s[24:25]
  s_waitcnt lgkmcnt(2)
  v_mfma_f32_16x16x32_bf16 v[72:75], v[64:67], v[24:27], v[72:75]
  v_mov_b64 v[46:47], s[24:25]
  v_mov_b32 v41, 0
  v_mfma_f32_16x16x32_bf16 v[76:79], v[12:15], v[12:15], 0
  v_mov_b32 v42, 0
  s_nop 0
  v_mfma_f32_16x16x32_bf16 v[76:79], v[16:19], v[16:19], v[76:79]
  buffer_store_dwordx2 v[32:33], v0, s[4:7], s50 offen sc1
  s_nop 0
  v_mfma_f32_16x16x32_bf16 v[76:79], v[20:23], v[20:23], v[76:79]
  v_max3_f32 v28, v68, v69, v70
  s_cmp_eq_u32 s42, s92
  v_mfma_f32_16x16x32_bf16 v[76:79], v[24:27], v[24:27], v[76:79]
  v_max3_f32 v28, v28, v71, v72
  v_max3_f32 v28, v28, v73, v74
  s_cbranch_scc1 L_loop3_last
L_loop3_back:
  v_max_f32 v28, v28, v75
  ds_read_b128 v[60:63], v2 offset:18432
  ds_read_b128 v[64:67], v2 offset:19456
  s_nop 1
  v_max3_f32 v28, v28, v76, v77
  v_mov_b32 v29, v28
  s_nop 1
  v_permlane16_swap_b32 v29, v28
  v_max_f32 v28, v28, v29
  v_mov_b32 v29, v28
  s_nop 1
  v_permlane32_swap_b32 v29, v28
  v_max_f32 v28, v28, v29
  v_mul_f32 v28, s46, v28
  v_pk_fma_f32 v[68:69], v[68:69], s[46:47], v[28:29] op_sel_hi:[1,0,0] neg_lo:[0,0,1] neg_hi:[0,0,1]
  v_pk_fma_f32 v[70:71], v[70:71], s[46:47], v[28:29] op_sel_hi:[1,0,0] neg_lo:[0,0,1] neg_hi:[0,0,1]
  v_pk_fma_f32 v[72:73], v[72:73], s[46:47], v[28:29] op_sel_hi:[1,0,0] neg_lo:[0,0,1] neg_hi:[0,0,1]
  v_pk_fma_f32 v[74:75], v[74:75], s[46:47], v[28:29] op_sel_hi:[1,0,0] neg_lo:[0,0,1] neg_hi:[0,0,1]
  v_pk_fma_f32 v[76:77], v[76:77], s[46:47], v[28:29] op_sel_hi:[1,0,0] neg_lo:[0,0,1] neg_hi:[0,0,1]
  v_exp_f32 v68, v68
  v_exp_f32 v69, v69
  v_exp_f32 v70, v70
  v_cvt_pk_bf16_f32 v36, v68, v69
  v_exp_f32 v71, v71
  v_exp_f32 v72, v72
  v_cvt_pk_bf16_f32 v37, v70, v71
  v_exp_f32 v73, v73
  v_exp_f32 v74, v74
  v_cvt_pk_bf16_f32 v38, v72, v73
  v_exp_f32 v75, v75
  v_exp_f32 v76, v76
  v_cvt_pk_bf16_f32 v39, v74, v75
  v_exp_f32 v77, v77
  s_waitcnt lgkmcnt(2)
  v_mfma_f32_16x16x32_bf16 v[20:23], v[44:47], v[36:39], 0
  v_cvt_pk_bf16_f32 v40, v76, v77
  v_cvt_pk_bf16_f32 v43, v76, v77
  v_mfma_f32_16x16x32_bf16 v[12:15], v[52:55], v[36:39], 0
  ds_read_b128 v[68:71], v2 offset:20480
  ds_read_b128 v[72:75], v2 offset:21504
  v_mfma_f32_16x16x32_bf16 v[16:19], v[56:59], v[36:39], 0
  ds_read_b128 v[52:55], v2 offset:22528
  ds_read_b128 v[56:59], v2 offset:23552
  v_mfma_f32_16x16x16_bf16 v[20:23], v[44:45], v[40:41], v[20:23]
  v_add_u32 v0, s14, v7
  v_mov_b64 v[24:25], 0
  v_mfma_f32_16x16x16_bf16 v[12:15], v[32:33], v[40:41], v[12:15]
  v_mov_b64 v[26:27], 0
  v_mov_b64 v[76:77], 0
  v_mfma_f32_16x16x16_bf16 v[16:19], v[32:33], v[42:43], v[16:19]
  v_mov_b64 v[78:79], 0
  s_nop 0
  v_rcp_f32 v30, v20
  s_mov_b32 m0, s94
  s_mov_b64 exec, s[26:27]
  v_pk_mul_f32 v[12:13], v[12:13], v[30:31] op_sel_hi:[1,0]
  v_pk_mul_f32 v[14:15], v[14:15], v[30:31] op_sel_hi:[1,0]
  v_cvt_pk_bf16_f32 v12, v12, v13
  v_pk_mul_f32 v[16:17], v[16:17], v[30:31] op_sel_hi:[1,0]
  v_pk_mul_f32 v[18:19], v[18:19], v[30:31] op_sel_hi:[1,0]
  v_cvt_pk_bf16_f32 v13, v14, v15
  v_cvt_pk_bf16_f32 v14, v16, v17
  v_cvt_pk_bf16_f32 v15, v18, v19
  ds_write_b128 v0, v[12:15]
  s_mov_b64 exec, -1
  ds_read_b128 v[36:39], v2 offset:24576
  ds_read_b128 v[40:43], v2 offset:25600
  v_mov_b64 v[20:21], 0
  v_mov_b64 v[22:23], 0
  v_mov_b64 v[44:45], 0
  v_mov_b64 v[46:47], 0
  v_mov_b64 v[48:49], 0
  v_mov_b64 v[50:51], 0
  buffer_load_dwordx4 v3, s[4:7], s93 offen offset:0 sc1 lds
  buffer_load_dwordx4 v3, s[4:7], s93 offen offset:1024 sc1 lds
  buffer_load_dwordx4 v3, s[4:7], s93 offen offset:2048 sc1 lds
  s_waitcnt lgkmcnt(2)
  s_barrier
  ds_read_b128 v[16:19], v7 offset:0
  ds_read_b128 v[12:15], v7 offset:1024
  ds_read_b128 v[28:31], v2 offset:26624
  ds_read_b128 v[32:35], v2 offset:27648
  s_add_u32 s50, s50, 131072
  s_waitcnt lgkmcnt(3)
  v_smfmac_f32_16x16x64_bf16 v[20:23], v[16:19], v[60:67], v1
  ds_read_b128 v[60:63], v2 offset:28672
  v_smfmac_f32_16x16x64_bf16 v[24:27], v[16:19], v[68:75], v1
  s_waitcnt lgkmcnt(3)
  v_smfmac_f32_16x16x64_bf16 v[20:23], v[12:15], v[52:59], v1
  ds_read_b128 v[64:67], v2 offset:29696
  v_smfmac_f32_16x16x64_bf16 v[24:27], v[12:15], v[36:43], v1
  s_waitcnt lgkmcnt(2)
  v_smfmac_f32_16x16x64_bf16 v[44:47], v[16:19], v[28:35], v1
  s_nop 0
  v_smfmac_f32_16x16x64_bf16 v[48:51], v[16:19], a[224:231], v1
  s_nop 0
  v_smfmac_f32_16x16x64_bf16 v[44:47], v[12:15], a[240:247], v1
  v_add_f32 v20, v20, v22
  v_smfmac_f32_16x16x64_bf16 v[48:51], v[12:15], a[248:255], v1
  v_add_f32 v21, v21, v23
  v_smfmac_f32_16x16x64_bf16 v[76:79], v[16:19], a[232:239], v1
  v_add_f32 v24, v24, v26
  s_waitcnt lgkmcnt(0)
  v_smfmac_f32_16x16x64_bf16 v[76:79], v[12:15], v[60:67], v1
  v_add_f32 v25, v25, v27
  v_cvt_pk_bf16_f32 v20, v20, v21
  v_cvt_pk_bf16_f32 v21, v24, v25
  v_and_or_b32 v20, v20, -2, s45
  buffer_store_dwordx2 v[20:21], v8, s[4:7], s51 offen
  v_pk_add_f32 v[44:45], v[44:45], v[46:47]
  v_pk_add_f32 v[48:49], v[48:49], v[50:51]
  v_cvt_pk_bf16_f32 v44, v44, v45
  v_cvt_pk_bf16_f32 v45, v48, v49
  v_and_or_b32 v44, v44, -2, s45
  buffer_store_dwordx2 v[44:45], v8, s[4:7], s90 offen
  v_pk_add_f32 v[76:77], v[76:77], v[78:79]
  v_cvt_pk_bf16_f32 v76, v76, v77
  v_and_or_b32 v76, v76, -2, s45
  buffer_store_dword v76, v9, s[4:7], s51 offen
  s_waitcnt vmcnt(0)
  s_barrier
  v_readfirstlane_b32 s3, v11
  s_add_u32 s42, s42, 1
  s_xor_b32 s45, s45, 1
  s_cmp_gt_u32 s3, s96
  s_cbranch_scc0 L_loop3_kvw
L_loop3_kvok:
  s_add_u32 s18, s18, 262144
  s_add_u32 s19, s19, 262144
  s_branch L_loop3_top
L_loop3_plr:
  s_waitcnt lgkmcnt(0)
  buffer_load_dwordx4 v[60:63], v4, s[4:7], s37 offen sc1
  buffer_load_dwordx4 v[64:67], v4, s[4:7], s37 offen offset:1024 sc1
  buffer_load_dwordx2 v[76:77], v52, s[4:7], s15 offen sc1
  s_waitcnt vmcnt(5)
  ds_write_b128 v11, v[68:71]
  s_waitcnt vmcnt(4)
  ds_write_b128 v11, v[72:75] offset:1024
  s_waitcnt vmcnt(3)
  ds_write_b64 v53, v[78:79] offset:4096
  v_max3_u32 v0, v68, v72, v78
  v_cmp_eq_u32 vcc, -1, v0
  s_cbranch_vccz L_loop3_plok
  s_waitcnt lgkmcnt(0)
  buffer_load_dwordx4 v[68:71], v4, s[4:7], s37 offen sc1
  buffer_load_dwordx4 v[72:75], v4, s[4:7], s37 offen offset:1024 sc1
  buffer_load_dwordx2 v[78:79], v52, s[4:7], s15 offen sc1
  s_sub_u32 s29, s29, 1
  s_cbranch_scc0 L_loop3_pl
  s_branch L_end
L_loop3_kvw:
  buffer_load_dword v11, off, s[4:7], s95 sc1
  s_waitcnt vmcnt(0)
  v_readfirstlane_b32 s3, v11
  s_nop 0
  s_cmp_gt_u32 s3, s96
  s_cbranch_scc1 L_loop3_kvok
  s_sleep 1
  s_sub_u32 s29, s29, 1
  s_cbranch_scc0 L_loop3_kvw
  s_branch L_end
L_loop3_rr0:
  buffer_load_dwordx4 v[60:63], v4, s[4:7], s38 offen offset:0 sc1
  buffer_load_dwordx4 v[64:67], v4, s[4:7], s38 offen offset:1024 sc1
  buffer_load_dwordx4 v[68:71], v4, s[4:7], s38 offen offset:2048 sc1
  buffer_load_dwordx4 v[72:75], v4, s[4:7], s38 offen offset:3072 sc1
  buffer_load_dwordx4 v[76:79], v4, s[4:7], s17 offen sc1
  s_mov_b32 m0, s62
  s_nop 0
  buffer_load_dwordx4 v3, s[4:7], s19 offen offset:0 sc1 lds
  buffer_load_dwordx4 v3, s[4:7], s19 offen offset:1024 sc1 lds
  s_waitcnt vmcnt(6)
  v_cmp_eq_u32 vcc, -1, v60
  s_cbranch_vccz L_loop3_rok0
  s_sub_u32 s29, s29, 1
  s_cbranch_scc0 L_loop3_rr0
  s_branch L_end
L_loop3_rr1:
  buffer_load_dwordx4 v[64:67], v4, s[4:7], s38 offen offset:1024 sc1
  buffer_load_dwordx4 v[68:71], v4, s[4:7], s38 offen offset:2048 sc1
  buffer_load_dwordx4 v[72:75], v4, s[4:7], s38 offen offset:3072 sc1
  buffer_load_dwordx4 v[76:79], v4, s[4:7], s17 offen sc1
  s_mov_b32 m0, s62
  s_nop 0
  buffer_load_dwordx4 v3, s[4:7], s19 offen offset:0 sc1 lds
  buffer_load_dwordx4 v3, s[4:7], s19 offen offset:1024 sc1 lds
  s_waitcnt vmcnt(5)
  v_cmp_eq_u32 vcc, -1, v64
  s_cbranch_vccz L_loop3_rok1
  s_sub_u32 s29, s29, 1
  s_cbranch_scc0 L_loop3_rr1
  s_branch L_end
L_loop3_rr2:
  buffer_load_dwordx4 v[68:71], v4, s[4:7], s38 offen offset:2048 sc1
  buffer_load_dwordx4 v[72:75], v4, s[4:7], s38 offen offset:3072 sc1
  buffer_load_dwordx4 v[76:79], v4, s[4:7], s17 offen sc1
  s_mov_b32 m0, s62
  s_nop 0
  buffer_load_dwordx4 v3, s[4:7], s19 offen offset:0 sc1 lds
  buffer_load_dwordx4 v3, s[4:7], s19 offen offset:1024 sc1 lds
  s_waitcnt vmcnt(4)
  v_cmp_eq_u32 vcc, -1, v68
  s_cbranch_vccz L_loop3_rok2
  s_sub_u32 s29, s29, 1
  s_cbranch_scc0 L_loop3_rr2
  s_branch L_end
L_loop3_rr3:
  buffer_load_dwordx4 v[72:75], v4, s[4:7], s38 offen offset:3072 sc1
  buffer_load_dwordx4 v[76:79], v4, s[4:7], s17 offen sc1
  s_mov_b32 m0, s62
  s_nop 0
  buffer_load_dwordx4 v3, s[4:7], s19 offen offset:0 sc1 lds
  buffer_load_dwordx4 v3, s[4:7], s19 offen offset:1024 sc1 lds
  s_waitcnt vmcnt(3)
  v_cmp_eq_u32 vcc, -1, v72
  s_cbranch_vccz L_loop3_rok3
  s_sub_u32 s29, s29, 1
  s_cbranch_scc0 L_loop3_rr3
  s_branch L_end
L_loop3_rr4:
  buffer_load_dwordx4 v[76:79], v4, s[4:7], s17 offen sc1
  s_mov_b32 m0, s62
  s_nop 0
  buffer_load_dwordx4 v3, s[4:7], s19 offen offset:0 sc1 lds
  buffer_load_dwordx4 v3, s[4:7], s19 offen offset:1024 sc1 lds
  s_waitcnt vmcnt(2)
  v_cmp_eq_u32 vcc, -1, v76
  s_cbranch_vccz L_loop3_rok4
  s_sub_u32 s29, s29, 1
  s_cbranch_scc0 L_loop3_rr4
  s_branch L_end
L_loop3_last:
  s_waitcnt vmcnt(0) lgkmcnt(0)
  s_barrier
  s_add_u32 s3, s42, 1
  v_mov_b32 v0, s3
  s_mov_b64 exec, 1
  buffer_store_dword v0, off, s[4:7], s48 sc1
  s_mov_b64 exec, -1
  s_mov_b32 s92, s3
  s_cmp_lt_u32 s42, 63
  s_cbranch_scc1 L_loop3_back
  s_branch L_fin
L_loop4:
  s_lshl_b32 s16, s44, 7
  s_lshl_b32 s3, s40, 7
  s_add_u32 s3, s3, 589824
  s_cmp_ge_u32 s44, 40
  s_cselect_b32 s16, s3, s16
  s_add_u32 s18, s49, 8388608
  s_lshl_b32 s3, s40, 13
  s_lshl_b32 s19, s28, 11
  s_add_u32 s19, s19, s3
  s_add_u32 s19, s19, 25165824
  s_lshl_b32 s94, s43, 12
  s_add_u32 s94, s94, 16384
  s_mov_b32 s92, 62
  s_add_u32 s90, s51, 16384
  s_add_u32 s93, s18, 262144
  s_add_u32 s3, s42, 0
  s_and_b32 s38, s3, 3
  s_lshl_b32 s38, s38, 15
  s_add_u32 s38, s38, s52
  s_add_u32 s38, s38, 16384
  s_add_u32 s17, s38, 4096
  s_add_u32 s3, s3, 2
  s_and_b32 s21, s3, 3
  s_and_b32 s3, s3, 3
  s_mul_i32 s20, s3, 12288
  s_lshl_b32 s21, s21, 15
  s_add_u32 s20, s20, s16
  s_add_u32 s21, s21, s16
  s_add_u32 s20, s20, 131072
  s_add_u32 s21, s21, 0
  s_add_u32 s21, s21, s52
L_loop4_top:
  s_barrier
  ds_read_b128 v[52:55], v3 offset:0
  ds_read_b128 v[56:59], v3 offset:1024
  buffer_load_dwordx4 v[60:63], v4, s[4:7], s38 offen offset:0 sc1
  buffer_load_dwordx4 v[64:67], v4, s[4:7], s38 offen offset:1024 sc1
  buffer_load_dwordx4 v[68:71], v4, s[4:7], s38 offen offset:2048 sc1
  s_waitcnt lgkmcnt(1)
  v_smfmac_f32_16x16x64_bf16 v[28:31], v[52:55], v[36:43], v1
  ds_read_b128 v[36:39], v2 offset:2048
  v_smfmac_f32_16x16x64_bf16 v[12:15], v[52:55], v[80:87], v1
  ds_read_b128 v[40:43], v2 offset:3072
  v_smfmac_f32_16x16x64_bf16 v[16:19], v[52:55], v[88:95], v1
  buffer_load_dwordx4 v[72:75], v4, s[4:7], s38 offen offset:3072 sc1
  v_smfmac_f32_16x16x64_bf16 v[32:35], v[52:55], v[44:51], v1
  ds_read_b128 v[44:47], v2 offset:4096
  v_smfmac_f32_16x16x64_bf16 v[20:23], v[52:55], v[240:247], v1
  ds_read_b128 v[48:51], v2 offset:5120
  buffer_load_dwordx4 v[76:79], v4, s[4:7], s17 offen sc1
  s_mov_b32 m0, s62
  v_smfmac_f32_16x16x64_bf16 v[24:27], v[52:55], v[248:255], v1
  ds_read_b128 v[52:55], v3 offset:2048
  s_waitcnt lgkmcnt(3)
  v_smfmac_f32_16x16x64_bf16 v[28:31], v[56:59], v[36:43], v1
  ds_read_b128 v[36:39], v2 offset:6144
  v_smfmac_f32_16x16x64_bf16 v[12:15], v[56:59], v[96:103], v1
  ds_read_b128 v[40:43], v2 offset:7168
  v_smfmac_f32_16x16x64_bf16 v[16:19], v[56:59], v[104:111], v1
  s_waitcnt lgkmcnt(3)
  v_smfmac_f32_16x16x64_bf16 v[32:35], v[56:59], v[44:51], v1
  ds_read_b128 v[44:47], v2 offset:8192
  v_smfmac_f32_16x16x64_bf16 v[20:23], v[56:59], a[0:7], v1
  ds_read_b128 v[48:51], v2 offset:9216
  buffer_load_dwordx4 v3, s[4:7], s19 offen offset:0 sc1 lds
  v_smfmac_f32_16x16x64_bf16 v[24:27], v[56:59], a[8:15], v1
  ds_read_b128 v[56:59], v3 offset:3072
  s_waitcnt lgkmcnt(3)
  v_smfmac_f32_16x16x64_bf16 v[28:31], v[52:55], v[36:43], v1
  ds_read_b128 v[36:39], v2 offset:10240
  v_smfmac_f32_16x16x64_bf16 v[12:15], v[52:55], v[112:119], v1
  ds_read_b128 v[40:43], v2 offset:11264
  v_smfmac_f32_16x16x64_bf16 v[16:19], v[52:55], v[120:127], v1
  s_waitcnt lgkmcnt(3)
  v_smfmac_f32_16x16x64_bf16 v[32:35], v[52:55], v[44:51], v1
  ds_read_b128 v[44:47], v2 offset:12288
  v_smfmac_f32_16x16x64_bf16 v[20:23], v[52:55], a[16:23], v1
  ds_read_b128 v[48:51], v2 offset:13312
  buffer_load_dwordx4 v3, s[4:7], s19 offen offset:1024 sc1 lds
  s_mov_b32 m0, s94
  s_nop 0
  v_smfmac_f32_16x16x64_bf16 v[24:27], v[52:55], a[24:31], v1
  ds_read_b128 v[52:55], v3 offset:4096
  s_waitcnt lgkmcnt(3)
  v_smfmac_f32_16x16x64_bf16 v[28:31], v[56:59], v[36:43], v1
  ds_read_b128 v[36:39], v2 offset:14336
  v_smfmac_f32_16x16x64_bf16 v[12:15], v[56:59], v[128:135], v1
  ds_read_b128 v[40:43], v2 offset:15360
  v_smfmac_f32_16x16x64_bf16 v[16:19], v[56:59], v[136:143], v1
  s_waitcnt lgkmcnt(3)
  v_smfmac_f32_16x16x64_bf16 v[32:35], v[56:59], v[44:51], v1
  ds_read_b128 v[44:47], v2 offset:16384
  v_smfmac_f32_16x16x64_bf16 v[20:23], v[56:59], a[32:39], v1
  ds_read_b128 v[48:51], v2 offset:17408
  buffer_load_dwordx4 v3, s[4:7], s18 offen offset:3072 sc1 lds
  v_smfmac_f32_16x16x64_bf16 v[24:27], v[56:59], a[40:47], v1
  s_waitcnt lgkmcnt(2)
  v_smfmac_f32_16x16x64_bf16 v[28:31], v[52:55], v[36:43], v1
  v_smfmac_f32_16x16x64_bf16 v[12:15], v[52:55], v[144:151], v1
  v_smfmac_f32_16x16x64_bf16 v[16:19], v[52:55], v[152:159], v1
  s_waitcnt lgkmcnt(0)
  v_smfmac_f32_16x16x64_bf16 v[32:35], v[52:55], v[44:51], v1
  s_waitcnt vmcnt(7)
  v_smfmac_f32_16x16x64_bf16 v[20:23], v[52:55], a[48:55], v1
  v_cmp_eq_u32 vcc, -1, v60
  v_smfmac_f32_16x16x64_bf16 v[24:27], v[52:55], a[56:63], v1
  s_cbranch_vccnz L_loop4_rr0
L_loop4_rok0:
  v_smfmac_f32_16x16x64_bf16 v[12:15], v[60:63], v[160:167], v1
  s_waitcnt vmcnt(6)
  v_smfmac_f32_16x16x64_bf16 v[16:19], v[60:63], v[168:175], v1
  v_cmp_eq_u32 vcc, -1, v64
  v_smfmac_f32_16x16x64_bf16 v[20:23], v[60:63], a[64:71], v1
  ds_read_b128 v[36:39], v3 offset:16384
  v_smfmac_f32_16x16x64_bf16 v[24:27], v[60:63], a[72:79], v1
  ds_read_b128 v[40:43], v3 offset:20480
  s_cbranch_vccnz L_loop4_rr1
L_loop4_rok1:
  v_smfmac_f32_16x16x64_bf16 v[12:15], v[64:67], v[176:183], v1
  s_waitcnt vmcnt(5)
  v_smfmac_f32_16x16x64_bf16 v[16:19], v[64:67], v[184:191], v1
  v_cmp_eq_u32 vcc, -1, v68
  v_smfmac_f32_16x16x64_bf16 v[20:23], v[64:67], a[80:87], v1
  ds_read_b128 v[44:47], v3 offset:17408
  v_smfmac_f32_16x16x64_bf16 v[24:27], v[64:67], a[88:95], v1
  ds_read_b128 v[48:51], v3 offset:21504
  s_cbranch_vccnz L_loop4_rr2
L_loop4_rok2:
  v_smfmac_f32_16x16x64_bf16 v[12:15], v[68:71], v[192:199], v1
  s_waitcnt vmcnt(4)
  v_smfmac_f32_16x16x64_bf16 v[16:19], v[68:71], v[200:207], v1
  v_cmp_eq_u32 vcc, -1, v72
  v_smfmac_f32_16x16x64_bf16 v[20:23], v[68:71], a[96:103], v1
  ds_read_b128 v[52:55], v3 offset:18432
  v_smfmac_f32_16x16x64_bf16 v[24:27], v[68:71], a[104:111], v1
  ds_read_b128 v[56:59], v3 offset:22528
  s_cbranch_vccnz L_loop4_rr3
L_loop4_rok3:
  v_smfmac_f32_16x16x64_bf16 v[12:15], v[72:75], v[208:215], v1
  s_waitcnt vmcnt(3)
  v_smfmac_f32_16x16x64_bf16 v[16:19], v[72:75], v[216:223], v1
  v_cmp_eq_u32 vcc, -1, v76
  v_smfmac_f32_16x16x64_bf16 v[20:23], v[72:75], a[112:119], v1
  v_smfmac_f32_16x16x64_bf16 v[24:27], v[72:75], a[120:127], v1
  s_cbranch_vccnz L_loop4_rr4
L_loop4_rok4:
  v_smfmac_f32_16x16x64_bf16 v[12:15], v[76:79], v[224:231], v1
  v_mov_b32 v11, -1
  v_smfmac_f32_16x16x64_bf16 v[16:19], v[76:79], v[232:239], v1
  v_smfmac_f32_16x16x64_bf16 v[20:23], v[76:79], a[128:135], v1
  v_smfmac_f32_16x16x64_bf16 v[24:27], v[76:79], a[136:143], v1
  v_smfmac_f32_16x16x64_bf16 v[28:31], v[60:63], a[144:151], v1
  s_nop 0
  v_smfmac_f32_16x16x64_bf16 v[32:35], v[60:63], a[152:159], v1
  s_nop 0
  v_add_f32 v12, v12, v14
  v_add_f32 v13, v13, v15
  v_add_f32 v16, v16, v18
  v_add_f32 v17, v17, v19
  v_add_f32 v20, v20, v22
  v_add_f32 v21, v21, v23
  v_add_f32 v24, v24, v26
  v_add_f32 v25, v25, v27
  v_cvt_pk_bf16_f32 v20, v20, v21
  v_cvt_pk_bf16_f32 v21, v12, v13
  v_cvt_pk_bf16_f32 v22, v24, v25
  v_cvt_pk_bf16_f32 v23, v16, v17
  ds_write2_b64 v5, v[20:21], v[22:23] offset0:0 offset1:64
  v_mov_b32 v12, v20
  v_mov_b32 v13, v22
  v_smfmac_f32_16x16x64_bf16 v[28:31], v[64:67], a[160:167], v1
  v_lshrrev_b32 v0, 1, v3
  v_smfmac_f32_16x16x64_bf16 v[32:35], v[64:67], a[168:175], v1
  buffer_store_dwordx2 v[12:13], v0, s[4:7], s50 offen sc1
  s_waitcnt vmcnt(1)
  s_waitcnt lgkmcnt(0)
  s_barrier
  ds_read_b64_tr_b16 v[12:13], v6 offset:0
  ds_read_b64_tr_b16 v[14:15], v6 offset:256
  v_smfmac_f32_16x16x64_bf16 v[28:31], v[68:71], a[176:183], v1
  ds_read_b64_tr_b16 v[16:17], v6 offset:1024
  v_smfmac_f32_16x16x64_bf16 v[32:35], v[68:71], a[184:191], v1
  ds_read_b64_tr_b16 v[18:19], v6 offset:1280
  buffer_store_dword v11, v10, s[4:7], s20 offen sc1
  v_smfmac_f32_16x16x64_bf16 v[28:31], v[72:75], a[192:199], v1
  ds_read_b64_tr_b16 v[20:21], v6 offset:2048
  buffer_store_dword v11, v10, s[4:7], s21 offen sc1
  v_smfmac_f32_16x16x64_bf16 v[32:35], v[72:75], a[200:207], v1
  ds_read_b64_tr_b16 v[22:23], v6 offset:2304
  v_smfmac_f32_16x16x64_bf16 v[28:31], v[76:79], a[208:215], v1
  ds_read_b64_tr_b16 v[24:25], v6 offset:3072
  v_smfmac_f32_16x16x64_bf16 v[32:35], v[76:79], a[216:223], v1
  ds_read_b64_tr_b16 v[26:27], v6 offset:3328
  s_waitcnt lgkmcnt(6)
  v_mfma_f32_16x16x32_bf16 v[68:71], v[36:39], v[12:15], 0
  ds_read_b128 v[60:63], v3 offset:19456
  ds_read_b128 v[64:67], v3 offset:23552
  v_mfma_f32_16x16x32_bf16 v[72:75], v[40:43], v[12:15], 0
  s_nop 0
  s_nop 0
  s_waitcnt lgkmcnt(6)
  v_mfma_f32_16x16x32_bf16 v[68:71], v[44:47], v[16:19], v[68:71]
  v_add_f32 v28, v28, v30
  v_add_f32 v29, v29, v31
  v_mfma_f32_16x16x32_bf16 v[72:75], v[48:51], v[16:19], v[72:75]
  v_add_f32 v32, v32, v34
  s_waitcnt lgkmcnt(4)
  v_mfma_f32_16x16x32_bf16 v[68:71], v[52:55], v[20:23], v[68:71]
  v_add_f32 v33, v33, v35
  v_cvt_pk_bf16_f32 v33, v32, v33
  v_mfma_f32_16x16x32_bf16 v[72:75], v[56:59], v[20:23], v[72:75]
  v_cvt_pk_bf16_f32 v32, v28, v29
  ds_read_b128 v[52:55], v2 offset:0
  ds_read_b128 v[56:59], v2 offset:1024
  s_waitcnt lgkmcnt(3)
  v_mfma_f32_16x16x32_bf16 v[68:71], v[60:63], v[24:27], v[68:71]
  v_mov_b64 v[44:45], s[24:25]
  s_waitcnt lgkmcnt(2)
  v_mfma_f32_16x16x32_bf16 v[72:75], v[64:67], v[24:27], v[72:75]
  v_mov_b64 v[46:47], s[24:25]
  v_mov_b32 v41, 0
  v_mfma_f32_16x16x32_bf16 v[76:79], v[12:15], v[12:15], 0
  v_mov_b32 v42, 0
  s_nop 0
  v_mfma_f32_16x16x32_bf16 v[76:79], v[16:19], v[16:19], v[76:79]
  s_nop 1
  v_mfma_f32_16x16x32_bf16 v[76:79], v[20:23], v[20:23], v[76:79]
  v_max3_f32 v28, v68, v69, v70
  s_cmp_eq_u32 s42, s92
  v_mfma_f32_16x16x32_bf16 v[76:79], v[24:27], v[24:27], v[76:79]
  v_max3_f32 v28, v28, v71, v72
  v_max3_f32 v28, v28, v73, v74
  s_cbranch_scc1 L_loop4_last
L_loop4_back:
  v_max_f32 v28, v28, v75
  ds_read_b128 v[60:63], v2 offset:18432
  ds_read_b128 v[64:67], v2 offset:19456
  s_nop 1
  v_max3_f32 v28, v28, v76, v77
  v_mov_b32 v29, v28
  s_nop 1
  v_permlane16_swap_b32 v29, v28
  v_max_f32 v28, v28, v29
  v_mov_b32 v29, v28
  s_nop 1
  v_permlane32_swap_b32 v29, v28
  v_max_f32 v28, v28, v29
  v_mul_f32 v28, s46, v28
  v_pk_fma_f32 v[68:69], v[68:69], s[46:47], v[28:29] op_sel_hi:[1,0,0] neg_lo:[0,0,1] neg_hi:[0,0,1]
  v_pk_fma_f32 v[70:71], v[70:71], s[46:47], v[28:29] op_sel_hi:[1,0,0] neg_lo:[0,0,1] neg_hi:[0,0,1]
  v_pk_fma_f32 v[72:73], v[72:73], s[46:47], v[28:29] op_sel_hi:[1,0,0] neg_lo:[0,0,1] neg_hi:[0,0,1]
  v_pk_fma_f32 v[74:75], v[74:75], s[46:47], v[28:29] op_sel_hi:[1,0,0] neg_lo:[0,0,1] neg_hi:[0,0,1]
  v_pk_fma_f32 v[76:77], v[76:77], s[46:47], v[28:29] op_sel_hi:[1,0,0] neg_lo:[0,0,1] neg_hi:[0,0,1]
  v_exp_f32 v68, v68
  v_exp_f32 v69, v69
  v_exp_f32 v70, v70
  v_cvt_pk_bf16_f32 v36, v68, v69
  v_exp_f32 v71, v71
  v_exp_f32 v72, v72
  v_cvt_pk_bf16_f32 v37, v70, v71
  v_exp_f32 v73, v73
  v_exp_f32 v74, v74
  v_cvt_pk_bf16_f32 v38, v72, v73
  v_exp_f32 v75, v75
  v_exp_f32 v76, v76
  v_cvt_pk_bf16_f32 v39, v74, v75
  v_exp_f32 v77, v77
  s_waitcnt lgkmcnt(2)
  v_mfma_f32_16x16x32_bf16 v[20:23], v[44:47], v[36:39], 0
  v_cvt_pk_bf16_f32 v40, v76, v77
  v_cvt_pk_bf16_f32 v43, v76, v77
  v_mfma_f32_16x16x32_bf16 v[12:15], v[52:55], v[36:39], 0
  ds_read_b128 v[68:71], v2 offset:20480
  ds_read_b128 v[72:75], v2 offset:21504
  v_mfma_f32_16x16x32_bf16 v[16:19], v[56:59], v[36:39], 0
  ds_read_b128 v[52:55], v2 offset:22528
  ds_read_b128 v[56:59], v2 offset:23552
  v_mfma_f32_16x16x16_bf16 v[20:23], v[44:45], v[40:41], v[20:23]
  v_add_u32 v0, s14, v7
  v_mov_b64 v[24:25], 0
  v_mfma_f32_16x16x16_bf16 v[12:15], v[32:33], v[40:41], v[12:15]
  v_mov_b64 v[26:27], 0
  v_mov_b64 v[76:77], 0
  v_mfma_f32_16x16x16_bf16 v[16:19], v[32:33], v[42:43], v[16:19]
  v_mov_b64 v[78:79], 0
  s_nop 0
  v_rcp_f32 v30, v20
  s_nop 0
  s_mov_b64 exec, s[26:27]
  v_pk_mul_f32 v[12:13], v[12:13], v[30:31] op_sel_hi:[1,0]
  v_pk_mul_f32 v[14:15], v[14:15], v[30:31] op_sel_hi:[1,0]
  v_cvt_pk_bf16_f32 v12, v12, v13
  v_pk_mul_f32 v[16:17], v[16:17], v[30:31] op_sel_hi:[1,0]
  v_pk_mul_f32 v[18:19], v[18:19], v[30:31] op_sel_hi:[1,0]
  v_cvt_pk_bf16_f32 v13, v14, v15
  v_cvt_pk_bf16_f32 v14, v16, v17
  v_cvt_pk_bf16_f32 v15, v18, v19
  ds_write_b128 v0, v[12:15]
  s_mov_b64 exec, -1
  ds_read_b128 v[36:39], v2 offset:24576
  ds_read_b128 v[40:43], v2 offset:25600
  v_mov_b64 v[20:21], 0
  v_mov_b64 v[22:23], 0
  v_mov_b64 v[44:45], 0
  v_mov_b64 v[46:47], 0
  v_mov_b64 v[48:49], 0
  v_mov_b64 v[50:51], 0
  s_waitcnt lgkmcnt(2)
  s_barrier
  ds_read_b128 v[16:19], v7 offset:0
  ds_read_b128 v[12:15], v7 offset:1024
  ds_read_b128 v[28:31], v2 offset:26624
  ds_read_b128 v[32:35], v2 offset:27648
  s_add_u32 s50, s50, 131072
  s_cmp_ge_u32 s44, 40
  s_waitcnt lgkmcnt(3)
  v_smfmac_f32_16x16x64_bf16 v[20:23], v[16:19], v[60:67], v1
  ds_read_b128 v[60:63], v2 offset:28672
  v_smfmac_f32_16x16x64_bf16 v[24:27], v[16:19], v[68:75], v1
  s_waitcnt lgkmcnt(3)
  v_smfmac_f32_16x16x64_bf16 v[20:23], v[12:15], v[52:59], v1
  ds_read_b128 v[64:67], v2 offset:29696
  v_smfmac_f32_16x16x64_bf16 v[24:27], v[12:15], v[36:43], v1
  s_waitcnt lgkmcnt(2)
  v_smfmac_f32_16x16x64_bf16 v[44:47], v[16:19], v[28:35], v1
  s_nop 0
  v_smfmac_f32_16x16x64_bf16 v[48:51], v[16:19], a[224:231], v1
  s_nop 0
  v_smfmac_f32_16x16x64_bf16 v[44:47], v[12:15], a[240:247], v1
  v_add_f32 v20, v20, v22
  v_smfmac_f32_16x16x64_bf16 v[48:51], v[12:15], a[248:255], v1
  v_add_f32 v21, v21, v23
  v_smfmac_f32_16x16x64_bf16 v[76:79], v[16:19], a[232:239], v1
  v_add_f32 v24, v24, v26
  s_waitcnt lgkmcnt(0)
  v_smfmac_f32_16x16x64_bf16 v[76:79], v[12:15], v[60:67], v1
  v_add_f32 v25, v25, v27
  v_cvt_pk_bf16_f32 v20, v20, v21
  v_cvt_pk_bf16_f32 v21, v24, v25
  v_and_or_b32 v20, v20, -2, s45
  buffer_store_dwordx2 v[20:21], v8, s[4:7], s51 offen sc1
  v_pk_add_f32 v[44:45], v[44:45], v[46:47]
  v_pk_add_f32 v[48:49], v[48:49], v[50:51]
  v_cvt_pk_bf16_f32 v44, v44, v45
  v_cvt_pk_bf16_f32 v45, v48, v49
  v_and_or_b32 v44, v44, -2, s45
  buffer_store_dwordx2 v[44:45], v8, s[4:7], s90 offen sc1
  v_pk_add_f32 v[76:77], v[76:77], v[78:79]
  v_cvt_pk_bf16_f32 v76, v76, v77
  v_and_or_b32 v76, v76, -2, s45
  buffer_store_dword v76, v9, s[4:7], s51 offen sc1
  s_cbranch_scc1 L_loop4_nored
  v_and_b32 v0, 16, v3
  v_mov_b32 v56, 0x3f80
  v_lshlrev_b32 v0, v0, v56
  v_cndmask_b32 v52, 0, v0, s[54:55]
  v_cndmask_b32 v53, 0, v0, s[56:57]
  v_cndmask_b32 v54, 0, v0, s[58:59]
  v_cndmask_b32 v55, 0, v0, s[60:61]
  v_mov_b32 v79, s45
  v_mov_b32 v28, 0
  v_mov_b32 v29, 0
  v_mov_b32 v30, 0
  v_mov_b32 v31, 0
  v_mov_b32 v32, 0
  v_mov_b32 v33, 0
  v_mov_b32 v34, 0
  v_mov_b32 v35, 0
  s_lshl_b32 s37, s44, 12
  s_add_u32 s37, s37, s51
  s_lshl_b32 s39, s44, 7
  s_add_u32 s53, s42, 1
  s_and_b32 s3, s53, 3
  s_lshl1_add_u32 s3, s3, 0
  s_mul_i32 s35, s3, 6144
  s_add_u32 s35, s35, s39
  s_add_u32 s35, s35, 131072
  s_and_b32 s3, s53, 3
  s_lshl1_add_u32 s3, s3, 0
  s_lshl_b32 s36, s3, 14
  s_add_u32 s36, s36, s39
  s_add_u32 s36, s36, s52
  s_add_u32 s36, s36, 0
  s_add_u32 s18, s18, 262144
  s_add_u32 s19, s19, 262144
  s_add_u32 s93, s18, 262144
  s_add_u32 s3, s42, 1
  s_and_b32 s38, s3, 3
  s_lshl_b32 s38, s38, 15
  s_add_u32 s38, s38, s52
  s_add_u32 s38, s38, 16384
  s_add_u32 s17, s38, 4096
  s_add_u32 s3, s3, 2
  s_and_b32 s21, s3, 3
  s_and_b32 s3, s3, 3
  s_mul_i32 s20, s3, 12288
  s_lshl_b32 s21, s21, 15
  s_add_u32 s20, s20, s16
  s_add_u32 s21, s21, s16
  s_add_u32 s20, s20, 131072
  s_add_u32 s21, s21, 0
  s_add_u32 s21, s21, s52
  buffer_load_dwordx4 v[60:63], v3, s[4:7], s37 offen offset:0 sc1
  buffer_load_dwordx4 v[64:67], v3, s[4:7], s37 offen offset:1024 sc1
  buffer_load_dwordx4 v[68:71], v3, s[4:7], s37 offen offset:2048 sc1
  buffer_load_dwordx4 v[72:75], v3, s[4:7], s37 offen offset:3072 sc1
  ds_read_b128 v[36:39], v2 offset:30720
  ds_read_b128 v[40:43], v2 offset:31744
  ds_read_b128 v[44:47], v2 offset:32768
  ds_read_b128 v[48:51], v2 offset:33792
  s_waitcnt lgkmcnt(0)
  buffer_load_dwordx4 v[12:15], v3, s[4:7], s37 offen offset:0 sc1
  buffer_load_dwordx4 v[16:19], v3, s[4:7], s37 offen offset:1024 sc1
  buffer_load_dwordx4 v[20:23], v3, s[4:7], s37 offen offset:2048 sc1
  buffer_load_dwordx4 v[24:27], v3, s[4:7], s37 offen offset:3072 sc1
L_loop4_rp:
  s_waitcnt vmcnt(7)
  v_mfma_f32_16x16x32_bf16 v[56:59], v[60:63], v[52:55], 0
  v_bitop3_b32 v0, v60, v62, v79 bitop3:0x7e
  s_waitcnt vmcnt(6)
  v_mfma_f32_16x16x32_bf16 v[56:59], v[64:67], v[52:55], v[56:59]
  v_bitop3_b32 v76, v64, v66, v79 bitop3:0x7e
  s_waitcnt vmcnt(5)
  v_mfma_f32_16x16x32_bf16 v[56:59], v[68:71], v[52:55], v[56:59]
  v_bitop3_b32 v77, v68, v70, v79 bitop3:0x7e
  v_or3_b32 v0, v0, v76, v77
  s_waitcnt vmcnt(4)
  v_mfma_f32_16x16x32_bf16 v[56:59], v[72:75], v[52:55], v[56:59]
  v_bitop3_b32 v78, v72, v74, v79 bitop3:0x7e
  v_bitop3_b32 v0, v0, v78, 1 bitop3:0xa8
  v_cmp_ne_u32 vcc, 0, v0
  s_nop 4
  v_permlane32_swap_b32 v56, v58
  v_permlane32_swap_b32 v57, v59
  v_pk_add_f32 v[56:57], v[56:57], v[58:59]
  v_cvt_pk_bf16_f32 v56, v56, v57
  v_min_u32 v56, -2, v56
  s_cbranch_vccnz L_loop4_rpr
L_loop4_rpok:
  buffer_store_dword v56, v10, s[4:7], s35 offen sc1
  buffer_store_dword v56, v10, s[4:7], s36 offen sc1
L_loop4_next:
  s_barrier
  s_waitcnt vmcnt(2)
  v_mov_b64 v[12:13], 0
  v_mov_b64 v[14:15], 0
  v_mov_b64 v[16:17], 0
  v_mov_b64 v[18:19], 0
  v_mov_b64 v[20:21], 0
  v_mov_b64 v[22:23], 0
  v_mov_b64 v[24:25], 0
  v_mov_b64 v[26:27], 0
  s_add_u32 s42, s42, 1
  s_xor_b32 s45, s45, 1
  s_waitcnt lgkmcnt(0)
  s_branch L_loop4_top
L_loop4_rpr:
  buffer_load_dwordx4 v[60:63], v3, s[4:7], s37 offen offset:0 sc1
  buffer_load_dwordx4 v[64:67], v3, s[4:7], s37 offen offset:1024 sc1
  buffer_load_dwordx4 v[68:71], v3, s[4:7], s37 offen offset:2048 sc1
  buffer_load_dwordx4 v[72:75], v3, s[4:7], s37 offen offset:3072 sc1
  s_waitcnt vmcnt(7)
  v_mfma_f32_16x16x32_bf16 v[56:59], v[12:15], v[52:55], 0
  v_bitop3_b32 v0, v12, v14, v79 bitop3:0x7e
  s_waitcnt vmcnt(6)
  v_mfma_f32_16x16x32_bf16 v[56:59], v[16:19], v[52:55], v[56:59]
  v_bitop3_b32 v76, v16, v18, v79 bitop3:0x7e
  s_waitcnt vmcnt(5)
  v_mfma_f32_16x16x32_bf16 v[56:59], v[20:23], v[52:55], v[56:59]
  v_bitop3_b32 v77, v20, v22, v79 bitop3:0x7e
  v_or3_b32 v0, v0, v76, v77
  s_waitcnt vmcnt(4)
  v_mfma_f32_16x16x32_bf16 v[56:59], v[24:27], v[52:55], v[56:59]
  v_bitop3_b32 v78, v24, v26, v79 bitop3:0x7e
  v_bitop3_b32 v0, v0, v78, 1 bitop3:0xa8
  v_cmp_ne_u32 vcc, 0, v0
  s_nop 4
  v_permlane32_swap_b32 v56, v58
  v_permlane32_swap_b32 v57, v59
  v_pk_add_f32 v[56:57], v[56:57], v[58:59]
  v_cvt_pk_bf16_f32 v56, v56, v57
  v_min_u32 v56, -2, v56
  s_cbranch_vccz L_loop4_rpok
  buffer_load_dwordx4 v[12:15], v3, s[4:7], s37 offen offset:0 sc1
  buffer_load_dwordx4 v[16:19], v3, s[4:7], s37 offen offset:1024 sc1
  buffer_load_dwordx4 v[20:23], v3, s[4:7], s37 offen offset:2048 sc1
  buffer_load_dwordx4 v[24:27], v3, s[4:7], s37 offen offset:3072 sc1
  s_sub_u32 s29, s29, 1
  s_cbranch_scc0 L_loop4_rp
  s_branch L_end
L_loop4_nored:
  ds_read_b128 v[36:39], v2 offset:30720
  ds_read_b128 v[40:43], v2 offset:31744
  ds_read_b128 v[44:47], v2 offset:32768
  ds_read_b128 v[48:51], v2 offset:33792
  v_mov_b64 v[12:13], 0
  v_mov_b64 v[14:15], 0
  v_mov_b64 v[16:17], 0
  v_mov_b64 v[18:19], 0
  v_mov_b64 v[20:21], 0
  v_mov_b64 v[22:23], 0
  v_mov_b64 v[24:25], 0
  v_mov_b64 v[26:27], 0
  v_mov_b64 v[28:29], 0
  v_mov_b64 v[30:31], 0
  v_mov_b64 v[32:33], 0
  v_mov_b64 v[34:35], 0
  s_add_u32 s18, s18, 262144
  s_add_u32 s19, s19, 262144
  s_add_u32 s93, s18, 262144
  s_add_u32 s3, s42, 1
  s_and_b32 s38, s3, 3
  s_lshl_b32 s38, s38, 15
  s_add_u32 s38, s38, s52
  s_add_u32 s38, s38, 16384
  s_add_u32 s17, s38, 4096
  s_add_u32 s3, s3, 2
  s_and_b32 s21, s3, 3
  s_and_b32 s3, s3, 3
  s_mul_i32 s20, s3, 12288
  s_lshl_b32 s21, s21, 15
  s_add_u32 s20, s20, s16
  s_add_u32 s21, s21, s16
  s_add_u32 s20, s20, 131072
  s_add_u32 s21, s21, 0
  s_add_u32 s21, s21, s52
  s_waitcnt vmcnt(0)
  s_mov_b32 s36, s16
  v_mov_b32 v56, 0
  s_branch L_loop4_next
L_loop4_rr0:
  buffer_load_dwordx4 v[60:63], v4, s[4:7], s38 offen offset:0 sc1
  buffer_load_dwordx4 v[64:67], v4, s[4:7], s38 offen offset:1024 sc1
  buffer_load_dwordx4 v[68:71], v4, s[4:7], s38 offen offset:2048 sc1
  buffer_load_dwordx4 v[72:75], v4, s[4:7], s38 offen offset:3072 sc1
  buffer_load_dwordx4 v[76:79], v4, s[4:7], s17 offen sc1
  s_mov_b32 m0, s62
  s_nop 0
  buffer_load_dwordx4 v3, s[4:7], s19 offen offset:0 sc1 lds
  buffer_load_dwordx4 v3, s[4:7], s19 offen offset:1024 sc1 lds
  s_mov_b32 m0, s94
  s_nop 0
  s_nop 0
  buffer_load_dwordx4 v3, s[4:7], s18 offen offset:3072 sc1 lds
  s_waitcnt vmcnt(7)
  v_cmp_eq_u32 vcc, -1, v60
  s_cbranch_vccz L_loop4_rok0
  s_sub_u32 s29, s29, 1
  s_cbranch_scc0 L_loop4_rr0
  s_branch L_end
L_loop4_rr1:
  buffer_load_dwordx4 v[64:67], v4, s[4:7], s38 offen offset:1024 sc1
  buffer_load_dwordx4 v[68:71], v4, s[4:7], s38 offen offset:2048 sc1
  buffer_load_dwordx4 v[72:75], v4, s[4:7], s38 offen offset:3072 sc1
  buffer_load_dwordx4 v[76:79], v4, s[4:7], s17 offen sc1
  s_mov_b32 m0, s62
  s_nop 0
  buffer_load_dwordx4 v3, s[4:7], s19 offen offset:0 sc1 lds
  buffer_load_dwordx4 v3, s[4:7], s19 offen offset:1024 sc1 lds
  s_mov_b32 m0, s94
  s_nop 0
  s_nop 0
  buffer_load_dwordx4 v3, s[4:7], s18 offen offset:3072 sc1 lds
  s_waitcnt vmcnt(6)
  v_cmp_eq_u32 vcc, -1, v64
  s_cbranch_vccz L_loop4_rok1
  s_sub_u32 s29, s29, 1
  s_cbranch_scc0 L_loop4_rr1
  s_branch L_end
L_loop4_rr2:
  buffer_load_dwordx4 v[68:71], v4, s[4:7], s38 offen offset:2048 sc1
  buffer_load_dwordx4 v[72:75], v4, s[4:7], s38 offen offset:3072 sc1
  buffer_load_dwordx4 v[76:79], v4, s[4:7], s17 offen sc1
  s_mov_b32 m0, s62
  s_nop 0
  buffer_load_dwordx4 v3, s[4:7], s19 offen offset:0 sc1 lds
  buffer_load_dwordx4 v3, s[4:7], s19 offen offset:1024 sc1 lds
  s_mov_b32 m0, s94
  s_nop 0
  s_nop 0
  buffer_load_dwordx4 v3, s[4:7], s18 offen offset:3072 sc1 lds
  s_waitcnt vmcnt(5)
  v_cmp_eq_u32 vcc, -1, v68
  s_cbranch_vccz L_loop4_rok2
  s_sub_u32 s29, s29, 1
  s_cbranch_scc0 L_loop4_rr2
  s_branch L_end
L_loop4_rr3:
  buffer_load_dwordx4 v[72:75], v4, s[4:7], s38 offen offset:3072 sc1
  buffer_load_dwordx4 v[76:79], v4, s[4:7], s17 offen sc1
  s_mov_b32 m0, s62
  s_nop 0
  buffer_load_dwordx4 v3, s[4:7], s19 offen offset:0 sc1 lds
  buffer_load_dwordx4 v3, s[4:7], s19 offen offset:1024 sc1 lds
  s_mov_b32 m0, s94
  s_nop 0
  s_nop 0
  buffer_load_dwordx4 v3, s[4:7], s18 offen offset:3072 sc1 lds
  s_waitcnt vmcnt(4)
  v_cmp_eq_u32 vcc, -1, v72
  s_cbranch_vccz L_loop4_rok3
  s_sub_u32 s29, s29, 1
  s_cbranch_scc0 L_loop4_rr3
  s_branch L_end
L_loop4_rr4:
  buffer_load_dwordx4 v[76:79], v4, s[4:7], s17 offen sc1
  s_mov_b32 m0, s62
  s_nop 0
  buffer_load_dwordx4 v3, s[4:7], s19 offen offset:0 sc1 lds
  buffer_load_dwordx4 v3, s[4:7], s19 offen offset:1024 sc1 lds
  s_mov_b32 m0, s94
  s_nop 0
  s_nop 0
  buffer_load_dwordx4 v3, s[4:7], s18 offen offset:3072 sc1 lds
  s_waitcnt vmcnt(3)
  v_cmp_eq_u32 vcc, -1, v76
  s_cbranch_vccz L_loop4_rok4
  s_sub_u32 s29, s29, 1
  s_cbranch_scc0 L_loop4_rr4
  s_branch L_end
L_loop4_last:
  s_waitcnt vmcnt(0) lgkmcnt(0)
  s_barrier
  s_add_u32 s3, s42, 1
  s_mov_b32 s92, s3
  s_cmp_lt_u32 s42, 63
  s_cbranch_scc1 L_loop4_back
  s_branch L_fin
L_loop5:
  s_add_u32 s18, s49, 8388608
  s_lshl_b32 s3, s40, 13
  s_lshl_b32 s19, s28, 11
  s_add_u32 s19, s19, s3
  s_add_u32 s19, s19, 25165824
  s_lshl_b32 s94, s43, 12
  s_add_u32 s94, s94, 16384
  v_lshlrev_b32 v0, 3, v3
  v_and_b32 v0, 0xf80, v0
  v_add_u32 v10, 16777216, v0
  v_cmp_gt_u32 vcc, 512, v3
  s_nop 1
  v_cndmask_b32 v10, v10, v0, vcc
  s_mov_b32 s92, 62
  s_add_u32 s90, s51, 16384
  s_lshl_b32 s3, s32, 7
  s_add_u32 s3, s3, 819200
  s_cmp_eq_u32 s43, 0
  s_cselect_b32 s48, s48, s3
L_loop5_top:
  s_add_u32 s93, s18, 262144
  s_add_u32 s3, s42, 0
  s_and_b32 s38, s3, 3
  s_lshl_b32 s38, s38, 15
  s_add_u32 s38, s38, s52
  s_add_u32 s38, s38, 16384
  s_add_u32 s17, s38, 4096
  s_and_b32 s3, s3, 3
  s_mul_i32 s3, s3, 12288
  s_add_u32 s15, s3, 135168
  s_lshl_b32 s37, s43, 11
  s_add_u32 s37, s37, s3
  s_add_u32 s37, s37, 131072
  s_add_u32 s3, s42, 2
  s_and_b32 s95, s3, 1
  s_lshl2_add_u32 s95, s95, s63
  s_lshr_b32 s96, s3, 1
  s_min_u32 s96, s96, 31
  s_lshl_b32 s3, s43, 11
  v_add_u32 v11, s3, v3
  s_lshl_b32 s3, s43, 9
  v_lshrrev_b32 v53, 1, v3
  v_and_b32 v0, 56, v53
  v_add_u32 v53, s3, v53
  v_bfe_u32 v52, v3, 7, 2
  v_lshl_add_u32 v0, v52, 7, v0
  v_lshrrev_b32 v52, 9, v3
  v_lshl_add_u32 v0, v52, 6, v0
  v_add_u32 v52, s3, v0
  buffer_load_dwordx4 v[60:63], v4, s[4:7], s37 offen sc1
  buffer_load_dwordx4 v[64:67], v4, s[4:7], s37 offen offset:1024 sc1
  buffer_load_dwordx2 v[76:77], v52, s[4:7], s15 offen sc1
  v_mov_b64 v[12:13], 0
  v_mov_b64 v[14:15], 0
  v_mov_b64 v[16:17], 0
  v_mov_b64 v[18:19], 0
  v_mov_b64 v[20:21], 0
  v_mov_b64 v[22:23], 0
  v_mov_b64 v[24:25], 0
  v_mov_b64 v[26:27], 0
  v_mov_b64 v[28:29], 0
  v_mov_b64 v[30:31], 0
  v_mov_b64 v[32:33], 0
  v_mov_b64 v[34:35], 0
  ds_read_b128 v[36:39], v2 offset:30720
  ds_read_b128 v[40:43], v2 offset:31744
  ds_read_b128 v[44:47], v2 offset:32768
  ds_read_b128 v[48:51], v2 offset:33792
  s_waitcnt lgkmcnt(0)
  buffer_load_dwordx4 v[68:71], v4, s[4:7], s37 offen sc1
  buffer_load_dwordx4 v[72:75], v4, s[4:7], s37 offen offset:1024 sc1
  buffer_load_dwordx2 v[78:79], v52, s[4:7], s15 offen sc1
L_loop5_pl:
  s_waitcnt vmcnt(5)
  ds_write_b128 v11, v[60:63]
  s_waitcnt vmcnt(4)
  ds_write_b128 v11, v[64:67] offset:1024
  s_waitcnt vmcnt(3)
  ds_write_b64 v53, v[76:77] offset:4096
  v_max3_u32 v0, v60, v64, v76
  v_cmp_eq_u32 vcc, -1, v0
  s_cbranch_vccnz L_loop5_plr
L_loop5_plok:
  s_waitcnt lgkmcnt(0)
  s_barrier
  ds_read_b128 v[52:55], v3 offset:0
  ds_read_b128 v[56:59], v3 offset:1024
  buffer_load_dwordx4 v[60:63], v4, s[4:7], s38 offen offset:0 sc1
  buffer_load_dwordx4 v[64:67], v4, s[4:7], s38 offen offset:1024 sc1
  buffer_load_dwordx4 v[68:71], v4, s[4:7], s38 offen offset:2048 sc1
  s_waitcnt lgkmcnt(1)
  v_smfmac_f32_16x16x64_bf16 v[28:31], v[52:55], v[36:43], v1
  ds_read_b128 v[36:39], v2 offset:2048
  v_smfmac_f32_16x16x64_bf16 v[12:15], v[52:55], v[80:87], v1
  ds_read_b128 v[40:43], v2 offset:3072
  v_smfmac_f32_16x16x64_bf16 v[16:19], v[52:55], v[88:95], v1
  buffer_load_dwordx4 v[72:75], v4, s[4:7], s38 offen offset:3072 sc1
  v_smfmac_f32_16x16x64_bf16 v[32:35], v[52:55], v[44:51], v1
  ds_read_b128 v[44:47], v2 offset:4096
  v_smfmac_f32_16x16x64_bf16 v[20:23], v[52:55], v[240:247], v1
  ds_read_b128 v[48:51], v2 offset:5120
  buffer_load_dwordx4 v[76:79], v4, s[4:7], s17 offen sc1
  s_mov_b32 m0, s62
  v_smfmac_f32_16x16x64_bf16 v[24:27], v[52:55], v[248:255], v1
  ds_read_b128 v[52:55], v3 offset:2048
  s_waitcnt lgkmcnt(3)
  v_smfmac_f32_16x16x64_bf16 v[28:31], v[56:59], v[36:43], v1
  ds_read_b128 v[36:39], v2 offset:6144
  v_smfmac_f32_16x16x64_bf16 v[12:15], v[56:59], v[96:103], v1
  ds_read_b128 v[40:43], v2 offset:7168
  v_smfmac_f32_16x16x64_bf16 v[16:19], v[56:59], v[104:111], v1
  s_waitcnt lgkmcnt(3)
  v_smfmac_f32_16x16x64_bf16 v[32:35], v[56:59], v[44:51], v1
  ds_read_b128 v[44:47], v2 offset:8192
  v_smfmac_f32_16x16x64_bf16 v[20:23], v[56:59], a[0:7], v1
  ds_read_b128 v[48:51], v2 offset:9216
  buffer_load_dwordx4 v3, s[4:7], s19 offen offset:0 sc1 lds
  v_smfmac_f32_16x16x64_bf16 v[24:27], v[56:59], a[8:15], v1
  ds_read_b128 v[56:59], v3 offset:3072
  s_waitcnt lgkmcnt(3)
  v_smfmac_f32_16x16x64_bf16 v[28:31], v[52:55], v[36:43], v1
  ds_read_b128 v[36:39], v2 offset:10240
  v_smfmac_f32_16x16x64_bf16 v[12:15], v[52:55], v[112:119], v1
  ds_read_b128 v[40:43], v2 offset:11264
  v_smfmac_f32_16x16x64_bf16 v[16:19], v[52:55], v[120:127], v1
  s_waitcnt lgkmcnt(3)
  v_smfmac_f32_16x16x64_bf16 v[32:35], v[52:55], v[44:51], v1
  ds_read_b128 v[44:47], v2 offset:12288
  v_smfmac_f32_16x16x64_bf16 v[20:23], v[52:55], a[16:23], v1
  ds_read_b128 v[48:51], v2 offset:13312
  buffer_load_dwordx4 v3, s[4:7], s19 offen offset:1024 sc1 lds
  v_smfmac_f32_16x16x64_bf16 v[24:27], v[52:55], a[24:31], v1
  ds_read_b128 v[52:55], v3 offset:4096
  s_waitcnt lgkmcnt(3)
  v_smfmac_f32_16x16x64_bf16 v[28:31], v[56:59], v[36:43], v1
  ds_read_b128 v[36:39], v2 offset:14336
  v_smfmac_f32_16x16x64_bf16 v[12:15], v[56:59], v[128:135], v1
  ds_read_b128 v[40:43], v2 offset:15360
  v_smfmac_f32_16x16x64_bf16 v[16:19], v[56:59], v[136:143], v1
  s_waitcnt lgkmcnt(3)
  v_smfmac_f32_16x16x64_bf16 v[32:35], v[56:59], v[44:51], v1
  ds_read_b128 v[44:47], v2 offset:16384
  v_smfmac_f32_16x16x64_bf16 v[20:23], v[56:59], a[32:39], v1
  ds_read_b128 v[48:51], v2 offset:17408
  v_smfmac_f32_16x16x64_bf16 v[24:27], v[56:59], a[40:47], v1
  s_waitcnt lgkmcnt(2)
  v_smfmac_f32_16x16x64_bf16 v[28:31], v[52:55], v[36:43], v1
  v_smfmac_f32_16x16x64_bf16 v[12:15], v[52:55], v[144:151], v1
  v_smfmac_f32_16x16x64_bf16 v[16:19], v[52:55], v[152:159], v1
  s_waitcnt lgkmcnt(0)
  v_smfmac_f32_16x16x64_bf16 v[32:35], v[52:55], v[44:51], v1
  s_waitcnt vmcnt(6)
  v_smfmac_f32_16x16x64_bf16 v[20:23], v[52:55], a[48:55], v1
  v_cmp_eq_u32 vcc, -1, v60
  v_smfmac_f32_16x16x64_bf16 v[24:27], v[52:55], a[56:63], v1
  s_cbranch_vccnz L_loop5_rr0
L_loop5_rok0:
  v_smfmac_f32_16x16x64_bf16 v[12:15], v[60:63], v[160:167], v1
  s_waitcnt vmcnt(5)
  v_smfmac_f32_16x16x64_bf16 v[16:19], v[60:63], v[168:175], v1
  v_cmp_eq_u32 vcc, -1, v64
  v_smfmac_f32_16x16x64_bf16 v[20:23], v[60:63], a[64:71], v1
  ds_read_b128 v[36:39], v3 offset:16384
  v_smfmac_f32_16x16x64_bf16 v[24:27], v[60:63], a[72:79], v1
  ds_read_b128 v[40:43], v3 offset:20480
  s_cbranch_vccnz L_loop5_rr1
L_loop5_rok1:
  v_smfmac_f32_16x16x64_bf16 v[12:15], v[64:67], v[176:183], v1
  s_waitcnt vmcnt(4)
  v_smfmac_f32_16x16x64_bf16 v[16:19], v[64:67], v[184:191], v1
  v_cmp_eq_u32 vcc, -1, v68
  v_smfmac_f32_16x16x64_bf16 v[20:23], v[64:67], a[80:87], v1
  ds_read_b128 v[44:47], v3 offset:17408
  v_smfmac_f32_16x16x64_bf16 v[24:27], v[64:67], a[88:95], v1
  ds_read_b128 v[48:51], v3 offset:21504
  s_cbranch_vccnz L_loop5_rr2
L_loop5_rok2:
  v_smfmac_f32_16x16x64_bf16 v[12:15], v[68:71], v[192:199], v1
  s_waitcnt vmcnt(3)
  v_smfmac_f32_16x16x64_bf16 v[16:19], v[68:71], v[200:207], v1
  v_cmp_eq_u32 vcc, -1, v72
  v_smfmac_f32_16x16x64_bf16 v[20:23], v[68:71], a[96:103], v1
  ds_read_b128 v[52:55], v3 offset:18432
  v_smfmac_f32_16x16x64_bf16 v[24:27], v[68:71], a[104:111], v1
  ds_read_b128 v[56:59], v3 offset:22528
  s_cbranch_vccnz L_loop5_rr3
L_loop5_rok3:
  v_smfmac_f32_16x16x64_bf16 v[12:15], v[72:75], v[208:215], v1
  s_waitcnt vmcnt(2)
  v_smfmac_f32_16x16x64_bf16 v[16:19], v[72:75], v[216:223], v1
  v_cmp_eq_u32 vcc, -1, v76
  v_smfmac_f32_16x16x64_bf16 v[20:23], v[72:75], a[112:119], v1
  v_smfmac_f32_16x16x64_bf16 v[24:27], v[72:75], a[120:127], v1
  s_cbranch_vccnz L_loop5_rr4
L_loop5_rok4:
  v_smfmac_f32_16x16x64_bf16 v[12:15], v[76:79], v[224:231], v1
  s_movk_i32 m0, 0x1800
  v_smfmac_f32_16x16x64_bf16 v[16:19], v[76:79], v[232:239], v1
  buffer_load_dword v10, s[4:7], s93 offen sc1 lds
  v_smfmac_f32_16x16x64_bf16 v[20:23], v[76:79], a[128:135], v1
  buffer_load_dword v11, off, s[4:7], s95 sc1
  v_smfmac_f32_16x16x64_bf16 v[24:27], v[76:79], a[136:143], v1
  v_smfmac_f32_16x16x64_bf16 v[28:31], v[60:63], a[144:151], v1
  s_nop 0
  v_smfmac_f32_16x16x64_bf16 v[32:35], v[60:63], a[152:159], v1
  s_nop 0
  v_add_f32 v12, v12, v14
  v_add_f32 v13, v13, v15
  v_add_f32 v16, v16, v18
  v_add_f32 v17, v17, v19
  v_add_f32 v20, v20, v22
  v_add_f32 v21, v21, v23
  v_add_f32 v24, v24, v26
  v_add_f32 v25, v25, v27
  v_cvt_pk_bf16_f32 v20, v20, v21
  v_cvt_pk_bf16_f32 v21, v12, v13
  v_cvt_pk_bf16_f32 v22, v24, v25
  v_cvt_pk_bf16_f32 v23, v16, v17
  ds_write2_b64 v5, v[20:21], v[22:23] offset0:0 offset1:64
  v_mov_b32 v12, v20
  v_mov_b32 v13, v22
  v_smfmac_f32_16x16x64_bf16 v[28:31], v[64:67], a[160:167], v1
  v_lshrrev_b32 v0, 1, v3
  v_smfmac_f32_16x16x64_bf16 v[32:35], v[64:67], a[168:175], v1
  buffer_store_dwordx2 v[12:13], v0, s[4:7], s50 offen sc1
  s_waitcnt lgkmcnt(0)
  s_barrier
  ds_read_b64_tr_b16 v[12:13], v6 offset:0
  ds_read_b64_tr_b16 v[14:15], v6 offset:256
  v_smfmac_f32_16x16x64_bf16 v[28:31], v[68:71], a[176:183], v1
  ds_read_b64_tr_b16 v[16:17], v6 offset:1024
  v_smfmac_f32_16x16x64_bf16 v[32:35], v[68:71], a[184:191], v1
  ds_read_b64_tr_b16 v[18:19], v6 offset:1280
  v_mov_b32 v60, s42
  v_smfmac_f32_16x16x64_bf16 v[28:31], v[72:75], a[192:199], v1
  ds_read_b64_tr_b16 v[20:21], v6 offset:2048
  buffer_store_dword v60, off, s[4:7], s48 sc1
  v_smfmac_f32_16x16x64_bf16 v[32:35], v[72:75], a[200:207], v1
  ds_read_b64_tr_b16 v[22:23], v6 offset:2304
  v_smfmac_f32_16x16x64_bf16 v[28:31], v[76:79], a[208:215], v1
  ds_read_b64_tr_b16 v[24:25], v6 offset:3072
  v_smfmac_f32_16x16x64_bf16 v[32:35], v[76:79], a[216:223], v1
  ds_read_b64_tr_b16 v[26:27], v6 offset:3328
  s_waitcnt lgkmcnt(6)
  v_mfma_f32_16x16x32_bf16 v[68:71], v[36:39], v[12:15], 0
  ds_read_b128 v[60:63], v3 offset:19456
  ds_read_b128 v[64:67], v3 offset:23552
  v_mfma_f32_16x16x32_bf16 v[72:75], v[40:43], v[12:15], 0
  s_nop 0
  s_nop 0
  s_waitcnt lgkmcnt(6)
  v_mfma_f32_16x16x32_bf16 v[68:71], v[44:47], v[16:19], v[68:71]
  v_add_f32 v28, v28, v30
  v_add_f32 v29, v29, v31
  v_mfma_f32_16x16x32_bf16 v[72:75], v[48:51], v[16:19], v[72:75]
  v_add_f32 v32, v32, v34
  s_waitcnt lgkmcnt(4)
  v_mfma_f32_16x16x32_bf16 v[68:71], v[52:55], v[20:23], v[68:71]
  v_add_f32 v33, v33, v35
  v_cvt_pk_bf16_f32 v33, v32, v33
  v_mfma_f32_16x16x32_bf16 v[72:75], v[56:59], v[20:23], v[72:75]
  v_cvt_pk_bf16_f32 v32, v28, v29
  s_waitcnt vmcnt(4)
  ds_read_b128 v[52:55], v2 offset:0
  ds_read_b128 v[56:59], v2 offset:1024
  s_waitcnt lgkmcnt(3)
  v_mfma_f32_16x16x32_bf16 v[68:71], v[60:63], v[24:27], v[68:71]
  v_mov_b64 v[44:45], s[24:25]
  s_waitcnt lgkmcnt(2)
  v_mfma_f32_16x16x32_bf16 v[72:75], v[64:67], v[24:27], v[72:75]
  v_mov_b64 v[46:47], s[24:25]
  v_mov_b32 v41, 0
  v_mfma_f32_16x16x32_bf16 v[76:79], v[12:15], v[12:15], 0
  v_mov_b32 v42, 0
  s_nop 0
  v_mfma_f32_16x16x32_bf16 v[76:79], v[16:19], v[16:19], v[76:79]
  s_nop 1
  v_mfma_f32_16x16x32_bf16 v[76:79], v[20:23], v[20:23], v[76:79]
  v_max3_f32 v28, v68, v69, v70
  s_cmp_eq_u32 s42, s92
  v_mfma_f32_16x16x32_bf16 v[76:79], v[24:27], v[24:27], v[76:79]
  v_max3_f32 v28, v28, v71, v72
  v_max3_f32 v28, v28, v73, v74
  s_cbranch_scc1 L_loop5_last
L_loop5_back:
  v_max_f32 v28, v28, v75
  ds_read_b128 v[60:63], v2 offset:18432
  ds_read_b128 v[64:67], v2 offset:19456
  s_nop 1
  v_max3_f32 v28, v28, v76, v77
  v_mov_b32 v29, v28
  s_nop 1
  v_permlane16_swap_b32 v29, v28
  v_max_f32 v28, v28, v29
  v_mov_b32 v29, v28
  s_nop 1
  v_permlane32_swap_b32 v29, v28
  v_max_f32 v28, v28, v29
  v_mul_f32 v28, s46, v28
  v_pk_fma_f32 v[68:69], v[68:69], s[46:47], v[28:29] op_sel_hi:[1,0,0] neg_lo:[0,0,1] neg_hi:[0,0,1]
  v_pk_fma_f32 v[70:71], v[70:71], s[46:47], v[28:29] op_sel_hi:[1,0,0] neg_lo:[0,0,1] neg_hi:[0,0,1]
  v_pk_fma_f32 v[72:73], v[72:73], s[46:47], v[28:29] op_sel_hi:[1,0,0] neg_lo:[0,0,1] neg_hi:[0,0,1]
  v_pk_fma_f32 v[74:75], v[74:75], s[46:47], v[28:29] op_sel_hi:[1,0,0] neg_lo:[0,0,1] neg_hi:[0,0,1]
  v_pk_fma_f32 v[76:77], v[76:77], s[46:47], v[28:29] op_sel_hi:[1,0,0] neg_lo:[0,0,1] neg_hi:[0,0,1]
  v_exp_f32 v68, v68
  v_exp_f32 v69, v69
  v_exp_f32 v70, v70
  v_cvt_pk_bf16_f32 v36, v68, v69
  v_exp_f32 v71, v71
  v_exp_f32 v72, v72
  v_cvt_pk_bf16_f32 v37, v70, v71
  v_exp_f32 v73, v73
  v_exp_f32 v74, v74
  v_cvt_pk_bf16_f32 v38, v72, v73
  v_exp_f32 v75, v75
  v_exp_f32 v76, v76
  v_cvt_pk_bf16_f32 v39, v74, v75
  v_exp_f32 v77, v77
  s_waitcnt lgkmcnt(2)
  v_mfma_f32_16x16x32_bf16 v[20:23], v[44:47], v[36:39], 0
  v_cvt_pk_bf16_f32 v40, v76, v77
  v_cvt_pk_bf16_f32 v43, v76, v77
  v_mfma_f32_16x16x32_bf16 v[12:15], v[52:55], v[36:39], 0
  ds_read_b128 v[68:71], v2 offset:20480
  ds_read_b128 v[72:75], v2 offset:21504
  v_mfma_f32_16x16x32_bf16 v[16:19], v[56:59], v[36:39], 0
  ds_read_b128 v[52:55], v2 offset:22528
  ds_read_b128 v[56:59], v2 offset:23552
  v_mfma_f32_16x16x16_bf16 v[20:23], v[44:45], v[40:41], v[20:23]
  v_add_u32 v0, s14, v7
  v_mov_b64 v[24:25], 0
  v_mfma_f32_16x16x16_bf16 v[12:15], v[32:33], v[40:41], v[12:15]
  v_mov_b64 v[26:27], 0
  v_mov_b64 v[76:77], 0
  v_mfma_f32_16x16x16_bf16 v[16:19], v[32:33], v[42:43], v[16:19]
  v_mov_b64 v[78:79], 0
  s_nop 0
  v_rcp_f32 v30, v20
  s_mov_b32 m0, s94
  s_mov_b64 exec, s[26:27]
  v_pk_mul_f32 v[12:13], v[12:13], v[30:31] op_sel_hi:[1,0]
  v_pk_mul_f32 v[14:15], v[14:15], v[30:31] op_sel_hi:[1,0]
  v_cvt_pk_bf16_f32 v12, v12, v13
  v_pk_mul_f32 v[16:17], v[16:17], v[30:31] op_sel_hi:[1,0]
  v_pk_mul_f32 v[18:19], v[18:19], v[30:31] op_sel_hi:[1,0]
  v_cvt_pk_bf16_f32 v13, v14, v15
  v_cvt_pk_bf16_f32 v14, v16, v17
  v_cvt_pk_bf16_f32 v15, v18, v19
  ds_write_b128 v0, v[12:15]
  s_mov_b64 exec, -1
  ds_read_b128 v[36:39], v2 offset:24576
  ds_read_b128 v[40:43], v2 offset:25600
  v_mov_b64 v[20:21], 0
  v_mov_b64 v[22:23], 0
  v_mov_b64 v[44:45], 0
  v_mov_b64 v[46:47], 0
  v_mov_b64 v[48:49], 0
  v_mov_b64 v[50:51], 0
  buffer_load_dwordx4 v3, s[4:7], s93 offen offset:0 sc1 lds
  buffer_load_dwordx4 v3, s[4:7], s93 offen offset:1024 sc1 lds
  buffer_load_dwordx4 v3, s[4:7], s93 offen offset:2048 sc1 lds
  s_waitcnt lgkmcnt(2)
  s_barrier
  ds_read_b128 v[16:19], v7 offset:0
  ds_read_b128 v[12:15], v7 offset:1024
  ds_read_b128 v[28:31], v2 offset:26624
  ds_read_b128 v[32:35], v2 offset:27648
  s_add_u32 s50, s50, 131072
  s_waitcnt lgkmcnt(3)
  v_smfmac_f32_16x16x64_bf16 v[20:23], v[16:19], v[60:67], v1
  ds_read_b128 v[60:63], v2 offset:28672
  v_smfmac_f32_16x16x64_bf16 v[24:27], v[16:19], v[68:75], v1
  s_waitcnt lgkmcnt(3)
  v_smfmac_f32_16x16x64_bf16 v[20:23], v[12:15], v[52:59], v1
  ds_read_b128 v[64:67], v2 offset:29696
  v_smfmac_f32_16x16x64_bf16 v[24:27], v[12:15], v[36:43], v1
  s_waitcnt lgkmcnt(2)
  v_smfmac_f32_16x16x64_bf16 v[44:47], v[16:19], v[28:35], v1
  s_nop 0
  v_smfmac_f32_16x16x64_bf16 v[48:51], v[16:19], a[224:231], v1
  s_nop 0
  v_smfmac_f32_16x16x64_bf16 v[44:47], v[12:15], a[240:247], v1
  v_add_f32 v20, v20, v22
  v_smfmac_f32_16x16x64_bf16 v[48:51], v[12:15], a[248:255], v1
  v_add_f32 v21, v21, v23
  v_smfmac_f32_16x16x64_bf16 v[76:79], v[16:19], a[232:239], v1
  v_add_f32 v24, v24, v26
  s_waitcnt lgkmcnt(0)
  v_smfmac_f32_16x16x64_bf16 v[76:79], v[12:15], v[60:67], v1
  v_add_f32 v25, v25, v27
  v_cvt_pk_bf16_f32 v20, v20, v21
  v_cvt_pk_bf16_f32 v21, v24, v25
  v_and_or_b32 v20, v20, -2, s45
  buffer_store_dwordx2 v[20:21], v8, s[4:7], s51 offen sc1
  v_pk_add_f32 v[44:45], v[44:45], v[46:47]
  v_pk_add_f32 v[48:49], v[48:49], v[50:51]
  v_cvt_pk_bf16_f32 v44, v44, v45
  v_cvt_pk_bf16_f32 v45, v48, v49
  v_and_or_b32 v44, v44, -2, s45
  buffer_store_dwordx2 v[44:45], v8, s[4:7], s90 offen sc1
  v_pk_add_f32 v[76:77], v[76:77], v[78:79]
  v_cvt_pk_bf16_f32 v76, v76, v77
  v_and_or_b32 v76, v76, -2, s45
  buffer_store_dword v76, v9, s[4:7], s51 offen sc1
  s_waitcnt vmcnt(0)
  s_barrier
  v_readfirstlane_b32 s3, v11
  s_add_u32 s42, s42, 1
  s_xor_b32 s45, s45, 1
  s_cmp_gt_u32 s3, s96
  s_cbranch_scc0 L_loop5_kvw
L_loop5_kvok:
  s_add_u32 s18, s18, 262144
  s_add_u32 s19, s19, 262144
  s_branch L_loop5_top
L_loop5_plr:
  s_waitcnt lgkmcnt(0)
  buffer_load_dwordx4 v[60:63], v4, s[4:7], s37 offen sc1
  buffer_load_dwordx4 v[64:67], v4, s[4:7], s37 offen offset:1024 sc1
  buffer_load_dwordx2 v[76:77], v52, s[4:7], s15 offen sc1
  s_waitcnt vmcnt(5)
  ds_write_b128 v11, v[68:71]
  s_waitcnt vmcnt(4)
  ds_write_b128 v11, v[72:75] offset:1024
  s_waitcnt vmcnt(3)
  ds_write_b64 v53, v[78:79] offset:4096
  v_max3_u32 v0, v68, v72, v78
  v_cmp_eq_u32 vcc, -1, v0
  s_cbranch_vccz L_loop5_plok
  s_waitcnt lgkmcnt(0)
  buffer_load_dwordx4 v[68:71], v4, s[4:7], s37 offen sc1
  buffer_load_dwordx4 v[72:75], v4, s[4:7], s37 offen offset:1024 sc1
  buffer_load_dwordx2 v[78:79], v52, s[4:7], s15 offen sc1
  s_sub_u32 s29, s29, 1
  s_cbranch_scc0 L_loop5_pl
  s_branch L_end
L_loop5_kvw:
  buffer_load_dword v11, off, s[4:7], s95 sc1
  s_waitcnt vmcnt(0)
  v_readfirstlane_b32 s3, v11
  s_nop 0
  s_cmp_gt_u32 s3, s96
  s_cbranch_scc1 L_loop5_kvok
  s_sleep 1
  s_sub_u32 s29, s29, 1
  s_cbranch_scc0 L_loop5_kvw
  s_branch L_end
L_loop5_rr0:
  buffer_load_dwordx4 v[60:63], v4, s[4:7], s38 offen offset:0 sc1
  buffer_load_dwordx4 v[64:67], v4, s[4:7], s38 offen offset:1024 sc1
  buffer_load_dwordx4 v[68:71], v4, s[4:7], s38 offen offset:2048 sc1
  buffer_load_dwordx4 v[72:75], v4, s[4:7], s38 offen offset:3072 sc1
  buffer_load_dwordx4 v[76:79], v4, s[4:7], s17 offen sc1
  s_mov_b32 m0, s62
  s_nop 0
  buffer_load_dwordx4 v3, s[4:7], s19 offen offset:0 sc1 lds
  buffer_load_dwordx4 v3, s[4:7], s19 offen offset:1024 sc1 lds
  s_waitcnt vmcnt(6)
  v_cmp_eq_u32 vcc, -1, v60
  s_cbranch_vccz L_loop5_rok0
  s_sub_u32 s29, s29, 1
  s_cbranch_scc0 L_loop5_rr0
  s_branch L_end
L_loop5_rr1:
  buffer_load_dwordx4 v[64:67], v4, s[4:7], s38 offen offset:1024 sc1
  buffer_load_dwordx4 v[68:71], v4, s[4:7], s38 offen offset:2048 sc1
  buffer_load_dwordx4 v[72:75], v4, s[4:7], s38 offen offset:3072 sc1
  buffer_load_dwordx4 v[76:79], v4, s[4:7], s17 offen sc1
  s_mov_b32 m0, s62
  s_nop 0
  buffer_load_dwordx4 v3, s[4:7], s19 offen offset:0 sc1 lds
  buffer_load_dwordx4 v3, s[4:7], s19 offen offset:1024 sc1 lds
  s_waitcnt vmcnt(5)
  v_cmp_eq_u32 vcc, -1, v64
  s_cbranch_vccz L_loop5_rok1
  s_sub_u32 s29, s29, 1
  s_cbranch_scc0 L_loop5_rr1
  s_branch L_end
L_loop5_rr2:
  buffer_load_dwordx4 v[68:71], v4, s[4:7], s38 offen offset:2048 sc1
  buffer_load_dwordx4 v[72:75], v4, s[4:7], s38 offen offset:3072 sc1
  buffer_load_dwordx4 v[76:79], v4, s[4:7], s17 offen sc1
  s_mov_b32 m0, s62
  s_nop 0
  buffer_load_dwordx4 v3, s[4:7], s19 offen offset:0 sc1 lds
  buffer_load_dwordx4 v3, s[4:7], s19 offen offset:1024 sc1 lds
  s_waitcnt vmcnt(4)
  v_cmp_eq_u32 vcc, -1, v68
  s_cbranch_vccz L_loop5_rok2
  s_sub_u32 s29, s29, 1
  s_cbranch_scc0 L_loop5_rr2
  s_branch L_end
L_loop5_rr3:
  buffer_load_dwordx4 v[72:75], v4, s[4:7], s38 offen offset:3072 sc1
  buffer_load_dwordx4 v[76:79], v4, s[4:7], s17 offen sc1
  s_mov_b32 m0, s62
  s_nop 0
  buffer_load_dwordx4 v3, s[4:7], s19 offen offset:0 sc1 lds
  buffer_load_dwordx4 v3, s[4:7], s19 offen offset:1024 sc1 lds
  s_waitcnt vmcnt(3)
  v_cmp_eq_u32 vcc, -1, v72
  s_cbranch_vccz L_loop5_rok3
  s_sub_u32 s29, s29, 1
  s_cbranch_scc0 L_loop5_rr3
  s_branch L_end
L_loop5_rr4:
  buffer_load_dwordx4 v[76:79], v4, s[4:7], s17 offen sc1
  s_mov_b32 m0, s62
  s_nop 0
  buffer_load_dwordx4 v3, s[4:7], s19 offen offset:0 sc1 lds
  buffer_load_dwordx4 v3, s[4:7], s19 offen offset:1024 sc1 lds
  s_waitcnt vmcnt(2)
  v_cmp_eq_u32 vcc, -1, v76
  s_cbranch_vccz L_loop5_rok4
  s_sub_u32 s29, s29, 1
  s_cbranch_scc0 L_loop5_rr4
  s_branch L_end
L_loop5_last:
  s_waitcnt vmcnt(0) lgkmcnt(0)
  s_barrier
  s_add_u32 s3, s42, 1
  v_mov_b32 v0, s3
  s_mov_b64 exec, 1
  buffer_store_dword v0, off, s[4:7], s48 sc1
  s_mov_b64 exec, -1
  s_mov_b32 s92, s3
  s_cmp_lt_u32 s42, 63
  s_cbranch_scc1 L_loop5_back
  s_branch L_fin
L_loop6:
  s_lshl_b32 s16, s44, 7
  s_lshl_b32 s3, s40, 7
  s_add_u32 s3, s3, 589824
  s_cmp_ge_u32 s44, 40
  s_cselect_b32 s16, s3, s16
  s_add_u32 s18, s49, 8388608
  s_lshl_b32 s3, s40, 13
  s_lshl_b32 s19, s28, 11
  s_add_u32 s19, s19, s3
  s_add_u32 s19, s19, 25165824
  s_lshl_b32 s94, s43, 12
  s_add_u32 s94, s94, 16384
  s_mov_b32 s92, 62
  s_add_u32 s90, s51, 16384
  s_add_u32 s93, s18, 262144
  s_add_u32 s3, s42, 0
  s_and_b32 s38, s3, 3
  s_lshl_b32 s38, s38, 15
  s_add_u32 s38, s38, s52
  s_add_u32 s38, s38, 0
  s_add_u32 s17, s38, 4096
  s_add_u32 s3, s3, 2
  s_and_b32 s21, s3, 3
  s_and_b32 s3, s3, 3
  s_mul_i32 s20, s3, 12288
  s_lshl_b32 s21, s21, 15
  s_add_u32 s20, s20, s16
  s_add_u32 s21, s21, s16
  s_add_u32 s20, s20, 137216
  s_add_u32 s21, s21, 16384
  s_add_u32 s21, s21, s52
L_loop6_top:
  s_barrier
  ds_read_b128 v[52:55], v3 offset:0
  ds_read_b128 v[56:59], v3 offset:1024
  buffer_load_dwordx4 v[60:63], v4, s[4:7], s38 offen offset:0 sc1
  buffer_load_dwordx4 v[64:67], v4, s[4:7], s38 offen offset:1024 sc1
  buffer_load_dwordx4 v[68:71], v4, s[4:7], s38 offen offset:2048 sc1
  s_waitcnt lgkmcnt(1)
  v_smfmac_f32_16x16x64_bf16 v[28:31], v[52:55], v[36:43], v1
  ds_read_b128 v[36:39], v2 offset:2048
  v_smfmac_f32_16x16x64_bf16 v[12:15], v[52:55], v[80:87], v1
  ds_read_b128 v[40:43], v2 offset:3072
  v_smfmac_f32_16x16x64_bf16 v[16:19], v[52:55], v[88:95], v1
  buffer_load_dwordx4 v[72:75], v4, s[4:7], s38 offen offset:3072 sc1
  v_smfmac_f32_16x16x64_bf16 v[32:35], v[52:55], v[44:51], v1
  ds_read_b128 v[44:47], v2 offset:4096
  v_smfmac_f32_16x16x64_bf16 v[20:23], v[52:55], v[240:247], v1
  ds_read_b128 v[48:51], v2 offset:5120
  buffer_load_dwordx4 v[76:79], v4, s[4:7], s17 offen sc1
  s_mov_b32 m0, s62
  v_smfmac_f32_16x16x64_bf16 v[24:27], v[52:55], v[248:255], v1
  ds_read_b128 v[52:55], v3 offset:2048
  s_waitcnt lgkmcnt(3)
  v_smfmac_f32_16x16x64_bf16 v[28:31], v[56:59], v[36:43], v1
  ds_read_b128 v[36:39], v2 offset:6144
  v_smfmac_f32_16x16x64_bf16 v[12:15], v[56:59], v[96:103], v1
  ds_read_b128 v[40:43], v2 offset:7168
  v_smfmac_f32_16x16x64_bf16 v[16:19], v[56:59], v[104:111], v1
  s_waitcnt lgkmcnt(3)
  v_smfmac_f32_16x16x64_bf16 v[32:35], v[56:59], v[44:51], v1
  ds_read_b128 v[44:47], v2 offset:8192
  v_smfmac_f32_16x16x64_bf16 v[20:23], v[56:59], a[0:7], v1
  ds_read_b128 v[48:51], v2 offset:9216
  buffer_load_dwordx4 v3, s[4:7], s19 offen offset:0 sc1 lds
  v_smfmac_f32_16x16x64_bf16 v[24:27], v[56:59], a[8:15], v1
  ds_read_b128 v[56:59], v3 offset:3072
  s_waitcnt lgkmcnt(3)
  v_smfmac_f32_16x16x64_bf16 v[28:31], v[52:55], v[36:43], v1
  ds_read_b128 v[36:39], v2 offset:10240
  v_smfmac_f32_16x16x64_bf16 v[12:15], v[52:55], v[112:119], v1
  ds_read_b128 v[40:43], v2 offset:11264
  v_smfmac_f32_16x16x64_bf16 v[16:19], v[52:55], v[120:127], v1
  s_waitcnt lgkmcnt(3)
  v_smfmac_f32_16x16x64_bf16 v[32:35], v[52:55], v[44:51], v1
  ds_read_b128 v[44:47], v2 offset:12288
  v_smfmac_f32_16x16x64_bf16 v[20:23], v[52:55], a[16:23], v1
  ds_read_b128 v[48:51], v2 offset:13312
  buffer_load_dwordx4 v3, s[4:7], s19 offen offset:1024 sc1 lds
  s_mov_b32 m0, s94
  s_nop 0
  v_smfmac_f32_16x16x64_bf16 v[24:27], v[52:55], a[24:31], v1
  ds_read_b128 v[52:55], v3 offset:4096
  s_waitcnt lgkmcnt(3)
  v_smfmac_f32_16x16x64_bf16 v[28:31], v[56:59], v[36:43], v1
  ds_read_b128 v[36:39], v2 offset:14336
  v_smfmac_f32_16x16x64_bf16 v[12:15], v[56:59], v[128:135], v1
  ds_read_b128 v[40:43], v2 offset:15360
  v_smfmac_f32_16x16x64_bf16 v[16:19], v[56:59], v[136:143], v1
  s_waitcnt lgkmcnt(3)
  v_smfmac_f32_16x16x64_bf16 v[32:35], v[56:59], v[44:51], v1
  ds_read_b128 v[44:47], v2 offset:16384
  v_smfmac_f32_16x16x64_bf16 v[20:23], v[56:59], a[32:39], v1
  ds_read_b128 v[48:51], v2 offset:17408
  buffer_load_dwordx4 v3, s[4:7], s18 offen offset:3072 sc1 lds
  v_smfmac_f32_16x16x64_bf16 v[24:27], v[56:59], a[40:47], v1
  s_waitcnt lgkmcnt(2)
  v_smfmac_f32_16x16x64_bf16 v[28:31], v[52:55], v[36:43], v1
  v_smfmac_f32_16x16x64_bf16 v[12:15], v[52:55], v[144:151], v1
  v_smfmac_f32_16x16x64_bf16 v[16:19], v[52:55], v[152:159], v1
  s_waitcnt lgkmcnt(0)
  v_smfmac_f32_16x16x64_bf16 v[32:35], v[52:55], v[44:51], v1
  s_waitcnt vmcnt(7)
  v_smfmac_f32_16x16x64_bf16 v[20:23], v[52:55], a[48:55], v1
  v_cmp_eq_u32 vcc, -1, v60
  v_smfmac_f32_16x16x64_bf16 v[24:27], v[52:55], a[56:63], v1
  s_cbranch_vccnz L_loop6_rr0
L_loop6_rok0:
  v_smfmac_f32_16x16x64_bf16 v[12:15], v[60:63], v[160:167], v1
  s_waitcnt vmcnt(6)
  v_smfmac_f32_16x16x64_bf16 v[16:19], v[60:63], v[168:175], v1
  v_cmp_eq_u32 vcc, -1, v64
  v_smfmac_f32_16x16x64_bf16 v[20:23], v[60:63], a[64:71], v1
  ds_read_b128 v[36:39], v3 offset:16384
  v_smfmac_f32_16x16x64_bf16 v[24:27], v[60:63], a[72:79], v1
  ds_read_b128 v[40:43], v3 offset:20480
  s_cbranch_vccnz L_loop6_rr1
L_loop6_rok1:
  v_smfmac_f32_16x16x64_bf16 v[12:15], v[64:67], v[176:183], v1
  s_waitcnt vmcnt(5)
  v_smfmac_f32_16x16x64_bf16 v[16:19], v[64:67], v[184:191], v1
  v_cmp_eq_u32 vcc, -1, v68
  v_smfmac_f32_16x16x64_bf16 v[20:23], v[64:67], a[80:87], v1
  ds_read_b128 v[44:47], v3 offset:17408
  v_smfmac_f32_16x16x64_bf16 v[24:27], v[64:67], a[88:95], v1
  ds_read_b128 v[48:51], v3 offset:21504
  s_cbranch_vccnz L_loop6_rr2
L_loop6_rok2:
  v_smfmac_f32_16x16x64_bf16 v[12:15], v[68:71], v[192:199], v1
  s_waitcnt vmcnt(4)
  v_smfmac_f32_16x16x64_bf16 v[16:19], v[68:71], v[200:207], v1
  v_cmp_eq_u32 vcc, -1, v72
  v_smfmac_f32_16x16x64_bf16 v[20:23], v[68:71], a[96:103], v1
  ds_read_b128 v[52:55], v3 offset:18432
  v_smfmac_f32_16x16x64_bf16 v[24:27], v[68:71], a[104:111], v1
  ds_read_b128 v[56:59], v3 offset:22528
  s_cbranch_vccnz L_loop6_rr3
L_loop6_rok3:
  v_smfmac_f32_16x16x64_bf16 v[12:15], v[72:75], v[208:215], v1
  s_waitcnt vmcnt(3)
  v_smfmac_f32_16x16x64_bf16 v[16:19], v[72:75], v[216:223], v1
  v_cmp_eq_u32 vcc, -1, v76
  v_smfmac_f32_16x16x64_bf16 v[20:23], v[72:75], a[112:119], v1
  v_smfmac_f32_16x16x64_bf16 v[24:27], v[72:75], a[120:127], v1
  s_cbranch_vccnz L_loop6_rr4
L_loop6_rok4:
  v_smfmac_f32_16x16x64_bf16 v[12:15], v[76:79], v[224:231], v1
  v_mov_b32 v11, -1
  v_smfmac_f32_16x16x64_bf16 v[16:19], v[76:79], v[232:239], v1
  v_smfmac_f32_16x16x64_bf16 v[20:23], v[76:79], a[128:135], v1
  v_smfmac_f32_16x16x64_bf16 v[24:27], v[76:79], a[136:143], v1
  v_smfmac_f32_16x16x64_bf16 v[28:31], v[60:63], a[144:151], v1
  s_nop 0
  v_smfmac_f32_16x16x64_bf16 v[32:35], v[60:63], a[152:159], v1
  s_nop 0
  v_add_f32 v12, v12, v14
  v_add_f32 v13, v13, v15
  v_add_f32 v16, v16, v18
  v_add_f32 v17, v17, v19
  v_add_f32 v20, v20, v22
  v_add_f32 v21, v21, v23
  v_add_f32 v24, v24, v26
  v_add_f32 v25, v25, v27
  v_cvt_pk_bf16_f32 v20, v20, v21
  v_cvt_pk_bf16_f32 v21, v12, v13
  v_cvt_pk_bf16_f32 v22, v24, v25
  v_cvt_pk_bf16_f32 v23, v16, v17
  ds_write2_b64 v5, v[20:21], v[22:23] offset0:0 offset1:64
  v_smfmac_f32_16x16x64_bf16 v[28:31], v[64:67], a[160:167], v1
  v_lshrrev_b32 v0, 1, v3
  v_smfmac_f32_16x16x64_bf16 v[32:35], v[64:67], a[168:175], v1
  s_waitcnt vmcnt(0)
  s_waitcnt lgkmcnt(0)
  s_barrier
  ds_read_b64_tr_b16 v[12:13], v6 offset:0
  ds_read_b64_tr_b16 v[14:15], v6 offset:256
  v_smfmac_f32_16x16x64_bf16 v[28:31], v[68:71], a[176:183], v1
  ds_read_b64_tr_b16 v[16:17], v6 offset:1024
  v_smfmac_f32_16x16x64_bf16 v[32:35], v[68:71], a[184:191], v1
  ds_read_b64_tr_b16 v[18:19], v6 offset:1280
  buffer_store_dword v11, v10, s[4:7], s20 offen sc1
  v_smfmac_f32_16x16x64_bf16 v[28:31], v[72:75], a[192:199], v1
  ds_read_b64_tr_b16 v[20:21], v6 offset:2048
  buffer_store_dword v11, v10, s[4:7], s21 offen sc1
  v_smfmac_f32_16x16x64_bf16 v[32:35], v[72:75], a[200:207], v1
  ds_read_b64_tr_b16 v[22:23], v6 offset:2304
  v_smfmac_f32_16x16x64_bf16 v[28:31], v[76:79], a[208:215], v1
  ds_read_b64_tr_b16 v[24:25], v6 offset:3072
  v_smfmac_f32_16x16x64_bf16 v[32:35], v[76:79], a[216:223], v1
  ds_read_b64_tr_b16 v[26:27], v6 offset:3328
  s_waitcnt lgkmcnt(6)
  v_mfma_f32_16x16x32_bf16 v[68:71], v[36:39], v[12:15], 0
  ds_read_b128 v[60:63], v3 offset:19456
  ds_read_b128 v[64:67], v3 offset:23552
  v_mfma_f32_16x16x32_bf16 v[72:75], v[40:43], v[12:15], 0
  s_nop 0
  s_nop 0
  s_waitcnt lgkmcnt(6)
  v_mfma_f32_16x16x32_bf16 v[68:71], v[44:47], v[16:19], v[68:71]
  v_add_f32 v28, v28, v30
  v_add_f32 v29, v29, v31
  v_mfma_f32_16x16x32_bf16 v[72:75], v[48:51], v[16:19], v[72:75]
  v_add_f32 v32, v32, v34
  s_waitcnt lgkmcnt(4)
  v_mfma_f32_16x16x32_bf16 v[68:71], v[52:55], v[20:23], v[68:71]
  v_add_f32 v33, v33, v35
  v_cvt_pk_bf16_f32 v33, v32, v33
  v_mfma_f32_16x16x32_bf16 v[72:75], v[56:59], v[20:23], v[72:75]
  v_cvt_pk_bf16_f32 v32, v28, v29
  ds_read_b128 v[52:55], v2 offset:0
  ds_read_b128 v[56:59], v2 offset:1024
  s_waitcnt lgkmcnt(3)
  v_mfma_f32_16x16x32_bf16 v[68:71], v[60:63], v[24:27], v[68:71]
  v_mov_b64 v[44:45], s[24:25]
  s_waitcnt lgkmcnt(2)
  v_mfma_f32_16x16x32_bf16 v[72:75], v[64:67], v[24:27], v[72:75]
  v_mov_b64 v[46:47], s[24:25]
  v_mov_b32 v41, 0
  v_mfma_f32_16x16x32_bf16 v[76:79], v[12:15], v[12:15], 0
  v_mov_b32 v42, 0
  s_nop 0
  v_mfma_f32_16x16x32_bf16 v[76:79], v[16:19], v[16:19], v[76:79]
  buffer_store_dwordx2 v[32:33], v0, s[4:7], s50 offen sc1
  s_nop 0
  v_mfma_f32_16x16x32_bf16 v[76:79], v[20:23], v[20:23], v[76:79]
  v_max3_f32 v28, v68, v69, v70
  s_cmp_eq_u32 s42, s92
  v_mfma_f32_16x16x32_bf16 v[76:79], v[24:27], v[24:27], v[76:79]
  v_max3_f32 v28, v28, v71, v72
  v_max3_f32 v28, v28, v73, v74
  s_cbranch_scc1 L_loop6_last
L_loop6_back:
  v_max_f32 v28, v28, v75
  ds_read_b128 v[60:63], v2 offset:18432
  ds_read_b128 v[64:67], v2 offset:19456
  s_nop 1
  v_max3_f32 v28, v28, v76, v77
  v_mov_b32 v29, v28
  s_nop 1
  v_permlane16_swap_b32 v29, v28
  v_max_f32 v28, v28, v29
  v_mov_b32 v29, v28
  s_nop 1
  v_permlane32_swap_b32 v29, v28
  v_max_f32 v28, v28, v29
  v_mul_f32 v28, s46, v28
  v_pk_fma_f32 v[68:69], v[68:69], s[46:47], v[28:29] op_sel_hi:[1,0,0] neg_lo:[0,0,1] neg_hi:[0,0,1]
  v_pk_fma_f32 v[70:71], v[70:71], s[46:47], v[28:29] op_sel_hi:[1,0,0] neg_lo:[0,0,1] neg_hi:[0,0,1]
  v_pk_fma_f32 v[72:73], v[72:73], s[46:47], v[28:29] op_sel_hi:[1,0,0] neg_lo:[0,0,1] neg_hi:[0,0,1]
  v_pk_fma_f32 v[74:75], v[74:75], s[46:47], v[28:29] op_sel_hi:[1,0,0] neg_lo:[0,0,1] neg_hi:[0,0,1]
  v_pk_fma_f32 v[76:77], v[76:77], s[46:47], v[28:29] op_sel_hi:[1,0,0] neg_lo:[0,0,1] neg_hi:[0,0,1]
  v_exp_f32 v68, v68
  v_exp_f32 v69, v69
  v_exp_f32 v70, v70
  v_cvt_pk_bf16_f32 v36, v68, v69
  v_exp_f32 v71, v71
  v_exp_f32 v72, v72
  v_cvt_pk_bf16_f32 v37, v70, v71
  v_exp_f32 v73, v73
  v_exp_f32 v74, v74
  v_cvt_pk_bf16_f32 v38, v72, v73
  v_exp_f32 v75, v75
  v_exp_f32 v76, v76
  v_cvt_pk_bf16_f32 v39, v74, v75
  v_exp_f32 v77, v77
  s_waitcnt lgkmcnt(2)
  v_mfma_f32_16x16x32_bf16 v[20:23], v[44:47], v[36:39], 0
  v_cvt_pk_bf16_f32 v40, v76, v77
  v_cvt_pk_bf16_f32 v43, v76, v77
  v_mfma_f32_16x16x32_bf16 v[12:15], v[52:55], v[36:39], 0
  ds_read_b128 v[68:71], v2 offset:20480
  ds_read_b128 v[72:75], v2 offset:21504
  v_mfma_f32_16x16x32_bf16 v[16:19], v[56:59], v[36:39], 0
  ds_read_b128 v[52:55], v2 offset:22528
  ds_read_b128 v[56:59], v2 offset:23552
  v_mfma_f32_16x16x16_bf16 v[20:23], v[44:45], v[40:41], v[20:23]
  v_add_u32 v0, s14, v7
  v_mov_b64 v[24:25], 0
  v_mfma_f32_16x16x16_bf16 v[12:15], v[32:33], v[40:41], v[12:15]
  v_mov_b64 v[26:27], 0
  v_mov_b64 v[76:77], 0
  v_mfma_f32_16x16x16_bf16 v[16:19], v[32:33], v[42:43], v[16:19]
  v_mov_b64 v[78:79], 0
  s_nop 0
  v_rcp_f32 v30, v20
  s_nop 0
  s_mov_b64 exec, s[26:27]
  v_pk_mul_f32 v[12:13], v[12:13], v[30:31] op_sel_hi:[1,0]
  v_pk_mul_f32 v[14:15], v[14:15], v[30:31] op_sel_hi:[1,0]
  v_cvt_pk_bf16_f32 v12, v12, v13
  v_pk_mul_f32 v[16:17], v[16:17], v[30:31] op_sel_hi:[1,0]
  v_pk_mul_f32 v[18:19], v[18:19], v[30:31] op_sel_hi:[1,0]
  v_cvt_pk_bf16_f32 v13, v14, v15
  v_cvt_pk_bf16_f32 v14, v16, v17
  v_cvt_pk_bf16_f32 v15, v18, v19
  ds_write_b128 v0, v[12:15]
  s_mov_b64 exec, -1
  ds_read_b128 v[36:39], v2 offset:24576
  ds_read_b128 v[40:43], v2 offset:25600
  v_mov_b64 v[20:21], 0
  v_mov_b64 v[22:23], 0
  v_mov_b64 v[44:45], 0
  v_mov_b64 v[46:47], 0
  v_mov_b64 v[48:49], 0
  v_mov_b64 v[50:51], 0
  s_waitcnt lgkmcnt(2)
  s_barrier
  ds_read_b128 v[16:19], v7 offset:0
  ds_read_b128 v[12:15], v7 offset:1024
  ds_read_b128 v[28:31], v2 offset:26624
  ds_read_b128 v[32:35], v2 offset:27648
  s_add_u32 s50, s50, 131072
  s_cmp_ge_u32 s44, 40
  s_waitcnt lgkmcnt(3)
  v_smfmac_f32_16x16x64_bf16 v[20:23], v[16:19], v[60:67], v1
  ds_read_b128 v[60:63], v2 offset:28672
  v_smfmac_f32_16x16x64_bf16 v[24:27], v[16:19], v[68:75], v1
  s_waitcnt lgkmcnt(3)
  v_smfmac_f32_16x16x64_bf16 v[20:23], v[12:15], v[52:59], v1
  ds_read_b128 v[64:67], v2 offset:29696
  v_smfmac_f32_16x16x64_bf16 v[24:27], v[12:15], v[36:43], v1
  s_waitcnt lgkmcnt(2)
  v_smfmac_f32_16x16x64_bf16 v[44:47], v[16:19], v[28:35], v1
  s_nop 0
  v_smfmac_f32_16x16x64_bf16 v[48:51], v[16:19], a[224:231], v1
  s_nop 0
  v_smfmac_f32_16x16x64_bf16 v[44:47], v[12:15], a[240:247], v1
  v_add_f32 v20, v20, v22
  v_smfmac_f32_16x16x64_bf16 v[48:51], v[12:15], a[248:255], v1
  v_add_f32 v21, v21, v23
  v_smfmac_f32_16x16x64_bf16 v[76:79], v[16:19], a[232:239], v1
  v_add_f32 v24, v24, v26
  s_waitcnt lgkmcnt(0)
  v_smfmac_f32_16x16x64_bf16 v[76:79], v[12:15], v[60:67], v1
  v_add_f32 v25, v25, v27
  v_cvt_pk_bf16_f32 v20, v20, v21
  v_cvt_pk_bf16_f32 v21, v24, v25
  v_and_or_b32 v20, v20, -2, s45
  buffer_store_dwordx2 v[20:21], v8, s[4:7], s51 offen sc1
  v_pk_add_f32 v[44:45], v[44:45], v[46:47]
  v_pk_add_f32 v[48:49], v[48:49], v[50:51]
  v_cvt_pk_bf16_f32 v44, v44, v45
  v_cvt_pk_bf16_f32 v45, v48, v49
  v_and_or_b32 v44, v44, -2, s45
  buffer_store_dwordx2 v[44:45], v8, s[4:7], s90 offen sc1
  v_pk_add_f32 v[76:77], v[76:77], v[78:79]
  v_cvt_pk_bf16_f32 v76, v76, v77
  v_and_or_b32 v76, v76, -2, s45
  buffer_store_dword v76, v9, s[4:7], s51 offen sc1
  s_cbranch_scc1 L_loop6_nored
  v_and_b32 v0, 16, v3
  v_mov_b32 v56, 0x3f80
  v_lshlrev_b32 v0, v0, v56
  v_cndmask_b32 v52, 0, v0, s[54:55]
  v_cndmask_b32 v53, 0, v0, s[56:57]
  v_cndmask_b32 v54, 0, v0, s[58:59]
  v_cndmask_b32 v55, 0, v0, s[60:61]
  v_mov_b32 v79, s45
  v_mov_b32 v28, 0
  v_mov_b32 v29, 0
  v_mov_b32 v30, 0
  v_mov_b32 v31, 0
  v_mov_b32 v32, 0
  v_mov_b32 v33, 0
  v_mov_b32 v34, 0
  v_mov_b32 v35, 0
  s_lshl_b32 s37, s44, 12
  s_add_u32 s37, s37, s51
  s_lshl_b32 s39, s44, 7
  s_add_u32 s53, s42, 1
  s_and_b32 s3, s53, 3
  s_lshl1_add_u32 s3, s3, 1
  s_mul_i32 s35, s3, 6144
  s_add_u32 s35, s35, s39
  s_add_u32 s35, s35, 131072
  s_and_b32 s3, s53, 3
  s_lshl1_add_u32 s3, s3, 1
  s_lshl_b32 s36, s3, 14
  s_add_u32 s36, s36, s39
  s_add_u32 s36, s36, s52
  s_add_u32 s36, s36, 0
  s_add_u32 s18, s18, 262144
  s_add_u32 s19, s19, 262144
  s_add_u32 s93, s18, 262144
  s_add_u32 s3, s42, 1
  s_and_b32 s38, s3, 3
  s_lshl_b32 s38, s38, 15
  s_add_u32 s38, s38, s52
  s_add_u32 s38, s38, 0
  s_add_u32 s17, s38, 4096
  s_add_u32 s3, s3, 2
  s_and_b32 s21, s3, 3
  s_and_b32 s3, s3, 3
  s_mul_i32 s20, s3, 12288
  s_lshl_b32 s21, s21, 15
  s_add_u32 s20, s20, s16
  s_add_u32 s21, s21, s16
  s_add_u32 s20, s20, 137216
  s_add_u32 s21, s21, 16384
  s_add_u32 s21, s21, s52
  buffer_load_dwordx4 v[60:63], v3, s[4:7], s37 offen offset:0 sc1
  buffer_load_dwordx4 v[64:67], v3, s[4:7], s37 offen offset:1024 sc1
  buffer_load_dwordx4 v[68:71], v3, s[4:7], s37 offen offset:2048 sc1
  buffer_load_dwordx4 v[72:75], v3, s[4:7], s37 offen offset:3072 sc1
  ds_read_b128 v[36:39], v2 offset:30720
  ds_read_b128 v[40:43], v2 offset:31744
  ds_read_b128 v[44:47], v2 offset:32768
  ds_read_b128 v[48:51], v2 offset:33792
  s_waitcnt lgkmcnt(0)
  buffer_load_dwordx4 v[12:15], v3, s[4:7], s37 offen offset:0 sc1
  buffer_load_dwordx4 v[16:19], v3, s[4:7], s37 offen offset:1024 sc1
  buffer_load_dwordx4 v[20:23], v3, s[4:7], s37 offen offset:2048 sc1
  buffer_load_dwordx4 v[24:27], v3, s[4:7], s37 offen offset:3072 sc1
L_loop6_rp:
  s_waitcnt vmcnt(7)
  v_mfma_f32_16x16x32_bf16 v[56:59], v[60:63], v[52:55], 0
  v_bitop3_b32 v0, v60, v62, v79 bitop3:0x7e
  s_waitcnt vmcnt(6)
  v_mfma_f32_16x16x32_bf16 v[56:59], v[64:67], v[52:55], v[56:59]
  v_bitop3_b32 v76, v64, v66, v79 bitop3:0x7e
  s_waitcnt vmcnt(5)
  v_mfma_f32_16x16x32_bf16 v[56:59], v[68:71], v[52:55], v[56:59]
  v_bitop3_b32 v77, v68, v70, v79 bitop3:0x7e
  v_or3_b32 v0, v0, v76, v77
  s_waitcnt vmcnt(4)
  v_mfma_f32_16x16x32_bf16 v[56:59], v[72:75], v[52:55], v[56:59]
  v_bitop3_b32 v78, v72, v74, v79 bitop3:0x7e
  v_bitop3_b32 v0, v0, v78, 1 bitop3:0xa8
  v_cmp_ne_u32 vcc, 0, v0
  s_nop 4
  v_permlane32_swap_b32 v56, v58
  v_permlane32_swap_b32 v57, v59
  v_pk_add_f32 v[56:57], v[56:57], v[58:59]
  v_cvt_pk_bf16_f32 v56, v56, v57
  v_min_u32 v56, -2, v56
  s_cbranch_vccnz L_loop6_rpr
L_loop6_rpok:
  buffer_store_dword v56, v10, s[4:7], s35 offen sc1
  buffer_store_dword v56, v10, s[4:7], s36 offen sc1
L_loop6_next:
  s_barrier
  s_waitcnt vmcnt(2)
  v_mov_b64 v[12:13], 0
  v_mov_b64 v[14:15], 0
  v_mov_b64 v[16:17], 0
  v_mov_b64 v[18:19], 0
  v_mov_b64 v[20:21], 0
  v_mov_b64 v[22:23], 0
  v_mov_b64 v[24:25], 0
  v_mov_b64 v[26:27], 0
  s_add_u32 s42, s42, 1
  s_xor_b32 s45, s45, 1
  s_waitcnt lgkmcnt(0)
  s_branch L_loop6_top
L_loop6_rpr:
  buffer_load_dwordx4 v[60:63], v3, s[4:7], s37 offen offset:0 sc1
  buffer_load_dwordx4 v[64:67], v3, s[4:7], s37 offen offset:1024 sc1
  buffer_load_dwordx4 v[68:71], v3, s[4:7], s37 offen offset:2048 sc1
  buffer_load_dwordx4 v[72:75], v3, s[4:7], s37 offen offset:3072 sc1
  s_waitcnt vmcnt(7)
  v_mfma_f32_16x16x32_bf16 v[56:59], v[12:15], v[52:55], 0
  v_bitop3_b32 v0, v12, v14, v79 bitop3:0x7e
  s_waitcnt vmcnt(6)
  v_mfma_f32_16x16x32_bf16 v[56:59], v[16:19], v[52:55], v[56:59]
  v_bitop3_b32 v76, v16, v18, v79 bitop3:0x7e
  s_waitcnt vmcnt(5)
  v_mfma_f32_16x16x32_bf16 v[56:59], v[20:23], v[52:55], v[56:59]
  v_bitop3_b32 v77, v20, v22, v79 bitop3:0x7e
  v_or3_b32 v0, v0, v76, v77
  s_waitcnt vmcnt(4)
  v_mfma_f32_16x16x32_bf16 v[56:59], v[24:27], v[52:55], v[56:59]
  v_bitop3_b32 v78, v24, v26, v79 bitop3:0x7e
  v_bitop3_b32 v0, v0, v78, 1 bitop3:0xa8
  v_cmp_ne_u32 vcc, 0, v0
  s_nop 4
  v_permlane32_swap_b32 v56, v58
  v_permlane32_swap_b32 v57, v59
  v_pk_add_f32 v[56:57], v[56:57], v[58:59]
  v_cvt_pk_bf16_f32 v56, v56, v57
  v_min_u32 v56, -2, v56
  s_cbranch_vccz L_loop6_rpok
  buffer_load_dwordx4 v[12:15], v3, s[4:7], s37 offen offset:0 sc1
  buffer_load_dwordx4 v[16:19], v3, s[4:7], s37 offen offset:1024 sc1
  buffer_load_dwordx4 v[20:23], v3, s[4:7], s37 offen offset:2048 sc1
  buffer_load_dwordx4 v[24:27], v3, s[4:7], s37 offen offset:3072 sc1
  s_sub_u32 s29, s29, 1
  s_cbranch_scc0 L_loop6_rp
  s_branch L_end
L_loop6_nored:
  ds_read_b128 v[36:39], v2 offset:30720
  ds_read_b128 v[40:43], v2 offset:31744
  ds_read_b128 v[44:47], v2 offset:32768
  ds_read_b128 v[48:51], v2 offset:33792
  v_mov_b64 v[12:13], 0
  v_mov_b64 v[14:15], 0
  v_mov_b64 v[16:17], 0
  v_mov_b64 v[18:19], 0
  v_mov_b64 v[20:21], 0
  v_mov_b64 v[22:23], 0
  v_mov_b64 v[24:25], 0
  v_mov_b64 v[26:27], 0
  v_mov_b64 v[28:29], 0
  v_mov_b64 v[30:31], 0
  v_mov_b64 v[32:33], 0
  v_mov_b64 v[34:35], 0
  s_add_u32 s18, s18, 262144
  s_add_u32 s19, s19, 262144
  s_add_u32 s93, s18, 262144
  s_add_u32 s3, s42, 1
  s_and_b32 s38, s3, 3
  s_lshl_b32 s38, s38, 15
  s_add_u32 s38, s38, s52
  s_add_u32 s38, s38, 0
  s_add_u32 s17, s38, 4096
  s_add_u32 s3, s3, 2
  s_and_b32 s21, s3, 3
  s_and_b32 s3, s3, 3
  s_mul_i32 s20, s3, 12288
  s_lshl_b32 s21, s21, 15
  s_add_u32 s20, s20, s16
  s_add_u32 s21, s21, s16
  s_add_u32 s20, s20, 137216
  s_add_u32 s21, s21, 16384
  s_add_u32 s21, s21, s52
  s_waitcnt vmcnt(0)
  s_mov_b32 s36, s16
  v_mov_b32 v56, 0
  s_branch L_loop6_next
L_loop6_rr0:
  buffer_load_dwordx4 v[60:63], v4, s[4:7], s38 offen offset:0 sc1
  buffer_load_dwordx4 v[64:67], v4, s[4:7], s38 offen offset:1024 sc1
  buffer_load_dwordx4 v[68:71], v4, s[4:7], s38 offen offset:2048 sc1
  buffer_load_dwordx4 v[72:75], v4, s[4:7], s38 offen offset:3072 sc1
  buffer_load_dwordx4 v[76:79], v4, s[4:7], s17 offen sc1
  s_mov_b32 m0, s62
  s_nop 0
  buffer_load_dwordx4 v3, s[4:7], s19 offen offset:0 sc1 lds
  buffer_load_dwordx4 v3, s[4:7], s19 offen offset:1024 sc1 lds
  s_mov_b32 m0, s94
  s_nop 0
  s_nop 0
  buffer_load_dwordx4 v3, s[4:7], s18 offen offset:3072 sc1 lds
  s_waitcnt vmcnt(7)
  v_cmp_eq_u32 vcc, -1, v60
  s_cbranch_vccz L_loop6_rok0
  s_sub_u32 s29, s29, 1
  s_cbranch_scc0 L_loop6_rr0
  s_branch L_end
L_loop6_rr1:
  buffer_load_dwordx4 v[64:67], v4, s[4:7], s38 offen offset:1024 sc1
  buffer_load_dwordx4 v[68:71], v4, s[4:7], s38 offen offset:2048 sc1
  buffer_load_dwordx4 v[72:75], v4, s[4:7], s38 offen offset:3072 sc1
  buffer_load_dwordx4 v[76:79], v4, s[4:7], s17 offen sc1
  s_mov_b32 m0, s62
  s_nop 0
  buffer_load_dwordx4 v3, s[4:7], s19 offen offset:0 sc1 lds
  buffer_load_dwordx4 v3, s[4:7], s19 offen offset:1024 sc1 lds
  s_mov_b32 m0, s94
  s_nop 0
  s_nop 0
  buffer_load_dwordx4 v3, s[4:7], s18 offen offset:3072 sc1 lds
  s_waitcnt vmcnt(6)
  v_cmp_eq_u32 vcc, -1, v64
  s_cbranch_vccz L_loop6_rok1
  s_sub_u32 s29, s29, 1
  s_cbranch_scc0 L_loop6_rr1
  s_branch L_end
L_loop6_rr2:
  buffer_load_dwordx4 v[68:71], v4, s[4:7], s38 offen offset:2048 sc1
  buffer_load_dwordx4 v[72:75], v4, s[4:7], s38 offen offset:3072 sc1
  buffer_load_dwordx4 v[76:79], v4, s[4:7], s17 offen sc1
  s_mov_b32 m0, s62
  s_nop 0
  buffer_load_dwordx4 v3, s[4:7], s19 offen offset:0 sc1 lds
  buffer_load_dwordx4 v3, s[4:7], s19 offen offset:1024 sc1 lds
  s_mov_b32 m0, s94
  s_nop 0
  s_nop 0
  buffer_load_dwordx4 v3, s[4:7], s18 offen offset:3072 sc1 lds
  s_waitcnt vmcnt(5)
  v_cmp_eq_u32 vcc, -1, v68
  s_cbranch_vccz L_loop6_rok2
  s_sub_u32 s29, s29, 1
  s_cbranch_scc0 L_loop6_rr2
  s_branch L_end
L_loop6_rr3:
  buffer_load_dwordx4 v[72:75], v4, s[4:7], s38 offen offset:3072 sc1
  buffer_load_dwordx4 v[76:79], v4, s[4:7], s17 offen sc1
  s_mov_b32 m0, s62
  s_nop 0
  buffer_load_dwordx4 v3, s[4:7], s19 offen offset:0 sc1 lds
  buffer_load_dwordx4 v3, s[4:7], s19 offen offset:1024 sc1 lds
  s_mov_b32 m0, s94
  s_nop 0
  s_nop 0
  buffer_load_dwordx4 v3, s[4:7], s18 offen offset:3072 sc1 lds
  s_waitcnt vmcnt(4)
  v_cmp_eq_u32 vcc, -1, v72
  s_cbranch_vccz L_loop6_rok3
  s_sub_u32 s29, s29, 1
  s_cbranch_scc0 L_loop6_rr3
  s_branch L_end
L_loop6_rr4:
  buffer_load_dwordx4 v[76:79], v4, s[4:7], s17 offen sc1
  s_mov_b32 m0, s62
  s_nop 0
  buffer_load_dwordx4 v3, s[4:7], s19 offen offset:0 sc1 lds
  buffer_load_dwordx4 v3, s[4:7], s19 offen offset:1024 sc1 lds
  s_mov_b32 m0, s94
  s_nop 0
  s_nop 0
  buffer_load_dwordx4 v3, s[4:7], s18 offen offset:3072 sc1 lds
  s_waitcnt vmcnt(3)
  v_cmp_eq_u32 vcc, -1, v76
  s_cbranch_vccz L_loop6_rok4
  s_sub_u32 s29, s29, 1
  s_cbranch_scc0 L_loop6_rr4
  s_branch L_end
L_loop6_last:
  s_waitcnt vmcnt(0) lgkmcnt(0)
  s_barrier
  s_add_u32 s3, s42, 1
  s_mov_b32 s92, s3
  s_cmp_lt_u32 s42, 63
  s_cbranch_scc1 L_loop6_back
  s_branch L_fin
L_loop7:
  s_add_u32 s18, s49, 8388608
  s_lshl_b32 s3, s40, 13
  s_lshl_b32 s19, s28, 11
  s_add_u32 s19, s19, s3
  s_add_u32 s19, s19, 25165824
  s_lshl_b32 s94, s43, 12
  s_add_u32 s94, s94, 16384
  v_lshlrev_b32 v0, 3, v3
  v_and_b32 v0, 0xf80, v0
  v_add_u32 v10, 16777216, v0
  v_cmp_gt_u32 vcc, 512, v3
  s_nop 1
  v_cndmask_b32 v10, v10, v0, vcc
  s_mov_b32 s92, 62
  s_add_u32 s90, s51, 16384
  s_lshl_b32 s3, s32, 7
  s_add_u32 s3, s3, 819200
  s_cmp_eq_u32 s43, 0
  s_cselect_b32 s48, s48, s3
L_loop7_top:
  s_add_u32 s93, s18, 262144
  s_add_u32 s3, s42, 0
  s_and_b32 s38, s3, 3
  s_lshl_b32 s38, s38, 15
  s_add_u32 s38, s38, s52
  s_add_u32 s38, s38, 0
  s_add_u32 s17, s38, 4096
  s_and_b32 s3, s3, 3
  s_mul_i32 s3, s3, 12288
  s_add_u32 s15, s3, 141312
  s_lshl_b32 s37, s43, 11
  s_add_u32 s37, s37, s3
  s_add_u32 s37, s37, 137216
  s_add_u32 s3, s42, 2
  s_and_b32 s95, s3, 1
  s_lshl2_add_u32 s95, s95, s63
  s_lshr_b32 s96, s3, 1
  s_min_u32 s96, s96, 31
  s_lshl_b32 s3, s43, 11
  v_add_u32 v11, s3, v3
  s_lshl_b32 s3, s43, 9
  v_lshrrev_b32 v53, 1, v3
  v_and_b32 v0, 56, v53
  v_add_u32 v53, s3, v53
  v_bfe_u32 v52, v3, 7, 2
  v_lshl_add_u32 v0, v52, 7, v0
  v_lshrrev_b32 v52, 9, v3
  v_lshl_add_u32 v0, v52, 6, v0
  v_add_u32 v52, s3, v0
  buffer_load_dwordx4 v[60:63], v4, s[4:7], s37 offen sc1
  buffer_load_dwordx4 v[64:67], v4, s[4:7], s37 offen offset:1024 sc1
  buffer_load_dwordx2 v[76:77], v52, s[4:7], s15 offen sc1
  v_mov_b64 v[12:13], 0
  v_mov_b64 v[14:15], 0
  v_mov_b64 v[16:17], 0
  v_mov_b64 v[18:19], 0
  v_mov_b64 v[20:21], 0
  v_mov_b64 v[22:23], 0
  v_mov_b64 v[24:25], 0
  v_mov_b64 v[26:27], 0
  v_mov_b64 v[28:29], 0
  v_mov_b64 v[30:31], 0
  v_mov_b64 v[32:33], 0
  v_mov_b64 v[34:35], 0
  ds_read_b128 v[36:39], v2 offset:30720
  ds_read_b128 v[40:43], v2 offset:31744
  ds_read_b128 v[44:47], v2 offset:32768
  ds_read_b128 v[48:51], v2 offset:33792
  s_waitcnt lgkmcnt(0)
  buffer_load_dwordx4 v[68:71], v4, s[4:7], s37 offen sc1
  buffer_load_dwordx4 v[72:75], v4, s[4:7], s37 offen offset:1024 sc1
  buffer_load_dwordx2 v[78:79], v52, s[4:7], s15 offen sc1
L_loop7_pl:
  s_waitcnt vmcnt(5)
  ds_write_b128 v11, v[60:63]
  s_waitcnt vmcnt(4)
  ds_write_b128 v11, v[64:67] offset:1024
  s_waitcnt vmcnt(3)
  ds_write_b64 v53, v[76:77] offset:4096
  v_max3_u32 v0, v60, v64, v76
  v_cmp_eq_u32 vcc, -1, v0
  s_cbranch_vccnz L_loop7_plr
L_loop7_plok:
  s_waitcnt lgkmcnt(0)
  s_barrier
  ds_read_b128 v[52:55], v3 offset:0
  ds_read_b128 v[56:59], v3 offset:1024
  buffer_load_dwordx4 v[60:63], v4, s[4:7], s38 offen offset:0 sc1
  buffer_load_dwordx4 v[64:67], v4, s[4:7], s38 offen offset:1024 sc1
  buffer_load_dwordx4 v[68:71], v4, s[4:7], s38 offen offset:2048 sc1
  s_waitcnt lgkmcnt(1)
  v_smfmac_f32_16x16x64_bf16 v[28:31], v[52:55], v[36:43], v1
  ds_read_b128 v[36:39], v2 offset:2048
  v_smfmac_f32_16x16x64_bf16 v[12:15], v[52:55], v[80:87], v1
  ds_read_b128 v[40:43], v2 offset:3072
  v_smfmac_f32_16x16x64_bf16 v[16:19], v[52:55], v[88:95], v1
  buffer_load_dwordx4 v[72:75], v4, s[4:7], s38 offen offset:3072 sc1
  v_smfmac_f32_16x16x64_bf16 v[32:35], v[52:55], v[44:51], v1
  ds_read_b128 v[44:47], v2 offset:4096
  v_smfmac_f32_16x16x64_bf16 v[20:23], v[52:55], v[240:247], v1
  ds_read_b128 v[48:51], v2 offset:5120
  buffer_load_dwordx4 v[76:79], v4, s[4:7], s17 offen sc1
  s_mov_b32 m0, s62
  v_smfmac_f32_16x16x64_bf16 v[24:27], v[52:55], v[248:255], v1
  ds_read_b128 v[52:55], v3 offset:2048
  s_waitcnt lgkmcnt(3)
  v_smfmac_f32_16x16x64_bf16 v[28:31], v[56:59], v[36:43], v1
  ds_read_b128 v[36:39], v2 offset:6144
  v_smfmac_f32_16x16x64_bf16 v[12:15], v[56:59], v[96:103], v1
  ds_read_b128 v[40:43], v2 offset:7168
  v_smfmac_f32_16x16x64_bf16 v[16:19], v[56:59], v[104:111], v1
  s_waitcnt lgkmcnt(3)
  v_smfmac_f32_16x16x64_bf16 v[32:35], v[56:59], v[44:51], v1
  ds_read_b128 v[44:47], v2 offset:8192
  v_smfmac_f32_16x16x64_bf16 v[20:23], v[56:59], a[0:7], v1
  ds_read_b128 v[48:51], v2 offset:9216
  buffer_load_dwordx4 v3, s[4:7], s19 offen offset:0 sc1 lds
  v_smfmac_f32_16x16x64_bf16 v[24:27], v[56:59], a[8:15], v1
  ds_read_b128 v[56:59], v3 offset:3072
  s_waitcnt lgkmcnt(3)
  v_smfmac_f32_16x16x64_bf16 v[28:31], v[52:55], v[36:43], v1
  ds_read_b128 v[36:39], v2 offset:10240
  v_smfmac_f32_16x16x64_bf16 v[12:15], v[52:55], v[112:119], v1
  ds_read_b128 v[40:43], v2 offset:11264
  v_smfmac_f32_16x16x64_bf16 v[16:19], v[52:55], v[120:127], v1
  s_waitcnt lgkmcnt(3)
  v_smfmac_f32_16x16x64_bf16 v[32:35], v[52:55], v[44:51], v1
  ds_read_b128 v[44:47], v2 offset:12288
  v_smfmac_f32_16x16x64_bf16 v[20:23], v[52:55], a[16:23], v1
  ds_read_b128 v[48:51], v2 offset:13312
  buffer_load_dwordx4 v3, s[4:7], s19 offen offset:1024 sc1 lds
  v_smfmac_f32_16x16x64_bf16 v[24:27], v[52:55], a[24:31], v1
  ds_read_b128 v[52:55], v3 offset:4096
  s_waitcnt lgkmcnt(3)
  v_smfmac_f32_16x16x64_bf16 v[28:31], v[56:59], v[36:43], v1
  ds_read_b128 v[36:39], v2 offset:14336
  v_smfmac_f32_16x16x64_bf16 v[12:15], v[56:59], v[128:135], v1
  ds_read_b128 v[40:43], v2 offset:15360
  v_smfmac_f32_16x16x64_bf16 v[16:19], v[56:59], v[136:143], v1
  s_waitcnt lgkmcnt(3)
  v_smfmac_f32_16x16x64_bf16 v[32:35], v[56:59], v[44:51], v1
  ds_read_b128 v[44:47], v2 offset:16384
  v_smfmac_f32_16x16x64_bf16 v[20:23], v[56:59], a[32:39], v1
  ds_read_b128 v[48:51], v2 offset:17408
  v_smfmac_f32_16x16x64_bf16 v[24:27], v[56:59], a[40:47], v1
  s_waitcnt lgkmcnt(2)
  v_smfmac_f32_16x16x64_bf16 v[28:31], v[52:55], v[36:43], v1
  v_smfmac_f32_16x16x64_bf16 v[12:15], v[52:55], v[144:151], v1
  v_smfmac_f32_16x16x64_bf16 v[16:19], v[52:55], v[152:159], v1
  s_waitcnt lgkmcnt(0)
  v_smfmac_f32_16x16x64_bf16 v[32:35], v[52:55], v[44:51], v1
  s_waitcnt vmcnt(6)
  v_smfmac_f32_16x16x64_bf16 v[20:23], v[52:55], a[48:55], v1
  v_cmp_eq_u32 vcc, -1, v60
  v_smfmac_f32_16x16x64_bf16 v[24:27], v[52:55], a[56:63], v1
  s_cbranch_vccnz L_loop7_rr0
L_loop7_rok0:
  v_smfmac_f32_16x16x64_bf16 v[12:15], v[60:63], v[160:167], v1
  s_waitcnt vmcnt(5)
  v_smfmac_f32_16x16x64_bf16 v[16:19], v[60:63], v[168:175], v1
  v_cmp_eq_u32 vcc, -1, v64
  v_smfmac_f32_16x16x64_bf16 v[20:23], v[60:63], a[64:71], v1
  ds_read_b128 v[36:39], v3 offset:16384
  v_smfmac_f32_16x16x64_bf16 v[24:27], v[60:63], a[72:79], v1
  ds_read_b128 v[40:43], v3 offset:20480
  s_cbranch_vccnz L_loop7_rr1
L_loop7_rok1:
  v_smfmac_f32_16x16x64_bf16 v[12:15], v[64:67], v[176:183], v1
  s_waitcnt vmcnt(4)
  v_smfmac_f32_16x16x64_bf16 v[16:19], v[64:67], v[184:191], v1
  v_cmp_eq_u32 vcc, -1, v68
  v_smfmac_f32_16x16x64_bf16 v[20:23], v[64:67], a[80:87], v1
  ds_read_b128 v[44:47], v3 offset:17408
  v_smfmac_f32_16x16x64_bf16 v[24:27], v[64:67], a[88:95], v1
  ds_read_b128 v[48:51], v3 offset:21504
  s_cbranch_vccnz L_loop7_rr2
L_loop7_rok2:
  v_smfmac_f32_16x16x64_bf16 v[12:15], v[68:71], v[192:199], v1
  s_waitcnt vmcnt(3)
  v_smfmac_f32_16x16x64_bf16 v[16:19], v[68:71], v[200:207], v1
  v_cmp_eq_u32 vcc, -1, v72
  v_smfmac_f32_16x16x64_bf16 v[20:23], v[68:71], a[96:103], v1
  ds_read_b128 v[52:55], v3 offset:18432
  v_smfmac_f32_16x16x64_bf16 v[24:27], v[68:71], a[104:111], v1
  ds_read_b128 v[56:59], v3 offset:22528
  s_cbranch_vccnz L_loop7_rr3
L_loop7_rok3:
  v_smfmac_f32_16x16x64_bf16 v[12:15], v[72:75], v[208:215], v1
  s_waitcnt vmcnt(2)
  v_smfmac_f32_16x16x64_bf16 v[16:19], v[72:75], v[216:223], v1
  v_cmp_eq_u32 vcc, -1, v76
  v_smfmac_f32_16x16x64_bf16 v[20:23], v[72:75], a[112:119], v1
  v_smfmac_f32_16x16x64_bf16 v[24:27], v[72:75], a[120:127], v1
  s_cbranch_vccnz L_loop7_rr4
L_loop7_rok4:
  v_smfmac_f32_16x16x64_bf16 v[12:15], v[76:79], v[224:231], v1
  s_movk_i32 m0, 0x1800
  v_smfmac_f32_16x16x64_bf16 v[16:19], v[76:79], v[232:239], v1
  buffer_load_dword v10, s[4:7], s93 offen sc1 lds
  v_smfmac_f32_16x16x64_bf16 v[20:23], v[76:79], a[128:135], v1
  buffer_load_dword v11, off, s[4:7], s95 sc1
  v_smfmac_f32_16x16x64_bf16 v[24:27], v[76:79], a[136:143], v1
  v_smfmac_f32_16x16x64_bf16 v[28:31], v[60:63], a[144:151], v1
  s_nop 0
  v_smfmac_f32_16x16x64_bf16 v[32:35], v[60:63], a[152:159], v1
  s_nop 0
  v_add_f32 v12, v12, v14
  v_add_f32 v13, v13, v15
  v_add_f32 v16, v16, v18
  v_add_f32 v17, v17, v19
  v_add_f32 v20, v20, v22
  v_add_f32 v21, v21, v23
  v_add_f32 v24, v24, v26
  v_add_f32 v25, v25, v27
  v_cvt_pk_bf16_f32 v20, v20, v21
  v_cvt_pk_bf16_f32 v21, v12, v13
  v_cvt_pk_bf16_f32 v22, v24, v25
  v_cvt_pk_bf16_f32 v23, v16, v17
  ds_write2_b64 v5, v[20:21], v[22:23] offset0:0 offset1:64
  v_smfmac_f32_16x16x64_bf16 v[28:31], v[64:67], a[160:167], v1
  v_lshrrev_b32 v0, 1, v3
  v_smfmac_f32_16x16x64_bf16 v[32:35], v[64:67], a[168:175], v1
  s_waitcnt lgkmcnt(0)
  s_barrier
  ds_read_b64_tr_b16 v[12:13], v6 offset:0
  ds_read_b64_tr_b16 v[14:15], v6 offset:256
  v_smfmac_f32_16x16x64_bf16 v[28:31], v[68:71], a[176:183], v1
  ds_read_b64_tr_b16 v[16:17], v6 offset:1024
  v_smfmac_f32_16x16x64_bf16 v[32:35], v[68:71], a[184:191], v1
  ds_read_b64_tr_b16 v[18:19], v6 offset:1280
  v_mov_b32 v60, s42
  v_smfmac_f32_16x16x64_bf16 v[28:31], v[72:75], a[192:199], v1
  ds_read_b64_tr_b16 v[20:21], v6 offset:2048
  buffer_store_dword v60, off, s[4:7], s48 sc1
  v_smfmac_f32_16x16x64_bf16 v[32:35], v[72:75], a[200:207], v1
  ds_read_b64_tr_b16 v[22:23], v6 offset:2304
  v_smfmac_f32_16x16x64_bf16 v[28:31], v[76:79], a[208:215], v1
  ds_read_b64_tr_b16 v[24:25], v6 offset:3072
  v_smfmac_f32_16x16x64_bf16 v[32:35], v[76:79], a[216:223], v1
  ds_read_b64_tr_b16 v[26:27], v6 offset:3328
  s_waitcnt lgkmcnt(6)
  v_mfma_f32_16x16x32_bf16 v[68:71], v[36:39], v[12:15], 0
  ds_read_b128 v[60:63], v3 offset:19456
  ds_read_b128 v[64:67], v3 offset:23552
  v_mfma_f32_16x16x32_bf16 v[72:75], v[40:43], v[12:15], 0
  s_nop 0
  s_nop 0
  s_waitcnt lgkmcnt(6)
  v_mfma_f32_16x16x32_bf16 v[68:71], v[44:47], v[16:19], v[68:71]
  v_add_f32 v28, v28, v30
  v_add_f32 v29, v29, v31
  v_mfma_f32_16x16x32_bf16 v[72:75], v[48:51], v[16:19], v[72:75]
  v_add_f32 v32, v32, v34
  s_waitcnt lgkmcnt(4)
  v_mfma_f32_16x16x32_bf16 v[68:71], v[52:55], v[20:23], v[68:71]
  v_add_f32 v33, v33, v35
  v_cvt_pk_bf16_f32 v33, v32, v33
  v_mfma_f32_16x16x32_bf16 v[72:75], v[56:59], v[20:23], v[72:75]
  v_cvt_pk_bf16_f32 v32, v28, v29
  s_waitcnt vmcnt(3)
  ds_read_b128 v[52:55], v2 offset:0
  ds_read_b128 v[56:59], v2 offset:1024
  s_waitcnt lgkmcnt(3)
  v_mfma_f32_16x16x32_bf16 v[68:71], v[60:63], v[24:27], v[68:71]
  v_mov_b64 v[44:45], s[24:25]
  s_waitcnt lgkmcnt(2)
  v_mfma_f32_16x16x32_bf16 v[72:75], v[64:67], v[24:27], v[72:75]
  v_mov_b64 v[46:47], s[24:25]
  v_mov_b32 v41, 0
  v_mfma_f32_16x16x32_bf16 v[76:79], v[12:15], v[12:15], 0
  v_mov_b32 v42, 0
  s_nop 0
  v_mfma_f32_16x16x32_bf16 v[76:79], v[16:19], v[16:19], v[76:79]
  buffer_store_dwordx2 v[32:33], v0, s[4:7], s50 offen sc1
  s_nop 0
  v_mfma_f32_16x16x32_bf16 v[76:79], v[20:23], v[20:23], v[76:79]
  v_max3_f32 v28, v68, v69, v70
  s_cmp_eq_u32 s42, s92
  v_mfma_f32_16x16x32_bf16 v[76:79], v[24:27], v[24:27], v[76:79]
  v_max3_f32 v28, v28, v71, v72
  v_max3_f32 v28, v28, v73, v74
  s_cbranch_scc1 L_loop7_last
L_loop7_back:
  v_max_f32 v28, v28, v75
  ds_read_b128 v[60:63], v2 offset:18432
  ds_read_b128 v[64:67], v2 offset:19456
  s_nop 1
  v_max3_f32 v28, v28, v76, v77
  v_mov_b32 v29, v28
  s_nop 1
  v_permlane16_swap_b32 v29, v28
  v_max_f32 v28, v28, v29
  v_mov_b32 v29, v28
  s_nop 1
  v_permlane32_swap_b32 v29, v28
  v_max_f32 v28, v28, v29
  v_mul_f32 v28, s46, v28
  v_pk_fma_f32 v[68:69], v[68:69], s[46:47], v[28:29] op_sel_hi:[1,0,0] neg_lo:[0,0,1] neg_hi:[0,0,1]
  v_pk_fma_f32 v[70:71], v[70:71], s[46:47], v[28:29] op_sel_hi:[1,0,0] neg_lo:[0,0,1] neg_hi:[0,0,1]
  v_pk_fma_f32 v[72:73], v[72:73], s[46:47], v[28:29] op_sel_hi:[1,0,0] neg_lo:[0,0,1] neg_hi:[0,0,1]
  v_pk_fma_f32 v[74:75], v[74:75], s[46:47], v[28:29] op_sel_hi:[1,0,0] neg_lo:[0,0,1] neg_hi:[0,0,1]
  v_pk_fma_f32 v[76:77], v[76:77], s[46:47], v[28:29] op_sel_hi:[1,0,0] neg_lo:[0,0,1] neg_hi:[0,0,1]
  v_exp_f32 v68, v68
  v_exp_f32 v69, v69
  v_exp_f32 v70, v70
  v_cvt_pk_bf16_f32 v36, v68, v69
  v_exp_f32 v71, v71
  v_exp_f32 v72, v72
  v_cvt_pk_bf16_f32 v37, v70, v71
  v_exp_f32 v73, v73
  v_exp_f32 v74, v74
  v_cvt_pk_bf16_f32 v38, v72, v73
  v_exp_f32 v75, v75
  v_exp_f32 v76, v76
  v_cvt_pk_bf16_f32 v39, v74, v75
  v_exp_f32 v77, v77
  s_waitcnt lgkmcnt(2)
  v_mfma_f32_16x16x32_bf16 v[20:23], v[44:47], v[36:39], 0
  v_cvt_pk_bf16_f32 v40, v76, v77
  v_cvt_pk_bf16_f32 v43, v76, v77
  v_mfma_f32_16x16x32_bf16 v[12:15], v[52:55], v[36:39], 0
  ds_read_b128 v[68:71], v2 offset:20480
  ds_read_b128 v[72:75], v2 offset:21504
  v_mfma_f32_16x16x32_bf16 v[16:19], v[56:59], v[36:39], 0
  ds_read_b128 v[52:55], v2 offset:22528
  ds_read_b128 v[56:59], v2 offset:23552
  v_mfma_f32_16x16x16_bf16 v[20:23], v[44:45], v[40:41], v[20:23]
  v_add_u32 v0, s14, v7
  v_mov_b64 v[24:25], 0
  v_mfma_f32_16x16x16_bf16 v[12:15], v[32:33], v[40:41], v[12:15]
  v_mov_b64 v[26:27], 0
  v_mov_b64 v[76:77], 0
  v_mfma_f32_16x16x16_bf16 v[16:19], v[32:33], v[42:43], v[16:19]
  v_mov_b64 v[78:79], 0
  s_nop 0
  v_rcp_f32 v30, v20
  s_mov_b32 m0, s94
  s_mov_b64 exec, s[26:27]
  v_pk_mul_f32 v[12:13], v[12:13], v[30:31] op_sel_hi:[1,0]
  v_pk_mul_f32 v[14:15], v[14:15], v[30:31] op_sel_hi:[1,0]
  v_cvt_pk_bf16_f32 v12, v12, v13
  v_pk_mul_f32 v[16:17], v[16:17], v[30:31] op_sel_hi:[1,0]
  v_pk_mul_f32 v[18:19], v[18:19], v[30:31] op_sel_hi:[1,0]
  v_cvt_pk_bf16_f32 v13, v14, v15
  v_cvt_pk_bf16_f32 v14, v16, v17
  v_cvt_pk_bf16_f32 v15, v18, v19
  ds_write_b128 v0, v[12:15]
  s_mov_b64 exec, -1
  ds_read_b128 v[36:39], v2 offset:24576
  ds_read_b128 v[40:43], v2 offset:25600
  v_mov_b64 v[20:21], 0
  v_mov_b64 v[22:23], 0
  v_mov_b64 v[44:45], 0
  v_mov_b64 v[46:47], 0
  v_mov_b64 v[48:49], 0
  v_mov_b64 v[50:51], 0
  buffer_load_dwordx4 v3, s[4:7], s93 offen offset:0 sc1 lds
  buffer_load_dwordx4 v3, s[4:7], s93 offen offset:1024 sc1 lds
  buffer_load_dwordx4 v3, s[4:7], s93 offen offset:2048 sc1 lds
  s_waitcnt lgkmcnt(2)
  s_barrier
  ds_read_b128 v[16:19], v7 offset:0
  ds_read_b128 v[12:15], v7 offset:1024
  ds_read_b128 v[28:31], v2 offset:26624
  ds_read_b128 v[32:35], v2 offset:27648
  s_add_u32 s50, s50, 131072
  s_waitcnt lgkmcnt(3)
  v_smfmac_f32_16x16x64_bf16 v[20:23], v[16:19], v[60:67], v1
  ds_read_b128 v[60:63], v2 offset:28672
  v_smfmac_f32_16x16x64_bf16 v[24:27], v[16:19], v[68:75], v1
  s_waitcnt lgkmcnt(3)
  v_smfmac_f32_16x16x64_bf16 v[20:23], v[12:15], v[52:59], v1
  ds_read_b128 v[64:67], v2 offset:29696
  v_smfmac_f32_16x16x64_bf16 v[24:27], v[12:15], v[36:43], v1
  s_waitcnt lgkmcnt(2)
  v_smfmac_f32_16x16x64_bf16 v[44:47], v[16:19], v[28:35], v1
  s_nop 0
  v_smfmac_f32_16x16x64_bf16 v[48:51], v[16:19], a[224:231], v1
  s_nop 0
  v_smfmac_f32_16x16x64_bf16 v[44:47], v[12:15], a[240:247], v1
  v_add_f32 v20, v20, v22
  v_smfmac_f32_16x16x64_bf16 v[48:51], v[12:15], a[248:255], v1
  v_add_f32 v21, v21, v23
  v_smfmac_f32_16x16x64_bf16 v[76:79], v[16:19], a[232:239], v1
  v_add_f32 v24, v24, v26
  s_waitcnt lgkmcnt(0)
  v_smfmac_f32_16x16x64_bf16 v[76:79], v[12:15], v[60:67], v1
  v_add_f32 v25, v25, v27
  v_cvt_pk_bf16_f32 v20, v20, v21
  v_cvt_pk_bf16_f32 v21, v24, v25
  v_and_or_b32 v20, v20, -2, s45
  buffer_store_dwordx2 v[20:21], v8, s[4:7], s51 offen sc1
  v_pk_add_f32 v[44:45], v[44:45], v[46:47]
  v_pk_add_f32 v[48:49], v[48:49], v[50:51]
  v_cvt_pk_bf16_f32 v44, v44, v45
  v_cvt_pk_bf16_f32 v45, v48, v49
  v_and_or_b32 v44, v44, -2, s45
  buffer_store_dwordx2 v[44:45], v8, s[4:7], s90 offen sc1
  v_pk_add_f32 v[76:77], v[76:77], v[78:79]
  v_cvt_pk_bf16_f32 v76, v76, v77
  v_and_or_b32 v76, v76, -2, s45
  buffer_store_dword v76, v9, s[4:7], s51 offen sc1
  s_waitcnt vmcnt(0)
  s_barrier
  v_readfirstlane_b32 s3, v11
  s_add_u32 s42, s42, 1
  s_xor_b32 s45, s45, 1
  s_cmp_gt_u32 s3, s96
  s_cbranch_scc0 L_loop7_kvw
L_loop7_kvok:
  s_add_u32 s18, s18, 262144
  s_add_u32 s19, s19, 262144
  s_branch L_loop7_top
L_loop7_plr:
  s_waitcnt lgkmcnt(0)
  buffer_load_dwordx4 v[60:63], v4, s[4:7], s37 offen sc1
  buffer_load_dwordx4 v[64:67], v4, s[4:7], s37 offen offset:1024 sc1
  buffer_load_dwordx2 v[76:77], v52, s[4:7], s15 offen sc1
  s_waitcnt vmcnt(5)
  ds_write_b128 v11, v[68:71]
  s_waitcnt vmcnt(4)
  ds_write_b128 v11, v[72:75] offset:1024
  s_waitcnt vmcnt(3)
  ds_write_b64 v53, v[78:79] offset:4096
  v_max3_u32 v0, v68, v72, v78
  v_cmp_eq_u32 vcc, -1, v0
  s_cbranch_vccz L_loop7_plok
  s_waitcnt lgkmcnt(0)
  buffer_load_dwordx4 v[68:71], v4, s[4:7], s37 offen sc1
  buffer_load_dwordx4 v[72:75], v4, s[4:7], s37 offen offset:1024 sc1
  buffer_load_dwordx2 v[78:79], v52, s[4:7], s15 offen sc1
  s_sub_u32 s29, s29, 1
  s_cbranch_scc0 L_loop7_pl
  s_branch L_end
L_loop7_kvw:
  buffer_load_dword v11, off, s[4:7], s95 sc1
  s_waitcnt vmcnt(0)
  v_readfirstlane_b32 s3, v11
  s_nop 0
  s_cmp_gt_u32 s3, s96
  s_cbranch_scc1 L_loop7_kvok
  s_sleep 1
  s_sub_u32 s29, s29, 1
  s_cbranch_scc0 L_loop7_kvw
  s_branch L_end
L_loop7_rr0:
  buffer_load_dwordx4 v[60:63], v4, s[4:7], s38 offen offset:0 sc1
  buffer_load_dwordx4 v[64:67], v4, s[4:7], s38 offen offset:1024 sc1
  buffer_load_dwordx4 v[68:71], v4, s[4:7], s38 offen offset:2048 sc1
  buffer_load_dwordx4 v[72:75], v4, s[4:7], s38 offen offset:3072 sc1
  buffer_load_dwordx4 v[76:79], v4, s[4:7], s17 offen sc1
  s_mov_b32 m0, s62
  s_nop 0
  buffer_load_dwordx4 v3, s[4:7], s19 offen offset:0 sc1 lds
  buffer_load_dwordx4 v3, s[4:7], s19 offen offset:1024 sc1 lds
  s_waitcnt vmcnt(6)
  v_cmp_eq_u32 vcc, -1, v60
  s_cbranch_vccz L_loop7_rok0
  s_sub_u32 s29, s29, 1
  s_cbranch_scc0 L_loop7_rr0
  s_branch L_end
L_loop7_rr1:
  buffer_load_dwordx4 v[64:67], v4, s[4:7], s38 offen offset:1024 sc1
  buffer_load_dwordx4 v[68:71], v4, s[4:7], s38 offen offset:2048 sc1
  buffer_load_dwordx4 v[72:75], v4, s[4:7], s38 offen offset:3072 sc1
  buffer_load_dwordx4 v[76:79], v4, s[4:7], s17 offen sc1
  s_mov_b32 m0, s62
  s_nop 0
  buffer_load_dwordx4 v3, s[4:7], s19 offen offset:0 sc1 lds
  buffer_load_dwordx4 v3, s[4:7], s19 offen offset:1024 sc1 lds
  s_waitcnt vmcnt(5)
  v_cmp_eq_u32 vcc, -1, v64
  s_cbranch_vccz L_loop7_rok1
  s_sub_u32 s29, s29, 1
  s_cbranch_scc0 L_loop7_rr1
  s_branch L_end
L_loop7_rr2:
  buffer_load_dwordx4 v[68:71], v4, s[4:7], s38 offen offset:2048 sc1
  buffer_load_dwordx4 v[72:75], v4, s[4:7], s38 offen offset:3072 sc1
  buffer_load_dwordx4 v[76:79], v4, s[4:7], s17 offen sc1
  s_mov_b32 m0, s62
  s_nop 0
  buffer_load_dwordx4 v3, s[4:7], s19 offen offset:0 sc1 lds
  buffer_load_dwordx4 v3, s[4:7], s19 offen offset:1024 sc1 lds
  s_waitcnt vmcnt(4)
  v_cmp_eq_u32 vcc, -1, v68
  s_cbranch_vccz L_loop7_rok2
  s_sub_u32 s29, s29, 1
  s_cbranch_scc0 L_loop7_rr2
  s_branch L_end
L_loop7_rr3:
  buffer_load_dwordx4 v[72:75], v4, s[4:7], s38 offen offset:3072 sc1
  buffer_load_dwordx4 v[76:79], v4, s[4:7], s17 offen sc1
  s_mov_b32 m0, s62
  s_nop 0
  buffer_load_dwordx4 v3, s[4:7], s19 offen offset:0 sc1 lds
  buffer_load_dwordx4 v3, s[4:7], s19 offen offset:1024 sc1 lds
  s_waitcnt vmcnt(3)
  v_cmp_eq_u32 vcc, -1, v72
  s_cbranch_vccz L_loop7_rok3
  s_sub_u32 s29, s29, 1
  s_cbranch_scc0 L_loop7_rr3
  s_branch L_end
L_loop7_rr4:
  buffer_load_dwordx4 v[76:79], v4, s[4:7], s17 offen sc1
  s_mov_b32 m0, s62
  s_nop 0
  buffer_load_dwordx4 v3, s[4:7], s19 offen offset:0 sc1 lds
  buffer_load_dwordx4 v3, s[4:7], s19 offen offset:1024 sc1 lds
  s_waitcnt vmcnt(2)
  v_cmp_eq_u32 vcc, -1, v76
  s_cbranch_vccz L_loop7_rok4
  s_sub_u32 s29, s29, 1
  s_cbranch_scc0 L_loop7_rr4
  s_branch L_end
L_loop7_last:
  s_waitcnt vmcnt(0) lgkmcnt(0)
  s_barrier
  s_add_u32 s3, s42, 1
  v_mov_b32 v0, s3
  s_mov_b64 exec, 1
  buffer_store_dword v0, off, s[4:7], s48 sc1
  s_mov_b64 exec, -1
  s_mov_b32 s92, s3
  s_cmp_lt_u32 s42, 63
  s_cbranch_scc1 L_loop7_back
  s_branch L_fin
L_kv:
  s_lshr_b32 s3, s32, 5
  s_and_b32 s38, s32, 31
  s_lshl4_add_u32 s40, s3, s38
  s_sub_u32 s40, s40, 96
  s_lshl3_add_u32 s3, s3, s38
  s_sub_u32 s3, s3, 36
  s_cmp_ge_u32 s32, 192
  s_cselect_b32 s40, s40, s3
  s_cselect_b32 s41, 0, 1
  s_cmp_lt_u32 s28, 2
  s_cselect_b32 s12, s70, s72
  s_cselect_b32 s13, s71, s73
  s_mov_b32 s14, 5242880
  s_mov_b32 s15, 0x20000
  s_and_b32 s3, s28, 1
  s_lshl_b32 s3, s3, 7
  s_lshl_b32 s38, s40, 8
  s_add_u32 s38, s38, s3
  v_lshrrev_b32 v2, 3, v1
  v_and_b32 v3, 7, v1
  v_lshlrev_b32 v4, 1, v2
  v_and_b32 v4, 4, v4
  v_xor_b32 v3, v3, v4
  s_mov_b32 s3, 8192
  v_mul_lo_u32 v2, v2, s3
  v_lshl_add_u32 v2, v3, 4, v2
  v_lshrrev_b32 v3, 5, v1
  v_lshlrev_b32 v3, 3, v3
  v_bfe_u32 v4, v1, 2, 2
  v_add_u32 v3, v3, v4
  v_mul_u32_u24 v3, 128, v3
  v_bfe_u32 v4, v1, 4, 1
  v_lshl_add_u32 v3, v4, 5, v3
  v_and_b32 v4, 3, v1
  v_lshl_add_u32 v3, v4, 3, v3
  s_lshl_b32 s35, s28, 15
  v_add_u32 v3, s35, v3
  v_bfe_u32 v4, v1, 3, 1
  v_lshl_add_u32 v3, v4, 6, v3
  v_xor_b32 v4, 64, v3
  s_add_u32 s36, s38, 0
  s_add_u32 m0, s35, 0
  s_nop 0
  buffer_load_dwordx4 v2, s[12:15], s36 offen lds
  s_add_u32 s36, s38, 65536
  s_add_u32 m0, s35, 1024
  s_nop 0
  buffer_load_dwordx4 v2, s[12:15], s36 offen lds
  s_add_u32 s36, s38, 131072
  s_add_u32 m0, s35, 2048
  s_nop 0
  buffer_load_dwordx4 v2, s[12:15], s36 offen lds
  s_add_u32 s36, s38, 196608
  s_add_u32 m0, s35, 3072
  s_nop 0
  buffer_load_dwordx4 v2, s[12:15], s36 offen lds
  s_add_u32 s36, s38, 262144
  s_add_u32 m0, s35, 4096
  s_nop 0
  buffer_load_dwordx4 v2, s[12:15], s36 offen lds
  s_add_u32 s36, s38, 327680
  s_add_u32 m0, s35, 5120
  s_nop 0
  buffer_load_dwordx4 v2, s[12:15], s36 offen lds
  s_add_u32 s36, s38, 393216
  s_add_u32 m0, s35, 6144
  s_nop 0
  buffer_load_dwordx4 v2, s[12:15], s36 offen lds
  s_add_u32 s36, s38, 458752
  s_add_u32 m0, s35, 7168
  s_nop 0
  buffer_load_dwordx4 v2, s[12:15], s36 offen lds
  s_add_u32 s36, s38, 524288
  s_add_u32 m0, s35, 8192
  s_nop 0
  buffer_load_dwordx4 v2, s[12:15], s36 offen lds
  s_add_u32 s36, s38, 589824
  s_add_u32 m0, s35, 9216
  s_nop 0
  buffer_load_dwordx4 v2, s[12:15], s36 offen lds
  s_add_u32 s36, s38, 655360
  s_add_u32 m0, s35, 10240
  s_nop 0
  buffer_load_dwordx4 v2, s[12:15], s36 offen lds
  s_add_u32 s36, s38, 720896
  s_add_u32 m0, s35, 11264
  s_nop 0
  buffer_load_dwordx4 v2, s[12:15], s36 offen lds
  s_add_u32 s36, s38, 786432
  s_add_u32 m0, s35, 12288
  s_nop 0
  buffer_load_dwordx4 v2, s[12:15], s36 offen lds
  s_add_u32 s36, s38, 851968
  s_add_u32 m0, s35, 13312
  s_nop 0
  buffer_load_dwordx4 v2, s[12:15], s36 offen lds
  s_add_u32 s36, s38, 917504
  s_add_u32 m0, s35, 14336
  s_nop 0
  buffer_load_dwordx4 v2, s[12:15], s36 offen lds
  s_add_u32 s36, s38, 983040
  s_add_u32 m0, s35, 15360
  s_nop 0
  buffer_load_dwordx4 v2, s[12:15], s36 offen lds
  s_add_u32 s36, s38, 1048576
  s_add_u32 m0, s35, 16384
  s_nop 0
  buffer_load_dwordx4 v2, s[12:15], s36 offen lds
  s_add_u32 s36, s38, 1114112
  s_add_u32 m0, s35, 17408
  s_nop 0
  buffer_load_dwordx4 v2, s[12:15], s36 offen lds
  s_add_u32 s36, s38, 1179648
  s_add_u32 m0, s35, 18432
  s_nop 0
  buffer_load_dwordx4 v2, s[12:15], s36 offen lds
  s_add_u32 s36, s38, 1245184
  s_add_u32 m0, s35, 19456
  s_nop 0
  buffer_load_dwordx4 v2, s[12:15], s36 offen lds
  s_add_u32 s36, s38, 1310720
  s_add_u32 m0, s35, 20480
  s_nop 0
  buffer_load_dwordx4 v2, s[12:15], s36 offen lds
  s_add_u32 s36, s38, 1376256
  s_add_u32 m0, s35, 21504
  s_nop 0
  buffer_load_dwordx4 v2, s[12:15], s36 offen lds
  s_add_u32 s36, s38, 1441792
  s_add_u32 m0, s35, 22528
  s_nop 0
  buffer_load_dwordx4 v2, s[12:15], s36 offen lds
  s_add_u32 s36, s38, 1507328
  s_add_u32 m0, s35, 23552
  s_nop 0
  buffer_load_dwordx4 v2, s[12:15], s36 offen lds
  s_add_u32 s36, s38, 1572864
  s_add_u32 m0, s35, 24576
  s_nop 0
  buffer_load_dwordx4 v2, s[12:15], s36 offen lds
  s_add_u32 s36, s38, 1638400
  s_add_u32 m0, s35, 25600
  s_nop 0
  buffer_load_dwordx4 v2, s[12:15], s36 offen lds
  s_add_u32 s36, s38, 1703936
  s_add_u32 m0, s35, 26624
  s_nop 0
  buffer_load_dwordx4 v2, s[12:15], s36 offen lds
  s_add_u32 s36, s38, 1769472
  s_add_u32 m0, s35, 27648
  s_nop 0
  buffer_load_dwordx4 v2, s[12:15], s36 offen lds
  s_add_u32 s36, s38, 1835008
  s_add_u32 m0, s35, 28672
  s_nop 0
  buffer_load_dwordx4 v2, s[12:15], s36 offen lds
  s_add_u32 s36, s38, 1900544
  s_add_u32 m0, s35, 29696
  s_nop 0
  buffer_load_dwordx4 v2, s[12:15], s36 offen lds
  s_add_u32 s36, s38, 1966080
  s_add_u32 m0, s35, 30720
  s_nop 0
  buffer_load_dwordx4 v2, s[12:15], s36 offen lds
  s_add_u32 s36, s38, 2031616
  s_add_u32 m0, s35, 31744
  s_nop 0
  buffer_load_dwordx4 v2, s[12:15], s36 offen lds
  s_waitcnt vmcnt(28)
  s_cmp_eq_u32 s101, 0
  s_cbranch_scc1 L_sig_16
  s_mov_b32 s101, 0
  s_mov_b64 exec, 1
  v_mov_b32 v0, 1
  buffer_atomic_add v0, off, s[8:11], 0 offset:32
  s_mov_b64 exec, -1
L_sig_16:
  ds_read_b64_tr_b16 v[192:193], v3 offset:0
  ds_read_b64_tr_b16 v[194:195], v3 offset:512
  ds_read_b64_tr_b16 a[96:97], v4 offset:0
  ds_read_b64_tr_b16 a[98:99], v4 offset:512
  ds_read_b64_tr_b16 v[196:197], v3 offset:2048
  ds_read_b64_tr_b16 v[198:199], v3 offset:2560
  ds_read_b64_tr_b16 a[100:101], v4 offset:2048
  ds_read_b64_tr_b16 a[102:103], v4 offset:2560
  s_waitcnt lgkmcnt(0)
  s_add_u32 s36, s38, 2097152
  s_add_u32 m0, s35, 0
  s_nop 0
  buffer_load_dwordx4 v2, s[12:15], s36 offen lds
  s_add_u32 s36, s38, 2162688
  s_add_u32 m0, s35, 1024
  s_nop 0
  buffer_load_dwordx4 v2, s[12:15], s36 offen lds
  s_add_u32 s36, s38, 2228224
  s_add_u32 m0, s35, 2048
  s_nop 0
  buffer_load_dwordx4 v2, s[12:15], s36 offen lds
  s_add_u32 s36, s38, 2293760
  s_add_u32 m0, s35, 3072
  s_nop 0
  buffer_load_dwordx4 v2, s[12:15], s36 offen lds
  s_waitcnt vmcnt(28)
  ds_read_b64_tr_b16 v[200:201], v3 offset:4096
  ds_read_b64_tr_b16 v[202:203], v3 offset:4608
  ds_read_b64_tr_b16 a[104:105], v4 offset:4096
  ds_read_b64_tr_b16 a[106:107], v4 offset:4608
  ds_read_b64_tr_b16 v[204:205], v3 offset:6144
  ds_read_b64_tr_b16 v[206:207], v3 offset:6656
  ds_read_b64_tr_b16 a[108:109], v4 offset:6144
  ds_read_b64_tr_b16 a[110:111], v4 offset:6656
  s_waitcnt lgkmcnt(0)
  s_add_u32 s36, s38, 2359296
  s_add_u32 m0, s35, 4096
  s_nop 0
  buffer_load_dwordx4 v2, s[12:15], s36 offen lds
  s_add_u32 s36, s38, 2424832
  s_add_u32 m0, s35, 5120
  s_nop 0
  buffer_load_dwordx4 v2, s[12:15], s36 offen lds
  s_add_u32 s36, s38, 2490368
  s_add_u32 m0, s35, 6144
  s_nop 0
  buffer_load_dwordx4 v2, s[12:15], s36 offen lds
  s_add_u32 s36, s38, 2555904
  s_add_u32 m0, s35, 7168
  s_nop 0
  buffer_load_dwordx4 v2, s[12:15], s36 offen lds
  s_waitcnt vmcnt(28)
  ds_read_b64_tr_b16 v[208:209], v3 offset:8192
  ds_read_b64_tr_b16 v[210:211], v3 offset:8704
  ds_read_b64_tr_b16 a[112:113], v4 offset:8192
  ds_read_b64_tr_b16 a[114:115], v4 offset:8704
  ds_read_b64_tr_b16 v[212:213], v3 offset:10240
  ds_read_b64_tr_b16 v[214:215], v3 offset:10752
  ds_read_b64_tr_b16 a[116:117], v4 offset:10240
  ds_read_b64_tr_b16 a[118:119], v4 offset:10752
  s_waitcnt lgkmcnt(0)
  s_add_u32 s36, s38, 2621440
  s_add_u32 m0, s35, 8192
  s_nop 0
  buffer_load_dwordx4 v2, s[12:15], s36 offen lds
  s_add_u32 s36, s38, 2686976
  s_add_u32 m0, s35, 9216
  s_nop 0
  buffer_load_dwordx4 v2, s[12:15], s36 offen lds
  s_add_u32 s36, s38, 2752512
  s_add_u32 m0, s35, 10240
  s_nop 0
  buffer_load_dwordx4 v2, s[12:15], s36 offen lds
  s_add_u32 s36, s38, 2818048
  s_add_u32 m0, s35, 11264
  s_nop 0
  buffer_load_dwordx4 v2, s[12:15], s36 offen lds
  s_waitcnt vmcnt(28)
  ds_read_b64_tr_b16 v[216:217], v3 offset:12288
  ds_read_b64_tr_b16 v[218:219], v3 offset:12800
  ds_read_b64_tr_b16 a[120:121], v4 offset:12288
  ds_read_b64_tr_b16 a[122:123], v4 offset:12800
  ds_read_b64_tr_b16 v[220:221], v3 offset:14336
  ds_read_b64_tr_b16 v[222:223], v3 offset:14848
  ds_read_b64_tr_b16 a[124:125], v4 offset:14336
  ds_read_b64_tr_b16 a[126:127], v4 offset:14848
  s_waitcnt lgkmcnt(0)
  s_add_u32 s36, s38, 2883584
  s_add_u32 m0, s35, 12288
  s_nop 0
  buffer_load_dwordx4 v2, s[12:15], s36 offen lds
  s_add_u32 s36, s38, 2949120
  s_add_u32 m0, s35, 13312
  s_nop 0
  buffer_load_dwordx4 v2, s[12:15], s36 offen lds
  s_add_u32 s36, s38, 3014656
  s_add_u32 m0, s35, 14336
  s_nop 0
  buffer_load_dwordx4 v2, s[12:15], s36 offen lds
  s_add_u32 s36, s38, 3080192
  s_add_u32 m0, s35, 15360
  s_nop 0
  buffer_load_dwordx4 v2, s[12:15], s36 offen lds
  s_waitcnt vmcnt(28)
  ds_read_b64_tr_b16 v[224:225], v3 offset:16384
  ds_read_b64_tr_b16 v[226:227], v3 offset:16896
  ds_read_b64_tr_b16 a[128:129], v4 offset:16384
  ds_read_b64_tr_b16 a[130:131], v4 offset:16896
  ds_read_b64_tr_b16 v[228:229], v3 offset:18432
  ds_read_b64_tr_b16 v[230:231], v3 offset:18944
  ds_read_b64_tr_b16 a[132:133], v4 offset:18432
  ds_read_b64_tr_b16 a[134:135], v4 offset:18944
  s_waitcnt lgkmcnt(0)
  s_add_u32 s36, s38, 3145728
  s_add_u32 m0, s35, 16384
  s_nop 0
  buffer_load_dwordx4 v2, s[12:15], s36 offen lds
  s_add_u32 s36, s38, 3211264
  s_add_u32 m0, s35, 17408
  s_nop 0
  buffer_load_dwordx4 v2, s[12:15], s36 offen lds
  s_add_u32 s36, s38, 3276800
  s_add_u32 m0, s35, 18432
  s_nop 0
  buffer_load_dwordx4 v2, s[12:15], s36 offen lds
  s_add_u32 s36, s38, 3342336
  s_add_u32 m0, s35, 19456
  s_nop 0
  buffer_load_dwordx4 v2, s[12:15], s36 offen lds
  s_waitcnt vmcnt(28)
  ds_read_b64_tr_b16 v[232:233], v3 offset:20480
  ds_read_b64_tr_b16 v[234:235], v3 offset:20992
  ds_read_b64_tr_b16 a[136:137], v4 offset:20480
  ds_read_b64_tr_b16 a[138:139], v4 offset:20992
  ds_read_b64_tr_b16 v[236:237], v3 offset:22528
  ds_read_b64_tr_b16 v[238:239], v3 offset:23040
  ds_read_b64_tr_b16 a[140:141], v4 offset:22528
  ds_read_b64_tr_b16 a[142:143], v4 offset:23040
  s_waitcnt lgkmcnt(0)
  s_add_u32 s36, s38, 3407872
  s_add_u32 m0, s35, 20480
  s_nop 0
  buffer_load_dwordx4 v2, s[12:15], s36 offen lds
  s_add_u32 s36, s38, 3473408
  s_add_u32 m0, s35, 21504
  s_nop 0
  buffer_load_dwordx4 v2, s[12:15], s36 offen lds
  s_add_u32 s36, s38, 3538944
  s_add_u32 m0, s35, 22528
  s_nop 0
  buffer_load_dwordx4 v2, s[12:15], s36 offen lds
  s_add_u32 s36, s38, 3604480
  s_add_u32 m0, s35, 23552
  s_nop 0
  buffer_load_dwordx4 v2, s[12:15], s36 offen lds
  s_waitcnt vmcnt(28)
  ds_read_b64_tr_b16 v[240:241], v3 offset:24576
  ds_read_b64_tr_b16 v[242:243], v3 offset:25088
  ds_read_b64_tr_b16 a[144:145], v4 offset:24576
  ds_read_b64_tr_b16 a[146:147], v4 offset:25088
  ds_read_b64_tr_b16 v[244:245], v3 offset:26624
  ds_read_b64_tr_b16 v[246:247], v3 offset:27136
  ds_read_b64_tr_b16 a[148:149], v4 offset:26624
  ds_read_b64_tr_b16 a[150:151], v4 offset:27136
  s_waitcnt lgkmcnt(0)
  s_add_u32 s36, s38, 3670016
  s_add_u32 m0, s35, 24576
  s_nop 0
  buffer_load_dwordx4 v2, s[12:15], s36 offen lds
  s_add_u32 s36, s38, 3735552
  s_add_u32 m0, s35, 25600
  s_nop 0
  buffer_load_dwordx4 v2, s[12:15], s36 offen lds
  s_add_u32 s36, s38, 3801088
  s_add_u32 m0, s35, 26624
  s_nop 0
  buffer_load_dwordx4 v2, s[12:15], s36 offen lds
  s_add_u32 s36, s38, 3866624
  s_add_u32 m0, s35, 27648
  s_nop 0
  buffer_load_dwordx4 v2, s[12:15], s36 offen lds
  s_waitcnt vmcnt(28)
  ds_read_b64_tr_b16 v[248:249], v3 offset:28672
  ds_read_b64_tr_b16 v[250:251], v3 offset:29184
  ds_read_b64_tr_b16 a[152:153], v4 offset:28672
  ds_read_b64_tr_b16 a[154:155], v4 offset:29184
  ds_read_b64_tr_b16 v[252:253], v3 offset:30720
  ds_read_b64_tr_b16 v[254:255], v3 offset:31232
  ds_read_b64_tr_b16 a[156:157], v4 offset:30720
  ds_read_b64_tr_b16 a[158:159], v4 offset:31232
  s_waitcnt lgkmcnt(0)
  s_add_u32 s36, s38, 3932160
  s_add_u32 m0, s35, 28672
  s_nop 0
  buffer_load_dwordx4 v2, s[12:15], s36 offen lds
  s_add_u32 s36, s38, 3997696
  s_add_u32 m0, s35, 29696
  s_nop 0
  buffer_load_dwordx4 v2, s[12:15], s36 offen lds
  s_add_u32 s36, s38, 4063232
  s_add_u32 m0, s35, 30720
  s_nop 0
  buffer_load_dwordx4 v2, s[12:15], s36 offen lds
  s_add_u32 s36, s38, 4128768
  s_add_u32 m0, s35, 31744
  s_nop 0
  buffer_load_dwordx4 v2, s[12:15], s36 offen lds
  s_waitcnt vmcnt(28)
  ds_read_b64_tr_b16 a[0:1], v3 offset:0
  ds_read_b64_tr_b16 a[2:3], v3 offset:512
  ds_read_b64_tr_b16 a[160:161], v4 offset:0
  ds_read_b64_tr_b16 a[162:163], v4 offset:512
  ds_read_b64_tr_b16 a[4:5], v3 offset:2048
  ds_read_b64_tr_b16 a[6:7], v3 offset:2560
  ds_read_b64_tr_b16 a[164:165], v4 offset:2048
  ds_read_b64_tr_b16 a[166:167], v4 offset:2560
  s_waitcnt lgkmcnt(0)
  s_add_u32 s36, s38, 4194304
  s_add_u32 m0, s35, 0
  s_nop 0
  buffer_load_dwordx4 v2, s[12:15], s36 offen lds
  s_add_u32 s36, s38, 4259840
  s_add_u32 m0, s35, 1024
  s_nop 0
  buffer_load_dwordx4 v2, s[12:15], s36 offen lds
  s_add_u32 s36, s38, 4325376
  s_add_u32 m0, s35, 2048
  s_nop 0
  buffer_load_dwordx4 v2, s[12:15], s36 offen lds
  s_add_u32 s36, s38, 4390912
  s_add_u32 m0, s35, 3072
  s_nop 0
  buffer_load_dwordx4 v2, s[12:15], s36 offen lds
  s_waitcnt vmcnt(28)
  ds_read_b64_tr_b16 a[8:9], v3 offset:4096
  ds_read_b64_tr_b16 a[10:11], v3 offset:4608
  ds_read_b64_tr_b16 a[168:169], v4 offset:4096
  ds_read_b64_tr_b16 a[170:171], v4 offset:4608
  ds_read_b64_tr_b16 a[12:13], v3 offset:6144
  ds_read_b64_tr_b16 a[14:15], v3 offset:6656
  ds_read_b64_tr_b16 a[172:173], v4 offset:6144
  ds_read_b64_tr_b16 a[174:175], v4 offset:6656
  s_waitcnt lgkmcnt(0)
  s_add_u32 s36, s38, 4456448
  s_add_u32 m0, s35, 4096
  s_nop 0
  buffer_load_dwordx4 v2, s[12:15], s36 offen lds
  s_add_u32 s36, s38, 4521984
  s_add_u32 m0, s35, 5120
  s_nop 0
  buffer_load_dwordx4 v2, s[12:15], s36 offen lds
  s_add_u32 s36, s38, 4587520
  s_add_u32 m0, s35, 6144
  s_nop 0
  buffer_load_dwordx4 v2, s[12:15], s36 offen lds
  s_add_u32 s36, s38, 4653056
  s_add_u32 m0, s35, 7168
  s_nop 0
  buffer_load_dwordx4 v2, s[12:15], s36 offen lds
  s_waitcnt vmcnt(28)
  ds_read_b64_tr_b16 a[16:17], v3 offset:8192
  ds_read_b64_tr_b16 a[18:19], v3 offset:8704
  ds_read_b64_tr_b16 a[176:177], v4 offset:8192
  ds_read_b64_tr_b16 a[178:179], v4 offset:8704
  ds_read_b64_tr_b16 a[20:21], v3 offset:10240
  ds_read_b64_tr_b16 a[22:23], v3 offset:10752
  ds_read_b64_tr_b16 a[180:181], v4 offset:10240
  ds_read_b64_tr_b16 a[182:183], v4 offset:10752
  s_waitcnt lgkmcnt(0)
  s_add_u32 s36, s38, 4718592
  s_add_u32 m0, s35, 8192
  s_nop 0
  buffer_load_dwordx4 v2, s[12:15], s36 offen lds
  s_add_u32 s36, s38, 4784128
  s_add_u32 m0, s35, 9216
  s_nop 0
  buffer_load_dwordx4 v2, s[12:15], s36 offen lds
  s_add_u32 s36, s38, 4849664
  s_add_u32 m0, s35, 10240
  s_nop 0
  buffer_load_dwordx4 v2, s[12:15], s36 offen lds
  s_add_u32 s36, s38, 4915200
  s_add_u32 m0, s35, 11264
  s_nop 0
  buffer_load_dwordx4 v2, s[12:15], s36 offen lds
  s_waitcnt vmcnt(28)
  ds_read_b64_tr_b16 a[24:25], v3 offset:12288
  ds_read_b64_tr_b16 a[26:27], v3 offset:12800
  ds_read_b64_tr_b16 a[184:185], v4 offset:12288
  ds_read_b64_tr_b16 a[186:187], v4 offset:12800
  ds_read_b64_tr_b16 a[28:29], v3 offset:14336
  ds_read_b64_tr_b16 a[30:31], v3 offset:14848
  ds_read_b64_tr_b16 a[188:189], v4 offset:14336
  ds_read_b64_tr_b16 a[190:191], v4 offset:14848
  s_waitcnt lgkmcnt(0)
  s_add_u32 s36, s38, 4980736
  s_add_u32 m0, s35, 12288
  s_nop 0
  buffer_load_dwordx4 v2, s[12:15], s36 offen lds
  s_add_u32 s36, s38, 5046272
  s_add_u32 m0, s35, 13312
  s_nop 0
  buffer_load_dwordx4 v2, s[12:15], s36 offen lds
  s_add_u32 s36, s38, 5111808
  s_add_u32 m0, s35, 14336
  s_nop 0
  buffer_load_dwordx4 v2, s[12:15], s36 offen lds
  s_add_u32 s36, s38, 5177344
  s_add_u32 m0, s35, 15360
  s_nop 0
  buffer_load_dwordx4 v2, s[12:15], s36 offen lds
  s_waitcnt vmcnt(28)
  ds_read_b64_tr_b16 a[32:33], v3 offset:16384
  ds_read_b64_tr_b16 a[34:35], v3 offset:16896
  ds_read_b64_tr_b16 a[192:193], v4 offset:16384
  ds_read_b64_tr_b16 a[194:195], v4 offset:16896
  ds_read_b64_tr_b16 a[36:37], v3 offset:18432
  ds_read_b64_tr_b16 a[38:39], v3 offset:18944
  ds_read_b64_tr_b16 a[196:197], v4 offset:18432
  ds_read_b64_tr_b16 a[198:199], v4 offset:18944
  s_waitcnt vmcnt(24)
  ds_read_b64_tr_b16 a[40:41], v3 offset:20480
  ds_read_b64_tr_b16 a[42:43], v3 offset:20992
  ds_read_b64_tr_b16 a[200:201], v4 offset:20480
  ds_read_b64_tr_b16 a[202:203], v4 offset:20992
  ds_read_b64_tr_b16 a[44:45], v3 offset:22528
  ds_read_b64_tr_b16 a[46:47], v3 offset:23040
  ds_read_b64_tr_b16 a[204:205], v4 offset:22528
  ds_read_b64_tr_b16 a[206:207], v4 offset:23040
  s_waitcnt vmcnt(20)
  ds_read_b64_tr_b16 a[48:49], v3 offset:24576
  ds_read_b64_tr_b16 a[50:51], v3 offset:25088
  ds_read_b64_tr_b16 a[208:209], v4 offset:24576
  ds_read_b64_tr_b16 a[210:211], v4 offset:25088
  ds_read_b64_tr_b16 a[52:53], v3 offset:26624
  ds_read_b64_tr_b16 a[54:55], v3 offset:27136
  ds_read_b64_tr_b16 a[212:213], v4 offset:26624
  ds_read_b64_tr_b16 a[214:215], v4 offset:27136
  s_waitcnt vmcnt(16)
  ds_read_b64_tr_b16 a[56:57], v3 offset:28672
  ds_read_b64_tr_b16 a[58:59], v3 offset:29184
  ds_read_b64_tr_b16 a[216:217], v4 offset:28672
  ds_read_b64_tr_b16 a[218:219], v4 offset:29184
  ds_read_b64_tr_b16 a[60:61], v3 offset:30720
  ds_read_b64_tr_b16 a[62:63], v3 offset:31232
  ds_read_b64_tr_b16 a[220:221], v4 offset:30720
  ds_read_b64_tr_b16 a[222:223], v4 offset:31232
  s_waitcnt vmcnt(12)
  ds_read_b64_tr_b16 a[64:65], v3 offset:0
  ds_read_b64_tr_b16 a[66:67], v3 offset:512
  ds_read_b64_tr_b16 a[224:225], v4 offset:0
  ds_read_b64_tr_b16 a[226:227], v4 offset:512
  ds_read_b64_tr_b16 a[68:69], v3 offset:2048
  ds_read_b64_tr_b16 a[70:71], v3 offset:2560
  ds_read_b64_tr_b16 a[228:229], v4 offset:2048
  ds_read_b64_tr_b16 a[230:231], v4 offset:2560
  s_waitcnt vmcnt(8)
  ds_read_b64_tr_b16 a[72:73], v3 offset:4096
  ds_read_b64_tr_b16 a[74:75], v3 offset:4608
  ds_read_b64_tr_b16 a[232:233], v4 offset:4096
  ds_read_b64_tr_b16 a[234:235], v4 offset:4608
  ds_read_b64_tr_b16 a[76:77], v3 offset:6144
  ds_read_b64_tr_b16 a[78:79], v3 offset:6656
  ds_read_b64_tr_b16 a[236:237], v4 offset:6144
  ds_read_b64_tr_b16 a[238:239], v4 offset:6656
  s_waitcnt vmcnt(4)
  ds_read_b64_tr_b16 a[80:81], v3 offset:8192
  ds_read_b64_tr_b16 a[82:83], v3 offset:8704
  ds_read_b64_tr_b16 a[240:241], v4 offset:8192
  ds_read_b64_tr_b16 a[242:243], v4 offset:8704
  ds_read_b64_tr_b16 a[84:85], v3 offset:10240
  ds_read_b64_tr_b16 a[86:87], v3 offset:10752
  ds_read_b64_tr_b16 a[244:245], v4 offset:10240
  ds_read_b64_tr_b16 a[246:247], v4 offset:10752
  s_waitcnt vmcnt(0)
  ds_read_b64_tr_b16 a[88:89], v3 offset:12288
  ds_read_b64_tr_b16 a[90:91], v3 offset:12800
  ds_read_b64_tr_b16 a[248:249], v4 offset:12288
  ds_read_b64_tr_b16 a[250:251], v4 offset:12800
  ds_read_b64_tr_b16 a[92:93], v3 offset:14336
  ds_read_b64_tr_b16 a[94:95], v3 offset:14848
  ds_read_b64_tr_b16 a[252:253], v4 offset:14336
  ds_read_b64_tr_b16 a[254:255], v4 offset:14848
  s_waitcnt lgkmcnt(0)
  s_cmp_lg_u32 s34, 0
  s_cbranch_scc1 L_verd_18
  s_cmp_eq_u32 s101, 0
  s_cbranch_scc1 L_sig_21
  s_mov_b32 s101, 0
  s_waitcnt vmcnt(0)
  s_mov_b64 exec, 1
  v_mov_b32 v0, 1
  buffer_atomic_add v0, off, s[8:11], 0 offset:32
  s_mov_b64 exec, -1
L_sig_21:
  v_lshlrev_b32 v2, 2, v1
L_ver_17:
  buffer_load_dword v3, v2, s[8:11], 0 offen sc1
  s_waitcnt vmcnt(0)
  v_readlane_b32 s3, v3, 8
  s_nop 0
  s_cmp_eq_u32 s3, 32
  s_cbranch_scc0 L_verf_20
  v_readlane_b32 s3, v3, 0
  v_readlane_b32 vcc_lo, v3, 1
  s_nop 0
  s_add_u32 s3, s3, vcc_lo
  v_readlane_b32 vcc_lo, v3, 34
  s_nop 0
  s_add_u32 s3, s3, vcc_lo
  v_readlane_b32 vcc_lo, v3, 35
  s_nop 0
  s_add_u32 s3, s3, vcc_lo
  v_readlane_b32 vcc_lo, v3, 36
  s_nop 0
  s_add_u32 s3, s3, vcc_lo
  v_readlane_b32 vcc_lo, v3, 37
  s_nop 0
  s_add_u32 s3, s3, vcc_lo
  v_readlane_b32 vcc_lo, v3, 38
  s_nop 0
  s_add_u32 s3, s3, vcc_lo
  v_readlane_b32 vcc_lo, v3, 39
  s_nop 0
  s_add_u32 s3, s3, vcc_lo
  s_cmp_eq_u32 s3, 0x100
  s_cbranch_scc1 L_verr_19
L_verf_20:
  s_sleep 2
  s_sub_u32 s29, s29, 1
  s_cbranch_scc0 L_ver_17
  s_branch L_end
L_verr_19:
  s_mov_b32 s34, 1
  v_cmp_ne_u32 vcc, 32, v3
  s_nop 4
  s_and_b32 vcc_lo, vcc_lo, 3
  s_and_b32 vcc_hi, vcc_hi, 0xfc
  s_cbranch_vccz L_verd_18
  s_mov_b32 s32, s31
  s_mov_b32 s33, 1
  v_readlane_b32 s3, v3, 0
  s_nop 0
  s_cmp_gt_u32 s30, 0
  s_cselect_b32 s3, s3, 0
  s_add_u32 s32, s32, s3
  v_readlane_b32 s3, v3, 1
  s_nop 0
  s_cmp_gt_u32 s30, 1
  s_cselect_b32 s3, s3, 0
  s_add_u32 s32, s32, s3
  v_readlane_b32 s3, v3, 34
  s_nop 0
  s_cmp_gt_u32 s30, 2
  s_cselect_b32 s3, s3, 0
  s_add_u32 s32, s32, s3
  v_readlane_b32 s3, v3, 35
  s_nop 0
  s_cmp_gt_u32 s30, 3
  s_cselect_b32 s3, s3, 0
  s_add_u32 s32, s32, s3
  v_readlane_b32 s3, v3, 36
  s_nop 0
  s_cmp_gt_u32 s30, 4
  s_cselect_b32 s3, s3, 0
  s_add_u32 s32, s32, s3
  v_readlane_b32 s3, v3, 37
  s_nop 0
  s_cmp_gt_u32 s30, 5
  s_cselect_b32 s3, s3, 0
  s_add_u32 s32, s32, s3
  v_readlane_b32 s3, v3, 38
  s_nop 0
  s_cmp_gt_u32 s30, 6
  s_cselect_b32 s3, s3, 0
  s_add_u32 s32, s32, s3
  s_branch L_restart
L_verd_18:
  s_mov_b32 s3, 180224
  s_mov_b32 s38, 1
  v_min_u32 v2, 63, v1
  v_mul_u32_u24 v2, 4, v2
L_wf_22:
  buffer_load_dword v3, v2, s[4:7], s3 offen sc1
  s_waitcnt vmcnt(0)
  v_cmp_gt_u32 vcc, s38, v3
  s_cbranch_vccz L_wfd_23
  s_sleep 1
  s_sub_u32 s29, s29, 1
  s_cbranch_scc0 L_wf_22
  s_branch L_end
L_wfd_23:
  v_lshlrev_b32 v5, 4, v1
  s_cmp_lt_u32 s28, 2
  s_cbranch_scc0 L_kv_va
  v_and_b32 v2, 7, v1
  v_bfe_u32 v3, v1, 4, 1
  v_lshl_add_u32 v2, v3, 3, v2
  v_lshlrev_b32 v2, 4, v2
  v_bfe_u32 v3, v1, 3, 1
  v_lshl_add_u32 v2, v3, 12, v2
  v_lshrrev_b32 v3, 5, v1
  v_lshl_add_u32 v7, v3, 8, v2
  s_lshl_b32 s3, s28, 11
  s_add_u32 s45, s3, 8388608
  s_branch L_kv_a
L_kv_va:
  v_and_b32 v2, 15, v1
  v_lshlrev_b32 v2, 4, v2
  v_bfe_u32 v3, v1, 4, 1
  v_lshl_add_u32 v2, v3, 10, v2
  v_lshrrev_b32 v3, 5, v1
  v_lshl_add_u32 v7, v3, 8, v2
  s_and_b32 s3, s28, 1
  s_lshl_b32 s3, s3, 12
  s_add_u32 s45, s3, 25165824
L_kv_a:
  s_lshl_b32 s3, s40, 13
  s_add_u32 s45, s45, s3
  s_lshl_b32 s3, s41, 18
  s_add_u32 s45, s45, s3
  s_mul_i32 s44, s41, 40960
  s_add_u32 s44, s44, 1048576
  s_lshl_b32 s46, s40, 7
  s_lshl2_add_u32 s46, s41, s46
  s_add_u32 s46, s46, 180480
  s_mov_b32 s43, 0
  s_mov_b32 s47, 0
  s_barrier
  s_mul_i32 s3, s28, 10240
  s_add_u32 s36, s44, s3
  s_add_u32 s37, s43, s3
  s_mov_b32 m0, s37
  s_nop 0
  buffer_load_dwordx4 v5, s[4:7], s36 offen offset:0 sc1 lds
  buffer_load_dwordx4 v5, s[4:7], s36 offen offset:1024 sc1 lds
  buffer_load_dwordx4 v5, s[4:7], s36 offen offset:2048 sc1 lds
  buffer_load_dwordx4 v5, s[4:7], s36 offen offset:3072 sc1 lds
  s_add_u32 s36, s36, 4096
  s_add_u32 s37, s37, 4096
  s_mov_b32 m0, s37
  s_nop 0
  buffer_load_dwordx4 v5, s[4:7], s36 offen offset:0 sc1 lds
  buffer_load_dwordx4 v5, s[4:7], s36 offen offset:1024 sc1 lds
  buffer_load_dwordx4 v5, s[4:7], s36 offen offset:2048 sc1 lds
  buffer_load_dwordx4 v5, s[4:7], s36 offen offset:3072 sc1 lds
  s_add_u32 s36, s36, 4096
  s_add_u32 s37, s37, 4096
  s_mov_b32 m0, s37
  s_nop 0
  buffer_load_dwordx4 v5, s[4:7], s36 offen offset:0 sc1 lds
  buffer_load_dwordx4 v5, s[4:7], s36 offen offset:1024 sc1 lds
L_kv_loop:
  s_waitcnt vmcnt(0)
  s_barrier
  s_cmp_lg_u32 s28, 0
  s_cbranch_scc1 L_kv_nf
  v_mov_b32 v2, s47
  s_mov_b64 exec, 1
  buffer_store_dword v2, off, s[4:7], s46 sc1
  s_mov_b64 exec, -1
L_kv_nf:
  s_cmp_eq_u32 s47, 32
  s_cbranch_scc1 L_kv_done
  v_add_u32 v6, s43, v5
  s_sub_u32 s43, 40960, s43
  s_add_u32 s44, s44, 81920
  s_cmp_eq_u32 s47, 31
  s_cbranch_scc1 L_kv_nd
  s_mul_i32 s3, s28, 10240
  s_add_u32 s36, s44, s3
  s_add_u32 s37, s43, s3
  s_mov_b32 m0, s37
  s_nop 0
  buffer_load_dwordx4 v5, s[4:7], s36 offen offset:0 sc1 lds
  buffer_load_dwordx4 v5, s[4:7], s36 offen offset:1024 sc1 lds
  buffer_load_dwordx4 v5, s[4:7], s36 offen offset:2048 sc1 lds
  buffer_load_dwordx4 v5, s[4:7], s36 offen offset:3072 sc1 lds
  s_add_u32 s36, s36, 4096
  s_add_u32 s37, s37, 4096
  s_mov_b32 m0, s37
  s_nop 0
  buffer_load_dwordx4 v5, s[4:7], s36 offen offset:0 sc1 lds
  buffer_load_dwordx4 v5, s[4:7], s36 offen offset:1024 sc1 lds
  buffer_load_dwordx4 v5, s[4:7], s36 offen offset:2048 sc1 lds
  buffer_load_dwordx4 v5, s[4:7], s36 offen offset:3072 sc1 lds
  s_add_u32 s36, s36, 4096
  s_add_u32 s37, s37, 4096
  s_mov_b32 m0, s37
  s_nop 0
  buffer_load_dwordx4 v5, s[4:7], s36 offen offset:0 sc1 lds
  buffer_load_dwordx4 v5, s[4:7], s36 offen offset:1024 sc1 lds
L_kv_nd:
  s_cmp_lt_u32 s28, 2
  s_cbranch_scc0 L_kv_v
  ds_read_b128 v[48:51], v6 offset:0
  ds_read_b128 v[52:55], v6 offset:1024
  ds_read_b128 v[56:59], v6 offset:2048
  ds_read_b128 v[60:63], v6 offset:3072
  s_waitcnt lgkmcnt(3)
  v_mfma_f32_32x32x16_bf16 v[16:31], v[192:195], v[48:51], 0
  v_mfma_f32_32x32x16_bf16 v[32:47], a[96:99], v[48:51], 0
  ds_read_b128 v[48:51], v6 offset:4096
  s_waitcnt lgkmcnt(3)
  v_mfma_f32_32x32x16_bf16 v[16:31], v[196:199], v[52:55], v[16:31]
  v_mfma_f32_32x32x16_bf16 v[32:47], a[100:103], v[52:55], v[32:47]
  ds_read_b128 v[52:55], v6 offset:5120
  s_waitcnt lgkmcnt(3)
  v_mfma_f32_32x32x16_bf16 v[16:31], v[200:203], v[56:59], v[16:31]
  v_mfma_f32_32x32x16_bf16 v[32:47], a[104:107], v[56:59], v[32:47]
  ds_read_b128 v[56:59], v6 offset:6144
  s_waitcnt lgkmcnt(3)
  v_mfma_f32_32x32x16_bf16 v[16:31], v[204:207], v[60:63], v[16:31]
  v_mfma_f32_32x32x16_bf16 v[32:47], a[108:111], v[60:63], v[32:47]
  ds_read_b128 v[60:63], v6 offset:7168
  s_waitcnt lgkmcnt(3)
  v_mfma_f32_32x32x16_bf16 v[16:31], v[208:211], v[48:51], v[16:31]
  v_mfma_f32_32x32x16_bf16 v[32:47], a[112:115], v[48:51], v[32:47]
  ds_read_b128 v[48:51], v6 offset:8192
  s_waitcnt lgkmcnt(3)
  v_mfma_f32_32x32x16_bf16 v[16:31], v[212:215], v[52:55], v[16:31]
  v_mfma_f32_32x32x16_bf16 v[32:47], a[116:119], v[52:55], v[32:47]
  ds_read_b128 v[52:55], v6 offset:9216
  s_waitcnt lgkmcnt(3)
  v_mfma_f32_32x32x16_bf16 v[16:31], v[216:219], v[56:59], v[16:31]
  v_mfma_f32_32x32x16_bf16 v[32:47], a[120:123], v[56:59], v[32:47]
  ds_read_b128 v[56:59], v6 offset:10240
  s_waitcnt lgkmcnt(3)
  v_mfma_f32_32x32x16_bf16 v[16:31], v[220:223], v[60:63], v[16:31]
  v_mfma_f32_32x32x16_bf16 v[32:47], a[124:127], v[60:63], v[32:47]
  ds_read_b128 v[60:63], v6 offset:11264
  s_waitcnt lgkmcnt(3)
  v_mfma_f32_32x32x16_bf16 v[16:31], v[224:227], v[48:51], v[16:31]
  v_mfma_f32_32x32x16_bf16 v[32:47], a[128:131], v[48:51], v[32:47]
  ds_read_b128 v[48:51], v6 offset:12288
  s_waitcnt lgkmcnt(3)
  v_mfma_f32_32x32x16_bf16 v[16:31], v[228:231], v[52:55], v[16:31]
  v_mfma_f32_32x32x16_bf16 v[32:47], a[132:135], v[52:55], v[32:47]
  ds_read_b128 v[52:55], v6 offset:13312
  s_waitcnt lgkmcnt(3)
  v_mfma_f32_32x32x16_bf16 v[16:31], v[232:235], v[56:59], v[16:31]
  v_mfma_f32_32x32x16_bf16 v[32:47], a[136:139], v[56:59], v[32:47]
  ds_read_b128 v[56:59], v6 offset:14336
  s_waitcnt lgkmcnt(3)
  v_mfma_f32_32x32x16_bf16 v[16:31], v[236:239], v[60:63], v[16:31]
  v_mfma_f32_32x32x16_bf16 v[32:47], a[140:143], v[60:63], v[32:47]
  ds_read_b128 v[60:63], v6 offset:15360
  s_waitcnt lgkmcnt(3)
  v_mfma_f32_32x32x16_bf16 v[16:31], v[240:243], v[48:51], v[16:31]
  v_mfma_f32_32x32x16_bf16 v[32:47], a[144:147], v[48:51], v[32:47]
  ds_read_b128 v[48:51], v6 offset:16384
  s_waitcnt lgkmcnt(3)
  v_mfma_f32_32x32x16_bf16 v[16:31], v[244:247], v[52:55], v[16:31]
  v_mfma_f32_32x32x16_bf16 v[32:47], a[148:151], v[52:55], v[32:47]
  ds_read_b128 v[52:55], v6 offset:17408
  s_waitcnt lgkmcnt(3)
  v_mfma_f32_32x32x16_bf16 v[16:31], v[248:251], v[56:59], v[16:31]
  v_mfma_f32_32x32x16_bf16 v[32:47], a[152:155], v[56:59], v[32:47]
  ds_read_b128 v[56:59], v6 offset:18432
  s_waitcnt lgkmcnt(3)
  v_mfma_f32_32x32x16_bf16 v[16:31], v[252:255], v[60:63], v[16:31]
  v_mfma_f32_32x32x16_bf16 v[32:47], a[156:159], v[60:63], v[32:47]
  ds_read_b128 v[60:63], v6 offset:19456
  s_waitcnt lgkmcnt(3)
  v_mfma_f32_32x32x16_bf16 v[16:31], a[0:3], v[48:51], v[16:31]
  v_mfma_f32_32x32x16_bf16 v[32:47], a[160:163], v[48:51], v[32:47]
  ds_read_b128 v[48:51], v6 offset:20480
  s_waitcnt lgkmcnt(3)
  v_mfma_f32_32x32x16_bf16 v[16:31], a[4:7], v[52:55], v[16:31]
  v_mfma_f32_32x32x16_bf16 v[32:47], a[164:167], v[52:55], v[32:47]
  ds_read_b128 v[52:55], v6 offset:21504
  s_waitcnt lgkmcnt(3)
  v_mfma_f32_32x32x16_bf16 v[16:31], a[8:11], v[56:59], v[16:31]
  v_mfma_f32_32x32x16_bf16 v[32:47], a[168:171], v[56:59], v[32:47]
  ds_read_b128 v[56:59], v6 offset:22528
  s_waitcnt lgkmcnt(3)
  v_mfma_f32_32x32x16_bf16 v[16:31], a[12:15], v[60:63], v[16:31]
  v_mfma_f32_32x32x16_bf16 v[32:47], a[172:175], v[60:63], v[32:47]
  ds_read_b128 v[60:63], v6 offset:23552
  s_waitcnt lgkmcnt(3)
  v_mfma_f32_32x32x16_bf16 v[16:31], a[16:19], v[48:51], v[16:31]
  v_mfma_f32_32x32x16_bf16 v[32:47], a[176:179], v[48:51], v[32:47]
  ds_read_b128 v[48:51], v6 offset:24576
  s_waitcnt lgkmcnt(3)
  v_mfma_f32_32x32x16_bf16 v[16:31], a[20:23], v[52:55], v[16:31]
  v_mfma_f32_32x32x16_bf16 v[32:47], a[180:183], v[52:55], v[32:47]
  ds_read_b128 v[52:55], v6 offset:25600
  s_waitcnt lgkmcnt(3)
  v_mfma_f32_32x32x16_bf16 v[16:31], a[24:27], v[56:59], v[16:31]
  v_mfma_f32_32x32x16_bf16 v[32:47], a[184:187], v[56:59], v[32:47]
  ds_read_b128 v[56:59], v6 offset:26624
  s_waitcnt lgkmcnt(3)
  v_mfma_f32_32x32x16_bf16 v[16:31], a[28:31], v[60:63], v[16:31]
  v_mfma_f32_32x32x16_bf16 v[32:47], a[188:191], v[60:63], v[32:47]
  ds_read_b128 v[60:63], v6 offset:27648
  s_waitcnt lgkmcnt(3)
  v_mfma_f32_32x32x16_bf16 v[16:31], a[32:35], v[48:51], v[16:31]
  v_mfma_f32_32x32x16_bf16 v[32:47], a[192:195], v[48:51], v[32:47]
  ds_read_b128 v[48:51], v6 offset:28672
  s_waitcnt lgkmcnt(3)
  v_mfma_f32_32x32x16_bf16 v[16:31], a[36:39], v[52:55], v[16:31]
  v_mfma_f32_32x32x16_bf16 v[32:47], a[196:199], v[52:55], v[32:47]
  ds_read_b128 v[52:55], v6 offset:29696
  s_waitcnt lgkmcnt(3)
  v_mfma_f32_32x32x16_bf16 v[16:31], a[40:43], v[56:59], v[16:31]
  v_mfma_f32_32x32x16_bf16 v[32:47], a[200:203], v[56:59], v[32:47]
  ds_read_b128 v[56:59], v6 offset:30720
  s_waitcnt lgkmcnt(3)
  v_mfma_f32_32x32x16_bf16 v[16:31], a[44:47], v[60:63], v[16:31]
  v_mfma_f32_32x32x16_bf16 v[32:47], a[204:207], v[60:63], v[32:47]
  ds_read_b128 v[60:63], v6 offset:31744
  s_waitcnt lgkmcnt(3)
  v_mfma_f32_32x32x16_bf16 v[16:31], a[48:51], v[48:51], v[16:31]
  v_mfma_f32_32x32x16_bf16 v[32:47], a[208:211], v[48:51], v[32:47]
  ds_read_b128 v[48:51], v6 offset:32768
  s_waitcnt lgkmcnt(3)
  v_mfma_f32_32x32x16_bf16 v[16:31], a[52:55], v[52:55], v[16:31]
  v_mfma_f32_32x32x16_bf16 v[32:47], a[212:215], v[52:55], v[32:47]
  ds_read_b128 v[52:55], v6 offset:33792
  s_waitcnt lgkmcnt(3)
  v_mfma_f32_32x32x16_bf16 v[16:31], a[56:59], v[56:59], v[16:31]
  v_mfma_f32_32x32x16_bf16 v[32:47], a[216:219], v[56:59], v[32:47]
  ds_read_b128 v[56:59], v6 offset:34816
  s_waitcnt lgkmcnt(3)
  v_mfma_f32_32x32x16_bf16 v[16:31], a[60:63], v[60:63], v[16:31]
  v_mfma_f32_32x32x16_bf16 v[32:47], a[220:223], v[60:63], v[32:47]
  ds_read_b128 v[60:63], v6 offset:35840
  s_waitcnt lgkmcnt(3)
  v_mfma_f32_32x32x16_bf16 v[16:31], a[64:67], v[48:51], v[16:31]
  v_mfma_f32_32x32x16_bf16 v[32:47], a[224:227], v[48:51], v[32:47]
  ds_read_b128 v[48:51], v6 offset:36864
  s_waitcnt lgkmcnt(3)
  v_mfma_f32_32x32x16_bf16 v[16:31], a[68:71], v[52:55], v[16:31]
  v_mfma_f32_32x32x16_bf16 v[32:47], a[228:231], v[52:55], v[32:47]
  ds_read_b128 v[52:55], v6 offset:37888
  s_waitcnt lgkmcnt(3)
  v_mfma_f32_32x32x16_bf16 v[16:31], a[72:75], v[56:59], v[16:31]
  v_mfma_f32_32x32x16_bf16 v[32:47], a[232:235], v[56:59], v[32:47]
  ds_read_b128 v[56:59], v6 offset:38912
  s_waitcnt lgkmcnt(3)
  v_mfma_f32_32x32x16_bf16 v[16:31], a[76:79], v[60:63], v[16:31]
  v_mfma_f32_32x32x16_bf16 v[32:47], a[236:239], v[60:63], v[32:47]
  ds_read_b128 v[60:63], v6 offset:39936
  s_waitcnt lgkmcnt(3)
  v_mfma_f32_32x32x16_bf16 v[16:31], a[80:83], v[48:51], v[16:31]
  v_mfma_f32_32x32x16_bf16 v[32:47], a[240:243], v[48:51], v[32:47]
  s_waitcnt lgkmcnt(2)
  v_mfma_f32_32x32x16_bf16 v[16:31], a[84:87], v[52:55], v[16:31]
  v_mfma_f32_32x32x16_bf16 v[32:47], a[244:247], v[52:55], v[32:47]
  s_waitcnt lgkmcnt(1)
  v_mfma_f32_32x32x16_bf16 v[16:31], a[88:91], v[56:59], v[16:31]
  v_mfma_f32_32x32x16_bf16 v[32:47], a[248:251], v[56:59], v[32:47]
  s_waitcnt lgkmcnt(0)
  v_mfma_f32_32x32x16_bf16 v[16:31], a[92:95], v[60:63], v[16:31]
  v_mfma_f32_32x32x16_bf16 v[32:47], a[252:255], v[60:63], v[32:47]
  s_nop 7
  s_nop 3
  v_cvt_pk_bf16_f32 v64, v16, v17
  v_cvt_pk_bf16_f32 v65, v18, v19
  v_cvt_pk_bf16_f32 v66, v20, v21
  v_cvt_pk_bf16_f32 v67, v22, v23
  v_cvt_pk_bf16_f32 v68, v24, v25
  v_cvt_pk_bf16_f32 v69, v26, v27
  v_cvt_pk_bf16_f32 v70, v28, v29
  v_cvt_pk_bf16_f32 v71, v30, v31
  buffer_store_dwordx4 v[64:67], v7, s[4:7], s45 offen offset:0 sc1
  buffer_store_dwordx4 v[68:71], v7, s[4:7], s45 offen offset:512 sc1
  v_cvt_pk_bf16_f32 v72, v32, v33
  v_cvt_pk_bf16_f32 v73, v34, v35
  v_cvt_pk_bf16_f32 v74, v36, v37
  v_cvt_pk_bf16_f32 v75, v38, v39
  v_cvt_pk_bf16_f32 v76, v40, v41
  v_cvt_pk_bf16_f32 v77, v42, v43
  v_cvt_pk_bf16_f32 v78, v44, v45
  v_cvt_pk_bf16_f32 v79, v46, v47
  buffer_store_dwordx4 v[72:75], v7, s[4:7], s45 offen offset:1024 sc1
  buffer_store_dwordx4 v[76:79], v7, s[4:7], s45 offen offset:1536 sc1
  s_branch L_kv_e
L_kv_v:
  ds_read_b128 v[48:51], v6 offset:0
  ds_read_b128 v[52:55], v6 offset:1024
  ds_read_b128 v[56:59], v6 offset:2048
  ds_read_b128 v[60:63], v6 offset:3072
  s_waitcnt lgkmcnt(3)
  v_mfma_f32_32x32x16_bf16 v[16:31], v[48:51], v[192:195], 0
  v_mfma_f32_32x32x16_bf16 v[32:47], v[48:51], a[96:99], 0
  ds_read_b128 v[48:51], v6 offset:4096
  s_waitcnt lgkmcnt(3)
  v_mfma_f32_32x32x16_bf16 v[16:31], v[52:55], v[196:199], v[16:31]
  v_mfma_f32_32x32x16_bf16 v[32:47], v[52:55], a[100:103], v[32:47]
  ds_read_b128 v[52:55], v6 offset:5120
  s_waitcnt lgkmcnt(3)
  v_mfma_f32_32x32x16_bf16 v[16:31], v[56:59], v[200:203], v[16:31]
  v_mfma_f32_32x32x16_bf16 v[32:47], v[56:59], a[104:107], v[32:47]
  ds_read_b128 v[56:59], v6 offset:6144
  s_waitcnt lgkmcnt(3)
  v_mfma_f32_32x32x16_bf16 v[16:31], v[60:63], v[204:207], v[16:31]
  v_mfma_f32_32x32x16_bf16 v[32:47], v[60:63], a[108:111], v[32:47]
  ds_read_b128 v[60:63], v6 offset:7168
  s_waitcnt lgkmcnt(3)
  v_mfma_f32_32x32x16_bf16 v[16:31], v[48:51], v[208:211], v[16:31]
  v_mfma_f32_32x32x16_bf16 v[32:47], v[48:51], a[112:115], v[32:47]
  ds_read_b128 v[48:51], v6 offset:8192
  s_waitcnt lgkmcnt(3)
  v_mfma_f32_32x32x16_bf16 v[16:31], v[52:55], v[212:215], v[16:31]
  v_mfma_f32_32x32x16_bf16 v[32:47], v[52:55], a[116:119], v[32:47]
  ds_read_b128 v[52:55], v6 offset:9216
  s_waitcnt lgkmcnt(3)
  v_mfma_f32_32x32x16_bf16 v[16:31], v[56:59], v[216:219], v[16:31]
  v_mfma_f32_32x32x16_bf16 v[32:47], v[56:59], a[120:123], v[32:47]
  ds_read_b128 v[56:59], v6 offset:10240
  s_waitcnt lgkmcnt(3)
  v_mfma_f32_32x32x16_bf16 v[16:31], v[60:63], v[220:223], v[16:31]
  v_mfma_f32_32x32x16_bf16 v[32:47], v[60:63], a[124:127], v[32:47]
  ds_read_b128 v[60:63], v6 offset:11264
  s_waitcnt lgkmcnt(3)
  v_mfma_f32_32x32x16_bf16 v[16:31], v[48:51], v[224:227], v[16:31]
  v_mfma_f32_32x32x16_bf16 v[32:47], v[48:51], a[128:131], v[32:47]
  ds_read_b128 v[48:51], v6 offset:12288
  s_waitcnt lgkmcnt(3)
  v_mfma_f32_32x32x16_bf16 v[16:31], v[52:55], v[228:231], v[16:31]
  v_mfma_f32_32x32x16_bf16 v[32:47], v[52:55], a[132:135], v[32:47]
  ds_read_b128 v[52:55], v6 offset:13312
  s_waitcnt lgkmcnt(3)
  v_mfma_f32_32x32x16_bf16 v[16:31], v[56:59], v[232:235], v[16:31]
  v_mfma_f32_32x32x16_bf16 v[32:47], v[56:59], a[136:139], v[32:47]
  ds_read_b128 v[56:59], v6 offset:14336
  s_waitcnt lgkmcnt(3)
  v_mfma_f32_32x32x16_bf16 v[16:31], v[60:63], v[236:239], v[16:31]
  v_mfma_f32_32x32x16_bf16 v[32:47], v[60:63], a[140:143], v[32:47]
  ds_read_b128 v[60:63], v6 offset:15360
  s_waitcnt lgkmcnt(3)
  v_mfma_f32_32x32x16_bf16 v[16:31], v[48:51], v[240:243], v[16:31]
  v_mfma_f32_32x32x16_bf16 v[32:47], v[48:51], a[144:147], v[32:47]
  ds_read_b128 v[48:51], v6 offset:16384
  s_waitcnt lgkmcnt(3)
  v_mfma_f32_32x32x16_bf16 v[16:31], v[52:55], v[244:247], v[16:31]
  v_mfma_f32_32x32x16_bf16 v[32:47], v[52:55], a[148:151], v[32:47]
  ds_read_b128 v[52:55], v6 offset:17408
  s_waitcnt lgkmcnt(3)
  v_mfma_f32_32x32x16_bf16 v[16:31], v[56:59], v[248:251], v[16:31]
  v_mfma_f32_32x32x16_bf16 v[32:47], v[56:59], a[152:155], v[32:47]
  ds_read_b128 v[56:59], v6 offset:18432
  s_waitcnt lgkmcnt(3)
  v_mfma_f32_32x32x16_bf16 v[16:31], v[60:63], v[252:255], v[16:31]
  v_mfma_f32_32x32x16_bf16 v[32:47], v[60:63], a[156:159], v[32:47]
  ds_read_b128 v[60:63], v6 offset:19456
  s_waitcnt lgkmcnt(3)
  v_mfma_f32_32x32x16_bf16 v[16:31], v[48:51], a[0:3], v[16:31]
  v_mfma_f32_32x32x16_bf16 v[32:47], v[48:51], a[160:163], v[32:47]
  ds_read_b128 v[48:51], v6 offset:20480
  s_waitcnt lgkmcnt(3)
  v_mfma_f32_32x32x16_bf16 v[16:31], v[52:55], a[4:7], v[16:31]
  v_mfma_f32_32x32x16_bf16 v[32:47], v[52:55], a[164:167], v[32:47]
  ds_read_b128 v[52:55], v6 offset:21504
  s_waitcnt lgkmcnt(3)
  v_mfma_f32_32x32x16_bf16 v[16:31], v[56:59], a[8:11], v[16:31]
  v_mfma_f32_32x32x16_bf16 v[32:47], v[56:59], a[168:171], v[32:47]
  ds_read_b128 v[56:59], v6 offset:22528
  s_waitcnt lgkmcnt(3)
  v_mfma_f32_32x32x16_bf16 v[16:31], v[60:63], a[12:15], v[16:31]
  v_mfma_f32_32x32x16_bf16 v[32:47], v[60:63], a[172:175], v[32:47]
  ds_read_b128 v[60:63], v6 offset:23552
  s_waitcnt lgkmcnt(3)
  v_mfma_f32_32x32x16_bf16 v[16:31], v[48:51], a[16:19], v[16:31]
  v_mfma_f32_32x32x16_bf16 v[32:47], v[48:51], a[176:179], v[32:47]
  ds_read_b128 v[48:51], v6 offset:24576
  s_waitcnt lgkmcnt(3)
  v_mfma_f32_32x32x16_bf16 v[16:31], v[52:55], a[20:23], v[16:31]
  v_mfma_f32_32x32x16_bf16 v[32:47], v[52:55], a[180:183], v[32:47]
  ds_read_b128 v[52:55], v6 offset:25600
  s_waitcnt lgkmcnt(3)
  v_mfma_f32_32x32x16_bf16 v[16:31], v[56:59], a[24:27], v[16:31]
  v_mfma_f32_32x32x16_bf16 v[32:47], v[56:59], a[184:187], v[32:47]
  ds_read_b128 v[56:59], v6 offset:26624
  s_waitcnt lgkmcnt(3)
  v_mfma_f32_32x32x16_bf16 v[16:31], v[60:63], a[28:31], v[16:31]
  v_mfma_f32_32x32x16_bf16 v[32:47], v[60:63], a[188:191], v[32:47]
  ds_read_b128 v[60:63], v6 offset:27648
  s_waitcnt lgkmcnt(3)
  v_mfma_f32_32x32x16_bf16 v[16:31], v[48:51], a[32:35], v[16:31]
  v_mfma_f32_32x32x16_bf16 v[32:47], v[48:51], a[192:195], v[32:47]
  ds_read_b128 v[48:51], v6 offset:28672
  s_waitcnt lgkmcnt(3)
  v_mfma_f32_32x32x16_bf16 v[16:31], v[52:55], a[36:39], v[16:31]
  v_mfma_f32_32x32x16_bf16 v[32:47], v[52:55], a[196:199], v[32:47]
  ds_read_b128 v[52:55], v6 offset:29696
  s_waitcnt lgkmcnt(3)
  v_mfma_f32_32x32x16_bf16 v[16:31], v[56:59], a[40:43], v[16:31]
  v_mfma_f32_32x32x16_bf16 v[32:47], v[56:59], a[200:203], v[32:47]
  ds_read_b128 v[56:59], v6 offset:30720
  s_waitcnt lgkmcnt(3)
  v_mfma_f32_32x32x16_bf16 v[16:31], v[60:63], a[44:47], v[16:31]
  v_mfma_f32_32x32x16_bf16 v[32:47], v[60:63], a[204:207], v[32:47]
  ds_read_b128 v[60:63], v6 offset:31744
  s_waitcnt lgkmcnt(3)
  v_mfma_f32_32x32x16_bf16 v[16:31], v[48:51], a[48:51], v[16:31]
  v_mfma_f32_32x32x16_bf16 v[32:47], v[48:51], a[208:211], v[32:47]
  ds_read_b128 v[48:51], v6 offset:32768
  s_waitcnt lgkmcnt(3)
  v_mfma_f32_32x32x16_bf16 v[16:31], v[52:55], a[52:55], v[16:31]
  v_mfma_f32_32x32x16_bf16 v[32:47], v[52:55], a[212:215], v[32:47]
  ds_read_b128 v[52:55], v6 offset:33792
  s_waitcnt lgkmcnt(3)
  v_mfma_f32_32x32x16_bf16 v[16:31], v[56:59], a[56:59], v[16:31]
  v_mfma_f32_32x32x16_bf16 v[32:47], v[56:59], a[216:219], v[32:47]
  ds_read_b128 v[56:59], v6 offset:34816
  s_waitcnt lgkmcnt(3)
  v_mfma_f32_32x32x16_bf16 v[16:31], v[60:63], a[60:63], v[16:31]
  v_mfma_f32_32x32x16_bf16 v[32:47], v[60:63], a[220:223], v[32:47]
  ds_read_b128 v[60:63], v6 offset:35840
  s_waitcnt lgkmcnt(3)
  v_mfma_f32_32x32x16_bf16 v[16:31], v[48:51], a[64:67], v[16:31]
  v_mfma_f32_32x32x16_bf16 v[32:47], v[48:51], a[224:227], v[32:47]
  ds_read_b128 v[48:51], v6 offset:36864
  s_waitcnt lgkmcnt(3)
  v_mfma_f32_32x32x16_bf16 v[16:31], v[52:55], a[68:71], v[16:31]
  v_mfma_f32_32x32x16_bf16 v[32:47], v[52:55], a[228:231], v[32:47]
  ds_read_b128 v[52:55], v6 offset:37888
  s_waitcnt lgkmcnt(3)
  v_mfma_f32_32x32x16_bf16 v[16:31], v[56:59], a[72:75], v[16:31]
  v_mfma_f32_32x32x16_bf16 v[32:47], v[56:59], a[232:235], v[32:47]
  ds_read_b128 v[56:59], v6 offset:38912
  s_waitcnt lgkmcnt(3)
  v_mfma_f32_32x32x16_bf16 v[16:31], v[60:63], a[76:79], v[16:31]
  v_mfma_f32_32x32x16_bf16 v[32:47], v[60:63], a[236:239], v[32:47]
  ds_read_b128 v[60:63], v6 offset:39936
  s_waitcnt lgkmcnt(3)
  v_mfma_f32_32x32x16_bf16 v[16:31], v[48:51], a[80:83], v[16:31]
  v_mfma_f32_32x32x16_bf16 v[32:47], v[48:51], a[240:243], v[32:47]
  s_waitcnt lgkmcnt(2)
  v_mfma_f32_32x32x16_bf16 v[16:31], v[52:55], a[84:87], v[16:31]
  v_mfma_f32_32x32x16_bf16 v[32:47], v[52:55], a[244:247], v[32:47]
  s_waitcnt lgkmcnt(1)
  v_mfma_f32_32x32x16_bf16 v[16:31], v[56:59], a[88:91], v[16:31]
  v_mfma_f32_32x32x16_bf16 v[32:47], v[56:59], a[248:251], v[32:47]
  s_waitcnt lgkmcnt(0)
  v_mfma_f32_32x32x16_bf16 v[16:31], v[60:63], a[92:95], v[16:31]
  v_mfma_f32_32x32x16_bf16 v[32:47], v[60:63], a[252:255], v[32:47]
  s_nop 7
  s_nop 3
  v_cvt_pk_bf16_f32 v64, v16, v17
  v_cvt_pk_bf16_f32 v65, v18, v19
  v_cvt_pk_bf16_f32 v66, v20, v21
  v_cvt_pk_bf16_f32 v67, v22, v23
  v_cvt_pk_bf16_f32 v68, v24, v25
  v_cvt_pk_bf16_f32 v69, v26, v27
  v_cvt_pk_bf16_f32 v70, v28, v29
  v_cvt_pk_bf16_f32 v71, v30, v31
  buffer_store_dwordx4 v[64:67], v7, s[4:7], s45 offen offset:0 sc1
  buffer_store_dwordx4 v[68:71], v7, s[4:7], s45 offen offset:512 sc1
  v_cvt_pk_bf16_f32 v72, v32, v33
  v_cvt_pk_bf16_f32 v73, v34, v35
  v_cvt_pk_bf16_f32 v74, v36, v37
  v_cvt_pk_bf16_f32 v75, v38, v39
  v_cvt_pk_bf16_f32 v76, v40, v41
  v_cvt_pk_bf16_f32 v77, v42, v43
  v_cvt_pk_bf16_f32 v78, v44, v45
  v_cvt_pk_bf16_f32 v79, v46, v47
  buffer_store_dwordx4 v[72:75], v7, s[4:7], s45 offen offset:2048 sc1
  buffer_store_dwordx4 v[76:79], v7, s[4:7], s45 offen offset:2560 sc1
L_kv_e:
  s_add_u32 s45, s45, 524288
  s_add_u32 s47, s47, 1
  s_branch L_kv_loop
L_kv_done:
  s_cmp_lg_u32 s41, 0
  s_cbranch_scc1 L_fin
  s_mov_b32 s63, 53
  s_branch L_qa_help
L_mlp:
  s_cmp_eq_u32 s101, 0
  s_cbranch_scc1 L_sig_24
  s_mov_b32 s101, 0
  s_waitcnt vmcnt(0)
  s_mov_b64 exec, 1
  v_mov_b32 v0, 1
  buffer_atomic_add v0, off, s[8:11], 0 offset:32
  s_mov_b64 exec, -1
L_sig_24:
  s_lshr_b32 s3, s32, 5
  s_and_b32 s36, s32, 15
  s_lshl4_add_u32 s37, s3, s36
  s_sub_u32 s37, s37, 64
  s_and_b32 s36, s32, 7
  s_lshl3_add_u32 s3, s3, s36
  s_sub_u32 s3, s3, 16
  s_cmp_ge_u32 s32, 192
  s_cselect_b32 s3, s37, s3
  s_lshl2_add_u32 s3, s3, s28
  s_mul_i32 s36, s3, 20480
  v_lshlrev_b32 v15, 4, v1
  s_lshl_b32 s37, s28, 12
  s_add_u32 m0, s37, 0x20000
  s_mov_b32 s24, s70
  s_mov_b32 s25, s71
  s_mov_b32 s26, 5242880
  s_mov_b32 s27, 0x20000
  s_mov_b32 s37, s36
  buffer_load_dwordx4 v15, s[24:27], s37 offen offset:0 lds
  buffer_load_dwordx4 v15, s[24:27], s37 offen offset:1024 lds
  buffer_load_dwordx4 v15, s[24:27], s37 offen offset:2048 lds
  buffer_load_dwordx4 v15, s[24:27], s37 offen offset:3072 lds
  s_add_u32 s37, s37, 4096
  buffer_load_dwordx4 v15, s[24:27], s37 offen offset:0 lds
  buffer_load_dwordx4 v15, s[24:27], s37 offen offset:1024 lds
  buffer_load_dwordx4 v15, s[24:27], s37 offen offset:2048 lds
  buffer_load_dwordx4 v15, s[24:27], s37 offen offset:3072 lds
  s_add_u32 s37, s37, 4096
  buffer_load_dwordx4 v15, s[24:27], s37 offen offset:0 lds
  buffer_load_dwordx4 v15, s[24:27], s37 offen offset:1024 lds
  buffer_load_dwordx4 v15, s[24:27], s37 offen offset:2048 lds
  buffer_load_dwordx4 v15, s[24:27], s37 offen offset:3072 lds
  s_add_u32 s37, s37, 4096
  buffer_load_dwordx4 v15, s[24:27], s37 offen offset:0 lds
  buffer_load_dwordx4 v15, s[24:27], s37 offen offset:1024 lds
  buffer_load_dwordx4 v15, s[24:27], s37 offen offset:2048 lds
  buffer_load_dwordx4 v15, s[24:27], s37 offen offset:3072 lds
  s_add_u32 s37, s37, 4096
  buffer_load_dwordx4 v15, s[24:27], s37 offen offset:0 lds
  buffer_load_dwordx4 v15, s[24:27], s37 offen offset:1024 lds
  buffer_load_dwordx4 v15, s[24:27], s37 offen offset:2048 lds
  buffer_load_dwordx4 v15, s[24:27], s37 offen offset:3072 lds
  s_mov_b32 s24, s72
  s_mov_b32 s25, s73
  s_mov_b32 s26, 5242880
  s_mov_b32 s27, 0x20000
  s_mov_b32 s37, s36
  buffer_load_dwordx4 v15, s[24:27], s37 offen offset:0 lds
  buffer_load_dwordx4 v15, s[24:27], s37 offen offset:1024 lds
  buffer_load_dwordx4 v15, s[24:27], s37 offen offset:2048 lds
  buffer_load_dwordx4 v15, s[24:27], s37 offen offset:3072 lds
  s_add_u32 s37, s37, 4096
  buffer_load_dwordx4 v15, s[24:27], s37 offen offset:0 lds
  buffer_load_dwordx4 v15, s[24:27], s37 offen offset:1024 lds
  buffer_load_dwordx4 v15, s[24:27], s37 offen offset:2048 lds
  buffer_load_dwordx4 v15, s[24:27], s37 offen offset:3072 lds
  s_add_u32 s37, s37, 4096
  buffer_load_dwordx4 v15, s[24:27], s37 offen offset:0 lds
  buffer_load_dwordx4 v15, s[24:27], s37 offen offset:1024 lds
  buffer_load_dwordx4 v15, s[24:27], s37 offen offset:2048 lds
  buffer_load_dwordx4 v15, s[24:27], s37 offen offset:3072 lds
  s_add_u32 s37, s37, 4096
  buffer_load_dwordx4 v15, s[24:27], s37 offen offset:0 lds
  buffer_load_dwordx4 v15, s[24:27], s37 offen offset:1024 lds
  buffer_load_dwordx4 v15, s[24:27], s37 offen offset:2048 lds
  buffer_load_dwordx4 v15, s[24:27], s37 offen offset:3072 lds
  s_add_u32 s37, s37, 4096
  buffer_load_dwordx4 v15, s[24:27], s37 offen offset:0 lds
  buffer_load_dwordx4 v15, s[24:27], s37 offen offset:1024 lds
  buffer_load_dwordx4 v15, s[24:27], s37 offen offset:2048 lds
  buffer_load_dwordx4 v15, s[24:27], s37 offen offset:3072 lds
  s_mov_b32 s24, s74
  s_mov_b32 s25, s75
  s_mov_b32 s26, 5242880
  s_mov_b32 s27, 0x20000
  s_mov_b32 s37, s36
  buffer_load_dwordx4 v15, s[24:27], s37 offen offset:0 lds
  buffer_load_dwordx4 v15, s[24:27], s37 offen offset:1024 lds
  buffer_load_dwordx4 v15, s[24:27], s37 offen offset:2048 lds
  buffer_load_dwordx4 v15, s[24:27], s37 offen offset:3072 lds
  s_add_u32 s37, s37, 4096
  buffer_load_dwordx4 v15, s[24:27], s37 offen offset:0 lds
  buffer_load_dwordx4 v15, s[24:27], s37 offen offset:1024 lds
  buffer_load_dwordx4 v15, s[24:27], s37 offen offset:2048 lds
  buffer_load_dwordx4 v15, s[24:27], s37 offen offset:3072 lds
  s_add_u32 s37, s37, 4096
  buffer_load_dwordx4 v15, s[24:27], s37 offen offset:0 lds
  buffer_load_dwordx4 v15, s[24:27], s37 offen offset:1024 lds
  buffer_load_dwordx4 v15, s[24:27], s37 offen offset:2048 lds
  buffer_load_dwordx4 v15, s[24:27], s37 offen offset:3072 lds
  s_add_u32 s37, s37, 4096
  buffer_load_dwordx4 v15, s[24:27], s37 offen offset:0 lds
  buffer_load_dwordx4 v15, s[24:27], s37 offen offset:1024 lds
  buffer_load_dwordx4 v15, s[24:27], s37 offen offset:2048 lds
  buffer_load_dwordx4 v15, s[24:27], s37 offen offset:3072 lds
  s_add_u32 s37, s37, 4096
  buffer_load_dwordx4 v15, s[24:27], s37 offen offset:0 lds
  buffer_load_dwordx4 v15, s[24:27], s37 offen offset:1024 lds
  buffer_load_dwordx4 v15, s[24:27], s37 offen offset:2048 lds
  buffer_load_dwordx4 v15, s[24:27], s37 offen offset:3072 lds
  s_lshr_b32 s3, s32, 5
  s_sub_u32 s3, s3, 2
  s_lshl_b32 s3, s3, 2
  s_and_b32 s38, s32, 3
  s_add_u32 s3, s3, s38
  s_cmp_ge_u32 s3, 14
  s_cbranch_scc1 L_idle
  s_lshr_b32 s40, s3, 1
  s_and_b32 s41, s3, 1
  s_mov_b32 s12, s80
  s_mov_b32 s13, s81
  s_mov_b32 s14, 2211840
  s_mov_b32 s15, 0x20000
  s_mov_b32 s16, s82
  s_mov_b32 s17, s83
  s_mov_b32 s18, 3456
  s_mov_b32 s19, 0x20000
  s_lshl_b32 s48, s40, 3
  s_lshl1_add_u32 s48, s28, s48
  s_min_u32 s38, s48, 52
  s_lshl_b32 s38, s38, 6
  s_cmp_lg_u32 s34, 0
  s_cbranch_scc1 L_verd_26
  s_cmp_eq_u32 s101, 0
  s_cbranch_scc1 L_sig_29
  s_mov_b32 s101, 0
  s_waitcnt vmcnt(0)
  s_mov_b64 exec, 1
  v_mov_b32 v0, 1
  buffer_atomic_add v0, off, s[8:11], 0 offset:32
  s_mov_b64 exec, -1
L_sig_29:
  v_lshlrev_b32 v2, 2, v1
L_ver_25:
  buffer_load_dword v3, v2, s[8:11], 0 offen sc1
  s_waitcnt vmcnt(0)
  v_readlane_b32 s3, v3, 8
  s_nop 0
  s_cmp_eq_u32 s3, 32
  s_cbranch_scc0 L_verf_28
  v_readlane_b32 s3, v3, 0
  v_readlane_b32 vcc_lo, v3, 1
  s_nop 0
  s_add_u32 s3, s3, vcc_lo
  v_readlane_b32 vcc_lo, v3, 34
  s_nop 0
  s_add_u32 s3, s3, vcc_lo
  v_readlane_b32 vcc_lo, v3, 35
  s_nop 0
  s_add_u32 s3, s3, vcc_lo
  v_readlane_b32 vcc_lo, v3, 36
  s_nop 0
  s_add_u32 s3, s3, vcc_lo
  v_readlane_b32 vcc_lo, v3, 37
  s_nop 0
  s_add_u32 s3, s3, vcc_lo
  v_readlane_b32 vcc_lo, v3, 38
  s_nop 0
  s_add_u32 s3, s3, vcc_lo
  v_readlane_b32 vcc_lo, v3, 39
  s_nop 0
  s_add_u32 s3, s3, vcc_lo
  s_cmp_eq_u32 s3, 0x100
  s_cbranch_scc1 L_verr_27
L_verf_28:
  s_sleep 2
  s_sub_u32 s29, s29, 1
  s_cbranch_scc0 L_ver_25
  s_branch L_end
L_verr_27:
  s_mov_b32 s34, 1
  v_cmp_ne_u32 vcc, 32, v3
  s_nop 4
  s_and_b32 vcc_lo, vcc_lo, 3
  s_and_b32 vcc_hi, vcc_hi, 0xfc
  s_cbranch_vccz L_verd_26
  s_mov_b32 s32, s31
  s_mov_b32 s33, 1
  v_readlane_b32 s3, v3, 0
  s_nop 0
  s_cmp_gt_u32 s30, 0
  s_cselect_b32 s3, s3, 0
  s_add_u32 s32, s32, s3
  v_readlane_b32 s3, v3, 1
  s_nop 0
  s_cmp_gt_u32 s30, 1
  s_cselect_b32 s3, s3, 0
  s_add_u32 s32, s32, s3
  v_readlane_b32 s3, v3, 34
  s_nop 0
  s_cmp_gt_u32 s30, 2
  s_cselect_b32 s3, s3, 0
  s_add_u32 s32, s32, s3
  v_readlane_b32 s3, v3, 35
  s_nop 0
  s_cmp_gt_u32 s30, 3
  s_cselect_b32 s3, s3, 0
  s_add_u32 s32, s32, s3
  v_readlane_b32 s3, v3, 36
  s_nop 0
  s_cmp_gt_u32 s30, 4
  s_cselect_b32 s3, s3, 0
  s_add_u32 s32, s32, s3
  v_readlane_b32 s3, v3, 37
  s_nop 0
  s_cmp_gt_u32 s30, 5
  s_cselect_b32 s3, s3, 0
  s_add_u32 s32, s32, s3
  v_readlane_b32 s3, v3, 38
  s_nop 0
  s_cmp_gt_u32 s30, 6
  s_cselect_b32 s3, s3, 0
  s_add_u32 s32, s32, s3
  s_branch L_restart
L_verd_26:
  s_mov_b32 s3, 180224
  s_mov_b32 s39, 1
  v_min_u32 v2, 63, v1
  v_mul_u32_u24 v2, 4, v2
L_wf_30:
  buffer_load_dword v3, v2, s[4:7], s3 offen sc1
  s_waitcnt vmcnt(0)
  v_cmp_gt_u32 vcc, s39, v3
  s_cbranch_vccz L_wfd_31
  s_sleep 8
  s_sub_u32 s29, s29, 1
  s_cbranch_scc0 L_wf_30
  s_branch L_end
L_wfd_31:
  v_lshrrev_b32 v2, 3, v1
  v_and_b32 v3, 7, v1
  v_lshlrev_b32 v4, 1, v2
  v_and_b32 v4, 4, v4
  v_xor_b32 v3, v3, v4
  s_mov_b32 s3, 3456
  v_mul_lo_u32 v2, v2, s3
  v_lshl_add_u32 v2, v3, 4, v2
  v_lshrrev_b32 v3, 5, v1
  v_lshlrev_b32 v3, 3, v3
  v_bfe_u32 v4, v1, 2, 2
  v_add_u32 v3, v3, v4
  v_mul_u32_u24 v3, 128, v3
  v_bfe_u32 v4, v1, 4, 1
  v_lshl_add_u32 v3, v4, 5, v3
  v_and_b32 v4, 3, v1
  v_lshl_add_u32 v3, v4, 3, v3
  s_lshl_b32 s35, s28, 15
  v_add_u32 v3, s35, v3
  v_bfe_u32 v4, v1, 3, 1
  v_lshl_add_u32 v3, v4, 6, v3
  v_xor_b32 v4, 64, v3
  s_add_u32 s36, s38, 0
  s_add_u32 m0, s35, 0
  s_nop 0
  buffer_load_dwordx4 v2, s[12:15], s36 offen lds
  s_add_u32 s36, s38, 27648
  s_add_u32 m0, s35, 1024
  s_nop 0
  buffer_load_dwordx4 v2, s[12:15], s36 offen lds
  s_add_u32 s36, s38, 55296
  s_add_u32 m0, s35, 2048
  s_nop 0
  buffer_load_dwordx4 v2, s[12:15], s36 offen lds
  s_add_u32 s36, s38, 82944
  s_add_u32 m0, s35, 3072
  s_nop 0
  buffer_load_dwordx4 v2, s[12:15], s36 offen lds
  s_add_u32 s36, s38, 110592
  s_add_u32 m0, s35, 4096
  s_nop 0
  buffer_load_dwordx4 v2, s[12:15], s36 offen lds
  s_add_u32 s36, s38, 138240
  s_add_u32 m0, s35, 5120
  s_nop 0
  buffer_load_dwordx4 v2, s[12:15], s36 offen lds
  s_add_u32 s36, s38, 165888
  s_add_u32 m0, s35, 6144
  s_nop 0
  buffer_load_dwordx4 v2, s[12:15], s36 offen lds
  s_add_u32 s36, s38, 193536
  s_add_u32 m0, s35, 7168
  s_nop 0
  buffer_load_dwordx4 v2, s[12:15], s36 offen lds
  s_add_u32 s36, s38, 221184
  s_add_u32 m0, s35, 8192
  s_nop 0
  buffer_load_dwordx4 v2, s[12:15], s36 offen lds
  s_add_u32 s36, s38, 248832
  s_add_u32 m0, s35, 9216
  s_nop 0
  buffer_load_dwordx4 v2, s[12:15], s36 offen lds
  s_add_u32 s36, s38, 276480
  s_add_u32 m0, s35, 10240
  s_nop 0
  buffer_load_dwordx4 v2, s[12:15], s36 offen lds
  s_add_u32 s36, s38, 304128
  s_add_u32 m0, s35, 11264
  s_nop 0
  buffer_load_dwordx4 v2, s[12:15], s36 offen lds
  s_add_u32 s36, s38, 331776
  s_add_u32 m0, s35, 12288
  s_nop 0
  buffer_load_dwordx4 v2, s[12:15], s36 offen lds
  s_add_u32 s36, s38, 359424
  s_add_u32 m0, s35, 13312
  s_nop 0
  buffer_load_dwordx4 v2, s[12:15], s36 offen lds
  s_add_u32 s36, s38, 387072
  s_add_u32 m0, s35, 14336
  s_nop 0
  buffer_load_dwordx4 v2, s[12:15], s36 offen lds
  s_add_u32 s36, s38, 414720
  s_add_u32 m0, s35, 15360
  s_nop 0
  buffer_load_dwordx4 v2, s[12:15], s36 offen lds
  s_add_u32 s36, s38, 442368
  s_add_u32 m0, s35, 16384
  s_nop 0
  buffer_load_dwordx4 v2, s[12:15], s36 offen lds
  s_add_u32 s36, s38, 470016
  s_add_u32 m0, s35, 17408
  s_nop 0
  buffer_load_dwordx4 v2, s[12:15], s36 offen lds
  s_add_u32 s36, s38, 497664
  s_add_u32 m0, s35, 18432
  s_nop 0
  buffer_load_dwordx4 v2, s[12:15], s36 offen lds
  s_add_u32 s36, s38, 525312
  s_add_u32 m0, s35, 19456
  s_nop 0
  buffer_load_dwordx4 v2, s[12:15], s36 offen lds
  s_add_u32 s36, s38, 552960
  s_add_u32 m0, s35, 20480
  s_nop 0
  buffer_load_dwordx4 v2, s[12:15], s36 offen lds
  s_add_u32 s36, s38, 580608
  s_add_u32 m0, s35, 21504
  s_nop 0
  buffer_load_dwordx4 v2, s[12:15], s36 offen lds
  s_add_u32 s36, s38, 608256
  s_add_u32 m0, s35, 22528
  s_nop 0
  buffer_load_dwordx4 v2, s[12:15], s36 offen lds
  s_add_u32 s36, s38, 635904
  s_add_u32 m0, s35, 23552
  s_nop 0
  buffer_load_dwordx4 v2, s[12:15], s36 offen lds
  s_add_u32 s36, s38, 663552
  s_add_u32 m0, s35, 24576
  s_nop 0
  buffer_load_dwordx4 v2, s[12:15], s36 offen lds
  s_add_u32 s36, s38, 691200
  s_add_u32 m0, s35, 25600
  s_nop 0
  buffer_load_dwordx4 v2, s[12:15], s36 offen lds
  s_add_u32 s36, s38, 718848
  s_add_u32 m0, s35, 26624
  s_nop 0
  buffer_load_dwordx4 v2, s[12:15], s36 offen lds
  s_add_u32 s36, s38, 746496
  s_add_u32 m0, s35, 27648
  s_nop 0
  buffer_load_dwordx4 v2, s[12:15], s36 offen lds
  s_add_u32 s36, s38, 774144
  s_add_u32 m0, s35, 28672
  s_nop 0
  buffer_load_dwordx4 v2, s[12:15], s36 offen lds
  s_add_u32 s36, s38, 801792
  s_add_u32 m0, s35, 29696
  s_nop 0
  buffer_load_dwordx4 v2, s[12:15], s36 offen lds
  s_add_u32 s36, s38, 829440
  s_add_u32 m0, s35, 30720
  s_nop 0
  buffer_load_dwordx4 v2, s[12:15], s36 offen lds
  s_add_u32 s36, s38, 857088
  s_add_u32 m0, s35, 31744
  s_nop 0
  buffer_load_dwordx4 v2, s[12:15], s36 offen lds
  s_waitcnt vmcnt(28)
  s_cmp_eq_u32 s101, 0
  s_cbranch_scc1 L_sig_32
  s_mov_b32 s101, 0
  s_mov_b64 exec, 1
  v_mov_b32 v0, 1
  buffer_atomic_add v0, off, s[8:11], 0 offset:32
  s_mov_b64 exec, -1
L_sig_32:
  ds_read_b64_tr_b16 v[192:193], v3 offset:0
  ds_read_b64_tr_b16 v[194:195], v3 offset:512
  ds_read_b64_tr_b16 a[96:97], v4 offset:0
  ds_read_b64_tr_b16 a[98:99], v4 offset:512
  ds_read_b64_tr_b16 v[196:197], v3 offset:2048
  ds_read_b64_tr_b16 v[198:199], v3 offset:2560
  ds_read_b64_tr_b16 a[100:101], v4 offset:2048
  ds_read_b64_tr_b16 a[102:103], v4 offset:2560
  s_waitcnt lgkmcnt(0)
  s_add_u32 s36, s38, 884736
  s_add_u32 m0, s35, 0
  s_nop 0
  buffer_load_dwordx4 v2, s[12:15], s36 offen lds
  s_add_u32 s36, s38, 912384
  s_add_u32 m0, s35, 1024
  s_nop 0
  buffer_load_dwordx4 v2, s[12:15], s36 offen lds
  s_add_u32 s36, s38, 940032
  s_add_u32 m0, s35, 2048
  s_nop 0
  buffer_load_dwordx4 v2, s[12:15], s36 offen lds
  s_add_u32 s36, s38, 967680
  s_add_u32 m0, s35, 3072
  s_nop 0
  buffer_load_dwordx4 v2, s[12:15], s36 offen lds
  s_waitcnt vmcnt(28)
  ds_read_b64_tr_b16 v[200:201], v3 offset:4096
  ds_read_b64_tr_b16 v[202:203], v3 offset:4608
  ds_read_b64_tr_b16 a[104:105], v4 offset:4096
  ds_read_b64_tr_b16 a[106:107], v4 offset:4608
  ds_read_b64_tr_b16 v[204:205], v3 offset:6144
  ds_read_b64_tr_b16 v[206:207], v3 offset:6656
  ds_read_b64_tr_b16 a[108:109], v4 offset:6144
  ds_read_b64_tr_b16 a[110:111], v4 offset:6656
  s_waitcnt lgkmcnt(0)
  s_add_u32 s36, s38, 995328
  s_add_u32 m0, s35, 4096
  s_nop 0
  buffer_load_dwordx4 v2, s[12:15], s36 offen lds
  s_add_u32 s36, s38, 1022976
  s_add_u32 m0, s35, 5120
  s_nop 0
  buffer_load_dwordx4 v2, s[12:15], s36 offen lds
  s_add_u32 s36, s38, 1050624
  s_add_u32 m0, s35, 6144
  s_nop 0
  buffer_load_dwordx4 v2, s[12:15], s36 offen lds
  s_add_u32 s36, s38, 1078272
  s_add_u32 m0, s35, 7168
  s_nop 0
  buffer_load_dwordx4 v2, s[12:15], s36 offen lds
  s_waitcnt vmcnt(28)
  ds_read_b64_tr_b16 v[208:209], v3 offset:8192
  ds_read_b64_tr_b16 v[210:211], v3 offset:8704
  ds_read_b64_tr_b16 a[112:113], v4 offset:8192
  ds_read_b64_tr_b16 a[114:115], v4 offset:8704
  ds_read_b64_tr_b16 v[212:213], v3 offset:10240
  ds_read_b64_tr_b16 v[214:215], v3 offset:10752
  ds_read_b64_tr_b16 a[116:117], v4 offset:10240
  ds_read_b64_tr_b16 a[118:119], v4 offset:10752
  s_waitcnt lgkmcnt(0)
  s_add_u32 s36, s38, 1105920
  s_add_u32 m0, s35, 8192
  s_nop 0
  buffer_load_dwordx4 v2, s[12:15], s36 offen lds
  s_add_u32 s36, s38, 1133568
  s_add_u32 m0, s35, 9216
  s_nop 0
  buffer_load_dwordx4 v2, s[12:15], s36 offen lds
  s_add_u32 s36, s38, 1161216
  s_add_u32 m0, s35, 10240
  s_nop 0
  buffer_load_dwordx4 v2, s[12:15], s36 offen lds
  s_add_u32 s36, s38, 1188864
  s_add_u32 m0, s35, 11264
  s_nop 0
  buffer_load_dwordx4 v2, s[12:15], s36 offen lds
  s_waitcnt vmcnt(28)
  ds_read_b64_tr_b16 v[216:217], v3 offset:12288
  ds_read_b64_tr_b16 v[218:219], v3 offset:12800
  ds_read_b64_tr_b16 a[120:121], v4 offset:12288
  ds_read_b64_tr_b16 a[122:123], v4 offset:12800
  ds_read_b64_tr_b16 v[220:221], v3 offset:14336
  ds_read_b64_tr_b16 v[222:223], v3 offset:14848
  ds_read_b64_tr_b16 a[124:125], v4 offset:14336
  ds_read_b64_tr_b16 a[126:127], v4 offset:14848
  s_waitcnt lgkmcnt(0)
  s_add_u32 s36, s38, 1216512
  s_add_u32 m0, s35, 12288
  s_nop 0
  buffer_load_dwordx4 v2, s[12:15], s36 offen lds
  s_add_u32 s36, s38, 1244160
  s_add_u32 m0, s35, 13312
  s_nop 0
  buffer_load_dwordx4 v2, s[12:15], s36 offen lds
  s_add_u32 s36, s38, 1271808
  s_add_u32 m0, s35, 14336
  s_nop 0
  buffer_load_dwordx4 v2, s[12:15], s36 offen lds
  s_add_u32 s36, s38, 1299456
  s_add_u32 m0, s35, 15360
  s_nop 0
  buffer_load_dwordx4 v2, s[12:15], s36 offen lds
  s_waitcnt vmcnt(28)
  ds_read_b64_tr_b16 v[224:225], v3 offset:16384
  ds_read_b64_tr_b16 v[226:227], v3 offset:16896
  ds_read_b64_tr_b16 a[128:129], v4 offset:16384
  ds_read_b64_tr_b16 a[130:131], v4 offset:16896
  ds_read_b64_tr_b16 v[228:229], v3 offset:18432
  ds_read_b64_tr_b16 v[230:231], v3 offset:18944
  ds_read_b64_tr_b16 a[132:133], v4 offset:18432
  ds_read_b64_tr_b16 a[134:135], v4 offset:18944
  s_waitcnt lgkmcnt(0)
  s_add_u32 s36, s38, 1327104
  s_add_u32 m0, s35, 16384
  s_nop 0
  buffer_load_dwordx4 v2, s[12:15], s36 offen lds
  s_add_u32 s36, s38, 1354752
  s_add_u32 m0, s35, 17408
  s_nop 0
  buffer_load_dwordx4 v2, s[12:15], s36 offen lds
  s_add_u32 s36, s38, 1382400
  s_add_u32 m0, s35, 18432
  s_nop 0
  buffer_load_dwordx4 v2, s[12:15], s36 offen lds
  s_add_u32 s36, s38, 1410048
  s_add_u32 m0, s35, 19456
  s_nop 0
  buffer_load_dwordx4 v2, s[12:15], s36 offen lds
  s_waitcnt vmcnt(28)
  ds_read_b64_tr_b16 v[232:233], v3 offset:20480
  ds_read_b64_tr_b16 v[234:235], v3 offset:20992
  ds_read_b64_tr_b16 a[136:137], v4 offset:20480
  ds_read_b64_tr_b16 a[138:139], v4 offset:20992
  ds_read_b64_tr_b16 v[236:237], v3 offset:22528
  ds_read_b64_tr_b16 v[238:239], v3 offset:23040
  ds_read_b64_tr_b16 a[140:141], v4 offset:22528
  ds_read_b64_tr_b16 a[142:143], v4 offset:23040
  s_waitcnt lgkmcnt(0)
  s_add_u32 s36, s38, 1437696
  s_add_u32 m0, s35, 20480
  s_nop 0
  buffer_load_dwordx4 v2, s[12:15], s36 offen lds
  s_add_u32 s36, s38, 1465344
  s_add_u32 m0, s35, 21504
  s_nop 0
  buffer_load_dwordx4 v2, s[12:15], s36 offen lds
  s_add_u32 s36, s38, 1492992
  s_add_u32 m0, s35, 22528
  s_nop 0
  buffer_load_dwordx4 v2, s[12:15], s36 offen lds
  s_add_u32 s36, s38, 1520640
  s_add_u32 m0, s35, 23552
  s_nop 0
  buffer_load_dwordx4 v2, s[12:15], s36 offen lds
  s_waitcnt vmcnt(28)
  ds_read_b64_tr_b16 v[240:241], v3 offset:24576
  ds_read_b64_tr_b16 v[242:243], v3 offset:25088
  ds_read_b64_tr_b16 a[144:145], v4 offset:24576
  ds_read_b64_tr_b16 a[146:147], v4 offset:25088
  ds_read_b64_tr_b16 v[244:245], v3 offset:26624
  ds_read_b64_tr_b16 v[246:247], v3 offset:27136
  ds_read_b64_tr_b16 a[148:149], v4 offset:26624
  ds_read_b64_tr_b16 a[150:151], v4 offset:27136
  s_waitcnt lgkmcnt(0)
  s_add_u32 s36, s38, 1548288
  s_add_u32 m0, s35, 24576
  s_nop 0
  buffer_load_dwordx4 v2, s[12:15], s36 offen lds
  s_add_u32 s36, s38, 1575936
  s_add_u32 m0, s35, 25600
  s_nop 0
  buffer_load_dwordx4 v2, s[12:15], s36 offen lds
  s_add_u32 s36, s38, 1603584
  s_add_u32 m0, s35, 26624
  s_nop 0
  buffer_load_dwordx4 v2, s[12:15], s36 offen lds
  s_add_u32 s36, s38, 1631232
  s_add_u32 m0, s35, 27648
  s_nop 0
  buffer_load_dwordx4 v2, s[12:15], s36 offen lds
  s_waitcnt vmcnt(28)
  ds_read_b64_tr_b16 v[248:249], v3 offset:28672
  ds_read_b64_tr_b16 v[250:251], v3 offset:29184
  ds_read_b64_tr_b16 a[152:153], v4 offset:28672
  ds_read_b64_tr_b16 a[154:155], v4 offset:29184
  ds_read_b64_tr_b16 v[252:253], v3 offset:30720
  ds_read_b64_tr_b16 v[254:255], v3 offset:31232
  ds_read_b64_tr_b16 a[156:157], v4 offset:30720
  ds_read_b64_tr_b16 a[158:159], v4 offset:31232
  s_waitcnt lgkmcnt(0)
  s_add_u32 s36, s38, 1658880
  s_add_u32 m0, s35, 28672
  s_nop 0
  buffer_load_dwordx4 v2, s[12:15], s36 offen lds
  s_add_u32 s36, s38, 1686528
  s_add_u32 m0, s35, 29696
  s_nop 0
  buffer_load_dwordx4 v2, s[12:15], s36 offen lds
  s_add_u32 s36, s38, 1714176
  s_add_u32 m0, s35, 30720
  s_nop 0
  buffer_load_dwordx4 v2, s[12:15], s36 offen lds
  s_add_u32 s36, s38, 1741824
  s_add_u32 m0, s35, 31744
  s_nop 0
  buffer_load_dwordx4 v2, s[12:15], s36 offen lds
  s_waitcnt vmcnt(28)
  ds_read_b64_tr_b16 a[0:1], v3 offset:0
  ds_read_b64_tr_b16 a[2:3], v3 offset:512
  ds_read_b64_tr_b16 a[160:161], v4 offset:0
  ds_read_b64_tr_b16 a[162:163], v4 offset:512
  ds_read_b64_tr_b16 a[4:5], v3 offset:2048
  ds_read_b64_tr_b16 a[6:7], v3 offset:2560
  ds_read_b64_tr_b16 a[164:165], v4 offset:2048
  ds_read_b64_tr_b16 a[166:167], v4 offset:2560
  s_waitcnt lgkmcnt(0)
  s_add_u32 s36, s38, 1769472
  s_add_u32 m0, s35, 0
  s_nop 0
  buffer_load_dwordx4 v2, s[12:15], s36 offen lds
  s_add_u32 s36, s38, 1797120
  s_add_u32 m0, s35, 1024
  s_nop 0
  buffer_load_dwordx4 v2, s[12:15], s36 offen lds
  s_add_u32 s36, s38, 1824768
  s_add_u32 m0, s35, 2048
  s_nop 0
  buffer_load_dwordx4 v2, s[12:15], s36 offen lds
  s_add_u32 s36, s38, 1852416
  s_add_u32 m0, s35, 3072
  s_nop 0
  buffer_load_dwordx4 v2, s[12:15], s36 offen lds
  s_waitcnt vmcnt(28)
  ds_read_b64_tr_b16 a[8:9], v3 offset:4096
  ds_read_b64_tr_b16 a[10:11], v3 offset:4608
  ds_read_b64_tr_b16 a[168:169], v4 offset:4096
  ds_read_b64_tr_b16 a[170:171], v4 offset:4608
  ds_read_b64_tr_b16 a[12:13], v3 offset:6144
  ds_read_b64_tr_b16 a[14:15], v3 offset:6656
  ds_read_b64_tr_b16 a[172:173], v4 offset:6144
  ds_read_b64_tr_b16 a[174:175], v4 offset:6656
  s_waitcnt lgkmcnt(0)
  s_add_u32 s36, s38, 1880064
  s_add_u32 m0, s35, 4096
  s_nop 0
  buffer_load_dwordx4 v2, s[12:15], s36 offen lds
  s_add_u32 s36, s38, 1907712
  s_add_u32 m0, s35, 5120
  s_nop 0
  buffer_load_dwordx4 v2, s[12:15], s36 offen lds
  s_add_u32 s36, s38, 1935360
  s_add_u32 m0, s35, 6144
  s_nop 0
  buffer_load_dwordx4 v2, s[12:15], s36 offen lds
  s_add_u32 s36, s38, 1963008
  s_add_u32 m0, s35, 7168
  s_nop 0
  buffer_load_dwordx4 v2, s[12:15], s36 offen lds
  s_waitcnt vmcnt(28)
  ds_read_b64_tr_b16 a[16:17], v3 offset:8192
  ds_read_b64_tr_b16 a[18:19], v3 offset:8704
  ds_read_b64_tr_b16 a[176:177], v4 offset:8192
  ds_read_b64_tr_b16 a[178:179], v4 offset:8704
  ds_read_b64_tr_b16 a[20:21], v3 offset:10240
  ds_read_b64_tr_b16 a[22:23], v3 offset:10752
  ds_read_b64_tr_b16 a[180:181], v4 offset:10240
  ds_read_b64_tr_b16 a[182:183], v4 offset:10752
  s_waitcnt lgkmcnt(0)
  s_add_u32 s36, s38, 1990656
  s_add_u32 m0, s35, 8192
  s_nop 0
  buffer_load_dwordx4 v2, s[12:15], s36 offen lds
  s_add_u32 s36, s38, 2018304
  s_add_u32 m0, s35, 9216
  s_nop 0
  buffer_load_dwordx4 v2, s[12:15], s36 offen lds
  s_add_u32 s36, s38, 2045952
  s_add_u32 m0, s35, 10240
  s_nop 0
  buffer_load_dwordx4 v2, s[12:15], s36 offen lds
  s_add_u32 s36, s38, 2073600
  s_add_u32 m0, s35, 11264
  s_nop 0
  buffer_load_dwordx4 v2, s[12:15], s36 offen lds
  s_waitcnt vmcnt(28)
  ds_read_b64_tr_b16 a[24:25], v3 offset:12288
  ds_read_b64_tr_b16 a[26:27], v3 offset:12800
  ds_read_b64_tr_b16 a[184:185], v4 offset:12288
  ds_read_b64_tr_b16 a[186:187], v4 offset:12800
  ds_read_b64_tr_b16 a[28:29], v3 offset:14336
  ds_read_b64_tr_b16 a[30:31], v3 offset:14848
  ds_read_b64_tr_b16 a[188:189], v4 offset:14336
  ds_read_b64_tr_b16 a[190:191], v4 offset:14848
  s_waitcnt lgkmcnt(0)
  s_add_u32 s36, s38, 2101248
  s_add_u32 m0, s35, 12288
  s_nop 0
  buffer_load_dwordx4 v2, s[12:15], s36 offen lds
  s_add_u32 s36, s38, 2128896
  s_add_u32 m0, s35, 13312
  s_nop 0
  buffer_load_dwordx4 v2, s[12:15], s36 offen lds
  s_add_u32 s36, s38, 2156544
  s_add_u32 m0, s35, 14336
  s_nop 0
  buffer_load_dwordx4 v2, s[12:15], s36 offen lds
  s_add_u32 s36, s38, 2184192
  s_add_u32 m0, s35, 15360
  s_nop 0
  buffer_load_dwordx4 v2, s[12:15], s36 offen lds
  s_waitcnt vmcnt(28)
  ds_read_b64_tr_b16 a[32:33], v3 offset:16384
  ds_read_b64_tr_b16 a[34:35], v3 offset:16896
  ds_read_b64_tr_b16 a[192:193], v4 offset:16384
  ds_read_b64_tr_b16 a[194:195], v4 offset:16896
  ds_read_b64_tr_b16 a[36:37], v3 offset:18432
  ds_read_b64_tr_b16 a[38:39], v3 offset:18944
  ds_read_b64_tr_b16 a[196:197], v4 offset:18432
  ds_read_b64_tr_b16 a[198:199], v4 offset:18944
  s_waitcnt vmcnt(24)
  ds_read_b64_tr_b16 a[40:41], v3 offset:20480
  ds_read_b64_tr_b16 a[42:43], v3 offset:20992
  ds_read_b64_tr_b16 a[200:201], v4 offset:20480
  ds_read_b64_tr_b16 a[202:203], v4 offset:20992
  ds_read_b64_tr_b16 a[44:45], v3 offset:22528
  ds_read_b64_tr_b16 a[46:47], v3 offset:23040
  ds_read_b64_tr_b16 a[204:205], v4 offset:22528
  ds_read_b64_tr_b16 a[206:207], v4 offset:23040
  s_waitcnt vmcnt(20)
  ds_read_b64_tr_b16 a[48:49], v3 offset:24576
  ds_read_b64_tr_b16 a[50:51], v3 offset:25088
  ds_read_b64_tr_b16 a[208:209], v4 offset:24576
  ds_read_b64_tr_b16 a[210:211], v4 offset:25088
  ds_read_b64_tr_b16 a[52:53], v3 offset:26624
  ds_read_b64_tr_b16 a[54:55], v3 offset:27136
  ds_read_b64_tr_b16 a[212:213], v4 offset:26624
  ds_read_b64_tr_b16 a[214:215], v4 offset:27136
  s_waitcnt vmcnt(16)
  ds_read_b64_tr_b16 a[56:57], v3 offset:28672
  ds_read_b64_tr_b16 a[58:59], v3 offset:29184
  ds_read_b64_tr_b16 a[216:217], v4 offset:28672
  ds_read_b64_tr_b16 a[218:219], v4 offset:29184
  ds_read_b64_tr_b16 a[60:61], v3 offset:30720
  ds_read_b64_tr_b16 a[62:63], v3 offset:31232
  ds_read_b64_tr_b16 a[220:221], v4 offset:30720
  ds_read_b64_tr_b16 a[222:223], v4 offset:31232
  s_waitcnt vmcnt(12)
  ds_read_b64_tr_b16 a[64:65], v3 offset:0
  ds_read_b64_tr_b16 a[66:67], v3 offset:512
  ds_read_b64_tr_b16 a[224:225], v4 offset:0
  ds_read_b64_tr_b16 a[226:227], v4 offset:512
  ds_read_b64_tr_b16 a[68:69], v3 offset:2048
  ds_read_b64_tr_b16 a[70:71], v3 offset:2560
  ds_read_b64_tr_b16 a[228:229], v4 offset:2048
  ds_read_b64_tr_b16 a[230:231], v4 offset:2560
  s_waitcnt vmcnt(8)
  ds_read_b64_tr_b16 a[72:73], v3 offset:4096
  ds_read_b64_tr_b16 a[74:75], v3 offset:4608
  ds_read_b64_tr_b16 a[232:233], v4 offset:4096
  ds_read_b64_tr_b16 a[234:235], v4 offset:4608
  ds_read_b64_tr_b16 a[76:77], v3 offset:6144
  ds_read_b64_tr_b16 a[78:79], v3 offset:6656
  ds_read_b64_tr_b16 a[236:237], v4 offset:6144
  ds_read_b64_tr_b16 a[238:239], v4 offset:6656
  s_waitcnt vmcnt(4)
  ds_read_b64_tr_b16 a[80:81], v3 offset:8192
  ds_read_b64_tr_b16 a[82:83], v3 offset:8704
  ds_read_b64_tr_b16 a[240:241], v4 offset:8192
  ds_read_b64_tr_b16 a[242:243], v4 offset:8704
  ds_read_b64_tr_b16 a[84:85], v3 offset:10240
  ds_read_b64_tr_b16 a[86:87], v3 offset:10752
  ds_read_b64_tr_b16 a[244:245], v4 offset:10240
  ds_read_b64_tr_b16 a[246:247], v4 offset:10752
  s_waitcnt vmcnt(0)
  ds_read_b64_tr_b16 a[88:89], v3 offset:12288
  ds_read_b64_tr_b16 a[90:91], v3 offset:12800
  ds_read_b64_tr_b16 a[248:249], v4 offset:12288
  ds_read_b64_tr_b16 a[250:251], v4 offset:12800
  ds_read_b64_tr_b16 a[92:93], v3 offset:14336
  ds_read_b64_tr_b16 a[94:95], v3 offset:14848
  ds_read_b64_tr_b16 a[252:253], v4 offset:14336
  ds_read_b64_tr_b16 a[254:255], v4 offset:14848
  s_waitcnt lgkmcnt(0)
  v_lshrrev_b32 v2, 5, v1
  v_lshlrev_b32 v2, 3, v2
  buffer_load_dwordx2 v[64:65], v2, s[16:19], s38 offen offset:0
  buffer_load_dwordx2 v[66:67], v2, s[16:19], s38 offen offset:16
  buffer_load_dwordx2 v[68:69], v2, s[16:19], s38 offen offset:32
  buffer_load_dwordx2 v[70:71], v2, s[16:19], s38 offen offset:48
  buffer_load_dwordx2 v[72:73], v2, s[16:19], s38 offen offset:64
  buffer_load_dwordx2 v[74:75], v2, s[16:19], s38 offen offset:80
  buffer_load_dwordx2 v[76:77], v2, s[16:19], s38 offen offset:96
  buffer_load_dwordx2 v[78:79], v2, s[16:19], s38 offen offset:112
  s_waitcnt vmcnt(0)
  v_lshlrev_b32 v80, 16, v64
  v_and_b32 v81, 0xffff0000, v64
  v_lshlrev_b32 v82, 16, v65
  v_and_b32 v83, 0xffff0000, v65
  v_lshlrev_b32 v84, 16, v66
  v_and_b32 v85, 0xffff0000, v66
  v_lshlrev_b32 v86, 16, v67
  v_and_b32 v87, 0xffff0000, v67
  v_lshlrev_b32 v88, 16, v68
  v_and_b32 v89, 0xffff0000, v68
  v_lshlrev_b32 v90, 16, v69
  v_and_b32 v91, 0xffff0000, v69
  v_lshlrev_b32 v92, 16, v70
  v_and_b32 v93, 0xffff0000, v70
  v_lshlrev_b32 v94, 16, v71
  v_and_b32 v95, 0xffff0000, v71
  v_lshlrev_b32 v96, 16, v72
  v_and_b32 v97, 0xffff0000, v72
  v_lshlrev_b32 v98, 16, v73
  v_and_b32 v99, 0xffff0000, v73
  v_lshlrev_b32 v100, 16, v74
  v_and_b32 v101, 0xffff0000, v74
  v_lshlrev_b32 v102, 16, v75
  v_and_b32 v103, 0xffff0000, v75
  v_lshlrev_b32 v104, 16, v76
  v_and_b32 v105, 0xffff0000, v76
  v_lshlrev_b32 v106, 16, v77
  v_and_b32 v107, 0xffff0000, v77
  v_lshlrev_b32 v108, 16, v78
  v_and_b32 v109, 0xffff0000, v78
  v_lshlrev_b32 v110, 16, v79
  v_and_b32 v111, 0xffff0000, v79
  s_cmp_lg_u32 s34, 0
  s_cbranch_scc1 L_verd_34
  s_cmp_eq_u32 s101, 0
  s_cbranch_scc1 L_sig_37
  s_mov_b32 s101, 0
  s_waitcnt vmcnt(0)
  s_mov_b64 exec, 1
  v_mov_b32 v0, 1
  buffer_atomic_add v0, off, s[8:11], 0 offset:32
  s_mov_b64 exec, -1
L_sig_37:
  v_lshlrev_b32 v2, 2, v1
L_ver_33:
  buffer_load_dword v3, v2, s[8:11], 0 offen sc1
  s_waitcnt vmcnt(0)
  v_readlane_b32 s3, v3, 8
  s_nop 0
  s_cmp_eq_u32 s3, 32
  s_cbranch_scc0 L_verf_36
  v_readlane_b32 s3, v3, 0
  v_readlane_b32 vcc_lo, v3, 1
  s_nop 0
  s_add_u32 s3, s3, vcc_lo
  v_readlane_b32 vcc_lo, v3, 34
  s_nop 0
  s_add_u32 s3, s3, vcc_lo
  v_readlane_b32 vcc_lo, v3, 35
  s_nop 0
  s_add_u32 s3, s3, vcc_lo
  v_readlane_b32 vcc_lo, v3, 36
  s_nop 0
  s_add_u32 s3, s3, vcc_lo
  v_readlane_b32 vcc_lo, v3, 37
  s_nop 0
  s_add_u32 s3, s3, vcc_lo
  v_readlane_b32 vcc_lo, v3, 38
  s_nop 0
  s_add_u32 s3, s3, vcc_lo
  v_readlane_b32 vcc_lo, v3, 39
  s_nop 0
  s_add_u32 s3, s3, vcc_lo
  s_cmp_eq_u32 s3, 0x100
  s_cbranch_scc1 L_verr_35
L_verf_36:
  s_sleep 2
  s_sub_u32 s29, s29, 1
  s_cbranch_scc0 L_ver_33
  s_branch L_end
L_verr_35:
  s_mov_b32 s34, 1
  v_cmp_ne_u32 vcc, 32, v3
  s_nop 4
  s_and_b32 vcc_lo, vcc_lo, 3
  s_and_b32 vcc_hi, vcc_hi, 0xfc
  s_cbranch_vccz L_verd_34
  s_mov_b32 s32, s31
  s_mov_b32 s33, 1
  v_readlane_b32 s3, v3, 0
  s_nop 0
  s_cmp_gt_u32 s30, 0
  s_cselect_b32 s3, s3, 0
  s_add_u32 s32, s32, s3
  v_readlane_b32 s3, v3, 1
  s_nop 0
  s_cmp_gt_u32 s30, 1
  s_cselect_b32 s3, s3, 0
  s_add_u32 s32, s32, s3
  v_readlane_b32 s3, v3, 34
  s_nop 0
  s_cmp_gt_u32 s30, 2
  s_cselect_b32 s3, s3, 0
  s_add_u32 s32, s32, s3
  v_readlane_b32 s3, v3, 35
  s_nop 0
  s_cmp_gt_u32 s30, 3
  s_cselect_b32 s3, s3, 0
  s_add_u32 s32, s32, s3
  v_readlane_b32 s3, v3, 36
  s_nop 0
  s_cmp_gt_u32 s30, 4
  s_cselect_b32 s3, s3, 0
  s_add_u32 s32, s32, s3
  v_readlane_b32 s3, v3, 37
  s_nop 0
  s_cmp_gt_u32 s30, 5
  s_cselect_b32 s3, s3, 0
  s_add_u32 s32, s32, s3
  v_readlane_b32 s3, v3, 38
  s_nop 0
  s_cmp_gt_u32 s30, 6
  s_cselect_b32 s3, s3, 0
  s_add_u32 s32, s32, s3
  s_branch L_restart
L_verd_34:
  s_mov_b32 s3, 180224
  s_mov_b32 s38, 2
  v_min_u32 v2, 63, v1
  v_mul_u32_u24 v2, 4, v2
L_wf_38:
  buffer_load_dword v3, v2, s[4:7], s3 offen sc1
  s_waitcnt vmcnt(0)
  v_cmp_gt_u32 vcc, s38, v3
  s_cbranch_vccz L_wfd_39
  s_sleep 1
  s_sub_u32 s29, s29, 1
  s_cbranch_scc0 L_wf_38
  s_branch L_end
L_wfd_39:
  v_lshlrev_b32 v5, 4, v1
  v_and_b32 v2, 15, v1
  v_lshlrev_b32 v2, 4, v2
  v_bfe_u32 v3, v1, 4, 1
  v_mul_u32_u24 v3, 55296, v3
  v_add_u32 v2, v2, v3
  v_lshrrev_b32 v3, 5, v1
  v_lshl_add_u32 v7, v3, 8, v2
  s_lshl_b32 s45, s48, 10
  s_mul_i32 s3, s41, 110592
  s_add_u32 s45, s45, s3
  s_add_u32 s45, s45, 75497472
  s_mul_i32 s44, s41, 40960
  s_add_u32 s44, s44, 3670016
  s_lshl_b32 s46, s41, 5
  s_lshl2_add_u32 s46, s40, s46
  s_add_u32 s46, s46, 189696
  s_mov_b32 s43, 0
  s_mov_b32 s47, 0
  s_barrier
  s_mov_b32 s50, 0xc0135761
  s_mov_b32 s51, 0xbdd2d3e8
  s_mul_i32 s3, s28, 10240
  s_add_u32 s36, s44, s3
  s_add_u32 s37, s43, s3
  s_mov_b32 m0, s37
  s_nop 0
  buffer_load_dwordx4 v5, s[4:7], s36 offen offset:0 sc1 lds
  buffer_load_dwordx4 v5, s[4:7], s36 offen offset:1024 sc1 lds
  buffer_load_dwordx4 v5, s[4:7], s36 offen offset:2048 sc1 lds
  buffer_load_dwordx4 v5, s[4:7], s36 offen offset:3072 sc1 lds
  s_add_u32 s36, s36, 4096
  s_add_u32 s37, s37, 4096
  s_mov_b32 m0, s37
  s_nop 0
  buffer_load_dwordx4 v5, s[4:7], s36 offen offset:0 sc1 lds
  buffer_load_dwordx4 v5, s[4:7], s36 offen offset:1024 sc1 lds
  buffer_load_dwordx4 v5, s[4:7], s36 offen offset:2048 sc1 lds
  buffer_load_dwordx4 v5, s[4:7], s36 offen offset:3072 sc1 lds
  s_add_u32 s36, s36, 4096
  s_add_u32 s37, s37, 4096
  s_mov_b32 m0, s37
  s_nop 0
  buffer_load_dwordx4 v5, s[4:7], s36 offen offset:0 sc1 lds
  buffer_load_dwordx4 v5, s[4:7], s36 offen offset:1024 sc1 lds
L_ml_loop:
  s_waitcnt vmcnt(0)
  s_barrier
  s_cmp_lg_u32 s28, 0
  s_cbranch_scc1 L_ml_nf
  v_mov_b32 v2, s47
  s_mov_b64 exec, 1
  buffer_store_dword v2, off, s[4:7], s46 sc1
  s_mov_b64 exec, -1
L_ml_nf:
  s_cmp_eq_u32 s47, 32
  s_cbranch_scc1 L_fin
  v_add_u32 v6, s43, v5
  s_sub_u32 s43, 40960, s43
  s_add_u32 s44, s44, 81920
  s_cmp_eq_u32 s47, 31
  s_cbranch_scc1 L_ml_nd
  s_mul_i32 s3, s28, 10240
  s_add_u32 s36, s44, s3
  s_add_u32 s37, s43, s3
  s_mov_b32 m0, s37
  s_nop 0
  buffer_load_dwordx4 v5, s[4:7], s36 offen offset:0 sc1 lds
  buffer_load_dwordx4 v5, s[4:7], s36 offen offset:1024 sc1 lds
  buffer_load_dwordx4 v5, s[4:7], s36 offen offset:2048 sc1 lds
  buffer_load_dwordx4 v5, s[4:7], s36 offen offset:3072 sc1 lds
  s_add_u32 s36, s36, 4096
  s_add_u32 s37, s37, 4096
  s_mov_b32 m0, s37
  s_nop 0
  buffer_load_dwordx4 v5, s[4:7], s36 offen offset:0 sc1 lds
  buffer_load_dwordx4 v5, s[4:7], s36 offen offset:1024 sc1 lds
  buffer_load_dwordx4 v5, s[4:7], s36 offen offset:2048 sc1 lds
  buffer_load_dwordx4 v5, s[4:7], s36 offen offset:3072 sc1 lds
  s_add_u32 s36, s36, 4096
  s_add_u32 s37, s37, 4096
  s_mov_b32 m0, s37
  s_nop 0
  buffer_load_dwordx4 v5, s[4:7], s36 offen offset:0 sc1 lds
  buffer_load_dwordx4 v5, s[4:7], s36 offen offset:1024 sc1 lds
L_ml_nd:
  s_cmp_ge_u32 s48, 54
  s_cbranch_scc1 L_ml_e
  ds_read_b128 v[48:51], v6 offset:0
  ds_read_b128 v[52:55], v6 offset:1024
  ds_read_b128 v[56:59], v6 offset:2048
  ds_read_b128 v[60:63], v6 offset:3072
  s_waitcnt lgkmcnt(3)
  v_mfma_f32_32x32x16_bf16 v[16:31], v[192:195], v[48:51], v[80:95]
  v_mfma_f32_32x32x16_bf16 v[32:47], a[96:99], v[48:51], v[96:111]
  ds_read_b128 v[48:51], v6 offset:4096
  s_waitcnt lgkmcnt(3)
  v_mfma_f32_32x32x16_bf16 v[16:31], v[196:199], v[52:55], v[16:31]
  v_mfma_f32_32x32x16_bf16 v[32:47], a[100:103], v[52:55], v[32:47]
  ds_read_b128 v[52:55], v6 offset:5120
  s_waitcnt lgkmcnt(3)
  v_mfma_f32_32x32x16_bf16 v[16:31], v[200:203], v[56:59], v[16:31]
  v_mfma_f32_32x32x16_bf16 v[32:47], a[104:107], v[56:59], v[32:47]
  ds_read_b128 v[56:59], v6 offset:6144
  s_waitcnt lgkmcnt(3)
  v_mfma_f32_32x32x16_bf16 v[16:31], v[204:207], v[60:63], v[16:31]
  v_mfma_f32_32x32x16_bf16 v[32:47], a[108:111], v[60:63], v[32:47]
  ds_read_b128 v[60:63], v6 offset:7168
  s_waitcnt lgkmcnt(3)
  v_mfma_f32_32x32x16_bf16 v[16:31], v[208:211], v[48:51], v[16:31]
  v_mfma_f32_32x32x16_bf16 v[32:47], a[112:115], v[48:51], v[32:47]
  ds_read_b128 v[48:51], v6 offset:8192
  s_waitcnt lgkmcnt(3)
  v_mfma_f32_32x32x16_bf16 v[16:31], v[212:215], v[52:55], v[16:31]
  v_mfma_f32_32x32x16_bf16 v[32:47], a[116:119], v[52:55], v[32:47]
  ds_read_b128 v[52:55], v6 offset:9216
  s_waitcnt lgkmcnt(3)
  v_mfma_f32_32x32x16_bf16 v[16:31], v[216:219], v[56:59], v[16:31]
  v_mfma_f32_32x32x16_bf16 v[32:47], a[120:123], v[56:59], v[32:47]
  ds_read_b128 v[56:59], v6 offset:10240
  s_waitcnt lgkmcnt(3)
  v_mfma_f32_32x32x16_bf16 v[16:31], v[220:223], v[60:63], v[16:31]
  v_mfma_f32_32x32x16_bf16 v[32:47], a[124:127], v[60:63], v[32:47]
  ds_read_b128 v[60:63], v6 offset:11264
  s_waitcnt lgkmcnt(3)
  v_mfma_f32_32x32x16_bf16 v[16:31], v[224:227], v[48:51], v[16:31]
  v_mfma_f32_32x32x16_bf16 v[32:47], a[128:131], v[48:51], v[32:47]
  ds_read_b128 v[48:51], v6 offset:12288
  s_waitcnt lgkmcnt(3)
  v_mfma_f32_32x32x16_bf16 v[16:31], v[228:231], v[52:55], v[16:31]
  v_mfma_f32_32x32x16_bf16 v[32:47], a[132:135], v[52:55], v[32:47]
  ds_read_b128 v[52:55], v6 offset:13312
  s_waitcnt lgkmcnt(3)
  v_mfma_f32_32x32x16_bf16 v[16:31], v[232:235], v[56:59], v[16:31]
  v_mfma_f32_32x32x16_bf16 v[32:47], a[136:139], v[56:59], v[32:47]
  ds_read_b128 v[56:59], v6 offset:14336
  s_waitcnt lgkmcnt(3)
  v_mfma_f32_32x32x16_bf16 v[16:31], v[236:239], v[60:63], v[16:31]
  v_mfma_f32_32x32x16_bf16 v[32:47], a[140:143], v[60:63], v[32:47]
  ds_read_b128 v[60:63], v6 offset:15360
  s_waitcnt lgkmcnt(3)
  v_mfma_f32_32x32x16_bf16 v[16:31], v[240:243], v[48:51], v[16:31]
  v_mfma_f32_32x32x16_bf16 v[32:47], a[144:147], v[48:51], v[32:47]
  ds_read_b128 v[48:51], v6 offset:16384
  s_waitcnt lgkmcnt(3)
  v_mfma_f32_32x32x16_bf16 v[16:31], v[244:247], v[52:55], v[16:31]
  v_mfma_f32_32x32x16_bf16 v[32:47], a[148:151], v[52:55], v[32:47]
  ds_read_b128 v[52:55], v6 offset:17408
  s_waitcnt lgkmcnt(3)
  v_mfma_f32_32x32x16_bf16 v[16:31], v[248:251], v[56:59], v[16:31]
  v_mfma_f32_32x32x16_bf16 v[32:47], a[152:155], v[56:59], v[32:47]
  ds_read_b128 v[56:59], v6 offset:18432
  s_waitcnt lgkmcnt(3)
  v_mfma_f32_32x32x16_bf16 v[16:31], v[252:255], v[60:63], v[16:31]
  v_mfma_f32_32x32x16_bf16 v[32:47], a[156:159], v[60:63], v[32:47]
  ds_read_b128 v[60:63], v6 offset:19456
  s_waitcnt lgkmcnt(3)
  v_mfma_f32_32x32x16_bf16 v[16:31], a[0:3], v[48:51], v[16:31]
  v_mfma_f32_32x32x16_bf16 v[32:47], a[160:163], v[48:51], v[32:47]
  ds_read_b128 v[48:51], v6 offset:20480
  s_waitcnt lgkmcnt(3)
  v_mfma_f32_32x32x16_bf16 v[16:31], a[4:7], v[52:55], v[16:31]
  v_mfma_f32_32x32x16_bf16 v[32:47], a[164:167], v[52:55], v[32:47]
  ds_read_b128 v[52:55], v6 offset:21504
  s_waitcnt lgkmcnt(3)
  v_mfma_f32_32x32x16_bf16 v[16:31], a[8:11], v[56:59], v[16:31]
  v_mfma_f32_32x32x16_bf16 v[32:47], a[168:171], v[56:59], v[32:47]
  ds_read_b128 v[56:59], v6 offset:22528
  s_waitcnt lgkmcnt(3)
  v_mfma_f32_32x32x16_bf16 v[16:31], a[12:15], v[60:63], v[16:31]
  v_mfma_f32_32x32x16_bf16 v[32:47], a[172:175], v[60:63], v[32:47]
  ds_read_b128 v[60:63], v6 offset:23552
  s_waitcnt lgkmcnt(3)
  v_mfma_f32_32x32x16_bf16 v[16:31], a[16:19], v[48:51], v[16:31]
  v_mfma_f32_32x32x16_bf16 v[32:47], a[176:179], v[48:51], v[32:47]
  ds_read_b128 v[48:51], v6 offset:24576
  s_waitcnt lgkmcnt(3)
  v_mfma_f32_32x32x16_bf16 v[16:31], a[20:23], v[52:55], v[16:31]
  v_mfma_f32_32x32x16_bf16 v[32:47], a[180:183], v[52:55], v[32:47]
  ds_read_b128 v[52:55], v6 offset:25600
  s_waitcnt lgkmcnt(3)
  v_mfma_f32_32x32x16_bf16 v[16:31], a[24:27], v[56:59], v[16:31]
  v_mfma_f32_32x32x16_bf16 v[32:47], a[184:187], v[56:59], v[32:47]
  ds_read_b128 v[56:59], v6 offset:26624
  s_waitcnt lgkmcnt(3)
  v_mfma_f32_32x32x16_bf16 v[16:31], a[28:31], v[60:63], v[16:31]
  v_mfma_f32_32x32x16_bf16 v[32:47], a[188:191], v[60:63], v[32:47]
  ds_read_b128 v[60:63], v6 offset:27648
  s_waitcnt lgkmcnt(3)
  v_mfma_f32_32x32x16_bf16 v[16:31], a[32:35], v[48:51], v[16:31]
  v_mfma_f32_32x32x16_bf16 v[32:47], a[192:195], v[48:51], v[32:47]
  ds_read_b128 v[48:51], v6 offset:28672
  s_waitcnt lgkmcnt(3)
  v_mfma_f32_32x32x16_bf16 v[16:31], a[36:39], v[52:55], v[16:31]
  v_mfma_f32_32x32x16_bf16 v[32:47], a[196:199], v[52:55], v[32:47]
  ds_read_b128 v[52:55], v6 offset:29696
  s_waitcnt lgkmcnt(3)
  v_mfma_f32_32x32x16_bf16 v[16:31], a[40:43], v[56:59], v[16:31]
  v_mfma_f32_32x32x16_bf16 v[32:47], a[200:203], v[56:59], v[32:47]
  ds_read_b128 v[56:59], v6 offset:30720
  s_waitcnt lgkmcnt(3)
  v_mfma_f32_32x32x16_bf16 v[16:31], a[44:47], v[60:63], v[16:31]
  v_mfma_f32_32x32x16_bf16 v[32:47], a[204:207], v[60:63], v[32:47]
  ds_read_b128 v[60:63], v6 offset:31744
  s_waitcnt lgkmcnt(3)
  v_mfma_f32_32x32x16_bf16 v[16:31], a[48:51], v[48:51], v[16:31]
  v_mfma_f32_32x32x16_bf16 v[32:47], a[208:211], v[48:51], v[32:47]
  ds_read_b128 v[48:51], v6 offset:32768
  s_waitcnt lgkmcnt(3)
  v_mfma_f32_32x32x16_bf16 v[16:31], a[52:55], v[52:55], v[16:31]
  v_mfma_f32_32x32x16_bf16 v[32:47], a[212:215], v[52:55], v[32:47]
  ds_read_b128 v[52:55], v6 offset:33792
  s_waitcnt lgkmcnt(3)
  v_mfma_f32_32x32x16_bf16 v[16:31], a[56:59], v[56:59], v[16:31]
  v_mfma_f32_32x32x16_bf16 v[32:47], a[216:219], v[56:59], v[32:47]
  ds_read_b128 v[56:59], v6 offset:34816
  s_waitcnt lgkmcnt(3)
  v_mfma_f32_32x32x16_bf16 v[16:31], a[60:63], v[60:63], v[16:31]
  v_mfma_f32_32x32x16_bf16 v[32:47], a[220:223], v[60:63], v[32:47]
  ds_read_b128 v[60:63], v6 offset:35840
  s_waitcnt lgkmcnt(3)
  v_mfma_f32_32x32x16_bf16 v[16:31], a[64:67], v[48:51], v[16:31]
  v_mfma_f32_32x32x16_bf16 v[32:47], a[224:227], v[48:51], v[32:47]
  ds_read_b128 v[48:51], v6 offset:36864
  s_waitcnt lgkmcnt(3)
  v_mfma_f32_32x32x16_bf16 v[16:31], a[68:71], v[52:55], v[16:31]
  v_mfma_f32_32x32x16_bf16 v[32:47], a[228:231], v[52:55], v[32:47]
  ds_read_b128 v[52:55], v6 offset:37888
  s_waitcnt lgkmcnt(3)
  v_mfma_f32_32x32x16_bf16 v[16:31], a[72:75], v[56:59], v[16:31]
  v_mfma_f32_32x32x16_bf16 v[32:47], a[232:235], v[56:59], v[32:47]
  ds_read_b128 v[56:59], v6 offset:38912
  s_waitcnt lgkmcnt(3)
  v_mfma_f32_32x32x16_bf16 v[16:31], a[76:79], v[60:63], v[16:31]
  v_mfma_f32_32x32x16_bf16 v[32:47], a[236:239], v[60:63], v[32:47]
  ds_read_b128 v[60:63], v6 offset:39936
  s_waitcnt lgkmcnt(3)
  v_mfma_f32_32x32x16_bf16 v[16:31], a[80:83], v[48:51], v[16:31]
  v_mfma_f32_32x32x16_bf16 v[32:47], a[240:243], v[48:51], v[32:47]
  s_waitcnt lgkmcnt(2)
  v_mfma_f32_32x32x16_bf16 v[16:31], a[84:87], v[52:55], v[16:31]
  v_mfma_f32_32x32x16_bf16 v[32:47], a[244:247], v[52:55], v[32:47]
  s_waitcnt lgkmcnt(1)
  v_mfma_f32_32x32x16_bf16 v[16:31], a[88:91], v[56:59], v[16:31]
  v_mfma_f32_32x32x16_bf16 v[32:47], a[248:251], v[56:59], v[32:47]
  s_waitcnt lgkmcnt(0)
  v_mfma_f32_32x32x16_bf16 v[16:31], a[92:95], v[60:63], v[16:31]
  v_mfma_f32_32x32x16_bf16 v[32:47], a[252:255], v[60:63], v[32:47]
  s_nop 7
  s_nop 3
  v_mov_b32 v9, s50
  v_mul_f32 v48, v16, v16
  v_mul_f32 v49, v17, v17
  v_mul_f32 v50, v18, v18
  v_mul_f32 v51, v19, v19
  v_fma_f32 v48, v48, s51, v9
  v_fma_f32 v49, v49, s51, v9
  v_fma_f32 v50, v50, s51, v9
  v_fma_f32 v51, v51, s51, v9
  v_mul_f32 v48, v48, v16
  v_mul_f32 v49, v49, v17
  v_mul_f32 v50, v50, v18
  v_mul_f32 v51, v51, v19
  v_exp_f32 v48, v48
  v_exp_f32 v49, v49
  v_exp_f32 v50, v50
  v_exp_f32 v51, v51
  v_add_f32 v48, 1.0, v48
  v_add_f32 v49, 1.0, v49
  v_add_f32 v50, 1.0, v50
  v_add_f32 v51, 1.0, v51
  v_rcp_f32 v48, v48
  v_rcp_f32 v49, v49
  v_rcp_f32 v50, v50
  v_rcp_f32 v51, v51
  v_mul_f32 v48, v48, v16
  v_mul_f32 v49, v49, v17
  v_mul_f32 v50, v50, v18
  v_mul_f32 v51, v51, v19
  v_cvt_pk_bf16_f32 v64, v48, v49
  v_cvt_pk_bf16_f32 v65, v50, v51
  v_mul_f32 v48, v20, v20
  v_mul_f32 v49, v21, v21
  v_mul_f32 v50, v22, v22
  v_mul_f32 v51, v23, v23
  v_fma_f32 v48, v48, s51, v9
  v_fma_f32 v49, v49, s51, v9
  v_fma_f32 v50, v50, s51, v9
  v_fma_f32 v51, v51, s51, v9
  v_mul_f32 v48, v48, v20
  v_mul_f32 v49, v49, v21
  v_mul_f32 v50, v50, v22
  v_mul_f32 v51, v51, v23
  v_exp_f32 v48, v48
  v_exp_f32 v49, v49
  v_exp_f32 v50, v50
  v_exp_f32 v51, v51
  v_add_f32 v48, 1.0, v48
  v_add_f32 v49, 1.0, v49
  v_add_f32 v50, 1.0, v50
  v_add_f32 v51, 1.0, v51
  v_rcp_f32 v48, v48
  v_rcp_f32 v49, v49
  v_rcp_f32 v50, v50
  v_rcp_f32 v51, v51
  v_mul_f32 v48, v48, v20
  v_mul_f32 v49, v49, v21
  v_mul_f32 v50, v50, v22
  v_mul_f32 v51, v51, v23
  v_cvt_pk_bf16_f32 v66, v48, v49
  v_cvt_pk_bf16_f32 v67, v50, v51
  v_mul_f32 v48, v24, v24
  v_mul_f32 v49, v25, v25
  v_mul_f32 v50, v26, v26
  v_mul_f32 v51, v27, v27
  v_fma_f32 v48, v48, s51, v9
  v_fma_f32 v49, v49, s51, v9
  v_fma_f32 v50, v50, s51, v9
  v_fma_f32 v51, v51, s51, v9
  v_mul_f32 v48, v48, v24
  v_mul_f32 v49, v49, v25
  v_mul_f32 v50, v50, v26
  v_mul_f32 v51, v51, v27
  v_exp_f32 v48, v48
  v_exp_f32 v49, v49
  v_exp_f32 v50, v50
  v_exp_f32 v51, v51
  v_add_f32 v48, 1.0, v48
  v_add_f32 v49, 1.0, v49
  v_add_f32 v50, 1.0, v50
  v_add_f32 v51, 1.0, v51
  v_rcp_f32 v48, v48
  v_rcp_f32 v49, v49
  v_rcp_f32 v50, v50
  v_rcp_f32 v51, v51
  v_mul_f32 v48, v48, v24
  v_mul_f32 v49, v49, v25
  v_mul_f32 v50, v50, v26
  v_mul_f32 v51, v51, v27
  v_cvt_pk_bf16_f32 v68, v48, v49
  v_cvt_pk_bf16_f32 v69, v50, v51
  v_mul_f32 v48, v28, v28
  v_mul_f32 v49, v29, v29
  v_mul_f32 v50, v30, v30
  v_mul_f32 v51, v31, v31
  v_fma_f32 v48, v48, s51, v9
  v_fma_f32 v49, v49, s51, v9
  v_fma_f32 v50, v50, s51, v9
  v_fma_f32 v51, v51, s51, v9
  v_mul_f32 v48, v48, v28
  v_mul_f32 v49, v49, v29
  v_mul_f32 v50, v50, v30
  v_mul_f32 v51, v51, v31
  v_exp_f32 v48, v48
  v_exp_f32 v49, v49
  v_exp_f32 v50, v50
  v_exp_f32 v51, v51
  v_add_f32 v48, 1.0, v48
  v_add_f32 v49, 1.0, v49
  v_add_f32 v50, 1.0, v50
  v_add_f32 v51, 1.0, v51
  v_rcp_f32 v48, v48
  v_rcp_f32 v49, v49
  v_rcp_f32 v50, v50
  v_rcp_f32 v51, v51
  v_mul_f32 v48, v48, v28
  v_mul_f32 v49, v49, v29
  v_mul_f32 v50, v50, v30
  v_mul_f32 v51, v51, v31
  v_cvt_pk_bf16_f32 v70, v48, v49
  v_cvt_pk_bf16_f32 v71, v50, v51
  buffer_store_dwordx4 v[64:67], v7, s[4:7], s45 offen offset:0 sc1
  buffer_store_dwordx4 v[68:71], v7, s[4:7], s45 offen offset:512 sc1
  v_mul_f32 v48, v32, v32
  v_mul_f32 v49, v33, v33
  v_mul_f32 v50, v34, v34
  v_mul_f32 v51, v35, v35
  v_fma_f32 v48, v48, s51, v9
  v_fma_f32 v49, v49, s51, v9
  v_fma_f32 v50, v50, s51, v9
  v_fma_f32 v51, v51, s51, v9
  v_mul_f32 v48, v48, v32
  v_mul_f32 v49, v49, v33
  v_mul_f32 v50, v50, v34
  v_mul_f32 v51, v51, v35
  v_exp_f32 v48, v48
  v_exp_f32 v49, v49
  v_exp_f32 v50, v50
  v_exp_f32 v51, v51
  v_add_f32 v48, 1.0, v48
  v_add_f32 v49, 1.0, v49
  v_add_f32 v50, 1.0, v50
  v_add_f32 v51, 1.0, v51
  v_rcp_f32 v48, v48
  v_rcp_f32 v49, v49
  v_rcp_f32 v50, v50
  v_rcp_f32 v51, v51
  v_mul_f32 v48, v48, v32
  v_mul_f32 v49, v49, v33
  v_mul_f32 v50, v50, v34
  v_mul_f32 v51, v51, v35
  v_cvt_pk_bf16_f32 v72, v48, v49
  v_cvt_pk_bf16_f32 v73, v50, v51
  v_mul_f32 v48, v36, v36
  v_mul_f32 v49, v37, v37
  v_mul_f32 v50, v38, v38
  v_mul_f32 v51, v39, v39
  v_fma_f32 v48, v48, s51, v9
  v_fma_f32 v49, v49, s51, v9
  v_fma_f32 v50, v50, s51, v9
  v_fma_f32 v51, v51, s51, v9
  v_mul_f32 v48, v48, v36
  v_mul_f32 v49, v49, v37
  v_mul_f32 v50, v50, v38
  v_mul_f32 v51, v51, v39
  v_exp_f32 v48, v48
  v_exp_f32 v49, v49
  v_exp_f32 v50, v50
  v_exp_f32 v51, v51
  v_add_f32 v48, 1.0, v48
  v_add_f32 v49, 1.0, v49
  v_add_f32 v50, 1.0, v50
  v_add_f32 v51, 1.0, v51
  v_rcp_f32 v48, v48
  v_rcp_f32 v49, v49
  v_rcp_f32 v50, v50
  v_rcp_f32 v51, v51
  v_mul_f32 v48, v48, v36
  v_mul_f32 v49, v49, v37
  v_mul_f32 v50, v50, v38
  v_mul_f32 v51, v51, v39
  v_cvt_pk_bf16_f32 v74, v48, v49
  v_cvt_pk_bf16_f32 v75, v50, v51
  v_mul_f32 v48, v40, v40
  v_mul_f32 v49, v41, v41
  v_mul_f32 v50, v42, v42
  v_mul_f32 v51, v43, v43
  v_fma_f32 v48, v48, s51, v9
  v_fma_f32 v49, v49, s51, v9
  v_fma_f32 v50, v50, s51, v9
  v_fma_f32 v51, v51, s51, v9
  v_mul_f32 v48, v48, v40
  v_mul_f32 v49, v49, v41
  v_mul_f32 v50, v50, v42
  v_mul_f32 v51, v51, v43
  v_exp_f32 v48, v48
  v_exp_f32 v49, v49
  v_exp_f32 v50, v50
  v_exp_f32 v51, v51
  v_add_f32 v48, 1.0, v48
  v_add_f32 v49, 1.0, v49
  v_add_f32 v50, 1.0, v50
  v_add_f32 v51, 1.0, v51
  v_rcp_f32 v48, v48
  v_rcp_f32 v49, v49
  v_rcp_f32 v50, v50
  v_rcp_f32 v51, v51
  v_mul_f32 v48, v48, v40
  v_mul_f32 v49, v49, v41
  v_mul_f32 v50, v50, v42
  v_mul_f32 v51, v51, v43
  v_cvt_pk_bf16_f32 v76, v48, v49
  v_cvt_pk_bf16_f32 v77, v50, v51
  v_mul_f32 v48, v44, v44
  v_mul_f32 v49, v45, v45
  v_mul_f32 v50, v46, v46
  v_mul_f32 v51, v47, v47
  v_fma_f32 v48, v48, s51, v9
  v_fma_f32 v49, v49, s51, v9
  v_fma_f32 v50, v50, s51, v9
  v_fma_f32 v51, v51, s51, v9
  v_mul_f32 v48, v48, v44
  v_mul_f32 v49, v49, v45
  v_mul_f32 v50, v50, v46
  v_mul_f32 v51, v51, v47
  v_exp_f32 v48, v48
  v_exp_f32 v49, v49
  v_exp_f32 v50, v50
  v_exp_f32 v51, v51
  v_add_f32 v48, 1.0, v48
  v_add_f32 v49, 1.0, v49
  v_add_f32 v50, 1.0, v50
  v_add_f32 v51, 1.0, v51
  v_rcp_f32 v48, v48
  v_rcp_f32 v49, v49
  v_rcp_f32 v50, v50
  v_rcp_f32 v51, v51
  v_mul_f32 v48, v48, v44
  v_mul_f32 v49, v49, v45
  v_mul_f32 v50, v50, v46
  v_mul_f32 v51, v51, v47
  v_cvt_pk_bf16_f32 v78, v48, v49
  v_cvt_pk_bf16_f32 v79, v50, v51
  buffer_store_dwordx4 v[72:75], v7, s[4:7], s45 offen offset:1024 sc1
  buffer_store_dwordx4 v[76:79], v7, s[4:7], s45 offen offset:1536 sc1
L_ml_e:
  s_add_u32 s45, s45, 221184
  s_add_u32 s47, s47, 1
  s_branch L_ml_loop
L_idle:
  s_cmp_lg_u32 s34, 0
  s_cbranch_scc1 L_verd_41
  s_cmp_eq_u32 s101, 0
  s_cbranch_scc1 L_sig_44
  s_mov_b32 s101, 0
  s_waitcnt vmcnt(0)
  s_mov_b64 exec, 1
  v_mov_b32 v0, 1
  buffer_atomic_add v0, off, s[8:11], 0 offset:32
  s_mov_b64 exec, -1
L_sig_44:
  v_lshlrev_b32 v2, 2, v1
L_ver_40:
  buffer_load_dword v3, v2, s[8:11], 0 offen sc1
  s_waitcnt vmcnt(0)
  v_readlane_b32 s3, v3, 8
  s_nop 0
  s_cmp_eq_u32 s3, 32
  s_cbranch_scc0 L_verf_43
  v_readlane_b32 s3, v3, 0
  v_readlane_b32 vcc_lo, v3, 1
  s_nop 0
  s_add_u32 s3, s3, vcc_lo
  v_readlane_b32 vcc_lo, v3, 34
  s_nop 0
  s_add_u32 s3, s3, vcc_lo
  v_readlane_b32 vcc_lo, v3, 35
  s_nop 0
  s_add_u32 s3, s3, vcc_lo
  v_readlane_b32 vcc_lo, v3, 36
  s_nop 0
  s_add_u32 s3, s3, vcc_lo
  v_readlane_b32 vcc_lo, v3, 37
  s_nop 0
  s_add_u32 s3, s3, vcc_lo
  v_readlane_b32 vcc_lo, v3, 38
  s_nop 0
  s_add_u32 s3, s3, vcc_lo
  v_readlane_b32 vcc_lo, v3, 39
  s_nop 0
  s_add_u32 s3, s3, vcc_lo
  s_cmp_eq_u32 s3, 0x100
  s_cbranch_scc1 L_verr_42
L_verf_43:
  s_sleep 2
  s_sub_u32 s29, s29, 1
  s_cbranch_scc0 L_ver_40
  s_branch L_end
L_verr_42:
  s_mov_b32 s34, 1
  v_cmp_ne_u32 vcc, 32, v3
  s_nop 4
  s_and_b32 vcc_lo, vcc_lo, 3
  s_and_b32 vcc_hi, vcc_hi, 0xfc
  s_cbranch_vccz L_verd_41
  s_mov_b32 s32, s31
  s_mov_b32 s33, 1
  v_readlane_b32 s3, v3, 0
  s_nop 0
  s_cmp_gt_u32 s30, 0
  s_cselect_b32 s3, s3, 0
  s_add_u32 s32, s32, s3
  v_readlane_b32 s3, v3, 1
  s_nop 0
  s_cmp_gt_u32 s30, 1
  s_cselect_b32 s3, s3, 0
  s_add_u32 s32, s32, s3
  v_readlane_b32 s3, v3, 34
  s_nop 0
  s_cmp_gt_u32 s30, 2
  s_cselect_b32 s3, s3, 0
  s_add_u32 s32, s32, s3
  v_readlane_b32 s3, v3, 35
  s_nop 0
  s_cmp_gt_u32 s30, 3
  s_cselect_b32 s3, s3, 0
  s_add_u32 s32, s32, s3
  v_readlane_b32 s3, v3, 36
  s_nop 0
  s_cmp_gt_u32 s30, 4
  s_cselect_b32 s3, s3, 0
  s_add_u32 s32, s32, s3
  v_readlane_b32 s3, v3, 37
  s_nop 0
  s_cmp_gt_u32 s30, 5
  s_cselect_b32 s3, s3, 0
  s_add_u32 s32, s32, s3
  v_readlane_b32 s3, v3, 38
  s_nop 0
  s_cmp_gt_u32 s30, 6
  s_cselect_b32 s3, s3, 0
  s_add_u32 s32, s32, s3
  s_branch L_restart
L_verd_41:
  s_branch L_end
L_qa:
  s_cmp_eq_u32 s101, 0
  s_cbranch_scc1 L_sig_45
  s_mov_b32 s101, 0
  s_waitcnt vmcnt(0)
  s_mov_b64 exec, 1
  v_mov_b32 v0, 1
  buffer_atomic_add v0, off, s[8:11], 0 offset:32
  s_mov_b64 exec, -1
L_sig_45:
  s_lshr_b32 s3, s32, 5
  s_and_b32 s36, s32, 15
  s_lshl4_add_u32 s37, s3, s36
  s_sub_u32 s37, s37, 64
  s_and_b32 s36, s32, 7
  s_lshl3_add_u32 s3, s3, s36
  s_sub_u32 s3, s3, 16
  s_cmp_ge_u32 s32, 192
  s_cselect_b32 s3, s37, s3
  s_lshl2_add_u32 s3, s3, s28
  s_mul_i32 s36, s3, 20480
  v_lshlrev_b32 v15, 4, v1
  s_lshl_b32 s37, s28, 12
  s_add_u32 m0, s37, 0x20000
  s_mov_b32 s24, s70
  s_mov_b32 s25, s71
  s_mov_b32 s26, 5242880
  s_mov_b32 s27, 0x20000
  s_mov_b32 s37, s36
  buffer_load_dwordx4 v15, s[24:27], s37 offen offset:0 lds
  buffer_load_dwordx4 v15, s[24:27], s37 offen offset:1024 lds
  buffer_load_dwordx4 v15, s[24:27], s37 offen offset:2048 lds
  buffer_load_dwordx4 v15, s[24:27], s37 offen offset:3072 lds
  s_add_u32 s37, s37, 4096
  buffer_load_dwordx4 v15, s[24:27], s37 offen offset:0 lds
  buffer_load_dwordx4 v15, s[24:27], s37 offen offset:1024 lds
  buffer_load_dwordx4 v15, s[24:27], s37 offen offset:2048 lds
  buffer_load_dwordx4 v15, s[24:27], s37 offen offset:3072 lds
  s_add_u32 s37, s37, 4096
  buffer_load_dwordx4 v15, s[24:27], s37 offen offset:0 lds
  buffer_load_dwordx4 v15, s[24:27], s37 offen offset:1024 lds
  buffer_load_dwordx4 v15, s[24:27], s37 offen offset:2048 lds
  buffer_load_dwordx4 v15, s[24:27], s37 offen offset:3072 lds
  s_add_u32 s37, s37, 4096
  buffer_load_dwordx4 v15, s[24:27], s37 offen offset:0 lds
  buffer_load_dwordx4 v15, s[24:27], s37 offen offset:1024 lds
  buffer_load_dwordx4 v15, s[24:27], s37 offen offset:2048 lds
  buffer_load_dwordx4 v15, s[24:27], s37 offen offset:3072 lds
  s_add_u32 s37, s37, 4096
  buffer_load_dwordx4 v15, s[24:27], s37 offen offset:0 lds
  buffer_load_dwordx4 v15, s[24:27], s37 offen offset:1024 lds
  buffer_load_dwordx4 v15, s[24:27], s37 offen offset:2048 lds
  buffer_load_dwordx4 v15, s[24:27], s37 offen offset:3072 lds
  s_mov_b32 s24, s72
  s_mov_b32 s25, s73
  s_mov_b32 s26, 5242880
  s_mov_b32 s27, 0x20000
  s_mov_b32 s37, s36
  buffer_load_dwordx4 v15, s[24:27], s37 offen offset:0 lds
  buffer_load_dwordx4 v15, s[24:27], s37 offen offset:1024 lds
  buffer_load_dwordx4 v15, s[24:27], s37 offen offset:2048 lds
  buffer_load_dwordx4 v15, s[24:27], s37 offen offset:3072 lds
  s_add_u32 s37, s37, 4096
  buffer_load_dwordx4 v15, s[24:27], s37 offen offset:0 lds
  buffer_load_dwordx4 v15, s[24:27], s37 offen offset:1024 lds
  buffer_load_dwordx4 v15, s[24:27], s37 offen offset:2048 lds
  buffer_load_dwordx4 v15, s[24:27], s37 offen offset:3072 lds
  s_add_u32 s37, s37, 4096
  buffer_load_dwordx4 v15, s[24:27], s37 offen offset:0 lds
  buffer_load_dwordx4 v15, s[24:27], s37 offen offset:1024 lds
  buffer_load_dwordx4 v15, s[24:27], s37 offen offset:2048 lds
  buffer_load_dwordx4 v15, s[24:27], s37 offen offset:3072 lds
  s_add_u32 s37, s37, 4096
  buffer_load_dwordx4 v15, s[24:27], s37 offen offset:0 lds
  buffer_load_dwordx4 v15, s[24:27], s37 offen offset:1024 lds
  buffer_load_dwordx4 v15, s[24:27], s37 offen offset:2048 lds
  buffer_load_dwordx4 v15, s[24:27], s37 offen offset:3072 lds
  s_add_u32 s37, s37, 4096
  buffer_load_dwordx4 v15, s[24:27], s37 offen offset:0 lds
  buffer_load_dwordx4 v15, s[24:27], s37 offen offset:1024 lds
  buffer_load_dwordx4 v15, s[24:27], s37 offen offset:2048 lds
  buffer_load_dwordx4 v15, s[24:27], s37 offen offset:3072 lds
  s_mov_b32 s24, s74
  s_mov_b32 s25, s75
  s_mov_b32 s26, 5242880
  s_mov_b32 s27, 0x20000
  s_mov_b32 s37, s36
  buffer_load_dwordx4 v15, s[24:27], s37 offen offset:0 lds
  buffer_load_dwordx4 v15, s[24:27], s37 offen offset:1024 lds
  buffer_load_dwordx4 v15, s[24:27], s37 offen offset:2048 lds
  buffer_load_dwordx4 v15, s[24:27], s37 offen offset:3072 lds
  s_add_u32 s37, s37, 4096
  buffer_load_dwordx4 v15, s[24:27], s37 offen offset:0 lds
  buffer_load_dwordx4 v15, s[24:27], s37 offen offset:1024 lds
  buffer_load_dwordx4 v15, s[24:27], s37 offen offset:2048 lds
  buffer_load_dwordx4 v15, s[24:27], s37 offen offset:3072 lds
  s_add_u32 s37, s37, 4096
  buffer_load_dwordx4 v15, s[24:27], s37 offen offset:0 lds
  buffer_load_dwordx4 v15, s[24:27], s37 offen offset:1024 lds
  buffer_load_dwordx4 v15, s[24:27], s37 offen offset:2048 lds
  buffer_load_dwordx4 v15, s[24:27], s37 offen offset:3072 lds
  s_add_u32 s37, s37, 4096
  buffer_load_dwordx4 v15, s[24:27], s37 offen offset:0 lds
  buffer_load_dwordx4 v15, s[24:27], s37 offen offset:1024 lds
  buffer_load_dwordx4 v15, s[24:27], s37 offen offset:2048 lds
  buffer_load_dwordx4 v15, s[24:27], s37 offen offset:3072 lds
  s_add_u32 s37, s37, 4096
  buffer_load_dwordx4 v15, s[24:27], s37 offen offset:0 lds
  buffer_load_dwordx4 v15, s[24:27], s37 offen offset:1024 lds
  buffer_load_dwordx4 v15, s[24:27], s37 offen offset:2048 lds
  buffer_load_dwordx4 v15, s[24:27], s37 offen offset:3072 lds
  s_lshr_b32 s3, s32, 5
  s_and_b32 s38, s32, 15
  s_lshl4_add_u32 s40, s3, s38
  s_sub_u32 s40, s40, 96
  s_cmp_lg_u32 s34, 0
  s_cbranch_scc1 L_verd_47
  s_cmp_eq_u32 s101, 0
  s_cbranch_scc1 L_sig_50
  s_mov_b32 s101, 0
  s_waitcnt vmcnt(0)
  s_mov_b64 exec, 1
  v_mov_b32 v0, 1
  buffer_atomic_add v0, off, s[8:11], 0 offset:32
  s_mov_b64 exec, -1
L_sig_50:
  v_lshlrev_b32 v2, 2, v1
L_ver_46:
  buffer_load_dword v3, v2, s[8:11], 0 offen sc1
  s_waitcnt vmcnt(0)
  v_readlane_b32 s3, v3, 8
  s_nop 0
  s_cmp_eq_u32 s3, 32
  s_cbranch_scc0 L_verf_49
  v_readlane_b32 s3, v3, 0
  v_readlane_b32 vcc_lo, v3, 1
  s_nop 0
  s_add_u32 s3, s3, vcc_lo
  v_readlane_b32 vcc_lo, v3, 34
  s_nop 0
  s_add_u32 s3, s3, vcc_lo
  v_readlane_b32 vcc_lo, v3, 35
  s_nop 0
  s_add_u32 s3, s3, vcc_lo
  v_readlane_b32 vcc_lo, v3, 36
  s_nop 0
  s_add_u32 s3, s3, vcc_lo
  v_readlane_b32 vcc_lo, v3, 37
  s_nop 0
  s_add_u32 s3, s3, vcc_lo
  v_readlane_b32 vcc_lo, v3, 38
  s_nop 0
  s_add_u32 s3, s3, vcc_lo
  v_readlane_b32 vcc_lo, v3, 39
  s_nop 0
  s_add_u32 s3, s3, vcc_lo
  s_cmp_eq_u32 s3, 0x100
  s_cbranch_scc1 L_verr_48
L_verf_49:
  s_sleep 2
  s_sub_u32 s29, s29, 1
  s_cbranch_scc0 L_ver_46
  s_branch L_end
L_verr_48:
  s_mov_b32 s34, 1
  v_cmp_ne_u32 vcc, 32, v3
  s_nop 4
  s_and_b32 vcc_lo, vcc_lo, 3
  s_and_b32 vcc_hi, vcc_hi, 0xfc
  s_cbranch_vccz L_verd_47
  s_mov_b32 s32, s31
  s_mov_b32 s33, 1
  v_readlane_b32 s3, v3, 0
  s_nop 0
  s_cmp_gt_u32 s30, 0
  s_cselect_b32 s3, s3, 0
  s_add_u32 s32, s32, s3
  v_readlane_b32 s3, v3, 1
  s_nop 0
  s_cmp_gt_u32 s30, 1
  s_cselect_b32 s3, s3, 0
  s_add_u32 s32, s32, s3
  v_readlane_b32 s3, v3, 34
  s_nop 0
  s_cmp_gt_u32 s30, 2
  s_cselect_b32 s3, s3, 0
  s_add_u32 s32, s32, s3
  v_readlane_b32 s3, v3, 35
  s_nop 0
  s_cmp_gt_u32 s30, 3
  s_cselect_b32 s3, s3, 0
  s_add_u32 s32, s32, s3
  v_readlane_b32 s3, v3, 36
  s_nop 0
  s_cmp_gt_u32 s30, 4
  s_cselect_b32 s3, s3, 0
  s_add_u32 s32, s32, s3
  v_readlane_b32 s3, v3, 37
  s_nop 0
  s_cmp_gt_u32 s30, 5
  s_cselect_b32 s3, s3, 0
  s_add_u32 s32, s32, s3
  v_readlane_b32 s3, v3, 38
  s_nop 0
  s_cmp_gt_u32 s30, 6
  s_cselect_b32 s3, s3, 0
  s_add_u32 s32, s32, s3
  s_branch L_restart
L_verd_47:
  s_mov_b32 s3, 180224
  s_mov_b32 s39, 1
  v_min_u32 v2, 63, v1
  v_mul_u32_u24 v2, 4, v2
L_wf_51:
  buffer_load_dword v3, v2, s[4:7], s3 offen sc1
  s_waitcnt vmcnt(0)
  v_cmp_gt_u32 vcc, s39, v3
  s_cbranch_vccz L_wfd_52
  s_sleep 8
  s_sub_u32 s29, s29, 1
  s_cbranch_scc0 L_wf_51
  s_branch L_end
L_wfd_52:
  s_mov_b32 s63, 0
L_qa_help:
  s_mov_b32 s12, s68
  s_mov_b32 s13, s69
  s_mov_b32 s14, 5242880
  s_mov_b32 s15, 0x20000
  s_lshl_b32 s38, s40, 8
  s_lshl_b32 s3, s28, 6
  s_add_u32 s38, s38, s3
  v_lshrrev_b32 v2, 2, v1
  v_and_b32 v3, 3, v1
  s_mov_b32 s3, 8192
  v_mul_lo_u32 v2, v2, s3
  v_lshl_add_u32 v2, v3, 4, v2
  v_lshrrev_b32 v3, 5, v1
  v_lshlrev_b32 v3, 3, v3
  v_bfe_u32 v4, v1, 2, 2
  v_add_u32 v3, v3, v4
  v_mul_u32_u24 v3, 64, v3
  v_bfe_u32 v4, v1, 4, 1
  v_lshl_add_u32 v3, v4, 5, v3
  v_and_b32 v4, 3, v1
  v_lshl_add_u32 v3, v4, 3, v3
  s_lshl_b32 s35, s28, 15
  v_add_u32 v3, s35, v3
  s_add_u32 s36, s38, 0
  s_add_u32 m0, s35, 0
  s_nop 0
  buffer_load_dwordx4 v2, s[12:15], s36 offen lds
  s_add_u32 s36, s38, 131072
  s_add_u32 m0, s35, 1024
  s_nop 0
  buffer_load_dwordx4 v2, s[12:15], s36 offen lds
  s_add_u32 s36, s38, 262144
  s_add_u32 m0, s35, 2048
  s_nop 0
  buffer_load_dwordx4 v2, s[12:15], s36 offen lds
  s_add_u32 s36, s38, 393216
  s_add_u32 m0, s35, 3072
  s_nop 0
  buffer_load_dwordx4 v2, s[12:15], s36 offen lds
  s_add_u32 s36, s38, 524288
  s_add_u32 m0, s35, 4096
  s_nop 0
  buffer_load_dwordx4 v2, s[12:15], s36 offen lds
  s_add_u32 s36, s38, 655360
  s_add_u32 m0, s35, 5120
  s_nop 0
  buffer_load_dwordx4 v2, s[12:15], s36 offen lds
  s_add_u32 s36, s38, 786432
  s_add_u32 m0, s35, 6144
  s_nop 0
  buffer_load_dwordx4 v2, s[12:15], s36 offen lds
  s_add_u32 s36, s38, 917504
  s_add_u32 m0, s35, 7168
  s_nop 0
  buffer_load_dwordx4 v2, s[12:15], s36 offen lds
  s_add_u32 s36, s38, 1048576
  s_add_u32 m0, s35, 8192
  s_nop 0
  buffer_load_dwordx4 v2, s[12:15], s36 offen lds
  s_add_u32 s36, s38, 1179648
  s_add_u32 m0, s35, 9216
  s_nop 0
  buffer_load_dwordx4 v2, s[12:15], s36 offen lds
  s_add_u32 s36, s38, 1310720
  s_add_u32 m0, s35, 10240
  s_nop 0
  buffer_load_dwordx4 v2, s[12:15], s36 offen lds
  s_add_u32 s36, s38, 1441792
  s_add_u32 m0, s35, 11264
  s_nop 0
  buffer_load_dwordx4 v2, s[12:15], s36 offen lds
  s_add_u32 s36, s38, 1572864
  s_add_u32 m0, s35, 12288
  s_nop 0
  buffer_load_dwordx4 v2, s[12:15], s36 offen lds
  s_add_u32 s36, s38, 1703936
  s_add_u32 m0, s35, 13312
  s_nop 0
  buffer_load_dwordx4 v2, s[12:15], s36 offen lds
  s_add_u32 s36, s38, 1835008
  s_add_u32 m0, s35, 14336
  s_nop 0
  buffer_load_dwordx4 v2, s[12:15], s36 offen lds
  s_add_u32 s36, s38, 1966080
  s_add_u32 m0, s35, 15360
  s_nop 0
  buffer_load_dwordx4 v2, s[12:15], s36 offen lds
  s_add_u32 s36, s38, 2097152
  s_add_u32 m0, s35, 16384
  s_nop 0
  buffer_load_dwordx4 v2, s[12:15], s36 offen lds
  s_add_u32 s36, s38, 2228224
  s_add_u32 m0, s35, 17408
  s_nop 0
  buffer_load_dwordx4 v2, s[12:15], s36 offen lds
  s_add_u32 s36, s38, 2359296
  s_add_u32 m0, s35, 18432
  s_nop 0
  buffer_load_dwordx4 v2, s[12:15], s36 offen lds
  s_add_u32 s36, s38, 2490368
  s_add_u32 m0, s35, 19456
  s_nop 0
  buffer_load_dwordx4 v2, s[12:15], s36 offen lds
  s_add_u32 s36, s38, 2621440
  s_add_u32 m0, s35, 20480
  s_nop 0
  buffer_load_dwordx4 v2, s[12:15], s36 offen lds
  s_add_u32 s36, s38, 2752512
  s_add_u32 m0, s35, 21504
  s_nop 0
  buffer_load_dwordx4 v2, s[12:15], s36 offen lds
  s_add_u32 s36, s38, 2883584
  s_add_u32 m0, s35, 22528
  s_nop 0
  buffer_load_dwordx4 v2, s[12:15], s36 offen lds
  s_add_u32 s36, s38, 3014656
  s_add_u32 m0, s35, 23552
  s_nop 0
  buffer_load_dwordx4 v2, s[12:15], s36 offen lds
  s_add_u32 s36, s38, 3145728
  s_add_u32 m0, s35, 24576
  s_nop 0
  buffer_load_dwordx4 v2, s[12:15], s36 offen lds
  s_add_u32 s36, s38, 3276800
  s_add_u32 m0, s35, 25600
  s_nop 0
  buffer_load_dwordx4 v2, s[12:15], s36 offen lds
  s_add_u32 s36, s38, 3407872
  s_add_u32 m0, s35, 26624
  s_nop 0
  buffer_load_dwordx4 v2, s[12:15], s36 offen lds
  s_add_u32 s36, s38, 3538944
  s_add_u32 m0, s35, 27648
  s_nop 0
  buffer_load_dwordx4 v2, s[12:15], s36 offen lds
  s_add_u32 s36, s38, 3670016
  s_add_u32 m0, s35, 28672
  s_nop 0
  buffer_load_dwordx4 v2, s[12:15], s36 offen lds
  s_add_u32 s36, s38, 3801088
  s_add_u32 m0, s35, 29696
  s_nop 0
  buffer_load_dwordx4 v2, s[12:15], s36 offen lds
  s_add_u32 s36, s38, 3932160
  s_add_u32 m0, s35, 30720
  s_nop 0
  buffer_load_dwordx4 v2, s[12:15], s36 offen lds
  s_add_u32 s36, s38, 4063232
  s_add_u32 m0, s35, 31744
  s_nop 0
  buffer_load_dwordx4 v2, s[12:15], s36 offen lds
  s_waitcnt vmcnt(28)
  s_cmp_eq_u32 s101, 0
  s_cbranch_scc1 L_sig_53
  s_mov_b32 s101, 0
  s_mov_b64 exec, 1
  v_mov_b32 v0, 1
  buffer_atomic_add v0, off, s[8:11], 0 offset:32
  s_mov_b64 exec, -1
L_sig_53:
  ds_read_b64_tr_b16 a[0:1], v3 offset:0
  ds_read_b64_tr_b16 a[2:3], v3 offset:256
  ds_read_b64_tr_b16 a[4:5], v3 offset:1024
  ds_read_b64_tr_b16 a[6:7], v3 offset:1280
  ds_read_b64_tr_b16 a[8:9], v3 offset:2048
  ds_read_b64_tr_b16 a[10:11], v3 offset:2304
  ds_read_b64_tr_b16 a[12:13], v3 offset:3072
  ds_read_b64_tr_b16 a[14:15], v3 offset:3328
  s_waitcnt lgkmcnt(0)
  s_add_u32 s36, s38, 4194304
  s_add_u32 m0, s35, 0
  s_nop 0
  buffer_load_dwordx4 v2, s[12:15], s36 offen lds
  s_add_u32 s36, s38, 4325376
  s_add_u32 m0, s35, 1024
  s_nop 0
  buffer_load_dwordx4 v2, s[12:15], s36 offen lds
  s_add_u32 s36, s38, 4456448
  s_add_u32 m0, s35, 2048
  s_nop 0
  buffer_load_dwordx4 v2, s[12:15], s36 offen lds
  s_add_u32 s36, s38, 4587520
  s_add_u32 m0, s35, 3072
  s_nop 0
  buffer_load_dwordx4 v2, s[12:15], s36 offen lds
  s_waitcnt vmcnt(28)
  ds_read_b64_tr_b16 a[16:17], v3 offset:4096
  ds_read_b64_tr_b16 a[18:19], v3 offset:4352
  ds_read_b64_tr_b16 a[20:21], v3 offset:5120
  ds_read_b64_tr_b16 a[22:23], v3 offset:5376
  ds_read_b64_tr_b16 a[24:25], v3 offset:6144
  ds_read_b64_tr_b16 a[26:27], v3 offset:6400
  ds_read_b64_tr_b16 a[28:29], v3 offset:7168
  ds_read_b64_tr_b16 a[30:31], v3 offset:7424
  s_waitcnt lgkmcnt(0)
  s_add_u32 s36, s38, 4718592
  s_add_u32 m0, s35, 4096
  s_nop 0
  buffer_load_dwordx4 v2, s[12:15], s36 offen lds
  s_add_u32 s36, s38, 4849664
  s_add_u32 m0, s35, 5120
  s_nop 0
  buffer_load_dwordx4 v2, s[12:15], s36 offen lds
  s_add_u32 s36, s38, 4980736
  s_add_u32 m0, s35, 6144
  s_nop 0
  buffer_load_dwordx4 v2, s[12:15], s36 offen lds
  s_add_u32 s36, s38, 5111808
  s_add_u32 m0, s35, 7168
  s_nop 0
  buffer_load_dwordx4 v2, s[12:15], s36 offen lds
  s_waitcnt vmcnt(28)
  ds_read_b64_tr_b16 a[32:33], v3 offset:8192
  ds_read_b64_tr_b16 a[34:35], v3 offset:8448
  ds_read_b64_tr_b16 a[36:37], v3 offset:9216
  ds_read_b64_tr_b16 a[38:39], v3 offset:9472
  ds_read_b64_tr_b16 a[40:41], v3 offset:10240
  ds_read_b64_tr_b16 a[42:43], v3 offset:10496
  ds_read_b64_tr_b16 a[44:45], v3 offset:11264
  ds_read_b64_tr_b16 a[46:47], v3 offset:11520
  s_waitcnt vmcnt(24)
  ds_read_b64_tr_b16 a[48:49], v3 offset:12288
  ds_read_b64_tr_b16 a[50:51], v3 offset:12544
  ds_read_b64_tr_b16 a[52:53], v3 offset:13312
  ds_read_b64_tr_b16 a[54:55], v3 offset:13568
  ds_read_b64_tr_b16 a[56:57], v3 offset:14336
  ds_read_b64_tr_b16 a[58:59], v3 offset:14592
  ds_read_b64_tr_b16 a[60:61], v3 offset:15360
  ds_read_b64_tr_b16 a[62:63], v3 offset:15616
  s_waitcnt vmcnt(20)
  ds_read_b64_tr_b16 a[64:65], v3 offset:16384
  ds_read_b64_tr_b16 a[66:67], v3 offset:16640
  ds_read_b64_tr_b16 a[68:69], v3 offset:17408
  ds_read_b64_tr_b16 a[70:71], v3 offset:17664
  ds_read_b64_tr_b16 a[72:73], v3 offset:18432
  ds_read_b64_tr_b16 a[74:75], v3 offset:18688
  ds_read_b64_tr_b16 a[76:77], v3 offset:19456
  ds_read_b64_tr_b16 a[78:79], v3 offset:19712
  s_waitcnt vmcnt(16)
  ds_read_b64_tr_b16 a[80:81], v3 offset:20480
  ds_read_b64_tr_b16 a[82:83], v3 offset:20736
  ds_read_b64_tr_b16 a[84:85], v3 offset:21504
  ds_read_b64_tr_b16 a[86:87], v3 offset:21760
  ds_read_b64_tr_b16 a[88:89], v3 offset:22528
  ds_read_b64_tr_b16 a[90:91], v3 offset:22784
  ds_read_b64_tr_b16 a[92:93], v3 offset:23552
  ds_read_b64_tr_b16 a[94:95], v3 offset:23808
  s_waitcnt vmcnt(12)
  ds_read_b64_tr_b16 a[96:97], v3 offset:24576
  ds_read_b64_tr_b16 a[98:99], v3 offset:24832
  ds_read_b64_tr_b16 a[100:101], v3 offset:25600
  ds_read_b64_tr_b16 a[102:103], v3 offset:25856
  ds_read_b64_tr_b16 a[104:105], v3 offset:26624
  ds_read_b64_tr_b16 a[106:107], v3 offset:26880
  ds_read_b64_tr_b16 a[108:109], v3 offset:27648
  ds_read_b64_tr_b16 a[110:111], v3 offset:27904
  s_waitcnt vmcnt(8)
  ds_read_b64_tr_b16 a[112:113], v3 offset:28672
  ds_read_b64_tr_b16 a[114:115], v3 offset:28928
  ds_read_b64_tr_b16 a[116:117], v3 offset:29696
  ds_read_b64_tr_b16 a[118:119], v3 offset:29952
  ds_read_b64_tr_b16 a[120:121], v3 offset:30720
  ds_read_b64_tr_b16 a[122:123], v3 offset:30976
  ds_read_b64_tr_b16 a[124:125], v3 offset:31744
  ds_read_b64_tr_b16 a[126:127], v3 offset:32000
  s_waitcnt vmcnt(4)
  ds_read_b64_tr_b16 a[128:129], v3 offset:0
  ds_read_b64_tr_b16 a[130:131], v3 offset:256
  ds_read_b64_tr_b16 a[132:133], v3 offset:1024
  ds_read_b64_tr_b16 a[134:135], v3 offset:1280
  ds_read_b64_tr_b16 a[136:137], v3 offset:2048
  ds_read_b64_tr_b16 a[138:139], v3 offset:2304
  ds_read_b64_tr_b16 a[140:141], v3 offset:3072
  ds_read_b64_tr_b16 a[142:143], v3 offset:3328
  s_waitcnt vmcnt(0)
  ds_read_b64_tr_b16 a[144:145], v3 offset:4096
  ds_read_b64_tr_b16 a[146:147], v3 offset:4352
  ds_read_b64_tr_b16 a[148:149], v3 offset:5120
  ds_read_b64_tr_b16 a[150:151], v3 offset:5376
  ds_read_b64_tr_b16 a[152:153], v3 offset:6144
  ds_read_b64_tr_b16 a[154:155], v3 offset:6400
  ds_read_b64_tr_b16 a[156:157], v3 offset:7168
  ds_read_b64_tr_b16 a[158:159], v3 offset:7424
  s_waitcnt lgkmcnt(0)
  s_cmp_lg_u32 s34, 0
  s_cbranch_scc1 L_verd_55
  s_cmp_eq_u32 s101, 0
  s_cbranch_scc1 L_sig_58
  s_mov_b32 s101, 0
  s_waitcnt vmcnt(0)
  s_mov_b64 exec, 1
  v_mov_b32 v0, 1
  buffer_atomic_add v0, off, s[8:11], 0 offset:32
  s_mov_b64 exec, -1
L_sig_58:
  v_lshlrev_b32 v2, 2, v1
L_ver_54:
  buffer_load_dword v3, v2, s[8:11], 0 offen sc1
  s_waitcnt vmcnt(0)
  v_readlane_b32 s3, v3, 8
  s_nop 0
  s_cmp_eq_u32 s3, 32
  s_cbranch_scc0 L_verf_57
  v_readlane_b32 s3, v3, 0
  v_readlane_b32 vcc_lo, v3, 1
  s_nop 0
  s_add_u32 s3, s3, vcc_lo
  v_readlane_b32 vcc_lo, v3, 34
  s_nop 0
  s_add_u32 s3, s3, vcc_lo
  v_readlane_b32 vcc_lo, v3, 35
  s_nop 0
  s_add_u32 s3, s3, vcc_lo
  v_readlane_b32 vcc_lo, v3, 36
  s_nop 0
  s_add_u32 s3, s3, vcc_lo
  v_readlane_b32 vcc_lo, v3, 37
  s_nop 0
  s_add_u32 s3, s3, vcc_lo
  v_readlane_b32 vcc_lo, v3, 38
  s_nop 0
  s_add_u32 s3, s3, vcc_lo
  v_readlane_b32 vcc_lo, v3, 39
  s_nop 0
  s_add_u32 s3, s3, vcc_lo
  s_cmp_eq_u32 s3, 0x100
  s_cbranch_scc1 L_verr_56
L_verf_57:
  s_sleep 2
  s_sub_u32 s29, s29, 1
  s_cbranch_scc0 L_ver_54
  s_branch L_end
L_verr_56:
  s_mov_b32 s34, 1
  v_cmp_ne_u32 vcc, 32, v3
  s_nop 4
  s_and_b32 vcc_lo, vcc_lo, 3
  s_and_b32 vcc_hi, vcc_hi, 0xfc
  s_cbranch_vccz L_verd_55
  s_mov_b32 s32, s31
  s_mov_b32 s33, 1
  v_readlane_b32 s3, v3, 0
  s_nop 0
  s_cmp_gt_u32 s30, 0
  s_cselect_b32 s3, s3, 0
  s_add_u32 s32, s32, s3
  v_readlane_b32 s3, v3, 1
  s_nop 0
  s_cmp_gt_u32 s30, 1
  s_cselect_b32 s3, s3, 0
  s_add_u32 s32, s32, s3
  v_readlane_b32 s3, v3, 34
  s_nop 0
  s_cmp_gt_u32 s30, 2
  s_cselect_b32 s3, s3, 0
  s_add_u32 s32, s32, s3
  v_readlane_b32 s3, v3, 35
  s_nop 0
  s_cmp_gt_u32 s30, 3
  s_cselect_b32 s3, s3, 0
  s_add_u32 s32, s32, s3
  v_readlane_b32 s3, v3, 36
  s_nop 0
  s_cmp_gt_u32 s30, 4
  s_cselect_b32 s3, s3, 0
  s_add_u32 s32, s32, s3
  v_readlane_b32 s3, v3, 37
  s_nop 0
  s_cmp_gt_u32 s30, 5
  s_cselect_b32 s3, s3, 0
  s_add_u32 s32, s32, s3
  v_readlane_b32 s3, v3, 38
  s_nop 0
  s_cmp_gt_u32 s30, 6
  s_cselect_b32 s3, s3, 0
  s_add_u32 s32, s32, s3
  s_branch L_restart
L_verd_55:
  s_mov_b32 s3, 180224
  s_mov_b32 s38, 1
  v_min_u32 v2, 63, v1
  v_mul_u32_u24 v2, 4, v2
L_wf_59:
  buffer_load_dword v3, v2, s[4:7], s3 offen sc1
  s_waitcnt vmcnt(0)
  v_cmp_gt_u32 vcc, s38, v3
  s_cbranch_vccz L_wfd_60
  s_sleep 1
  s_sub_u32 s29, s29, 1
  s_cbranch_scc0 L_wf_59
  s_branch L_end
L_wfd_60:
  s_and_b32 s54, s28, 1
  s_lshr_b32 s55, s28, 1
  v_lshlrev_b32 v5, 4, v1
  v_mov_b32 v196, 0x3f803f80
  v_mov_b32 v197, 0x3f803f80
  v_mov_b32 v198, 0x3f803f80
  v_mov_b32 v199, 0x3f803f80
  v_and_b32 v2, 15, v1
  v_lshlrev_b32 v2, 4, v2
  v_bfe_u32 v3, v1, 4, 1
  v_lshl_add_u32 v2, v3, 12, v2
  v_lshrrev_b32 v3, 5, v1
  v_lshl_add_u32 v2, v3, 8, v2
  s_lshl_b32 s3, s28, 10
  s_add_u32 s3, s3, 81920
  v_add_u32 v7, s3, v2
  s_lshl_b32 s3, s54, 12
  s_add_u32 s3, s3, 81920
  v_add_u32 v8, s3, v5
  v_lshrrev_b32 v2, 5, v1
  v_lshlrev_b32 v2, 4, v2
  v_bfe_u32 v3, v1, 4, 1
  v_lshl_add_u32 v2, v3, 2, v2
  v_and_b32 v3, 15, v1
  s_lshl_b32 s3, s54, 4
  v_add_u32 v3, s3, v3
  v_sub_u32 v3, v3, v2
  v_mov_b32 v4, 0xf149f2ca
  v_cmp_gt_i32 vcc, 0, v3
  s_nop 1
  v_cndmask_b32 v56, 0, v4, vcc
  v_cmp_gt_i32 vcc, 1, v3
  s_nop 1
  v_cndmask_b32 v57, 0, v4, vcc
  v_cmp_gt_i32 vcc, 2, v3
  s_nop 1
  v_cndmask_b32 v58, 0, v4, vcc
  v_cmp_gt_i32 vcc, 3, v3
  s_nop 1
  v_cndmask_b32 v59, 0, v4, vcc
  v_cmp_gt_i32 vcc, 8, v3
  s_nop 1
  v_cndmask_b32 v60, 0, v4, vcc
  v_cmp_gt_i32 vcc, 9, v3
  s_nop 1
  v_cndmask_b32 v61, 0, v4, vcc
  v_cmp_gt_i32 vcc, 10, v3
  s_nop 1
  v_cndmask_b32 v62, 0, v4, vcc
  v_cmp_gt_i32 vcc, 11, v3
  s_nop 1
  v_cndmask_b32 v63, 0, v4, vcc
  v_mov_b32 v173, 0
  v_mov_b32 v174, 0
  v_lshlrev_b32 v64, 3, v1
  s_lshl_b32 s45, s40, 13
  s_lshl_b32 s46, s40, 12
  s_lshl_b32 s48, s40, 12
  s_lshl_b32 s3, s54, 17
  s_add_u32 s48, s48, s3
  s_lshl_b32 s3, s55, 11
  s_add_u32 s48, s48, s3
  s_add_u32 s48, s48, 58720256
  s_lshl_b32 s3, s40, 7
  s_add_u32 s49, s3, 180480
  s_add_u32 s50, s3, 184576
  s_lshr_b32 s3, s40, 3
  s_lshl2_add_u32 s3, s54, s3
  s_lshl_b32 s3, s3, 7
  s_and_b32 s38, s40, 7
  s_lshl1_add_u32 s38, s38, s55
  s_lshl2_add_u32 s3, s38, s3
  s_add_u32 s51, s3, 188672
  s_cmp_eq_u32 s63, 0
  s_cselect_b32 s3, 0, 1792
  s_add_u32 s51, s51, s3
  s_mov_b32 s52, 0x3e0293ee
  s_mov_b32 s53, s52
  s_mul_i32 s44, s63, 40960
  s_add_u32 s44, s44, 1048576
  s_mov_b32 s43, 0
  s_mov_b32 s47, s63
  s_mov_b32 s56, 0
  s_barrier
  s_lshl_b32 s3, s63, 18
  s_add_u32 s45, s45, s3
  s_mov_b32 s41, 0
  s_mov_b32 s62, 0
  v_lshrrev_b32 v2, 5, v1
  v_lshlrev_b32 v15, 9, v2
  v_and_b32 v2, 3, v1
  v_lshl_add_u32 v15, v2, 6, v15
  v_bfe_u32 v2, v1, 2, 3
  v_lshl_add_u32 v15, v2, 3, v15
  v_add_u32 v15, 122880, v15
  v_bfe_u32 v2, v1, 3, 1
  v_lshlrev_b32 v3, 8, v2
  v_lshrrev_b32 v2, 4, v1
  v_lshl_add_u32 v3, v2, 6, v3
  v_and_b32 v2, 7, v1
  v_lshl_add_u32 v14, v2, 3, v3
  s_lshl_b32 s3, s28, 10
  s_add_u32 s3, s3, 122880
  v_add_u32 v14, s3, v14
  s_cmp_lt_u32 s28, 2
  s_cselect_b32 s3, 0, 16777216
  s_add_u32 s45, s45, s3
  s_lshl_b32 s3, s54, 12
  s_add_u32 s45, s45, s3
  s_add_u32 s45, s45, 8388608
  s_lshl_b32 s61, s28, 12
  s_add_u32 s61, s61, 90112
  s_mov_b32 s60, 0
  s_mul_i32 s3, s28, 10240
  s_add_u32 s36, s44, s3
  s_add_u32 s37, s43, s3
  s_mov_b32 m0, s37
  s_nop 0
  buffer_load_dwordx4 v5, s[4:7], s36 offen offset:0 sc1 lds
  buffer_load_dwordx4 v5, s[4:7], s36 offen offset:1024 sc1 lds
  buffer_load_dwordx4 v5, s[4:7], s36 offen offset:2048 sc1 lds
  buffer_load_dwordx4 v5, s[4:7], s36 offen offset:3072 sc1 lds
  s_add_u32 s36, s36, 4096
  s_add_u32 s37, s37, 4096
  s_mov_b32 m0, s37
  s_nop 0
  buffer_load_dwordx4 v5, s[4:7], s36 offen offset:0 sc1 lds
  buffer_load_dwordx4 v5, s[4:7], s36 offen offset:1024 sc1 lds
  buffer_load_dwordx4 v5, s[4:7], s36 offen offset:2048 sc1 lds
  buffer_load_dwordx4 v5, s[4:7], s36 offen offset:3072 sc1 lds
  s_add_u32 s36, s36, 4096
  s_add_u32 s37, s37, 4096
  s_mov_b32 m0, s37
  s_nop 0
  buffer_load_dwordx4 v5, s[4:7], s36 offen offset:0 sc1 lds
  buffer_load_dwordx4 v5, s[4:7], s36 offen offset:1024 sc1 lds
  s_add_u32 s58, s47, 0
  s_min_u32 s58, s58, 63
  s_cmp_lt_u32 s58, s56
  s_cbranch_scc1 L_qa_kvok0
  s_waitcnt vmcnt(0)
L_qa_kvp0:
  buffer_load_dwordx2 v[2:3], off, s[4:7], s49 sc1
  s_waitcnt vmcnt(0)
  v_readfirstlane_b32 s38, v2
  v_readfirstlane_b32 s39, v3
  s_lshl_b32 s38, s38, 1
  s_lshl1_add_u32 s39, s39, 1
  s_min_u32 s56, s38, s39
  s_cmp_lt_u32 s58, s56
  s_cbranch_scc1 L_qa_kvok0
  s_sleep 2
  s_sub_u32 s29, s29, 1
  s_cbranch_scc0 L_qa_kvp0
  s_branch L_end
L_qa_kvok0:
  s_add_u32 m0, s61, s60
  s_nop 0
  buffer_load_dwordx4 v5, s[4:7], s45 offen offset:0 sc1 lds
  buffer_load_dwordx4 v5, s[4:7], s45 offen offset:1024 sc1 lds
  buffer_load_dwordx4 v5, s[4:7], s45 offen offset:2048 sc1 lds
  buffer_load_dwordx4 v5, s[4:7], s45 offen offset:3072 sc1 lds
  v_mov_b32 v10, 0
  v_mov_b32 v11, 0
  s_waitcnt vmcnt(0)
L_qa_loop:
  s_barrier
  s_mov_b32 s57, 0
  s_cmp_ge_u32 s47, 52
  s_cselect_b32 s42, 2, 1
  s_cmp_ge_u32 s47, 64
  s_cbranch_scc1 L_qa_last
  s_add_u32 s58, s47, s42
  s_min_u32 s58, s58, 63
  s_cmp_lt_u32 s58, s56
  s_cbranch_scc1 L_qa_kvok1
  s_waitcnt vmcnt(0)
  v_mov_b32 v2, s62
  s_mov_b64 exec, 1
  buffer_store_dword v2, off, s[4:7], s51 sc1
  s_mov_b64 exec, -1
L_qa_kvp1:
  buffer_load_dwordx2 v[2:3], off, s[4:7], s49 sc1
  s_waitcnt vmcnt(0)
  v_readfirstlane_b32 s38, v2
  v_readfirstlane_b32 s39, v3
  s_lshl_b32 s38, s38, 1
  s_lshl1_add_u32 s39, s39, 1
  s_min_u32 s56, s38, s39
  s_cmp_lt_u32 s58, s56
  s_cbranch_scc1 L_qa_kvok1
  s_sleep 2
  s_sub_u32 s29, s29, 1
  s_cbranch_scc0 L_qa_kvp1
  s_branch L_end
L_qa_kvok1:
  v_add_u32 v6, s43, v5
  s_sub_u32 s43, 40960, s43
  s_mul_i32 s3, s42, 40960
  s_add_u32 s44, s44, s3
  s_add_u32 s3, s60, 90112
  v_add_u32 v12, s3, v5
  s_lshl_b32 s59, s55, 12
  s_add_u32 s3, s3, s59
  v_add_u32 v13, s3, v5
  s_xor_b32 s60, s60, 16384
  s_min_u32 s58, s44, 3629056
  s_mul_i32 s3, s28, 10240
  s_add_u32 s36, s58, s3
  s_add_u32 s37, s43, s3
  s_add_u32 s3, s47, s42
  s_cmp_lt_u32 s3, 64
  s_cselect_b32 s3, s42, 0
  s_lshl_b32 s3, s3, 18
  s_add_u32 s45, s45, s3
  v_min_u32 v10, v10, v11
  s_nop 0
  v_readfirstlane_b32 s3, v10
  s_nop 0
  s_cmp_ge_u32 s3, s41
  s_cbranch_scc0 L_qa_ne
  s_cmp_eq_u32 s41, 0
  s_cbranch_scc1 L_qa_ne
  s_mov_b32 s57, 1
  s_lshl_b32 s35, s41, 17
  s_add_u32 s35, s35, s46
  s_lshl_b32 s3, s28, 9
  s_add_u32 s38, s35, s3
  s_add_u32 s38, s38, 41811968
  buffer_load_dwordx2 v[204:205], v64, s[4:7], s38 offen sc1
  s_lshl_b32 s3, s55, 10
  s_add_u32 s38, s35, s3
  s_add_u32 s38, s38, 50200576
  buffer_load_dwordx2 v[148:149], v64, s[4:7], s38 offen offset:0 sc1
  buffer_load_dwordx2 v[150:151], v64, s[4:7], s38 offen offset:512 sc1
L_qa_ne:
  ds_read_b128 v[32:35], v6 offset:0
  ds_read_b128 v[36:39], v6 offset:1024
  ds_read_b128 v[40:43], v6 offset:2048
  ds_read_b128 v[44:47], v6 offset:3072
  s_waitcnt lgkmcnt(3)
  v_mfma_f32_32x32x16_bf16 v[16:31], a[0:3], v[32:35], 0
  s_add_u32 m0, s61, s60
  s_nop 0
  buffer_load_dwordx4 v5, s[4:7], s45 offen offset:0 sc1 lds
  ds_read_b128 v[32:35], v6 offset:4096
  s_waitcnt lgkmcnt(3)
  v_mfma_f32_32x32x16_bf16 v[16:31], a[4:7], v[36:39], v[16:31]
  buffer_load_dwordx4 v5, s[4:7], s45 offen offset:1024 sc1 lds
  ds_read_b128 v[36:39], v6 offset:5120
  s_waitcnt lgkmcnt(3)
  v_mfma_f32_32x32x16_bf16 v[16:31], a[8:11], v[40:43], v[16:31]
  ds_read_b128 v[84:87], v12 offset:0
  buffer_load_dwordx4 v5, s[4:7], s45 offen offset:2048 sc1 lds
  ds_read_b128 v[40:43], v6 offset:6144
  s_waitcnt lgkmcnt(4)
  v_mfma_f32_32x32x16_bf16 v[16:31], a[12:15], v[44:47], v[16:31]
  buffer_load_dwordx4 v5, s[4:7], s45 offen offset:3072 sc1 lds
  ds_read_b128 v[44:47], v6 offset:7168
  s_waitcnt lgkmcnt(4)
  v_mfma_f32_32x32x16_bf16 v[16:31], a[16:19], v[32:35], v[16:31]
  ds_read_b128 v[88:91], v12 offset:1024
  s_mov_b32 m0, s37
  s_nop 0
  buffer_load_dwordx4 v5, s[4:7], s36 offen offset:0 sc1 lds
  ds_read_b128 v[32:35], v6 offset:8192
  s_waitcnt lgkmcnt(5)
  v_mfma_f32_32x32x16_bf16 v[16:31], a[20:23], v[36:39], v[16:31]
  ds_read_b128 v[36:39], v6 offset:9216
  s_waitcnt lgkmcnt(4)
  v_mfma_f32_32x32x16_bf16 v[16:31], a[24:27], v[40:43], v[16:31]
  ds_read_b128 v[92:95], v12 offset:2048
  buffer_load_dwordx4 v5, s[4:7], s36 offen offset:1024 sc1 lds
  ds_read_b128 v[40:43], v6 offset:10240
  s_waitcnt lgkmcnt(5)
  v_mfma_f32_32x32x16_bf16 v[16:31], a[28:31], v[44:47], v[16:31]
  ds_read_b128 v[44:47], v6 offset:11264
  s_waitcnt lgkmcnt(4)
  v_mfma_f32_32x32x16_bf16 v[16:31], a[32:35], v[32:35], v[16:31]
  ds_read_b128 v[96:99], v12 offset:3072
  buffer_load_dwordx4 v5, s[4:7], s36 offen offset:2048 sc1 lds
  ds_read_b128 v[32:35], v6 offset:12288
  s_waitcnt lgkmcnt(5)
  v_mfma_f32_32x32x16_bf16 v[16:31], a[36:39], v[36:39], v[16:31]
  ds_read_b128 v[36:39], v6 offset:13312
  s_waitcnt lgkmcnt(4)
  v_mfma_f32_32x32x16_bf16 v[16:31], a[40:43], v[40:43], v[16:31]
  ds_read_b128 v[100:103], v12 offset:4096
  buffer_load_dwordx4 v5, s[4:7], s36 offen offset:3072 sc1 lds
  ds_read_b128 v[40:43], v6 offset:14336
  s_waitcnt lgkmcnt(5)
  v_mfma_f32_32x32x16_bf16 v[16:31], a[44:47], v[44:47], v[16:31]
  ds_read_b128 v[44:47], v6 offset:15360
  s_waitcnt lgkmcnt(4)
  v_mfma_f32_32x32x16_bf16 v[16:31], a[48:51], v[32:35], v[16:31]
  ds_read_b128 v[104:107], v12 offset:5120
  s_add_u32 s36, s36, 4096
  s_add_u32 s37, s37, 4096
  s_mov_b32 m0, s37
  s_nop 0
  buffer_load_dwordx4 v5, s[4:7], s36 offen offset:0 sc1 lds
  ds_read_b128 v[32:35], v6 offset:16384
  s_waitcnt lgkmcnt(5)
  v_mfma_f32_32x32x16_bf16 v[16:31], a[52:55], v[36:39], v[16:31]
  ds_read_b128 v[36:39], v6 offset:17408
  s_waitcnt lgkmcnt(4)
  v_mfma_f32_32x32x16_bf16 v[16:31], a[56:59], v[40:43], v[16:31]
  ds_read_b128 v[108:111], v12 offset:6144
  buffer_load_dwordx4 v5, s[4:7], s36 offen offset:1024 sc1 lds
  ds_read_b128 v[40:43], v6 offset:18432
  s_waitcnt lgkmcnt(5)
  v_mfma_f32_32x32x16_bf16 v[16:31], a[60:63], v[44:47], v[16:31]
  ds_read_b128 v[44:47], v6 offset:19456
  s_waitcnt lgkmcnt(4)
  v_mfma_f32_32x32x16_bf16 v[16:31], a[64:67], v[32:35], v[16:31]
  ds_read_b128 v[112:115], v12 offset:7168
  buffer_load_dwordx4 v5, s[4:7], s36 offen offset:2048 sc1 lds
  ds_read_b128 v[32:35], v6 offset:20480
  s_waitcnt lgkmcnt(5)
  v_mfma_f32_32x32x16_bf16 v[16:31], a[68:71], v[36:39], v[16:31]
  ds_read_b128 v[36:39], v6 offset:21504
  s_waitcnt lgkmcnt(4)
  v_mfma_f32_32x32x16_bf16 v[16:31], a[72:75], v[40:43], v[16:31]
  ds_read_b128 v[232:235], v13 offset:8192
  buffer_load_dwordx4 v5, s[4:7], s36 offen offset:3072 sc1 lds
  ds_read_b128 v[40:43], v6 offset:22528
  s_waitcnt lgkmcnt(5)
  v_mfma_f32_32x32x16_bf16 v[16:31], a[76:79], v[44:47], v[16:31]
  ds_read_b128 v[44:47], v6 offset:23552
  s_waitcnt lgkmcnt(4)
  v_mfma_f32_32x32x16_bf16 v[16:31], a[80:83], v[32:35], v[16:31]
  ds_read_b128 v[236:239], v13 offset:9216
  s_add_u32 s36, s36, 4096
  s_add_u32 s37, s37, 4096
  s_mov_b32 m0, s37
  s_nop 0
  buffer_load_dwordx4 v5, s[4:7], s36 offen offset:0 sc1 lds
  ds_read_b128 v[32:35], v6 offset:24576
  s_waitcnt lgkmcnt(5)
  v_mfma_f32_32x32x16_bf16 v[16:31], a[84:87], v[36:39], v[16:31]
  ds_read_b128 v[36:39], v6 offset:25600
  s_waitcnt lgkmcnt(4)
  v_mfma_f32_32x32x16_bf16 v[16:31], a[88:91], v[40:43], v[16:31]
  ds_read_b128 v[240:243], v13 offset:10240
  buffer_load_dwordx4 v5, s[4:7], s36 offen offset:1024 sc1 lds
  ds_read_b128 v[40:43], v6 offset:26624
  s_waitcnt lgkmcnt(5)
  v_mfma_f32_32x32x16_bf16 v[16:31], a[92:95], v[44:47], v[16:31]
  ds_read_b128 v[44:47], v6 offset:27648
  s_waitcnt lgkmcnt(4)
  v_mfma_f32_32x32x16_bf16 v[16:31], a[96:99], v[32:35], v[16:31]
  ds_read_b128 v[244:247], v13 offset:11264
  ds_read_b128 v[32:35], v6 offset:28672
  s_waitcnt lgkmcnt(5)
  v_mfma_f32_32x32x16_bf16 v[16:31], a[100:103], v[36:39], v[16:31]
  ds_read_b128 v[36:39], v6 offset:29696
  s_waitcnt lgkmcnt(4)
  v_mfma_f32_32x32x16_bf16 v[16:31], a[104:107], v[40:43], v[16:31]
  s_waitcnt vmcnt(14)
  v_mov_b32 v2, s62
  s_mov_b64 exec, 1
  buffer_store_dword v2, off, s[4:7], s51 sc1
  s_mov_b64 exec, -1
  ds_read_b128 v[40:43], v6 offset:30720
  s_waitcnt lgkmcnt(4)
  v_mfma_f32_32x32x16_bf16 v[16:31], a[108:111], v[44:47], v[16:31]
  ds_read_b128 v[44:47], v6 offset:31744
  s_waitcnt lgkmcnt(3)
  v_mfma_f32_32x32x16_bf16 v[16:31], a[112:115], v[32:35], v[16:31]
  ds_read_b128 v[32:35], v6 offset:32768
  s_waitcnt lgkmcnt(3)
  v_mfma_f32_32x32x16_bf16 v[16:31], a[116:119], v[36:39], v[16:31]
  ds_read_b128 v[36:39], v6 offset:33792
  s_waitcnt lgkmcnt(3)
  v_mfma_f32_32x32x16_bf16 v[16:31], a[120:123], v[40:43], v[16:31]
  ds_read_b128 v[40:43], v6 offset:34816
  s_waitcnt lgkmcnt(3)
  v_mfma_f32_32x32x16_bf16 v[16:31], a[124:127], v[44:47], v[16:31]
  ds_read_b128 v[44:47], v6 offset:35840
  s_waitcnt lgkmcnt(3)
  v_mfma_f32_32x32x16_bf16 v[16:31], a[128:131], v[32:35], v[16:31]
  ds_read_b128 v[32:35], v6 offset:36864
  s_waitcnt lgkmcnt(3)
  v_mfma_f32_32x32x16_bf16 v[16:31], a[132:135], v[36:39], v[16:31]
  ds_read_b128 v[36:39], v6 offset:37888
  s_waitcnt lgkmcnt(3)
  v_mfma_f32_32x32x16_bf16 v[16:31], a[136:139], v[40:43], v[16:31]
  ds_read_b128 v[40:43], v6 offset:38912
  s_waitcnt lgkmcnt(3)
  v_mfma_f32_32x32x16_bf16 v[16:31], a[140:143], v[44:47], v[16:31]
  ds_read_b128 v[44:47], v6 offset:39936
  s_waitcnt lgkmcnt(3)
  v_mfma_f32_32x32x16_bf16 v[16:31], a[144:147], v[32:35], v[16:31]
  buffer_load_dwordx2 v[10:11], off, s[4:7], s50 sc1
  s_waitcnt lgkmcnt(2)
  v_mfma_f32_32x32x16_bf16 v[16:31], a[148:151], v[36:39], v[16:31]
  s_waitcnt lgkmcnt(1)
  v_mfma_f32_32x32x16_bf16 v[16:31], a[152:155], v[40:43], v[16:31]
  s_waitcnt lgkmcnt(0)
  v_mfma_f32_32x32x16_bf16 v[16:31], a[156:159], v[44:47], v[16:31]
  s_cmp_lg_u32 s57, 0
  s_cbranch_scc0 L_qa_nw
  ds_write2_b32 v14, v204, v205 offset0:0 offset1:128
L_qa_nw:
  s_nop 7
  s_nop 1
  v_cvt_pk_bf16_f32 v48, v16, v17
  v_cvt_pk_bf16_f32 v49, v18, v19
  v_cvt_pk_bf16_f32 v50, v20, v21
  v_cvt_pk_bf16_f32 v51, v22, v23
  v_cvt_pk_bf16_f32 v52, v24, v25
  v_cvt_pk_bf16_f32 v53, v26, v27
  v_cvt_pk_bf16_f32 v54, v28, v29
  v_cvt_pk_bf16_f32 v55, v30, v31
  ds_write_b128 v7, v[48:51] offset:0
  ds_write_b128 v7, v[52:55] offset:512
  s_waitcnt lgkmcnt(0)
  s_barrier
  ds_read_b128 v[208:211], v8 offset:0
  ds_read_b128 v[212:215], v8 offset:1024
  ds_read_b128 v[216:219], v8 offset:2048
  ds_read_b128 v[220:223], v8 offset:3072
  s_cmp_lg_u32 s57, 0
  s_cbranch_scc0 L_qa_late
  s_barrier
  ds_read_b64_tr_b16 v[132:133], v15 offset:0
  ds_read_b64_tr_b16 v[134:135], v15 offset:256
  ds_read_b64_tr_b16 v[136:137], v15 offset:1024
  ds_read_b64_tr_b16 v[138:139], v15 offset:1280
  ds_read_b64_tr_b16 v[140:141], v15 offset:2048
  ds_read_b64_tr_b16 v[142:143], v15 offset:2304
  ds_read_b64_tr_b16 v[144:145], v15 offset:3072
  ds_read_b64_tr_b16 v[146:147], v15 offset:3328
  s_waitcnt lgkmcnt(11)
  v_mfma_f32_16x16x32_bf16 v[224:227], v[84:87], v[208:211], v[56:59]
  v_mfma_f32_16x16x32_bf16 v[228:231], v[100:103], v[208:211], v[60:63]
  s_waitcnt lgkmcnt(10)
  v_mfma_f32_16x16x32_bf16 v[224:227], v[88:91], v[212:215], v[224:227]
  v_mfma_f32_16x16x32_bf16 v[228:231], v[104:107], v[212:215], v[228:231]
  s_waitcnt lgkmcnt(9)
  v_mfma_f32_16x16x32_bf16 v[224:227], v[92:95], v[216:219], v[224:227]
  v_mfma_f32_16x16x32_bf16 v[228:231], v[108:111], v[216:219], v[228:231]
  s_waitcnt lgkmcnt(8)
  v_mfma_f32_16x16x32_bf16 v[224:227], v[96:99], v[220:223], v[224:227]
  v_mfma_f32_16x16x32_bf16 v[228:231], v[112:115], v[220:223], v[228:231]
  s_branch L_qa_have
L_qa_last:
  s_waitcnt vmcnt(0)
  v_mov_b32 v2, s62
  s_mov_b64 exec, 1
  buffer_store_dword v2, off, s[4:7], s51 sc1
  s_mov_b64 exec, -1
  s_branch L_qa_late2
L_qa_late:
  s_waitcnt lgkmcnt(3)
  v_mfma_f32_16x16x32_bf16 v[224:227], v[84:87], v[208:211], v[56:59]
  v_mfma_f32_16x16x32_bf16 v[228:231], v[100:103], v[208:211], v[60:63]
  s_waitcnt lgkmcnt(2)
  v_mfma_f32_16x16x32_bf16 v[224:227], v[88:91], v[212:215], v[224:227]
  v_mfma_f32_16x16x32_bf16 v[228:231], v[104:107], v[212:215], v[228:231]
  s_waitcnt lgkmcnt(1)
  v_mfma_f32_16x16x32_bf16 v[224:227], v[92:95], v[216:219], v[224:227]
  v_mfma_f32_16x16x32_bf16 v[228:231], v[108:111], v[216:219], v[228:231]
  s_waitcnt lgkmcnt(0)
  v_mfma_f32_16x16x32_bf16 v[224:227], v[96:99], v[220:223], v[224:227]
  v_mfma_f32_16x16x32_bf16 v[228:231], v[112:115], v[220:223], v[228:231]
  s_cmp_lg_u32 s41, 0
  s_cbranch_scc1 L_qa_late2
  s_waitcnt vmcnt(0)
  s_nop 4
  s_branch L_qa_copy
L_qa_late2:
  v_min_u32 v2, 1, v1
  v_mul_u32_u24 v2, 4, v2
L_wf_61:
  buffer_load_dword v3, v2, s[4:7], s50 offen sc1
  s_waitcnt vmcnt(0)
  v_cmp_gt_u32 vcc, s41, v3
  s_cbranch_vccz L_wfd_62
  s_sleep 1
  s_sub_u32 s29, s29, 1
  s_cbranch_scc0 L_wf_61
  s_branch L_end
L_wfd_62:
  v_readlane_b32 s38, v3, 0
  v_readlane_b32 s39, v3, 1
  s_nop 0
  s_min_u32 s38, s38, s39
  v_mov_b32 v10, s38
  v_mov_b32 v11, s38
  s_lshl_b32 s35, s41, 17
  s_add_u32 s35, s35, s46
  s_lshl_b32 s3, s28, 9
  s_add_u32 s38, s35, s3
  s_add_u32 s38, s38, 41811968
  buffer_load_dwordx2 v[204:205], v64, s[4:7], s38 offen sc1
  s_lshl_b32 s3, s55, 10
  s_add_u32 s38, s35, s3
  s_add_u32 s38, s38, 50200576
  buffer_load_dwordx2 v[148:149], v64, s[4:7], s38 offen offset:0 sc1
  buffer_load_dwordx2 v[150:151], v64, s[4:7], s38 offen offset:512 sc1
  s_waitcnt vmcnt(2)
  ds_write2_b32 v14, v204, v205 offset0:0 offset1:128
  s_waitcnt lgkmcnt(0)
  s_barrier
  ds_read_b64_tr_b16 v[132:133], v15 offset:0
  ds_read_b64_tr_b16 v[134:135], v15 offset:256
  ds_read_b64_tr_b16 v[136:137], v15 offset:1024
  ds_read_b64_tr_b16 v[138:139], v15 offset:1280
  ds_read_b64_tr_b16 v[140:141], v15 offset:2048
  ds_read_b64_tr_b16 v[142:143], v15 offset:2304
  ds_read_b64_tr_b16 v[144:145], v15 offset:3072
  ds_read_b64_tr_b16 v[146:147], v15 offset:3328
  s_waitcnt vmcnt(0)
L_qa_have:
  s_waitcnt lgkmcnt(6)
  v_mfma_f32_16x16x32_bf16 v[164:167], v[132:135], v[68:71], 0
  s_waitcnt lgkmcnt(4)
  v_mfma_f32_16x16x32_bf16 v[164:167], v[136:139], v[72:75], v[164:167]
  s_waitcnt lgkmcnt(2)
  v_mfma_f32_16x16x32_bf16 v[164:167], v[140:143], v[76:79], v[164:167]
  s_waitcnt lgkmcnt(0)
  v_mfma_f32_16x16x32_bf16 v[164:167], v[144:147], v[80:83], v[164:167]
  v_max3_f32 v192, v156, v157, v158
  v_max3_f32 v192, v192, v159, v160
  v_max3_f32 v192, v192, v161, v162
  v_max_f32 v192, v192, v163
  s_nop 3
  v_max3_f32 v192, v192, v164, v165
  v_mov_b32 v193, v192
  s_nop 1
  v_permlane16_swap_b32 v193, v192
  v_max_f32 v192, v192, v193
  v_mov_b32 v193, v192
  s_nop 1
  v_permlane32_swap_b32 v193, v192
  v_max_f32 v192, v192, v193
  v_mul_f32 v192, s52, v192
  v_pk_fma_f32 v[156:157], v[156:157], s[52:53], v[192:193] op_sel_hi:[1,0,0] neg_lo:[0,0,1] neg_hi:[0,0,1]
  v_pk_fma_f32 v[158:159], v[158:159], s[52:53], v[192:193] op_sel_hi:[1,0,0] neg_lo:[0,0,1] neg_hi:[0,0,1]
  v_pk_fma_f32 v[160:161], v[160:161], s[52:53], v[192:193] op_sel_hi:[1,0,0] neg_lo:[0,0,1] neg_hi:[0,0,1]
  v_pk_fma_f32 v[162:163], v[162:163], s[52:53], v[192:193] op_sel_hi:[1,0,0] neg_lo:[0,0,1] neg_hi:[0,0,1]
  v_pk_fma_f32 v[164:165], v[164:165], s[52:53], v[192:193] op_sel_hi:[1,0,0] neg_lo:[0,0,1] neg_hi:[0,0,1]
  v_exp_f32 v156, v156
  v_exp_f32 v157, v157
  v_exp_f32 v158, v158
  v_exp_f32 v159, v159
  v_exp_f32 v160, v160
  v_exp_f32 v161, v161
  v_exp_f32 v162, v162
  v_exp_f32 v163, v163
  v_exp_f32 v164, v164
  v_exp_f32 v165, v165
  s_nop 0
  v_cvt_pk_bf16_f32 v168, v156, v157
  v_cvt_pk_bf16_f32 v169, v158, v159
  v_cvt_pk_bf16_f32 v170, v160, v161
  v_cvt_pk_bf16_f32 v171, v162, v163
  v_cvt_pk_bf16_f32 v172, v164, v165
  v_cvt_pk_bf16_f32 v175, v164, v165
  s_nop 1
  v_mfma_f32_16x16x32_bf16 v[200:203], v[196:199], v[168:171], 0
  v_mfma_f32_16x16x32_bf16 v[176:179], v[116:119], v[168:171], 0
  v_mfma_f32_16x16x32_bf16 v[180:183], v[120:123], v[168:171], 0
  v_mfma_f32_16x16x32_bf16 v[184:187], v[124:127], v[168:171], 0
  v_mfma_f32_16x16x32_bf16 v[188:191], v[128:131], v[168:171], 0
  s_nop 1
  v_mfma_f32_16x16x16_bf16 v[200:203], v[196:197], v[172:173], v[200:203]
  v_mfma_f32_16x16x16_bf16 v[176:179], v[148:149], v[172:173], v[176:179]
  v_mfma_f32_16x16x16_bf16 v[180:183], v[148:149], v[174:175], v[180:183]
  v_mfma_f32_16x16x16_bf16 v[184:187], v[150:151], v[172:173], v[184:187]
  v_mfma_f32_16x16x16_bf16 v[188:191], v[150:151], v[174:175], v[188:191]
  s_nop 3
  v_rcp_f32 v194, v200
  v_mov_b32 v195, 0
  s_nop 2
  v_pk_mul_f32 v[176:177], v[176:177], v[194:195] op_sel_hi:[1,0]
  v_pk_mul_f32 v[178:179], v[178:179], v[194:195] op_sel_hi:[1,0]
  v_pk_mul_f32 v[180:181], v[180:181], v[194:195] op_sel_hi:[1,0]
  v_pk_mul_f32 v[182:183], v[182:183], v[194:195] op_sel_hi:[1,0]
  v_pk_mul_f32 v[184:185], v[184:185], v[194:195] op_sel_hi:[1,0]
  v_pk_mul_f32 v[186:187], v[186:187], v[194:195] op_sel_hi:[1,0]
  v_pk_mul_f32 v[188:189], v[188:189], v[194:195] op_sel_hi:[1,0]
  v_pk_mul_f32 v[190:191], v[190:191], v[194:195] op_sel_hi:[1,0]
  v_cvt_pk_bf16_f32 v48, v176, v177
  v_cvt_pk_bf16_f32 v49, v178, v179
  v_cvt_pk_bf16_f32 v50, v180, v181
  v_cvt_pk_bf16_f32 v51, v182, v183
  v_cvt_pk_bf16_f32 v52, v184, v185
  v_cvt_pk_bf16_f32 v53, v186, v187
  v_cvt_pk_bf16_f32 v54, v188, v189
  v_cvt_pk_bf16_f32 v55, v190, v191
  s_lshl_b32 s35, s41, 18
  s_add_u32 s35, s35, s48
  s_sub_u32 s35, s35, 262144
  buffer_store_dwordx4 v[48:51], v5, s[4:7], s35 offen offset:0 sc1
  buffer_store_dwordx4 v[52:55], v5, s[4:7], s35 offen offset:1024 sc1
  s_mov_b32 s62, s41
  s_cmp_ge_u32 s47, 64
  s_cbranch_scc1 L_qa_end
L_qa_copy:
  v_mov_b64 v[68:69], v[208:209]
  v_mov_b64 v[70:71], v[210:211]
  v_mov_b64 v[72:73], v[212:213]
  v_mov_b64 v[74:75], v[214:215]
  v_mov_b64 v[76:77], v[216:217]
  v_mov_b64 v[78:79], v[218:219]
  v_mov_b64 v[80:81], v[220:221]
  v_mov_b64 v[82:83], v[222:223]
  v_mov_b64 v[156:157], v[224:225]
  v_mov_b64 v[158:159], v[226:227]
  v_mov_b64 v[160:161], v[228:229]
  v_mov_b64 v[162:163], v[230:231]
  v_mov_b64 v[116:117], v[232:233]
  v_mov_b64 v[118:119], v[234:235]
  v_mov_b64 v[120:121], v[236:237]
  v_mov_b64 v[122:123], v[238:239]
  v_mov_b64 v[124:125], v[240:241]
  v_mov_b64 v[126:127], v[242:243]
  v_mov_b64 v[128:129], v[244:245]
  v_mov_b64 v[130:131], v[246:247]
  s_add_u32 s41, s47, 1
  s_add_u32 s47, s47, s42
  s_waitcnt vmcnt(2)
  s_branch L_qa_loop
L_qa_end:
  s_waitcnt vmcnt(0)
  v_mov_b32 v2, s62
  s_mov_b64 exec, 1
  buffer_store_dword v2, off, s[4:7], s51 sc1
  s_mov_b64 exec, -1
  s_branch L_fin
L_wo:
  s_lshr_b32 s40, s32, 5
  s_sub_u32 s40, s40, 2
  s_and_b32 s41, s32, 31
  s_mov_b32 s12, s74
  s_mov_b32 s13, s75
  s_mov_b32 s14, 5242880
  s_mov_b32 s15, 0x20000
  s_mov_b32 s16, s84
  s_mov_b32 s17, s85
  s_mov_b32 s18, 2211840
  s_mov_b32 s19, 0x20000
  s_mov_b32 s20, s64
  s_mov_b32 s21, s65
  s_mov_b32 s22, 2621440
  s_mov_b32 s23, 0x20000
  s_cmp_ge_u32 s41, 16
  s_cbranch_scc1 L_wo_pre
  s_lshl4_add_u32 s50, s40, s41
  v_lshrrev_b32 v2, 3, v1
  s_lshl_b32 s3, s28, 3
  v_add_u32 v2, s3, v2
  v_and_b32 v3, 7, v1
  v_mul_u32_u24 v4, 1280, v2
  v_lshl_add_u32 v4, v3, 4, v4
  v_lshlrev_b32 v5, 9, v3
  v_lshl_add_u32 v5, v2, 4, v5
  s_mul_i32 s38, s50, 40960
  buffer_load_dwordx4 v[16:19], v4, s[20:23], s38 offen offset:0
  buffer_load_dwordx4 v[20:23], v4, s[20:23], s38 offen offset:128
  buffer_load_dwordx4 v[24:27], v4, s[20:23], s38 offen offset:256
  buffer_load_dwordx4 v[28:31], v4, s[20:23], s38 offen offset:384
  buffer_load_dwordx4 v[32:35], v4, s[20:23], s38 offen offset:512
  buffer_load_dwordx4 v[36:39], v4, s[20:23], s38 offen offset:640
  buffer_load_dwordx4 v[40:43], v4, s[20:23], s38 offen offset:768
  buffer_load_dwordx4 v[44:47], v4, s[20:23], s38 offen offset:896
  buffer_load_dwordx4 v[48:51], v4, s[20:23], s38 offen offset:1024
  buffer_load_dwordx4 v[52:55], v4, s[20:23], s38 offen offset:1152
  s_waitcnt vmcnt(9)
  v_lshlrev_b32 v56, 16, v16
  v_and_b32 v57, 0xffff0000, v16
  v_lshlrev_b32 v58, 16, v17
  v_and_b32 v59, 0xffff0000, v17
  v_lshlrev_b32 v60, 16, v18
  v_and_b32 v61, 0xffff0000, v18
  v_lshlrev_b32 v62, 16, v19
  v_and_b32 v63, 0xffff0000, v19
  s_waitcnt vmcnt(8)
  v_lshlrev_b32 v64, 16, v20
  v_and_b32 v65, 0xffff0000, v20
  v_lshlrev_b32 v66, 16, v21
  v_and_b32 v67, 0xffff0000, v21
  v_lshlrev_b32 v68, 16, v22
  v_and_b32 v69, 0xffff0000, v22
  v_lshlrev_b32 v70, 16, v23
  v_and_b32 v71, 0xffff0000, v23
  s_waitcnt vmcnt(7)
  v_lshlrev_b32 v72, 16, v24
  v_and_b32 v73, 0xffff0000, v24
  v_lshlrev_b32 v74, 16, v25
  v_and_b32 v75, 0xffff0000, v25
  v_lshlrev_b32 v76, 16, v26
  v_and_b32 v77, 0xffff0000, v26
  v_lshlrev_b32 v78, 16, v27
  v_and_b32 v79, 0xffff0000, v27
  s_waitcnt vmcnt(6)
  v_lshlrev_b32 v80, 16, v28
  v_and_b32 v81, 0xffff0000, v28
  v_lshlrev_b32 v82, 16, v29
  v_and_b32 v83, 0xffff0000, v29
  v_lshlrev_b32 v84, 16, v30
  v_and_b32 v85, 0xffff0000, v30
  v_lshlrev_b32 v86, 16, v31
  v_and_b32 v87, 0xffff0000, v31
  s_waitcnt vmcnt(5)
  v_lshlrev_b32 v88, 16, v32
  v_and_b32 v89, 0xffff0000, v32
  v_lshlrev_b32 v90, 16, v33
  v_and_b32 v91, 0xffff0000, v33
  v_lshlrev_b32 v92, 16, v34
  v_and_b32 v93, 0xffff0000, v34
  v_lshlrev_b32 v94, 16, v35
  v_and_b32 v95, 0xffff0000, v35
  s_waitcnt vmcnt(4)
  v_lshlrev_b32 v96, 16, v36
  v_and_b32 v97, 0xffff0000, v36
  v_lshlrev_b32 v98, 16, v37
  v_and_b32 v99, 0xffff0000, v37
  v_lshlrev_b32 v100, 16, v38
  v_and_b32 v101, 0xffff0000, v38
  v_lshlrev_b32 v102, 16, v39
  v_and_b32 v103, 0xffff0000, v39
  s_waitcnt vmcnt(3)
  v_lshlrev_b32 v104, 16, v40
  v_and_b32 v105, 0xffff0000, v40
  v_lshlrev_b32 v106, 16, v41
  v_and_b32 v107, 0xffff0000, v41
  v_lshlrev_b32 v108, 16, v42
  v_and_b32 v109, 0xffff0000, v42
  v_lshlrev_b32 v110, 16, v43
  v_and_b32 v111, 0xffff0000, v43
  s_waitcnt vmcnt(2)
  v_lshlrev_b32 v112, 16, v44
  v_and_b32 v113, 0xffff0000, v44
  v_lshlrev_b32 v114, 16, v45
  v_and_b32 v115, 0xffff0000, v45
  v_lshlrev_b32 v116, 16, v46
  v_and_b32 v117, 0xffff0000, v46
  v_lshlrev_b32 v118, 16, v47
  v_and_b32 v119, 0xffff0000, v47
  s_waitcnt vmcnt(1)
  v_lshlrev_b32 v120, 16, v48
  v_and_b32 v121, 0xffff0000, v48
  v_lshlrev_b32 v122, 16, v49
  v_and_b32 v123, 0xffff0000, v49
  v_lshlrev_b32 v124, 16, v50
  v_and_b32 v125, 0xffff0000, v50
  v_lshlrev_b32 v126, 16, v51
  v_and_b32 v127, 0xffff0000, v51
  s_waitcnt vmcnt(0)
  v_lshlrev_b32 v128, 16, v52
  v_and_b32 v129, 0xffff0000, v52
  v_lshlrev_b32 v130, 16, v53
  v_and_b32 v131, 0xffff0000, v53
  v_lshlrev_b32 v132, 16, v54
  v_and_b32 v133, 0xffff0000, v54
  v_lshlrev_b32 v134, 16, v55
  v_and_b32 v135, 0xffff0000, v55
  s_cmp_eq_u32 s101, 0
  s_cbranch_scc1 L_sig_63
  s_mov_b32 s101, 0
  s_mov_b64 exec, 1
  v_mov_b32 v0, 1
  buffer_atomic_add v0, off, s[8:11], 0 offset:32
  s_mov_b64 exec, -1
L_sig_63:
  v_pk_add_f32 v[136:137], v[56:57], v[58:59]
  v_pk_add_f32 v[136:137], v[136:137], v[60:61]
  v_pk_add_f32 v[136:137], v[136:137], v[62:63]
  v_pk_add_f32 v[136:137], v[136:137], v[64:65]
  v_pk_add_f32 v[136:137], v[136:137], v[66:67]
  v_pk_add_f32 v[136:137], v[136:137], v[68:69]
  v_pk_add_f32 v[136:137], v[136:137], v[70:71]
  v_pk_add_f32 v[136:137], v[136:137], v[72:73]
  v_pk_add_f32 v[136:137], v[136:137], v[74:75]
  v_pk_add_f32 v[136:137], v[136:137], v[76:77]
  v_pk_add_f32 v[136:137], v[136:137], v[78:79]
  v_pk_add_f32 v[136:137], v[136:137], v[80:81]
  v_pk_add_f32 v[136:137], v[136:137], v[82:83]
  v_pk_add_f32 v[136:137], v[136:137], v[84:85]
  v_pk_add_f32 v[136:137], v[136:137], v[86:87]
  v_pk_add_f32 v[136:137], v[136:137], v[88:89]
  v_pk_add_f32 v[136:137], v[136:137], v[90:91]
  v_pk_add_f32 v[136:137], v[136:137], v[92:93]
  v_pk_add_f32 v[136:137], v[136:137], v[94:95]
  v_pk_add_f32 v[136:137], v[136:137], v[96:97]
  v_pk_add_f32 v[136:137], v[136:137], v[98:99]
  v_pk_add_f32 v[136:137], v[136:137], v[100:101]
  v_pk_add_f32 v[136:137], v[136:137], v[102:103]
  v_pk_add_f32 v[136:137], v[136:137], v[104:105]
  v_pk_add_f32 v[136:137], v[136:137], v[106:107]
  v_pk_add_f32 v[136:137], v[136:137], v[108:109]
  v_pk_add_f32 v[136:137], v[136:137], v[110:111]
  v_pk_add_f32 v[136:137], v[136:137], v[112:113]
  v_pk_add_f32 v[136:137], v[136:137], v[114:115]
  v_pk_add_f32 v[136:137], v[136:137], v[116:117]
  v_pk_add_f32 v[136:137], v[136:137], v[118:119]
  v_pk_add_f32 v[136:137], v[136:137], v[120:121]
  v_pk_add_f32 v[136:137], v[136:137], v[122:123]
  v_pk_add_f32 v[136:137], v[136:137], v[124:125]
  v_pk_add_f32 v[136:137], v[136:137], v[126:127]
  v_pk_add_f32 v[136:137], v[136:137], v[128:129]
  v_pk_add_f32 v[136:137], v[136:137], v[130:131]
  v_pk_add_f32 v[136:137], v[136:137], v[132:133]
  v_pk_add_f32 v[136:137], v[136:137], v[134:135]
  v_add_f32 v136, v136, v137
  s_nop 1
  v_add_f32_dpp v136, v136, v136 quad_perm:[1,0,3,2] row_mask:0xf bank_mask:0xf
  s_nop 1
  v_add_f32_dpp v136, v136, v136 quad_perm:[2,3,0,1] row_mask:0xf bank_mask:0xf
  s_nop 1
  v_add_f32_dpp v136, v136, v136 row_half_mirror row_mask:0xf bank_mask:0xf
  v_mul_f32 v136, 0x3acccccd, v136
  v_mov_b32 v137, v136
  v_pk_add_f32 v[140:141], v[56:57], v[136:137] neg_lo:[0,1] neg_hi:[0,1]
  v_pk_mul_f32 v[138:139], v[140:141], v[140:141]
  v_pk_add_f32 v[140:141], v[58:59], v[136:137] neg_lo:[0,1] neg_hi:[0,1]
  v_pk_fma_f32 v[138:139], v[140:141], v[140:141], v[138:139]
  v_pk_add_f32 v[140:141], v[60:61], v[136:137] neg_lo:[0,1] neg_hi:[0,1]
  v_pk_fma_f32 v[138:139], v[140:141], v[140:141], v[138:139]
  v_pk_add_f32 v[140:141], v[62:63], v[136:137] neg_lo:[0,1] neg_hi:[0,1]
  v_pk_fma_f32 v[138:139], v[140:141], v[140:141], v[138:139]
  v_pk_add_f32 v[140:141], v[64:65], v[136:137] neg_lo:[0,1] neg_hi:[0,1]
  v_pk_fma_f32 v[138:139], v[140:141], v[140:141], v[138:139]
  v_pk_add_f32 v[140:141], v[66:67], v[136:137] neg_lo:[0,1] neg_hi:[0,1]
  v_pk_fma_f32 v[138:139], v[140:141], v[140:141], v[138:139]
  v_pk_add_f32 v[140:141], v[68:69], v[136:137] neg_lo:[0,1] neg_hi:[0,1]
  v_pk_fma_f32 v[138:139], v[140:141], v[140:141], v[138:139]
  v_pk_add_f32 v[140:141], v[70:71], v[136:137] neg_lo:[0,1] neg_hi:[0,1]
  v_pk_fma_f32 v[138:139], v[140:141], v[140:141], v[138:139]
  v_pk_add_f32 v[140:141], v[72:73], v[136:137] neg_lo:[0,1] neg_hi:[0,1]
  v_pk_fma_f32 v[138:139], v[140:141], v[140:141], v[138:139]
  v_pk_add_f32 v[140:141], v[74:75], v[136:137] neg_lo:[0,1] neg_hi:[0,1]
  v_pk_fma_f32 v[138:139], v[140:141], v[140:141], v[138:139]
  v_pk_add_f32 v[140:141], v[76:77], v[136:137] neg_lo:[0,1] neg_hi:[0,1]
  v_pk_fma_f32 v[138:139], v[140:141], v[140:141], v[138:139]
  v_pk_add_f32 v[140:141], v[78:79], v[136:137] neg_lo:[0,1] neg_hi:[0,1]
  v_pk_fma_f32 v[138:139], v[140:141], v[140:141], v[138:139]
  v_pk_add_f32 v[140:141], v[80:81], v[136:137] neg_lo:[0,1] neg_hi:[0,1]
  v_pk_fma_f32 v[138:139], v[140:141], v[140:141], v[138:139]
  v_pk_add_f32 v[140:141], v[82:83], v[136:137] neg_lo:[0,1] neg_hi:[0,1]
  v_pk_fma_f32 v[138:139], v[140:141], v[140:141], v[138:139]
  v_pk_add_f32 v[140:141], v[84:85], v[136:137] neg_lo:[0,1] neg_hi:[0,1]
  v_pk_fma_f32 v[138:139], v[140:141], v[140:141], v[138:139]
  v_pk_add_f32 v[140:141], v[86:87], v[136:137] neg_lo:[0,1] neg_hi:[0,1]
  v_pk_fma_f32 v[138:139], v[140:141], v[140:141], v[138:139]
  v_pk_add_f32 v[140:141], v[88:89], v[136:137] neg_lo:[0,1] neg_hi:[0,1]
  v_pk_fma_f32 v[138:139], v[140:141], v[140:141], v[138:139]
  v_pk_add_f32 v[140:141], v[90:91], v[136:137] neg_lo:[0,1] neg_hi:[0,1]
  v_pk_fma_f32 v[138:139], v[140:141], v[140:141], v[138:139]
  v_pk_add_f32 v[140:141], v[92:93], v[136:137] neg_lo:[0,1] neg_hi:[0,1]
  v_pk_fma_f32 v[138:139], v[140:141], v[140:141], v[138:139]
  v_pk_add_f32 v[140:141], v[94:95], v[136:137] neg_lo:[0,1] neg_hi:[0,1]
  v_pk_fma_f32 v[138:139], v[140:141], v[140:141], v[138:139]
  v_pk_add_f32 v[140:141], v[96:97], v[136:137] neg_lo:[0,1] neg_hi:[0,1]
  v_pk_fma_f32 v[138:139], v[140:141], v[140:141], v[138:139]
  v_pk_add_f32 v[140:141], v[98:99], v[136:137] neg_lo:[0,1] neg_hi:[0,1]
  v_pk_fma_f32 v[138:139], v[140:141], v[140:141], v[138:139]
  v_pk_add_f32 v[140:141], v[100:101], v[136:137] neg_lo:[0,1] neg_hi:[0,1]
  v_pk_fma_f32 v[138:139], v[140:141], v[140:141], v[138:139]
  v_pk_add_f32 v[140:141], v[102:103], v[136:137] neg_lo:[0,1] neg_hi:[0,1]
  v_pk_fma_f32 v[138:139], v[140:141], v[140:141], v[138:139]
  v_pk_add_f32 v[140:141], v[104:105], v[136:137] neg_lo:[0,1] neg_hi:[0,1]
  v_pk_fma_f32 v[138:139], v[140:141], v[140:141], v[138:139]
  v_pk_add_f32 v[140:141], v[106:107], v[136:137] neg_lo:[0,1] neg_hi:[0,1]
  v_pk_fma_f32 v[138:139], v[140:141], v[140:141], v[138:139]
  v_pk_add_f32 v[140:141], v[108:109], v[136:137] neg_lo:[0,1] neg_hi:[0,1]
  v_pk_fma_f32 v[138:139], v[140:141], v[140:141], v[138:139]
  v_pk_add_f32 v[140:141], v[110:111], v[136:137] neg_lo:[0,1] neg_hi:[0,1]
  v_pk_fma_f32 v[138:139], v[140:141], v[140:141], v[138:139]
  v_pk_add_f32 v[140:141], v[112:113], v[136:137] neg_lo:[0,1] neg_hi:[0,1]
  v_pk_fma_f32 v[138:139], v[140:141], v[140:141], v[138:139]
  v_pk_add_f32 v[140:141], v[114:115], v[136:137] neg_lo:[0,1] neg_hi:[0,1]
  v_pk_fma_f32 v[138:139], v[140:141], v[140:141], v[138:139]
  v_pk_add_f32 v[140:141], v[116:117], v[136:137] neg_lo:[0,1] neg_hi:[0,1]
  v_pk_fma_f32 v[138:139], v[140:141], v[140:141], v[138:139]
  v_pk_add_f32 v[140:141], v[118:119], v[136:137] neg_lo:[0,1] neg_hi:[0,1]
  v_pk_fma_f32 v[138:139], v[140:141], v[140:141], v[138:139]
  v_pk_add_f32 v[140:141], v[120:121], v[136:137] neg_lo:[0,1] neg_hi:[0,1]
  v_pk_fma_f32 v[138:139], v[140:141], v[140:141], v[138:139]
  v_pk_add_f32 v[140:141], v[122:123], v[136:137] neg_lo:[0,1] neg_hi:[0,1]
  v_pk_fma_f32 v[138:139], v[140:141], v[140:141], v[138:139]
  v_pk_add_f32 v[140:141], v[124:125], v[136:137] neg_lo:[0,1] neg_hi:[0,1]
  v_pk_fma_f32 v[138:139], v[140:141], v[140:141], v[138:139]
  v_pk_add_f32 v[140:141], v[126:127], v[136:137] neg_lo:[0,1] neg_hi:[0,1]
  v_pk_fma_f32 v[138:139], v[140:141], v[140:141], v[138:139]
  v_pk_add_f32 v[140:141], v[128:129], v[136:137] neg_lo:[0,1] neg_hi:[0,1]
  v_pk_fma_f32 v[138:139], v[140:141], v[140:141], v[138:139]
  v_pk_add_f32 v[140:141], v[130:131], v[136:137] neg_lo:[0,1] neg_hi:[0,1]
  v_pk_fma_f32 v[138:139], v[140:141], v[140:141], v[138:139]
  v_pk_add_f32 v[140:141], v[132:133], v[136:137] neg_lo:[0,1] neg_hi:[0,1]
  v_pk_fma_f32 v[138:139], v[140:141], v[140:141], v[138:139]
  v_pk_add_f32 v[140:141], v[134:135], v[136:137] neg_lo:[0,1] neg_hi:[0,1]
  v_pk_fma_f32 v[138:139], v[140:141], v[140:141], v[138:139]
  v_add_f32 v138, v138, v139
  s_nop 1
  v_add_f32_dpp v138, v138, v138 quad_perm:[1,0,3,2] row_mask:0xf bank_mask:0xf
  s_nop 1
  v_add_f32_dpp v138, v138, v138 quad_perm:[2,3,0,1] row_mask:0xf bank_mask:0xf
  s_nop 1
  v_add_f32_dpp v138, v138, v138 row_half_mirror row_mask:0xf bank_mask:0xf
  v_mul_f32 v138, 0x3acccccd, v138
  v_cvt_pk_bf16_f32 v138, v138, v138
  v_lshlrev_b32 v138, 16, v138
  v_add_f32 v138, 0x3727c5ac, v138
  v_cvt_pk_bf16_f32 v138, v138, v138
  v_lshlrev_b32 v138, 16, v138
  v_sqrt_f32 v138, v138
  s_nop 0
  v_cvt_pk_bf16_f32 v138, v138, v138
  v_lshlrev_b32 v138, 16, v138
  v_rcp_f32 v138, v138
  v_cvt_pk_bf16_f32 v136, v136, v136
  v_lshlrev_b32 v136, 16, v136
  v_mov_b32 v137, v136
  v_mov_b32 v139, v138
  v_pk_add_f32 v[56:57], v[56:57], v[136:137] neg_lo:[0,1] neg_hi:[0,1]
  v_cvt_pk_bf16_f32 v140, v56, v57
  v_lshlrev_b32 v56, 16, v140
  v_and_b32 v57, 0xffff0000, v140
  v_pk_mul_f32 v[56:57], v[56:57], v[138:139]
  v_cvt_pk_bf16_f32 v16, v56, v57
  v_pk_add_f32 v[58:59], v[58:59], v[136:137] neg_lo:[0,1] neg_hi:[0,1]
  v_cvt_pk_bf16_f32 v140, v58, v59
  v_lshlrev_b32 v58, 16, v140
  v_and_b32 v59, 0xffff0000, v140
  v_pk_mul_f32 v[58:59], v[58:59], v[138:139]
  v_cvt_pk_bf16_f32 v17, v58, v59
  v_pk_add_f32 v[60:61], v[60:61], v[136:137] neg_lo:[0,1] neg_hi:[0,1]
  v_cvt_pk_bf16_f32 v140, v60, v61
  v_lshlrev_b32 v60, 16, v140
  v_and_b32 v61, 0xffff0000, v140
  v_pk_mul_f32 v[60:61], v[60:61], v[138:139]
  v_cvt_pk_bf16_f32 v18, v60, v61
  v_pk_add_f32 v[62:63], v[62:63], v[136:137] neg_lo:[0,1] neg_hi:[0,1]
  v_cvt_pk_bf16_f32 v140, v62, v63
  v_lshlrev_b32 v62, 16, v140
  v_and_b32 v63, 0xffff0000, v140
  v_pk_mul_f32 v[62:63], v[62:63], v[138:139]
  v_cvt_pk_bf16_f32 v19, v62, v63
  v_pk_add_f32 v[64:65], v[64:65], v[136:137] neg_lo:[0,1] neg_hi:[0,1]
  v_cvt_pk_bf16_f32 v140, v64, v65
  v_lshlrev_b32 v64, 16, v140
  v_and_b32 v65, 0xffff0000, v140
  v_pk_mul_f32 v[64:65], v[64:65], v[138:139]
  v_cvt_pk_bf16_f32 v20, v64, v65
  v_pk_add_f32 v[66:67], v[66:67], v[136:137] neg_lo:[0,1] neg_hi:[0,1]
  v_cvt_pk_bf16_f32 v140, v66, v67
  v_lshlrev_b32 v66, 16, v140
  v_and_b32 v67, 0xffff0000, v140
  v_pk_mul_f32 v[66:67], v[66:67], v[138:139]
  v_cvt_pk_bf16_f32 v21, v66, v67
  v_pk_add_f32 v[68:69], v[68:69], v[136:137] neg_lo:[0,1] neg_hi:[0,1]
  v_cvt_pk_bf16_f32 v140, v68, v69
  v_lshlrev_b32 v68, 16, v140
  v_and_b32 v69, 0xffff0000, v140
  v_pk_mul_f32 v[68:69], v[68:69], v[138:139]
  v_cvt_pk_bf16_f32 v22, v68, v69
  v_pk_add_f32 v[70:71], v[70:71], v[136:137] neg_lo:[0,1] neg_hi:[0,1]
  v_cvt_pk_bf16_f32 v140, v70, v71
  v_lshlrev_b32 v70, 16, v140
  v_and_b32 v71, 0xffff0000, v140
  v_pk_mul_f32 v[70:71], v[70:71], v[138:139]
  v_cvt_pk_bf16_f32 v23, v70, v71
  v_pk_add_f32 v[72:73], v[72:73], v[136:137] neg_lo:[0,1] neg_hi:[0,1]
  v_cvt_pk_bf16_f32 v140, v72, v73
  v_lshlrev_b32 v72, 16, v140
  v_and_b32 v73, 0xffff0000, v140
  v_pk_mul_f32 v[72:73], v[72:73], v[138:139]
  v_cvt_pk_bf16_f32 v24, v72, v73
  v_pk_add_f32 v[74:75], v[74:75], v[136:137] neg_lo:[0,1] neg_hi:[0,1]
  v_cvt_pk_bf16_f32 v140, v74, v75
  v_lshlrev_b32 v74, 16, v140
  v_and_b32 v75, 0xffff0000, v140
  v_pk_mul_f32 v[74:75], v[74:75], v[138:139]
  v_cvt_pk_bf16_f32 v25, v74, v75
  v_pk_add_f32 v[76:77], v[76:77], v[136:137] neg_lo:[0,1] neg_hi:[0,1]
  v_cvt_pk_bf16_f32 v140, v76, v77
  v_lshlrev_b32 v76, 16, v140
  v_and_b32 v77, 0xffff0000, v140
  v_pk_mul_f32 v[76:77], v[76:77], v[138:139]
  v_cvt_pk_bf16_f32 v26, v76, v77
  v_pk_add_f32 v[78:79], v[78:79], v[136:137] neg_lo:[0,1] neg_hi:[0,1]
  v_cvt_pk_bf16_f32 v140, v78, v79
  v_lshlrev_b32 v78, 16, v140
  v_and_b32 v79, 0xffff0000, v140
  v_pk_mul_f32 v[78:79], v[78:79], v[138:139]
  v_cvt_pk_bf16_f32 v27, v78, v79
  v_pk_add_f32 v[80:81], v[80:81], v[136:137] neg_lo:[0,1] neg_hi:[0,1]
  v_cvt_pk_bf16_f32 v140, v80, v81
  v_lshlrev_b32 v80, 16, v140
  v_and_b32 v81, 0xffff0000, v140
  v_pk_mul_f32 v[80:81], v[80:81], v[138:139]
  v_cvt_pk_bf16_f32 v28, v80, v81
  v_pk_add_f32 v[82:83], v[82:83], v[136:137] neg_lo:[0,1] neg_hi:[0,1]
  v_cvt_pk_bf16_f32 v140, v82, v83
  v_lshlrev_b32 v82, 16, v140
  v_and_b32 v83, 0xffff0000, v140
  v_pk_mul_f32 v[82:83], v[82:83], v[138:139]
  v_cvt_pk_bf16_f32 v29, v82, v83
  v_pk_add_f32 v[84:85], v[84:85], v[136:137] neg_lo:[0,1] neg_hi:[0,1]
  v_cvt_pk_bf16_f32 v140, v84, v85
  v_lshlrev_b32 v84, 16, v140
  v_and_b32 v85, 0xffff0000, v140
  v_pk_mul_f32 v[84:85], v[84:85], v[138:139]
  v_cvt_pk_bf16_f32 v30, v84, v85
  v_pk_add_f32 v[86:87], v[86:87], v[136:137] neg_lo:[0,1] neg_hi:[0,1]
  v_cvt_pk_bf16_f32 v140, v86, v87
  v_lshlrev_b32 v86, 16, v140
  v_and_b32 v87, 0xffff0000, v140
  v_pk_mul_f32 v[86:87], v[86:87], v[138:139]
  v_cvt_pk_bf16_f32 v31, v86, v87
  v_pk_add_f32 v[88:89], v[88:89], v[136:137] neg_lo:[0,1] neg_hi:[0,1]
  v_cvt_pk_bf16_f32 v140, v88, v89
  v_lshlrev_b32 v88, 16, v140
  v_and_b32 v89, 0xffff0000, v140
  v_pk_mul_f32 v[88:89], v[88:89], v[138:139]
  v_cvt_pk_bf16_f32 v32, v88, v89
  v_pk_add_f32 v[90:91], v[90:91], v[136:137] neg_lo:[0,1] neg_hi:[0,1]
  v_cvt_pk_bf16_f32 v140, v90, v91
  v_lshlrev_b32 v90, 16, v140
  v_and_b32 v91, 0xffff0000, v140
  v_pk_mul_f32 v[90:91], v[90:91], v[138:139]
  v_cvt_pk_bf16_f32 v33, v90, v91
  v_pk_add_f32 v[92:93], v[92:93], v[136:137] neg_lo:[0,1] neg_hi:[0,1]
  v_cvt_pk_bf16_f32 v140, v92, v93
  v_lshlrev_b32 v92, 16, v140
  v_and_b32 v93, 0xffff0000, v140
  v_pk_mul_f32 v[92:93], v[92:93], v[138:139]
  v_cvt_pk_bf16_f32 v34, v92, v93
  v_pk_add_f32 v[94:95], v[94:95], v[136:137] neg_lo:[0,1] neg_hi:[0,1]
  v_cvt_pk_bf16_f32 v140, v94, v95
  v_lshlrev_b32 v94, 16, v140
  v_and_b32 v95, 0xffff0000, v140
  v_pk_mul_f32 v[94:95], v[94:95], v[138:139]
  v_cvt_pk_bf16_f32 v35, v94, v95
  v_pk_add_f32 v[96:97], v[96:97], v[136:137] neg_lo:[0,1] neg_hi:[0,1]
  v_cvt_pk_bf16_f32 v140, v96, v97
  v_lshlrev_b32 v96, 16, v140
  v_and_b32 v97, 0xffff0000, v140
  v_pk_mul_f32 v[96:97], v[96:97], v[138:139]
  v_cvt_pk_bf16_f32 v36, v96, v97
  v_pk_add_f32 v[98:99], v[98:99], v[136:137] neg_lo:[0,1] neg_hi:[0,1]
  v_cvt_pk_bf16_f32 v140, v98, v99
  v_lshlrev_b32 v98, 16, v140
  v_and_b32 v99, 0xffff0000, v140
  v_pk_mul_f32 v[98:99], v[98:99], v[138:139]
  v_cvt_pk_bf16_f32 v37, v98, v99
  v_pk_add_f32 v[100:101], v[100:101], v[136:137] neg_lo:[0,1] neg_hi:[0,1]
  v_cvt_pk_bf16_f32 v140, v100, v101
  v_lshlrev_b32 v100, 16, v140
  v_and_b32 v101, 0xffff0000, v140
  v_pk_mul_f32 v[100:101], v[100:101], v[138:139]
  v_cvt_pk_bf16_f32 v38, v100, v101
  v_pk_add_f32 v[102:103], v[102:103], v[136:137] neg_lo:[0,1] neg_hi:[0,1]
  v_cvt_pk_bf16_f32 v140, v102, v103
  v_lshlrev_b32 v102, 16, v140
  v_and_b32 v103, 0xffff0000, v140
  v_pk_mul_f32 v[102:103], v[102:103], v[138:139]
  v_cvt_pk_bf16_f32 v39, v102, v103
  v_pk_add_f32 v[104:105], v[104:105], v[136:137] neg_lo:[0,1] neg_hi:[0,1]
  v_cvt_pk_bf16_f32 v140, v104, v105
  v_lshlrev_b32 v104, 16, v140
  v_and_b32 v105, 0xffff0000, v140
  v_pk_mul_f32 v[104:105], v[104:105], v[138:139]
  v_cvt_pk_bf16_f32 v40, v104, v105
  v_pk_add_f32 v[106:107], v[106:107], v[136:137] neg_lo:[0,1] neg_hi:[0,1]
  v_cvt_pk_bf16_f32 v140, v106, v107
  v_lshlrev_b32 v106, 16, v140
  v_and_b32 v107, 0xffff0000, v140
  v_pk_mul_f32 v[106:107], v[106:107], v[138:139]
  v_cvt_pk_bf16_f32 v41, v106, v107
  v_pk_add_f32 v[108:109], v[108:109], v[136:137] neg_lo:[0,1] neg_hi:[0,1]
  v_cvt_pk_bf16_f32 v140, v108, v109
  v_lshlrev_b32 v108, 16, v140
  v_and_b32 v109, 0xffff0000, v140
  v_pk_mul_f32 v[108:109], v[108:109], v[138:139]
  v_cvt_pk_bf16_f32 v42, v108, v109
  v_pk_add_f32 v[110:111], v[110:111], v[136:137] neg_lo:[0,1] neg_hi:[0,1]
  v_cvt_pk_bf16_f32 v140, v110, v111
  v_lshlrev_b32 v110, 16, v140
  v_and_b32 v111, 0xffff0000, v140
  v_pk_mul_f32 v[110:111], v[110:111], v[138:139]
  v_cvt_pk_bf16_f32 v43, v110, v111
  v_pk_add_f32 v[112:113], v[112:113], v[136:137] neg_lo:[0,1] neg_hi:[0,1]
  v_cvt_pk_bf16_f32 v140, v112, v113
  v_lshlrev_b32 v112, 16, v140
  v_and_b32 v113, 0xffff0000, v140
  v_pk_mul_f32 v[112:113], v[112:113], v[138:139]
  v_cvt_pk_bf16_f32 v44, v112, v113
  v_pk_add_f32 v[114:115], v[114:115], v[136:137] neg_lo:[0,1] neg_hi:[0,1]
  v_cvt_pk_bf16_f32 v140, v114, v115
  v_lshlrev_b32 v114, 16, v140
  v_and_b32 v115, 0xffff0000, v140
  v_pk_mul_f32 v[114:115], v[114:115], v[138:139]
  v_cvt_pk_bf16_f32 v45, v114, v115
  v_pk_add_f32 v[116:117], v[116:117], v[136:137] neg_lo:[0,1] neg_hi:[0,1]
  v_cvt_pk_bf16_f32 v140, v116, v117
  v_lshlrev_b32 v116, 16, v140
  v_and_b32 v117, 0xffff0000, v140
  v_pk_mul_f32 v[116:117], v[116:117], v[138:139]
  v_cvt_pk_bf16_f32 v46, v116, v117
  v_pk_add_f32 v[118:119], v[118:119], v[136:137] neg_lo:[0,1] neg_hi:[0,1]
  v_cvt_pk_bf16_f32 v140, v118, v119
  v_lshlrev_b32 v118, 16, v140
  v_and_b32 v119, 0xffff0000, v140
  v_pk_mul_f32 v[118:119], v[118:119], v[138:139]
  v_cvt_pk_bf16_f32 v47, v118, v119
  v_pk_add_f32 v[120:121], v[120:121], v[136:137] neg_lo:[0,1] neg_hi:[0,1]
  v_cvt_pk_bf16_f32 v140, v120, v121
  v_lshlrev_b32 v120, 16, v140
  v_and_b32 v121, 0xffff0000, v140
  v_pk_mul_f32 v[120:121], v[120:121], v[138:139]
  v_cvt_pk_bf16_f32 v48, v120, v121
  v_pk_add_f32 v[122:123], v[122:123], v[136:137] neg_lo:[0,1] neg_hi:[0,1]
  v_cvt_pk_bf16_f32 v140, v122, v123
  v_lshlrev_b32 v122, 16, v140
  v_and_b32 v123, 0xffff0000, v140
  v_pk_mul_f32 v[122:123], v[122:123], v[138:139]
  v_cvt_pk_bf16_f32 v49, v122, v123
  v_pk_add_f32 v[124:125], v[124:125], v[136:137] neg_lo:[0,1] neg_hi:[0,1]
  v_cvt_pk_bf16_f32 v140, v124, v125
  v_lshlrev_b32 v124, 16, v140
  v_and_b32 v125, 0xffff0000, v140
  v_pk_mul_f32 v[124:125], v[124:125], v[138:139]
  v_cvt_pk_bf16_f32 v50, v124, v125
  v_pk_add_f32 v[126:127], v[126:127], v[136:137] neg_lo:[0,1] neg_hi:[0,1]
  v_cvt_pk_bf16_f32 v140, v126, v127
  v_lshlrev_b32 v126, 16, v140
  v_and_b32 v127, 0xffff0000, v140
  v_pk_mul_f32 v[126:127], v[126:127], v[138:139]
  v_cvt_pk_bf16_f32 v51, v126, v127
  v_pk_add_f32 v[128:129], v[128:129], v[136:137] neg_lo:[0,1] neg_hi:[0,1]
  v_cvt_pk_bf16_f32 v140, v128, v129
  v_lshlrev_b32 v128, 16, v140
  v_and_b32 v129, 0xffff0000, v140
  v_pk_mul_f32 v[128:129], v[128:129], v[138:139]
  v_cvt_pk_bf16_f32 v52, v128, v129
  v_pk_add_f32 v[130:131], v[130:131], v[136:137] neg_lo:[0,1] neg_hi:[0,1]
  v_cvt_pk_bf16_f32 v140, v130, v131
  v_lshlrev_b32 v130, 16, v140
  v_and_b32 v131, 0xffff0000, v140
  v_pk_mul_f32 v[130:131], v[130:131], v[138:139]
  v_cvt_pk_bf16_f32 v53, v130, v131
  v_pk_add_f32 v[132:133], v[132:133], v[136:137] neg_lo:[0,1] neg_hi:[0,1]
  v_cvt_pk_bf16_f32 v140, v132, v133
  v_lshlrev_b32 v132, 16, v140
  v_and_b32 v133, 0xffff0000, v140
  v_pk_mul_f32 v[132:133], v[132:133], v[138:139]
  v_cvt_pk_bf16_f32 v54, v132, v133
  v_pk_add_f32 v[134:135], v[134:135], v[136:137] neg_lo:[0,1] neg_hi:[0,1]
  v_cvt_pk_bf16_f32 v140, v134, v135
  v_lshlrev_b32 v134, 16, v140
  v_and_b32 v135, 0xffff0000, v140
  v_pk_mul_f32 v[134:135], v[134:135], v[138:139]
  v_cvt_pk_bf16_f32 v55, v134, v135
  s_add_u32 s39, s38, 1048576
  buffer_store_dwordx4 v[16:19], v5, s[4:7], s39 offen sc1
  s_add_u32 s39, s39, 4096
  buffer_store_dwordx4 v[20:23], v5, s[4:7], s39 offen sc1
  s_add_u32 s39, s39, 4096
  buffer_store_dwordx4 v[24:27], v5, s[4:7], s39 offen sc1
  s_add_u32 s39, s39, 4096
  buffer_store_dwordx4 v[28:31], v5, s[4:7], s39 offen sc1
  s_add_u32 s39, s39, 4096
  buffer_store_dwordx4 v[32:35], v5, s[4:7], s39 offen sc1
  s_add_u32 s39, s39, 4096
  buffer_store_dwordx4 v[36:39], v5, s[4:7], s39 offen sc1
  s_add_u32 s39, s39, 4096
  buffer_store_dwordx4 v[40:43], v5, s[4:7], s39 offen sc1
  s_add_u32 s39, s39, 4096
  buffer_store_dwordx4 v[44:47], v5, s[4:7], s39 offen sc1
  s_add_u32 s39, s39, 4096
  buffer_store_dwordx4 v[48:51], v5, s[4:7], s39 offen sc1
  s_add_u32 s39, s39, 4096
  buffer_store_dwordx4 v[52:55], v5, s[4:7], s39 offen sc1
  s_add_u32 s39, s39, 4096
  v_lshlrev_b32 v56, 16, v16
  v_and_b32 v57, 0xffff0000, v16
  v_lshlrev_b32 v58, 16, v17
  v_and_b32 v59, 0xffff0000, v17
  v_lshlrev_b32 v60, 16, v18
  v_and_b32 v61, 0xffff0000, v18
  v_lshlrev_b32 v62, 16, v19
  v_and_b32 v63, 0xffff0000, v19
  v_lshlrev_b32 v64, 16, v20
  v_and_b32 v65, 0xffff0000, v20
  v_lshlrev_b32 v66, 16, v21
  v_and_b32 v67, 0xffff0000, v21
  v_lshlrev_b32 v68, 16, v22
  v_and_b32 v69, 0xffff0000, v22
  v_lshlrev_b32 v70, 16, v23
  v_and_b32 v71, 0xffff0000, v23
  v_lshlrev_b32 v72, 16, v24
  v_and_b32 v73, 0xffff0000, v24
  v_lshlrev_b32 v74, 16, v25
  v_and_b32 v75, 0xffff0000, v25
  v_lshlrev_b32 v76, 16, v26
  v_and_b32 v77, 0xffff0000, v26
  v_lshlrev_b32 v78, 16, v27
  v_and_b32 v79, 0xffff0000, v27
  v_lshlrev_b32 v80, 16, v28
  v_and_b32 v81, 0xffff0000, v28
  v_lshlrev_b32 v82, 16, v29
  v_and_b32 v83, 0xffff0000, v29
  v_lshlrev_b32 v84, 16, v30
  v_and_b32 v85, 0xffff0000, v30
  v_lshlrev_b32 v86, 16, v31
  v_and_b32 v87, 0xffff0000, v31
  v_lshlrev_b32 v88, 16, v32
  v_and_b32 v89, 0xffff0000, v32
  v_lshlrev_b32 v90, 16, v33
  v_and_b32 v91, 0xffff0000, v33
  v_lshlrev_b32 v92, 16, v34
  v_and_b32 v93, 0xffff0000, v34
  v_lshlrev_b32 v94, 16, v35
  v_and_b32 v95, 0xffff0000, v35
  v_lshlrev_b32 v96, 16, v36
  v_and_b32 v97, 0xffff0000, v36
  v_lshlrev_b32 v98, 16, v37
  v_and_b32 v99, 0xffff0000, v37
  v_lshlrev_b32 v100, 16, v38
  v_and_b32 v101, 0xffff0000, v38
  v_lshlrev_b32 v102, 16, v39
  v_and_b32 v103, 0xffff0000, v39
  v_lshlrev_b32 v104, 16, v40
  v_and_b32 v105, 0xffff0000, v40
  v_lshlrev_b32 v106, 16, v41
  v_and_b32 v107, 0xffff0000, v41
  v_lshlrev_b32 v108, 16, v42
  v_and_b32 v109, 0xffff0000, v42
  v_lshlrev_b32 v110, 16, v43
  v_and_b32 v111, 0xffff0000, v43
  v_lshlrev_b32 v112, 16, v44
  v_and_b32 v113, 0xffff0000, v44
  v_lshlrev_b32 v114, 16, v45
  v_and_b32 v115, 0xffff0000, v45
  v_lshlrev_b32 v116, 16, v46
  v_and_b32 v117, 0xffff0000, v46
  v_lshlrev_b32 v118, 16, v47
  v_and_b32 v119, 0xffff0000, v47
  v_lshlrev_b32 v120, 16, v48
  v_and_b32 v121, 0xffff0000, v48
  v_lshlrev_b32 v122, 16, v49
  v_and_b32 v123, 0xffff0000, v49
  v_lshlrev_b32 v124, 16, v50
  v_and_b32 v125, 0xffff0000, v50
  v_lshlrev_b32 v126, 16, v51
  v_and_b32 v127, 0xffff0000, v51
  v_lshlrev_b32 v128, 16, v52
  v_and_b32 v129, 0xffff0000, v52
  v_lshlrev_b32 v130, 16, v53
  v_and_b32 v131, 0xffff0000, v53
  v_lshlrev_b32 v132, 16, v54
  v_and_b32 v133, 0xffff0000, v54
  v_lshlrev_b32 v134, 16, v55
  v_and_b32 v135, 0xffff0000, v55
  s_cmp_lg_u32 s34, 0
  s_cbranch_scc1 L_verd_65
  s_cmp_eq_u32 s101, 0
  s_cbranch_scc1 L_sig_68
  s_mov_b32 s101, 0
  s_waitcnt vmcnt(0)
  s_mov_b64 exec, 1
  v_mov_b32 v0, 1
  buffer_atomic_add v0, off, s[8:11], 0 offset:32
  s_mov_b64 exec, -1
L_sig_68:
  v_lshlrev_b32 v2, 2, v1
L_ver_64:
  buffer_load_dword v3, v2, s[8:11], 0 offen sc1
  s_waitcnt vmcnt(0)
  v_readlane_b32 s3, v3, 8
  s_nop 0
  s_cmp_eq_u32 s3, 32
  s_cbranch_scc0 L_verf_67
  v_readlane_b32 s3, v3, 0
  v_readlane_b32 vcc_lo, v3, 1
  s_nop 0
  s_add_u32 s3, s3, vcc_lo
  v_readlane_b32 vcc_lo, v3, 34
  s_nop 0
  s_add_u32 s3, s3, vcc_lo
  v_readlane_b32 vcc_lo, v3, 35
  s_nop 0
  s_add_u32 s3, s3, vcc_lo
  v_readlane_b32 vcc_lo, v3, 36
  s_nop 0
  s_add_u32 s3, s3, vcc_lo
  v_readlane_b32 vcc_lo, v3, 37
  s_nop 0
  s_add_u32 s3, s3, vcc_lo
  v_readlane_b32 vcc_lo, v3, 38
  s_nop 0
  s_add_u32 s3, s3, vcc_lo
  v_readlane_b32 vcc_lo, v3, 39
  s_nop 0
  s_add_u32 s3, s3, vcc_lo
  s_cmp_eq_u32 s3, 0x100
  s_cbranch_scc1 L_verr_66
L_verf_67:
  s_sleep 2
  s_sub_u32 s29, s29, 1
  s_cbranch_scc0 L_ver_64
  s_branch L_end
L_verr_66:
  s_mov_b32 s34, 1
  v_cmp_ne_u32 vcc, 32, v3
  s_nop 4
  s_and_b32 vcc_lo, vcc_lo, 3
  s_and_b32 vcc_hi, vcc_hi, 0xfc
  s_cbranch_vccz L_verd_65
  s_mov_b32 s32, s31
  s_mov_b32 s33, 1
  v_readlane_b32 s3, v3, 0
  s_nop 0
  s_cmp_gt_u32 s30, 0
  s_cselect_b32 s3, s3, 0
  s_add_u32 s32, s32, s3
  v_readlane_b32 s3, v3, 1
  s_nop 0
  s_cmp_gt_u32 s30, 1
  s_cselect_b32 s3, s3, 0
  s_add_u32 s32, s32, s3
  v_readlane_b32 s3, v3, 34
  s_nop 0
  s_cmp_gt_u32 s30, 2
  s_cselect_b32 s3, s3, 0
  s_add_u32 s32, s32, s3
  v_readlane_b32 s3, v3, 35
  s_nop 0
  s_cmp_gt_u32 s30, 3
  s_cselect_b32 s3, s3, 0
  s_add_u32 s32, s32, s3
  v_readlane_b32 s3, v3, 36
  s_nop 0
  s_cmp_gt_u32 s30, 4
  s_cselect_b32 s3, s3, 0
  s_add_u32 s32, s32, s3
  v_readlane_b32 s3, v3, 37
  s_nop 0
  s_cmp_gt_u32 s30, 5
  s_cselect_b32 s3, s3, 0
  s_add_u32 s32, s32, s3
  v_readlane_b32 s3, v3, 38
  s_nop 0
  s_cmp_gt_u32 s30, 6
  s_cselect_b32 s3, s3, 0
  s_add_u32 s32, s32, s3
  s_branch L_restart
L_verd_65:
  s_waitcnt vmcnt(0)
  s_barrier
  s_cmp_lg_u32 s28, 0
  s_cbranch_scc1 L_ln_nf0
  s_lshl_b32 s3, s50, 2
  s_add_u32 s3, s3, 180224
  v_mov_b32 v2, 1
  s_mov_b64 exec, 1
  buffer_store_dword v2, off, s[4:7], s3 sc1
  s_mov_b64 exec, -1
L_ln_nf0:
  v_pk_add_f32 v[136:137], v[56:57], v[58:59]
  v_pk_add_f32 v[136:137], v[136:137], v[60:61]
  v_pk_add_f32 v[136:137], v[136:137], v[62:63]
  v_pk_add_f32 v[136:137], v[136:137], v[64:65]
  v_pk_add_f32 v[136:137], v[136:137], v[66:67]
  v_pk_add_f32 v[136:137], v[136:137], v[68:69]
  v_pk_add_f32 v[136:137], v[136:137], v[70:71]
  v_pk_add_f32 v[136:137], v[136:137], v[72:73]
  v_pk_add_f32 v[136:137], v[136:137], v[74:75]
  v_pk_add_f32 v[136:137], v[136:137], v[76:77]
  v_pk_add_f32 v[136:137], v[136:137], v[78:79]
  v_pk_add_f32 v[136:137], v[136:137], v[80:81]
  v_pk_add_f32 v[136:137], v[136:137], v[82:83]
  v_pk_add_f32 v[136:137], v[136:137], v[84:85]
  v_pk_add_f32 v[136:137], v[136:137], v[86:87]
  v_pk_add_f32 v[136:137], v[136:137], v[88:89]
  v_pk_add_f32 v[136:137], v[136:137], v[90:91]
  v_pk_add_f32 v[136:137], v[136:137], v[92:93]
  v_pk_add_f32 v[136:137], v[136:137], v[94:95]
  v_pk_add_f32 v[136:137], v[136:137], v[96:97]
  v_pk_add_f32 v[136:137], v[136:137], v[98:99]
  v_pk_add_f32 v[136:137], v[136:137], v[100:101]
  v_pk_add_f32 v[136:137], v[136:137], v[102:103]
  v_pk_add_f32 v[136:137], v[136:137], v[104:105]
  v_pk_add_f32 v[136:137], v[136:137], v[106:107]
  v_pk_add_f32 v[136:137], v[136:137], v[108:109]
  v_pk_add_f32 v[136:137], v[136:137], v[110:111]
  v_pk_add_f32 v[136:137], v[136:137], v[112:113]
  v_pk_add_f32 v[136:137], v[136:137], v[114:115]
  v_pk_add_f32 v[136:137], v[136:137], v[116:117]
  v_pk_add_f32 v[136:137], v[136:137], v[118:119]
  v_pk_add_f32 v[136:137], v[136:137], v[120:121]
  v_pk_add_f32 v[136:137], v[136:137], v[122:123]
  v_pk_add_f32 v[136:137], v[136:137], v[124:125]
  v_pk_add_f32 v[136:137], v[136:137], v[126:127]
  v_pk_add_f32 v[136:137], v[136:137], v[128:129]
  v_pk_add_f32 v[136:137], v[136:137], v[130:131]
  v_pk_add_f32 v[136:137], v[136:137], v[132:133]
  v_pk_add_f32 v[136:137], v[136:137], v[134:135]
  v_add_f32 v136, v136, v137
  s_nop 1
  v_add_f32_dpp v136, v136, v136 quad_perm:[1,0,3,2] row_mask:0xf bank_mask:0xf
  s_nop 1
  v_add_f32_dpp v136, v136, v136 quad_perm:[2,3,0,1] row_mask:0xf bank_mask:0xf
  s_nop 1
  v_add_f32_dpp v136, v136, v136 row_half_mirror row_mask:0xf bank_mask:0xf
  v_mul_f32 v136, 0x3acccccd, v136
  v_mov_b32 v137, v136
  v_pk_add_f32 v[140:141], v[56:57], v[136:137] neg_lo:[0,1] neg_hi:[0,1]
  v_pk_mul_f32 v[138:139], v[140:141], v[140:141]
  v_pk_add_f32 v[140:141], v[58:59], v[136:137] neg_lo:[0,1] neg_hi:[0,1]
  v_pk_fma_f32 v[138:139], v[140:141], v[140:141], v[138:139]
  v_pk_add_f32 v[140:141], v[60:61], v[136:137] neg_lo:[0,1] neg_hi:[0,1]
  v_pk_fma_f32 v[138:139], v[140:141], v[140:141], v[138:139]
  v_pk_add_f32 v[140:141], v[62:63], v[136:137] neg_lo:[0,1] neg_hi:[0,1]
  v_pk_fma_f32 v[138:139], v[140:141], v[140:141], v[138:139]
  v_pk_add_f32 v[140:141], v[64:65], v[136:137] neg_lo:[0,1] neg_hi:[0,1]
  v_pk_fma_f32 v[138:139], v[140:141], v[140:141], v[138:139]
  v_pk_add_f32 v[140:141], v[66:67], v[136:137] neg_lo:[0,1] neg_hi:[0,1]
  v_pk_fma_f32 v[138:139], v[140:141], v[140:141], v[138:139]
  v_pk_add_f32 v[140:141], v[68:69], v[136:137] neg_lo:[0,1] neg_hi:[0,1]
  v_pk_fma_f32 v[138:139], v[140:141], v[140:141], v[138:139]
  v_pk_add_f32 v[140:141], v[70:71], v[136:137] neg_lo:[0,1] neg_hi:[0,1]
  v_pk_fma_f32 v[138:139], v[140:141], v[140:141], v[138:139]
  v_pk_add_f32 v[140:141], v[72:73], v[136:137] neg_lo:[0,1] neg_hi:[0,1]
  v_pk_fma_f32 v[138:139], v[140:141], v[140:141], v[138:139]
  v_pk_add_f32 v[140:141], v[74:75], v[136:137] neg_lo:[0,1] neg_hi:[0,1]
  v_pk_fma_f32 v[138:139], v[140:141], v[140:141], v[138:139]
  v_pk_add_f32 v[140:141], v[76:77], v[136:137] neg_lo:[0,1] neg_hi:[0,1]
  v_pk_fma_f32 v[138:139], v[140:141], v[140:141], v[138:139]
  v_pk_add_f32 v[140:141], v[78:79], v[136:137] neg_lo:[0,1] neg_hi:[0,1]
  v_pk_fma_f32 v[138:139], v[140:141], v[140:141], v[138:139]
  v_pk_add_f32 v[140:141], v[80:81], v[136:137] neg_lo:[0,1] neg_hi:[0,1]
  v_pk_fma_f32 v[138:139], v[140:141], v[140:141], v[138:139]
  v_pk_add_f32 v[140:141], v[82:83], v[136:137] neg_lo:[0,1] neg_hi:[0,1]
  v_pk_fma_f32 v[138:139], v[140:141], v[140:141], v[138:139]
  v_pk_add_f32 v[140:141], v[84:85], v[136:137] neg_lo:[0,1] neg_hi:[0,1]
  v_pk_fma_f32 v[138:139], v[140:141], v[140:141], v[138:139]
  v_pk_add_f32 v[140:141], v[86:87], v[136:137] neg_lo:[0,1] neg_hi:[0,1]
  v_pk_fma_f32 v[138:139], v[140:141], v[140:141], v[138:139]
  v_pk_add_f32 v[140:141], v[88:89], v[136:137] neg_lo:[0,1] neg_hi:[0,1]
  v_pk_fma_f32 v[138:139], v[140:141], v[140:141], v[138:139]
  v_pk_add_f32 v[140:141], v[90:91], v[136:137] neg_lo:[0,1] neg_hi:[0,1]
  v_pk_fma_f32 v[138:139], v[140:141], v[140:141], v[138:139]
  v_pk_add_f32 v[140:141], v[92:93], v[136:137] neg_lo:[0,1] neg_hi:[0,1]
  v_pk_fma_f32 v[138:139], v[140:141], v[140:141], v[138:139]
  v_pk_add_f32 v[140:141], v[94:95], v[136:137] neg_lo:[0,1] neg_hi:[0,1]
  v_pk_fma_f32 v[138:139], v[140:141], v[140:141], v[138:139]
  v_pk_add_f32 v[140:141], v[96:97], v[136:137] neg_lo:[0,1] neg_hi:[0,1]
  v_pk_fma_f32 v[138:139], v[140:141], v[140:141], v[138:139]
  v_pk_add_f32 v[140:141], v[98:99], v[136:137] neg_lo:[0,1] neg_hi:[0,1]
  v_pk_fma_f32 v[138:139], v[140:141], v[140:141], v[138:139]
  v_pk_add_f32 v[140:141], v[100:101], v[136:137] neg_lo:[0,1] neg_hi:[0,1]
  v_pk_fma_f32 v[138:139], v[140:141], v[140:141], v[138:139]
  v_pk_add_f32 v[140:141], v[102:103], v[136:137] neg_lo:[0,1] neg_hi:[0,1]
  v_pk_fma_f32 v[138:139], v[140:141], v[140:141], v[138:139]
  v_pk_add_f32 v[140:141], v[104:105], v[136:137] neg_lo:[0,1] neg_hi:[0,1]
  v_pk_fma_f32 v[138:139], v[140:141], v[140:141], v[138:139]
  v_pk_add_f32 v[140:141], v[106:107], v[136:137] neg_lo:[0,1] neg_hi:[0,1]
  v_pk_fma_f32 v[138:139], v[140:141], v[140:141], v[138:139]
  v_pk_add_f32 v[140:141], v[108:109], v[136:137] neg_lo:[0,1] neg_hi:[0,1]
  v_pk_fma_f32 v[138:139], v[140:141], v[140:141], v[138:139]
  v_pk_add_f32 v[140:141], v[110:111], v[136:137] neg_lo:[0,1] neg_hi:[0,1]
  v_pk_fma_f32 v[138:139], v[140:141], v[140:141], v[138:139]
  v_pk_add_f32 v[140:141], v[112:113], v[136:137] neg_lo:[0,1] neg_hi:[0,1]
  v_pk_fma_f32 v[138:139], v[140:141], v[140:141], v[138:139]
  v_pk_add_f32 v[140:141], v[114:115], v[136:137] neg_lo:[0,1] neg_hi:[0,1]
  v_pk_fma_f32 v[138:139], v[140:141], v[140:141], v[138:139]
  v_pk_add_f32 v[140:141], v[116:117], v[136:137] neg_lo:[0,1] neg_hi:[0,1]
  v_pk_fma_f32 v[138:139], v[140:141], v[140:141], v[138:139]
  v_pk_add_f32 v[140:141], v[118:119], v[136:137] neg_lo:[0,1] neg_hi:[0,1]
  v_pk_fma_f32 v[138:139], v[140:141], v[140:141], v[138:139]
  v_pk_add_f32 v[140:141], v[120:121], v[136:137] neg_lo:[0,1] neg_hi:[0,1]
  v_pk_fma_f32 v[138:139], v[140:141], v[140:141], v[138:139]
  v_pk_add_f32 v[140:141], v[122:123], v[136:137] neg_lo:[0,1] neg_hi:[0,1]
  v_pk_fma_f32 v[138:139], v[140:141], v[140:141], v[138:139]
  v_pk_add_f32 v[140:141], v[124:125], v[136:137] neg_lo:[0,1] neg_hi:[0,1]
  v_pk_fma_f32 v[138:139], v[140:141], v[140:141], v[138:139]
  v_pk_add_f32 v[140:141], v[126:127], v[136:137] neg_lo:[0,1] neg_hi:[0,1]
  v_pk_fma_f32 v[138:139], v[140:141], v[140:141], v[138:139]
  v_pk_add_f32 v[140:141], v[128:129], v[136:137] neg_lo:[0,1] neg_hi:[0,1]
  v_pk_fma_f32 v[138:139], v[140:141], v[140:141], v[138:139]
  v_pk_add_f32 v[140:141], v[130:131], v[136:137] neg_lo:[0,1] neg_hi:[0,1]
  v_pk_fma_f32 v[138:139], v[140:141], v[140:141], v[138:139]
  v_pk_add_f32 v[140:141], v[132:133], v[136:137] neg_lo:[0,1] neg_hi:[0,1]
  v_pk_fma_f32 v[138:139], v[140:141], v[140:141], v[138:139]
  v_pk_add_f32 v[140:141], v[134:135], v[136:137] neg_lo:[0,1] neg_hi:[0,1]
  v_pk_fma_f32 v[138:139], v[140:141], v[140:141], v[138:139]
  v_add_f32 v138, v138, v139
  s_nop 1
  v_add_f32_dpp v138, v138, v138 quad_perm:[1,0,3,2] row_mask:0xf bank_mask:0xf
  s_nop 1
  v_add_f32_dpp v138, v138, v138 quad_perm:[2,3,0,1] row_mask:0xf bank_mask:0xf
  s_nop 1
  v_add_f32_dpp v138, v138, v138 row_half_mirror row_mask:0xf bank_mask:0xf
  v_mul_f32 v138, 0x3acccccd, v138
  v_cvt_pk_bf16_f32 v138, v138, v138
  v_lshlrev_b32 v138, 16, v138
  v_add_f32 v138, 0x3727c5ac, v138
  v_cvt_pk_bf16_f32 v138, v138, v138
  v_lshlrev_b32 v138, 16, v138
  v_sqrt_f32 v138, v138
  s_nop 0
  v_cvt_pk_bf16_f32 v138, v138, v138
  v_lshlrev_b32 v138, 16, v138
  v_rcp_f32 v138, v138
  v_cvt_pk_bf16_f32 v136, v136, v136
  v_lshlrev_b32 v136, 16, v136
  v_mov_b32 v137, v136
  v_mov_b32 v139, v138
  v_pk_add_f32 v[56:57], v[56:57], v[136:137] neg_lo:[0,1] neg_hi:[0,1]
  v_cvt_pk_bf16_f32 v140, v56, v57
  v_lshlrev_b32 v56, 16, v140
  v_and_b32 v57, 0xffff0000, v140
  v_pk_mul_f32 v[56:57], v[56:57], v[138:139]
  v_cvt_pk_bf16_f32 v144, v56, v57
  v_pk_add_f32 v[58:59], v[58:59], v[136:137] neg_lo:[0,1] neg_hi:[0,1]
  v_cvt_pk_bf16_f32 v140, v58, v59
  v_lshlrev_b32 v58, 16, v140
  v_and_b32 v59, 0xffff0000, v140
  v_pk_mul_f32 v[58:59], v[58:59], v[138:139]
  v_cvt_pk_bf16_f32 v145, v58, v59
  v_pk_add_f32 v[60:61], v[60:61], v[136:137] neg_lo:[0,1] neg_hi:[0,1]
  v_cvt_pk_bf16_f32 v140, v60, v61
  v_lshlrev_b32 v60, 16, v140
  v_and_b32 v61, 0xffff0000, v140
  v_pk_mul_f32 v[60:61], v[60:61], v[138:139]
  v_cvt_pk_bf16_f32 v146, v60, v61
  v_pk_add_f32 v[62:63], v[62:63], v[136:137] neg_lo:[0,1] neg_hi:[0,1]
  v_cvt_pk_bf16_f32 v140, v62, v63
  v_lshlrev_b32 v62, 16, v140
  v_and_b32 v63, 0xffff0000, v140
  v_pk_mul_f32 v[62:63], v[62:63], v[138:139]
  v_cvt_pk_bf16_f32 v147, v62, v63
  v_pk_add_f32 v[64:65], v[64:65], v[136:137] neg_lo:[0,1] neg_hi:[0,1]
  v_cvt_pk_bf16_f32 v140, v64, v65
  v_lshlrev_b32 v64, 16, v140
  v_and_b32 v65, 0xffff0000, v140
  v_pk_mul_f32 v[64:65], v[64:65], v[138:139]
  v_cvt_pk_bf16_f32 v148, v64, v65
  v_pk_add_f32 v[66:67], v[66:67], v[136:137] neg_lo:[0,1] neg_hi:[0,1]
  v_cvt_pk_bf16_f32 v140, v66, v67
  v_lshlrev_b32 v66, 16, v140
  v_and_b32 v67, 0xffff0000, v140
  v_pk_mul_f32 v[66:67], v[66:67], v[138:139]
  v_cvt_pk_bf16_f32 v149, v66, v67
  v_pk_add_f32 v[68:69], v[68:69], v[136:137] neg_lo:[0,1] neg_hi:[0,1]
  v_cvt_pk_bf16_f32 v140, v68, v69
  v_lshlrev_b32 v68, 16, v140
  v_and_b32 v69, 0xffff0000, v140
  v_pk_mul_f32 v[68:69], v[68:69], v[138:139]
  v_cvt_pk_bf16_f32 v150, v68, v69
  v_pk_add_f32 v[70:71], v[70:71], v[136:137] neg_lo:[0,1] neg_hi:[0,1]
  v_cvt_pk_bf16_f32 v140, v70, v71
  v_lshlrev_b32 v70, 16, v140
  v_and_b32 v71, 0xffff0000, v140
  v_pk_mul_f32 v[70:71], v[70:71], v[138:139]
  v_cvt_pk_bf16_f32 v151, v70, v71
  v_pk_add_f32 v[72:73], v[72:73], v[136:137] neg_lo:[0,1] neg_hi:[0,1]
  v_cvt_pk_bf16_f32 v140, v72, v73
  v_lshlrev_b32 v72, 16, v140
  v_and_b32 v73, 0xffff0000, v140
  v_pk_mul_f32 v[72:73], v[72:73], v[138:139]
  v_cvt_pk_bf16_f32 v152, v72, v73
  v_pk_add_f32 v[74:75], v[74:75], v[136:137] neg_lo:[0,1] neg_hi:[0,1]
  v_cvt_pk_bf16_f32 v140, v74, v75
  v_lshlrev_b32 v74, 16, v140
  v_and_b32 v75, 0xffff0000, v140
  v_pk_mul_f32 v[74:75], v[74:75], v[138:139]
  v_cvt_pk_bf16_f32 v153, v74, v75
  v_pk_add_f32 v[76:77], v[76:77], v[136:137] neg_lo:[0,1] neg_hi:[0,1]
  v_cvt_pk_bf16_f32 v140, v76, v77
  v_lshlrev_b32 v76, 16, v140
  v_and_b32 v77, 0xffff0000, v140
  v_pk_mul_f32 v[76:77], v[76:77], v[138:139]
  v_cvt_pk_bf16_f32 v154, v76, v77
  v_pk_add_f32 v[78:79], v[78:79], v[136:137] neg_lo:[0,1] neg_hi:[0,1]
  v_cvt_pk_bf16_f32 v140, v78, v79
  v_lshlrev_b32 v78, 16, v140
  v_and_b32 v79, 0xffff0000, v140
  v_pk_mul_f32 v[78:79], v[78:79], v[138:139]
  v_cvt_pk_bf16_f32 v155, v78, v79
  v_pk_add_f32 v[80:81], v[80:81], v[136:137] neg_lo:[0,1] neg_hi:[0,1]
  v_cvt_pk_bf16_f32 v140, v80, v81
  v_lshlrev_b32 v80, 16, v140
  v_and_b32 v81, 0xffff0000, v140
  v_pk_mul_f32 v[80:81], v[80:81], v[138:139]
  v_cvt_pk_bf16_f32 v156, v80, v81
  v_pk_add_f32 v[82:83], v[82:83], v[136:137] neg_lo:[0,1] neg_hi:[0,1]
  v_cvt_pk_bf16_f32 v140, v82, v83
  v_lshlrev_b32 v82, 16, v140
  v_and_b32 v83, 0xffff0000, v140
  v_pk_mul_f32 v[82:83], v[82:83], v[138:139]
  v_cvt_pk_bf16_f32 v157, v82, v83
  v_pk_add_f32 v[84:85], v[84:85], v[136:137] neg_lo:[0,1] neg_hi:[0,1]
  v_cvt_pk_bf16_f32 v140, v84, v85
  v_lshlrev_b32 v84, 16, v140
  v_and_b32 v85, 0xffff0000, v140
  v_pk_mul_f32 v[84:85], v[84:85], v[138:139]
  v_cvt_pk_bf16_f32 v158, v84, v85
  v_pk_add_f32 v[86:87], v[86:87], v[136:137] neg_lo:[0,1] neg_hi:[0,1]
  v_cvt_pk_bf16_f32 v140, v86, v87
  v_lshlrev_b32 v86, 16, v140
  v_and_b32 v87, 0xffff0000, v140
  v_pk_mul_f32 v[86:87], v[86:87], v[138:139]
  v_cvt_pk_bf16_f32 v159, v86, v87
  v_pk_add_f32 v[88:89], v[88:89], v[136:137] neg_lo:[0,1] neg_hi:[0,1]
  v_cvt_pk_bf16_f32 v140, v88, v89
  v_lshlrev_b32 v88, 16, v140
  v_and_b32 v89, 0xffff0000, v140
  v_pk_mul_f32 v[88:89], v[88:89], v[138:139]
  v_cvt_pk_bf16_f32 v160, v88, v89
  v_pk_add_f32 v[90:91], v[90:91], v[136:137] neg_lo:[0,1] neg_hi:[0,1]
  v_cvt_pk_bf16_f32 v140, v90, v91
  v_lshlrev_b32 v90, 16, v140
  v_and_b32 v91, 0xffff0000, v140
  v_pk_mul_f32 v[90:91], v[90:91], v[138:139]
  v_cvt_pk_bf16_f32 v161, v90, v91
  v_pk_add_f32 v[92:93], v[92:93], v[136:137] neg_lo:[0,1] neg_hi:[0,1]
  v_cvt_pk_bf16_f32 v140, v92, v93
  v_lshlrev_b32 v92, 16, v140
  v_and_b32 v93, 0xffff0000, v140
  v_pk_mul_f32 v[92:93], v[92:93], v[138:139]
  v_cvt_pk_bf16_f32 v162, v92, v93
  v_pk_add_f32 v[94:95], v[94:95], v[136:137] neg_lo:[0,1] neg_hi:[0,1]
  v_cvt_pk_bf16_f32 v140, v94, v95
  v_lshlrev_b32 v94, 16, v140
  v_and_b32 v95, 0xffff0000, v140
  v_pk_mul_f32 v[94:95], v[94:95], v[138:139]
  v_cvt_pk_bf16_f32 v163, v94, v95
  v_pk_add_f32 v[96:97], v[96:97], v[136:137] neg_lo:[0,1] neg_hi:[0,1]
  v_cvt_pk_bf16_f32 v140, v96, v97
  v_lshlrev_b32 v96, 16, v140
  v_and_b32 v97, 0xffff0000, v140
  v_pk_mul_f32 v[96:97], v[96:97], v[138:139]
  v_cvt_pk_bf16_f32 v164, v96, v97
  v_pk_add_f32 v[98:99], v[98:99], v[136:137] neg_lo:[0,1] neg_hi:[0,1]
  v_cvt_pk_bf16_f32 v140, v98, v99
  v_lshlrev_b32 v98, 16, v140
  v_and_b32 v99, 0xffff0000, v140
  v_pk_mul_f32 v[98:99], v[98:99], v[138:139]
  v_cvt_pk_bf16_f32 v165, v98, v99
  v_pk_add_f32 v[100:101], v[100:101], v[136:137] neg_lo:[0,1] neg_hi:[0,1]
  v_cvt_pk_bf16_f32 v140, v100, v101
  v_lshlrev_b32 v100, 16, v140
  v_and_b32 v101, 0xffff0000, v140
  v_pk_mul_f32 v[100:101], v[100:101], v[138:139]
  v_cvt_pk_bf16_f32 v166, v100, v101
  v_pk_add_f32 v[102:103], v[102:103], v[136:137] neg_lo:[0,1] neg_hi:[0,1]
  v_cvt_pk_bf16_f32 v140, v102, v103
  v_lshlrev_b32 v102, 16, v140
  v_and_b32 v103, 0xffff0000, v140
  v_pk_mul_f32 v[102:103], v[102:103], v[138:139]
  v_cvt_pk_bf16_f32 v167, v102, v103
  v_pk_add_f32 v[104:105], v[104:105], v[136:137] neg_lo:[0,1] neg_hi:[0,1]
  v_cvt_pk_bf16_f32 v140, v104, v105
  v_lshlrev_b32 v104, 16, v140
  v_and_b32 v105, 0xffff0000, v140
  v_pk_mul_f32 v[104:105], v[104:105], v[138:139]
  v_cvt_pk_bf16_f32 v168, v104, v105
  v_pk_add_f32 v[106:107], v[106:107], v[136:137] neg_lo:[0,1] neg_hi:[0,1]
  v_cvt_pk_bf16_f32 v140, v106, v107
  v_lshlrev_b32 v106, 16, v140
  v_and_b32 v107, 0xffff0000, v140
  v_pk_mul_f32 v[106:107], v[106:107], v[138:139]
  v_cvt_pk_bf16_f32 v169, v106, v107
  v_pk_add_f32 v[108:109], v[108:109], v[136:137] neg_lo:[0,1] neg_hi:[0,1]
  v_cvt_pk_bf16_f32 v140, v108, v109
  v_lshlrev_b32 v108, 16, v140
  v_and_b32 v109, 0xffff0000, v140
  v_pk_mul_f32 v[108:109], v[108:109], v[138:139]
  v_cvt_pk_bf16_f32 v170, v108, v109
  v_pk_add_f32 v[110:111], v[110:111], v[136:137] neg_lo:[0,1] neg_hi:[0,1]
  v_cvt_pk_bf16_f32 v140, v110, v111
  v_lshlrev_b32 v110, 16, v140
  v_and_b32 v111, 0xffff0000, v140
  v_pk_mul_f32 v[110:111], v[110:111], v[138:139]
  v_cvt_pk_bf16_f32 v171, v110, v111
  v_pk_add_f32 v[112:113], v[112:113], v[136:137] neg_lo:[0,1] neg_hi:[0,1]
  v_cvt_pk_bf16_f32 v140, v112, v113
  v_lshlrev_b32 v112, 16, v140
  v_and_b32 v113, 0xffff0000, v140
  v_pk_mul_f32 v[112:113], v[112:113], v[138:139]
  v_cvt_pk_bf16_f32 v172, v112, v113
  v_pk_add_f32 v[114:115], v[114:115], v[136:137] neg_lo:[0,1] neg_hi:[0,1]
  v_cvt_pk_bf16_f32 v140, v114, v115
  v_lshlrev_b32 v114, 16, v140
  v_and_b32 v115, 0xffff0000, v140
  v_pk_mul_f32 v[114:115], v[114:115], v[138:139]
  v_cvt_pk_bf16_f32 v173, v114, v115
  v_pk_add_f32 v[116:117], v[116:117], v[136:137] neg_lo:[0,1] neg_hi:[0,1]
  v_cvt_pk_bf16_f32 v140, v116, v117
  v_lshlrev_b32 v116, 16, v140
  v_and_b32 v117, 0xffff0000, v140
  v_pk_mul_f32 v[116:117], v[116:117], v[138:139]
  v_cvt_pk_bf16_f32 v174, v116, v117
  v_pk_add_f32 v[118:119], v[118:119], v[136:137] neg_lo:[0,1] neg_hi:[0,1]
  v_cvt_pk_bf16_f32 v140, v118, v119
  v_lshlrev_b32 v118, 16, v140
  v_and_b32 v119, 0xffff0000, v140
  v_pk_mul_f32 v[118:119], v[118:119], v[138:139]
  v_cvt_pk_bf16_f32 v175, v118, v119
  v_pk_add_f32 v[120:121], v[120:121], v[136:137] neg_lo:[0,1] neg_hi:[0,1]
  v_cvt_pk_bf16_f32 v140, v120, v121
  v_lshlrev_b32 v120, 16, v140
  v_and_b32 v121, 0xffff0000, v140
  v_pk_mul_f32 v[120:121], v[120:121], v[138:139]
  v_cvt_pk_bf16_f32 v176, v120, v121
  v_pk_add_f32 v[122:123], v[122:123], v[136:137] neg_lo:[0,1] neg_hi:[0,1]
  v_cvt_pk_bf16_f32 v140, v122, v123
  v_lshlrev_b32 v122, 16, v140
  v_and_b32 v123, 0xffff0000, v140
  v_pk_mul_f32 v[122:123], v[122:123], v[138:139]
  v_cvt_pk_bf16_f32 v177, v122, v123
  v_pk_add_f32 v[124:125], v[124:125], v[136:137] neg_lo:[0,1] neg_hi:[0,1]
  v_cvt_pk_bf16_f32 v140, v124, v125
  v_lshlrev_b32 v124, 16, v140
  v_and_b32 v125, 0xffff0000, v140
  v_pk_mul_f32 v[124:125], v[124:125], v[138:139]
  v_cvt_pk_bf16_f32 v178, v124, v125
  v_pk_add_f32 v[126:127], v[126:127], v[136:137] neg_lo:[0,1] neg_hi:[0,1]
  v_cvt_pk_bf16_f32 v140, v126, v127
  v_lshlrev_b32 v126, 16, v140
  v_and_b32 v127, 0xffff0000, v140
  v_pk_mul_f32 v[126:127], v[126:127], v[138:139]
  v_cvt_pk_bf16_f32 v179, v126, v127
  v_pk_add_f32 v[128:129], v[128:129], v[136:137] neg_lo:[0,1] neg_hi:[0,1]
  v_cvt_pk_bf16_f32 v140, v128, v129
  v_lshlrev_b32 v128, 16, v140
  v_and_b32 v129, 0xffff0000, v140
  v_pk_mul_f32 v[128:129], v[128:129], v[138:139]
  v_cvt_pk_bf16_f32 v180, v128, v129
  v_pk_add_f32 v[130:131], v[130:131], v[136:137] neg_lo:[0,1] neg_hi:[0,1]
  v_cvt_pk_bf16_f32 v140, v130, v131
  v_lshlrev_b32 v130, 16, v140
  v_and_b32 v131, 0xffff0000, v140
  v_pk_mul_f32 v[130:131], v[130:131], v[138:139]
  v_cvt_pk_bf16_f32 v181, v130, v131
  v_pk_add_f32 v[132:133], v[132:133], v[136:137] neg_lo:[0,1] neg_hi:[0,1]
  v_cvt_pk_bf16_f32 v140, v132, v133
  v_lshlrev_b32 v132, 16, v140
  v_and_b32 v133, 0xffff0000, v140
  v_pk_mul_f32 v[132:133], v[132:133], v[138:139]
  v_cvt_pk_bf16_f32 v182, v132, v133
  v_pk_add_f32 v[134:135], v[134:135], v[136:137] neg_lo:[0,1] neg_hi:[0,1]
  v_cvt_pk_bf16_f32 v140, v134, v135
  v_lshlrev_b32 v134, 16, v140
  v_and_b32 v135, 0xffff0000, v140
  v_pk_mul_f32 v[134:135], v[134:135], v[138:139]
  v_cvt_pk_bf16_f32 v183, v134, v135
  s_add_u32 s39, s38, 3670016
  buffer_store_dwordx4 v[144:147], v5, s[4:7], s39 offen sc1
  s_add_u32 s39, s39, 4096
  buffer_store_dwordx4 v[148:151], v5, s[4:7], s39 offen sc1
  s_add_u32 s39, s39, 4096
  buffer_store_dwordx4 v[152:155], v5, s[4:7], s39 offen sc1
  s_add_u32 s39, s39, 4096
  buffer_store_dwordx4 v[156:159], v5, s[4:7], s39 offen sc1
  s_add_u32 s39, s39, 4096
  buffer_store_dwordx4 v[160:163], v5, s[4:7], s39 offen sc1
  s_add_u32 s39, s39, 4096
  buffer_store_dwordx4 v[164:167], v5, s[4:7], s39 offen sc1
  s_add_u32 s39, s39, 4096
  buffer_store_dwordx4 v[168:171], v5, s[4:7], s39 offen sc1
  s_add_u32 s39, s39, 4096
  buffer_store_dwordx4 v[172:175], v5, s[4:7], s39 offen sc1
  s_add_u32 s39, s39, 4096
  buffer_store_dwordx4 v[176:179], v5, s[4:7], s39 offen sc1
  s_add_u32 s39, s39, 4096
  buffer_store_dwordx4 v[180:183], v5, s[4:7], s39 offen sc1
  s_add_u32 s39, s39, 4096
  s_waitcnt vmcnt(0)
  s_barrier
  s_cmp_lg_u32 s28, 0
  s_cbranch_scc1 L_ln_nf
  s_lshl_b32 s3, s50, 2
  s_add_u32 s3, s3, 180224
  v_mov_b32 v2, 2
  s_mov_b64 exec, 1
  buffer_store_dword v2, off, s[4:7], s3 sc1
  s_mov_b64 exec, -1
L_ln_nf:
  s_branch L_wo_noln
L_wo_pre:
  s_cmp_lg_u32 s32, 80
  s_cbranch_scc1 L_wo_pre2
  s_cmp_eq_u32 s101, 0
  s_cbranch_scc1 L_sig_69
  s_mov_b32 s101, 0
  s_waitcnt vmcnt(0)
  s_mov_b64 exec, 1
  v_mov_b32 v0, 1
  buffer_atomic_add v0, off, s[8:11], 0 offset:32
  s_mov_b64 exec, -1
L_sig_69:
  s_cmp_lg_u32 s28, 0
  s_cbranch_scc1 L_wo_noln
  s_mov_b32 s50, -1
  s_mov_b32 s51, -1
  s_mov_b32 s52, 0
  s_mov_b32 s38, 114688
  s_mov_b32 s39, 122880
L_cal:
  s_memtime s[54:55]
  s_waitcnt lgkmcnt(0)
  buffer_load_dword v2, off, s[4:7], s38 sc0 sc1
  s_waitcnt vmcnt(0)
  s_memtime s[56:57]
  s_waitcnt lgkmcnt(0)
  s_sub_u32 s3, s56, s54
  s_min_u32 s50, s50, s3
  s_add_u32 s38, s38, 384
  s_memtime s[54:55]
  s_waitcnt lgkmcnt(0)
  buffer_load_dword v2, off, s[4:7], s39 sc0 sc1
  s_waitcnt vmcnt(0)
  s_memtime s[56:57]
  s_waitcnt lgkmcnt(0)
  s_sub_u32 s3, s56, s54
  s_min_u32 s51, s51, s3
  s_add_u32 s39, s39, 384
  s_add_u32 s52, s52, 1
  s_cmp_lt_u32 s52, 5
  s_cbranch_scc1 L_cal
  s_cmp_ge_u32 s52, 20
  s_cbranch_scc1 L_cal_d
  s_min_u32 s3, s50, s51
  s_max_u32 s53, s50, s51
  s_sub_u32 s53, s53, s3
  s_cmp_lt_u32 s53, 160
  s_cbranch_scc1 L_cal
  s_cmp_gt_u32 s3, 600
  s_cbranch_scc1 L_cal
L_cal_d:
  s_cmp_lg_u32 s34, 0
  s_cbranch_scc1 L_verd_71
  s_cmp_eq_u32 s101, 0
  s_cbranch_scc1 L_sig_74
  s_mov_b32 s101, 0
  s_waitcnt vmcnt(0)
  s_mov_b64 exec, 1
  v_mov_b32 v0, 1
  buffer_atomic_add v0, off, s[8:11], 0 offset:32
  s_mov_b64 exec, -1
L_sig_74:
  v_lshlrev_b32 v2, 2, v1
L_ver_70:
  buffer_load_dword v3, v2, s[8:11], 0 offen sc1
  s_waitcnt vmcnt(0)
  v_readlane_b32 s3, v3, 8
  s_nop 0
  s_cmp_eq_u32 s3, 32
  s_cbranch_scc0 L_verf_73
  v_readlane_b32 s3, v3, 0
  v_readlane_b32 vcc_lo, v3, 1
  s_nop 0
  s_add_u32 s3, s3, vcc_lo
  v_readlane_b32 vcc_lo, v3, 34
  s_nop 0
  s_add_u32 s3, s3, vcc_lo
  v_readlane_b32 vcc_lo, v3, 35
  s_nop 0
  s_add_u32 s3, s3, vcc_lo
  v_readlane_b32 vcc_lo, v3, 36
  s_nop 0
  s_add_u32 s3, s3, vcc_lo
  v_readlane_b32 vcc_lo, v3, 37
  s_nop 0
  s_add_u32 s3, s3, vcc_lo
  v_readlane_b32 vcc_lo, v3, 38
  s_nop 0
  s_add_u32 s3, s3, vcc_lo
  v_readlane_b32 vcc_lo, v3, 39
  s_nop 0
  s_add_u32 s3, s3, vcc_lo
  s_cmp_eq_u32 s3, 0x100
  s_cbranch_scc1 L_verr_72
L_verf_73:
  s_sleep 2
  s_sub_u32 s29, s29, 1
  s_cbranch_scc0 L_ver_70
  s_branch L_end
L_verr_72:
  s_mov_b32 s34, 1
  v_cmp_ne_u32 vcc, 32, v3
  s_nop 4
  s_and_b32 vcc_lo, vcc_lo, 3
  s_and_b32 vcc_hi, vcc_hi, 0xfc
  s_cbranch_vccz L_verd_71
  s_mov_b32 s32, s31
  s_mov_b32 s33, 1
  v_readlane_b32 s3, v3, 0
  s_nop 0
  s_cmp_gt_u32 s30, 0
  s_cselect_b32 s3, s3, 0
  s_add_u32 s32, s32, s3
  v_readlane_b32 s3, v3, 1
  s_nop 0
  s_cmp_gt_u32 s30, 1
  s_cselect_b32 s3, s3, 0
  s_add_u32 s32, s32, s3
  v_readlane_b32 s3, v3, 34
  s_nop 0
  s_cmp_gt_u32 s30, 2
  s_cselect_b32 s3, s3, 0
  s_add_u32 s32, s32, s3
  v_readlane_b32 s3, v3, 35
  s_nop 0
  s_cmp_gt_u32 s30, 3
  s_cselect_b32 s3, s3, 0
  s_add_u32 s32, s32, s3
  v_readlane_b32 s3, v3, 36
  s_nop 0
  s_cmp_gt_u32 s30, 4
  s_cselect_b32 s3, s3, 0
  s_add_u32 s32, s32, s3
  v_readlane_b32 s3, v3, 37
  s_nop 0
  s_cmp_gt_u32 s30, 5
  s_cselect_b32 s3, s3, 0
  s_add_u32 s32, s32, s3
  v_readlane_b32 s3, v3, 38
  s_nop 0
  s_cmp_gt_u32 s30, 6
  s_cselect_b32 s3, s3, 0
  s_add_u32 s32, s32, s3
  s_branch L_restart
L_verd_71:
  s_cmp_le_u32 s50, s51
  s_cselect_b32 s50, 1, 0x2001
  s_mov_b32 s3, 189952
  v_mov_b32 v2, s50
  s_mov_b64 exec, 1
  buffer_store_dword v2, off, s[4:7], s3 sc1
  s_mov_b64 exec, -1
  s_branch L_wo_noln
L_wo_pre2:
  s_cmp_eq_u32 s101, 0
  s_cbranch_scc1 L_sig_75
  s_mov_b32 s101, 0
  s_waitcnt vmcnt(0)
  s_mov_b64 exec, 1
  v_mov_b32 v0, 1
  buffer_atomic_add v0, off, s[8:11], 0 offset:32
  s_mov_b64 exec, -1
L_sig_75:
  s_lshr_b32 s3, s32, 5
  s_and_b32 s36, s32, 15
  s_lshl4_add_u32 s37, s3, s36
  s_sub_u32 s37, s37, 64
  s_and_b32 s36, s32, 7
  s_lshl3_add_u32 s3, s3, s36
  s_sub_u32 s3, s3, 16
  s_cmp_ge_u32 s32, 192
  s_cselect_b32 s3, s37, s3
  s_lshl2_add_u32 s3, s3, s28
  s_mul_i32 s36, s3, 20480
  v_lshlrev_b32 v15, 4, v1
  s_lshl_b32 s37, s28, 12
  s_add_u32 m0, s37, 0x20000
  s_mov_b32 s24, s70
  s_mov_b32 s25, s71
  s_mov_b32 s26, 5242880
  s_mov_b32 s27, 0x20000
  s_mov_b32 s37, s36
  buffer_load_dwordx4 v15, s[24:27], s37 offen offset:0 lds
  buffer_load_dwordx4 v15, s[24:27], s37 offen offset:1024 lds
  buffer_load_dwordx4 v15, s[24:27], s37 offen offset:2048 lds
  buffer_load_dwordx4 v15, s[24:27], s37 offen offset:3072 lds
  s_add_u32 s37, s37, 4096
  buffer_load_dwordx4 v15, s[24:27], s37 offen offset:0 lds
  buffer_load_dwordx4 v15, s[24:27], s37 offen offset:1024 lds
  buffer_load_dwordx4 v15, s[24:27], s37 offen offset:2048 lds
  buffer_load_dwordx4 v15, s[24:27], s37 offen offset:3072 lds
  s_add_u32 s37, s37, 4096
  buffer_load_dwordx4 v15, s[24:27], s37 offen offset:0 lds
  buffer_load_dwordx4 v15, s[24:27], s37 offen offset:1024 lds
  buffer_load_dwordx4 v15, s[24:27], s37 offen offset:2048 lds
  buffer_load_dwordx4 v15, s[24:27], s37 offen offset:3072 lds
  s_add_u32 s37, s37, 4096
  buffer_load_dwordx4 v15, s[24:27], s37 offen offset:0 lds
  buffer_load_dwordx4 v15, s[24:27], s37 offen offset:1024 lds
  buffer_load_dwordx4 v15, s[24:27], s37 offen offset:2048 lds
  buffer_load_dwordx4 v15, s[24:27], s37 offen offset:3072 lds
  s_add_u32 s37, s37, 4096
  buffer_load_dwordx4 v15, s[24:27], s37 offen offset:0 lds
  buffer_load_dwordx4 v15, s[24:27], s37 offen offset:1024 lds
  buffer_load_dwordx4 v15, s[24:27], s37 offen offset:2048 lds
  buffer_load_dwordx4 v15, s[24:27], s37 offen offset:3072 lds
  s_mov_b32 s24, s72
  s_mov_b32 s25, s73
  s_mov_b32 s26, 5242880
  s_mov_b32 s27, 0x20000
  s_mov_b32 s37, s36
  buffer_load_dwordx4 v15, s[24:27], s37 offen offset:0 lds
  buffer_load_dwordx4 v15, s[24:27], s37 offen offset:1024 lds
  buffer_load_dwordx4 v15, s[24:27], s37 offen offset:2048 lds
  buffer_load_dwordx4 v15, s[24:27], s37 offen offset:3072 lds
  s_add_u32 s37, s37, 4096
  buffer_load_dwordx4 v15, s[24:27], s37 offen offset:0 lds
  buffer_load_dwordx4 v15, s[24:27], s37 offen offset:1024 lds
  buffer_load_dwordx4 v15, s[24:27], s37 offen offset:2048 lds
  buffer_load_dwordx4 v15, s[24:27], s37 offen offset:3072 lds
  s_add_u32 s37, s37, 4096
  buffer_load_dwordx4 v15, s[24:27], s37 offen offset:0 lds
  buffer_load_dwordx4 v15, s[24:27], s37 offen offset:1024 lds
  buffer_load_dwordx4 v15, s[24:27], s37 offen offset:2048 lds
  buffer_load_dwordx4 v15, s[24:27], s37 offen offset:3072 lds
  s_add_u32 s37, s37, 4096
  buffer_load_dwordx4 v15, s[24:27], s37 offen offset:0 lds
  buffer_load_dwordx4 v15, s[24:27], s37 offen offset:1024 lds
  buffer_load_dwordx4 v15, s[24:27], s37 offen offset:2048 lds
  buffer_load_dwordx4 v15, s[24:27], s37 offen offset:3072 lds
  s_add_u32 s37, s37, 4096
  buffer_load_dwordx4 v15, s[24:27], s37 offen offset:0 lds
  buffer_load_dwordx4 v15, s[24:27], s37 offen offset:1024 lds
  buffer_load_dwordx4 v15, s[24:27], s37 offen offset:2048 lds
  buffer_load_dwordx4 v15, s[24:27], s37 offen offset:3072 lds
  s_mov_b32 s24, s74
  s_mov_b32 s25, s75
  s_mov_b32 s26, 5242880
  s_mov_b32 s27, 0x20000
  s_mov_b32 s37, s36
  buffer_load_dwordx4 v15, s[24:27], s37 offen offset:0 lds
  buffer_load_dwordx4 v15, s[24:27], s37 offen offset:1024 lds
  buffer_load_dwordx4 v15, s[24:27], s37 offen offset:2048 lds
  buffer_load_dwordx4 v15, s[24:27], s37 offen offset:3072 lds
  s_add_u32 s37, s37, 4096
  buffer_load_dwordx4 v15, s[24:27], s37 offen offset:0 lds
  buffer_load_dwordx4 v15, s[24:27], s37 offen offset:1024 lds
  buffer_load_dwordx4 v15, s[24:27], s37 offen offset:2048 lds
  buffer_load_dwordx4 v15, s[24:27], s37 offen offset:3072 lds
  s_add_u32 s37, s37, 4096
  buffer_load_dwordx4 v15, s[24:27], s37 offen offset:0 lds
  buffer_load_dwordx4 v15, s[24:27], s37 offen offset:1024 lds
  buffer_load_dwordx4 v15, s[24:27], s37 offen offset:2048 lds
  buffer_load_dwordx4 v15, s[24:27], s37 offen offset:3072 lds
  s_add_u32 s37, s37, 4096
  buffer_load_dwordx4 v15, s[24:27], s37 offen offset:0 lds
  buffer_load_dwordx4 v15, s[24:27], s37 offen offset:1024 lds
  buffer_load_dwordx4 v15, s[24:27], s37 offen offset:2048 lds
  buffer_load_dwordx4 v15, s[24:27], s37 offen offset:3072 lds
  s_add_u32 s37, s37, 4096
  buffer_load_dwordx4 v15, s[24:27], s37 offen offset:0 lds
  buffer_load_dwordx4 v15, s[24:27], s37 offen offset:1024 lds
  buffer_load_dwordx4 v15, s[24:27], s37 offen offset:2048 lds
  buffer_load_dwordx4 v15, s[24:27], s37 offen offset:3072 lds
L_wo_noln:
  s_cmp_lg_u32 s34, 0
  s_cbranch_scc1 L_verd_77
  s_cmp_eq_u32 s101, 0
  s_cbranch_scc1 L_sig_80
  s_mov_b32 s101, 0
  s_waitcnt vmcnt(0)
  s_mov_b64 exec, 1
  v_mov_b32 v0, 1
  buffer_atomic_add v0, off, s[8:11], 0 offset:32
  s_mov_b64 exec, -1
L_sig_80:
  v_lshlrev_b32 v2, 2, v1
L_ver_76:
  buffer_load_dword v3, v2, s[8:11], 0 offen sc1
  s_waitcnt vmcnt(0)
  v_readlane_b32 s3, v3, 8
  s_nop 0
  s_cmp_eq_u32 s3, 32
  s_cbranch_scc0 L_verf_79
  v_readlane_b32 s3, v3, 0
  v_readlane_b32 vcc_lo, v3, 1
  s_nop 0
  s_add_u32 s3, s3, vcc_lo
  v_readlane_b32 vcc_lo, v3, 34
  s_nop 0
  s_add_u32 s3, s3, vcc_lo
  v_readlane_b32 vcc_lo, v3, 35
  s_nop 0
  s_add_u32 s3, s3, vcc_lo
  v_readlane_b32 vcc_lo, v3, 36
  s_nop 0
  s_add_u32 s3, s3, vcc_lo
  v_readlane_b32 vcc_lo, v3, 37
  s_nop 0
  s_add_u32 s3, s3, vcc_lo
  v_readlane_b32 vcc_lo, v3, 38
  s_nop 0
  s_add_u32 s3, s3, vcc_lo
  v_readlane_b32 vcc_lo, v3, 39
  s_nop 0
  s_add_u32 s3, s3, vcc_lo
  s_cmp_eq_u32 s3, 0x100
  s_cbranch_scc1 L_verr_78
L_verf_79:
  s_sleep 2
  s_sub_u32 s29, s29, 1
  s_cbranch_scc0 L_ver_76
  s_branch L_end
L_verr_78:
  s_mov_b32 s34, 1
  v_cmp_ne_u32 vcc, 32, v3
  s_nop 4
  s_and_b32 vcc_lo, vcc_lo, 3
  s_and_b32 vcc_hi, vcc_hi, 0xfc
  s_cbranch_vccz L_verd_77
  s_mov_b32 s32, s31
  s_mov_b32 s33, 1
  v_readlane_b32 s3, v3, 0
  s_nop 0
  s_cmp_gt_u32 s30, 0
  s_cselect_b32 s3, s3, 0
  s_add_u32 s32, s32, s3
  v_readlane_b32 s3, v3, 1
  s_nop 0
  s_cmp_gt_u32 s30, 1
  s_cselect_b32 s3, s3, 0
  s_add_u32 s32, s32, s3
  v_readlane_b32 s3, v3, 34
  s_nop 0
  s_cmp_gt_u32 s30, 2
  s_cselect_b32 s3, s3, 0
  s_add_u32 s32, s32, s3
  v_readlane_b32 s3, v3, 35
  s_nop 0
  s_cmp_gt_u32 s30, 3
  s_cselect_b32 s3, s3, 0
  s_add_u32 s32, s32, s3
  v_readlane_b32 s3, v3, 36
  s_nop 0
  s_cmp_gt_u32 s30, 4
  s_cselect_b32 s3, s3, 0
  s_add_u32 s32, s32, s3
  v_readlane_b32 s3, v3, 37
  s_nop 0
  s_cmp_gt_u32 s30, 5
  s_cselect_b32 s3, s3, 0
  s_add_u32 s32, s32, s3
  v_readlane_b32 s3, v3, 38
  s_nop 0
  s_cmp_gt_u32 s30, 6
  s_cselect_b32 s3, s3, 0
  s_add_u32 s32, s32, s3
  s_branch L_restart
L_verd_77:
  s_mov_b32 s3, 190080
  s_mov_b32 s39, 1
  v_min_u32 v2, 0, v1
  v_mul_u32_u24 v2, 4, v2
L_wf_81:
  buffer_load_dword v3, v2, s[4:7], s3 offen sc1
  s_waitcnt vmcnt(0)
  v_cmp_gt_u32 vcc, s39, v3
  s_cbranch_vccz L_wfd_82
  s_sleep 8
  s_sub_u32 s29, s29, 1
  s_cbranch_scc0 L_wf_81
  s_branch L_end
L_wfd_82:
  s_lshl_b32 s49, s41, 6
  s_mul_i32 s43, s28, 14
  s_cmp_eq_u32 s28, 3
  s_cselect_b32 s3, 1, 0
  s_sub_u32 s43, s43, s3
  v_lshrrev_b32 v2, 2, v1
  v_and_b32 v5, 3, v1
  v_lshlrev_b32 v5, 4, v5
  v_mul_u32_u24 v3, 1280, v2
  v_add_u32 v3, v3, v5
  v_and_b32 v4, 7, v2
  v_lshrrev_b32 v2, 3, v2
  v_lshl_add_u32 v4, v2, 4, v4
  v_mul_u32_u24 v4, 1280, v4
  v_add_u32 v4, v4, v5
  s_lshl_b32 s35, s28, 15
  v_lshlrev_b32 v5, 4, v1
  v_add_u32 v5, s35, v5
  s_mul_i32 s38, s28, 1310720
  s_add_u32 s38, s38, s49
  s_mul_i32 s39, s43, 40960
  s_add_u32 s39, s39, s49
  s_add_u32 s36, s38, 0
  s_add_u32 m0, s35, 0
  s_nop 0
  buffer_load_dwordx4 v3, s[12:15], s36 offen lds
  s_add_u32 s36, s38, 20480
  s_add_u32 m0, s35, 1024
  s_nop 0
  buffer_load_dwordx4 v3, s[12:15], s36 offen lds
  s_add_u32 s36, s38, 40960
  s_add_u32 m0, s35, 2048
  s_nop 0
  buffer_load_dwordx4 v3, s[12:15], s36 offen lds
  s_add_u32 s36, s38, 61440
  s_add_u32 m0, s35, 3072
  s_nop 0
  buffer_load_dwordx4 v3, s[12:15], s36 offen lds
  s_add_u32 s36, s38, 81920
  s_add_u32 m0, s35, 4096
  s_nop 0
  buffer_load_dwordx4 v3, s[12:15], s36 offen lds
  s_add_u32 s36, s38, 102400
  s_add_u32 m0, s35, 5120
  s_nop 0
  buffer_load_dwordx4 v3, s[12:15], s36 offen lds
  s_add_u32 s36, s38, 122880
  s_add_u32 m0, s35, 6144
  s_nop 0
  buffer_load_dwordx4 v3, s[12:15], s36 offen lds
  s_add_u32 s36, s38, 143360
  s_add_u32 m0, s35, 7168
  s_nop 0
  buffer_load_dwordx4 v3, s[12:15], s36 offen lds
  s_add_u32 s36, s38, 163840
  s_add_u32 m0, s35, 8192
  s_nop 0
  buffer_load_dwordx4 v3, s[12:15], s36 offen lds
  s_add_u32 s36, s38, 184320
  s_add_u32 m0, s35, 9216
  s_nop 0
  buffer_load_dwordx4 v3, s[12:15], s36 offen lds
  s_add_u32 s36, s38, 204800
  s_add_u32 m0, s35, 10240
  s_nop 0
  buffer_load_dwordx4 v3, s[12:15], s36 offen lds
  s_add_u32 s36, s38, 225280
  s_add_u32 m0, s35, 11264
  s_nop 0
  buffer_load_dwordx4 v3, s[12:15], s36 offen lds
  s_add_u32 s36, s38, 245760
  s_add_u32 m0, s35, 12288
  s_nop 0
  buffer_load_dwordx4 v3, s[12:15], s36 offen lds
  s_add_u32 s36, s38, 266240
  s_add_u32 m0, s35, 13312
  s_nop 0
  buffer_load_dwordx4 v3, s[12:15], s36 offen lds
  s_add_u32 s36, s38, 286720
  s_add_u32 m0, s35, 14336
  s_nop 0
  buffer_load_dwordx4 v3, s[12:15], s36 offen lds
  s_add_u32 s36, s38, 307200
  s_add_u32 m0, s35, 15360
  s_nop 0
  buffer_load_dwordx4 v3, s[12:15], s36 offen lds
  s_add_u32 s36, s38, 327680
  s_add_u32 m0, s35, 16384
  s_nop 0
  buffer_load_dwordx4 v3, s[12:15], s36 offen lds
  s_add_u32 s36, s38, 348160
  s_add_u32 m0, s35, 17408
  s_nop 0
  buffer_load_dwordx4 v3, s[12:15], s36 offen lds
  s_add_u32 s36, s38, 368640
  s_add_u32 m0, s35, 18432
  s_nop 0
  buffer_load_dwordx4 v3, s[12:15], s36 offen lds
  s_add_u32 s36, s38, 389120
  s_add_u32 m0, s35, 19456
  s_nop 0
  buffer_load_dwordx4 v3, s[12:15], s36 offen lds
  s_add_u32 s36, s38, 409600
  s_add_u32 m0, s35, 20480
  s_nop 0
  buffer_load_dwordx4 v3, s[12:15], s36 offen lds
  s_add_u32 s36, s38, 430080
  s_add_u32 m0, s35, 21504
  s_nop 0
  buffer_load_dwordx4 v3, s[12:15], s36 offen lds
  s_add_u32 s36, s38, 450560
  s_add_u32 m0, s35, 22528
  s_nop 0
  buffer_load_dwordx4 v3, s[12:15], s36 offen lds
  s_add_u32 s36, s38, 471040
  s_add_u32 m0, s35, 23552
  s_nop 0
  buffer_load_dwordx4 v3, s[12:15], s36 offen lds
  s_add_u32 s36, s38, 491520
  s_add_u32 m0, s35, 24576
  s_nop 0
  buffer_load_dwordx4 v3, s[12:15], s36 offen lds
  s_add_u32 s36, s38, 512000
  s_add_u32 m0, s35, 25600
  s_nop 0
  buffer_load_dwordx4 v3, s[12:15], s36 offen lds
  s_add_u32 s36, s38, 532480
  s_add_u32 m0, s35, 26624
  s_nop 0
  buffer_load_dwordx4 v3, s[12:15], s36 offen lds
  s_add_u32 s36, s38, 552960
  s_add_u32 m0, s35, 27648
  s_nop 0
  buffer_load_dwordx4 v3, s[12:15], s36 offen lds
  s_add_u32 s36, s38, 573440
  s_add_u32 m0, s35, 28672
  s_nop 0
  buffer_load_dwordx4 v3, s[12:15], s36 offen lds
  s_add_u32 s36, s38, 593920
  s_add_u32 m0, s35, 29696
  s_nop 0
  buffer_load_dwordx4 v3, s[12:15], s36 offen lds
  s_add_u32 s36, s38, 614400
  s_add_u32 m0, s35, 30720
  s_nop 0
  buffer_load_dwordx4 v3, s[12:15], s36 offen lds
  s_add_u32 s36, s38, 634880
  s_add_u32 m0, s35, 31744
  s_nop 0
  buffer_load_dwordx4 v3, s[12:15], s36 offen lds
  s_waitcnt vmcnt(28)
  s_cmp_eq_u32 s101, 0
  s_cbranch_scc1 L_sig_83
  s_mov_b32 s101, 0
  s_mov_b64 exec, 1
  v_mov_b32 v0, 1
  buffer_atomic_add v0, off, s[8:11], 0 offset:32
  s_mov_b64 exec, -1
L_sig_83:
  ds_read_b64_tr_b16 v[144:145], v5 offset:0
  ds_read_b64_tr_b16 v[148:149], v5 offset:8
  ds_read_b64_tr_b16 v[146:147], v5 offset:1024
  ds_read_b64_tr_b16 v[150:151], v5 offset:1032
  ds_read_b64_tr_b16 v[152:153], v5 offset:2048
  ds_read_b64_tr_b16 v[156:157], v5 offset:2056
  ds_read_b64_tr_b16 v[154:155], v5 offset:3072
  ds_read_b64_tr_b16 v[158:159], v5 offset:3080
  s_waitcnt lgkmcnt(0)
  s_add_u32 s36, s38, 655360
  s_add_u32 m0, s35, 0
  s_nop 0
  buffer_load_dwordx4 v3, s[12:15], s36 offen lds
  s_add_u32 s36, s38, 675840
  s_add_u32 m0, s35, 1024
  s_nop 0
  buffer_load_dwordx4 v3, s[12:15], s36 offen lds
  s_add_u32 s36, s38, 696320
  s_add_u32 m0, s35, 2048
  s_nop 0
  buffer_load_dwordx4 v3, s[12:15], s36 offen lds
  s_add_u32 s36, s38, 716800
  s_add_u32 m0, s35, 3072
  s_nop 0
  buffer_load_dwordx4 v3, s[12:15], s36 offen lds
  s_waitcnt vmcnt(28)
  ds_read_b64_tr_b16 v[160:161], v5 offset:4096
  ds_read_b64_tr_b16 v[164:165], v5 offset:4104
  ds_read_b64_tr_b16 v[162:163], v5 offset:5120
  ds_read_b64_tr_b16 v[166:167], v5 offset:5128
  ds_read_b64_tr_b16 v[168:169], v5 offset:6144
  ds_read_b64_tr_b16 v[172:173], v5 offset:6152
  ds_read_b64_tr_b16 v[170:171], v5 offset:7168
  ds_read_b64_tr_b16 v[174:175], v5 offset:7176
  s_waitcnt lgkmcnt(0)
  s_add_u32 s36, s38, 737280
  s_add_u32 m0, s35, 4096
  s_nop 0
  buffer_load_dwordx4 v3, s[12:15], s36 offen lds
  s_add_u32 s36, s38, 757760
  s_add_u32 m0, s35, 5120
  s_nop 0
  buffer_load_dwordx4 v3, s[12:15], s36 offen lds
  s_add_u32 s36, s38, 778240
  s_add_u32 m0, s35, 6144
  s_nop 0
  buffer_load_dwordx4 v3, s[12:15], s36 offen lds
  s_add_u32 s36, s38, 798720
  s_add_u32 m0, s35, 7168
  s_nop 0
  buffer_load_dwordx4 v3, s[12:15], s36 offen lds
  s_waitcnt vmcnt(28)
  ds_read_b64_tr_b16 v[176:177], v5 offset:8192
  ds_read_b64_tr_b16 v[180:181], v5 offset:8200
  ds_read_b64_tr_b16 v[178:179], v5 offset:9216
  ds_read_b64_tr_b16 v[182:183], v5 offset:9224
  ds_read_b64_tr_b16 v[184:185], v5 offset:10240
  ds_read_b64_tr_b16 v[188:189], v5 offset:10248
  ds_read_b64_tr_b16 v[186:187], v5 offset:11264
  ds_read_b64_tr_b16 v[190:191], v5 offset:11272
  s_waitcnt lgkmcnt(0)
  s_add_u32 s36, s38, 819200
  s_add_u32 m0, s35, 8192
  s_nop 0
  buffer_load_dwordx4 v3, s[12:15], s36 offen lds
  s_add_u32 s36, s38, 839680
  s_add_u32 m0, s35, 9216
  s_nop 0
  buffer_load_dwordx4 v3, s[12:15], s36 offen lds
  s_add_u32 s36, s38, 860160
  s_add_u32 m0, s35, 10240
  s_nop 0
  buffer_load_dwordx4 v3, s[12:15], s36 offen lds
  s_add_u32 s36, s38, 880640
  s_add_u32 m0, s35, 11264
  s_nop 0
  buffer_load_dwordx4 v3, s[12:15], s36 offen lds
  s_waitcnt vmcnt(28)
  ds_read_b64_tr_b16 v[192:193], v5 offset:12288
  ds_read_b64_tr_b16 v[196:197], v5 offset:12296
  ds_read_b64_tr_b16 v[194:195], v5 offset:13312
  ds_read_b64_tr_b16 v[198:199], v5 offset:13320
  ds_read_b64_tr_b16 v[200:201], v5 offset:14336
  ds_read_b64_tr_b16 v[204:205], v5 offset:14344
  ds_read_b64_tr_b16 v[202:203], v5 offset:15360
  ds_read_b64_tr_b16 v[206:207], v5 offset:15368
  s_waitcnt lgkmcnt(0)
  s_add_u32 s36, s38, 901120
  s_add_u32 m0, s35, 12288
  s_nop 0
  buffer_load_dwordx4 v3, s[12:15], s36 offen lds
  s_add_u32 s36, s38, 921600
  s_add_u32 m0, s35, 13312
  s_nop 0
  buffer_load_dwordx4 v3, s[12:15], s36 offen lds
  s_add_u32 s36, s38, 942080
  s_add_u32 m0, s35, 14336
  s_nop 0
  buffer_load_dwordx4 v3, s[12:15], s36 offen lds
  s_add_u32 s36, s38, 962560
  s_add_u32 m0, s35, 15360
  s_nop 0
  buffer_load_dwordx4 v3, s[12:15], s36 offen lds
  s_waitcnt vmcnt(28)
  ds_read_b64_tr_b16 v[208:209], v5 offset:16384
  ds_read_b64_tr_b16 v[212:213], v5 offset:16392
  ds_read_b64_tr_b16 v[210:211], v5 offset:17408
  ds_read_b64_tr_b16 v[214:215], v5 offset:17416
  ds_read_b64_tr_b16 v[216:217], v5 offset:18432
  ds_read_b64_tr_b16 v[220:221], v5 offset:18440
  ds_read_b64_tr_b16 v[218:219], v5 offset:19456
  ds_read_b64_tr_b16 v[222:223], v5 offset:19464
  s_waitcnt lgkmcnt(0)
  s_add_u32 s36, s38, 983040
  s_add_u32 m0, s35, 16384
  s_nop 0
  buffer_load_dwordx4 v3, s[12:15], s36 offen lds
  s_add_u32 s36, s38, 1003520
  s_add_u32 m0, s35, 17408
  s_nop 0
  buffer_load_dwordx4 v3, s[12:15], s36 offen lds
  s_add_u32 s36, s38, 1024000
  s_add_u32 m0, s35, 18432
  s_nop 0
  buffer_load_dwordx4 v3, s[12:15], s36 offen lds
  s_add_u32 s36, s38, 1044480
  s_add_u32 m0, s35, 19456
  s_nop 0
  buffer_load_dwordx4 v3, s[12:15], s36 offen lds
  s_waitcnt vmcnt(28)
  ds_read_b64_tr_b16 v[224:225], v5 offset:20480
  ds_read_b64_tr_b16 v[228:229], v5 offset:20488
  ds_read_b64_tr_b16 v[226:227], v5 offset:21504
  ds_read_b64_tr_b16 v[230:231], v5 offset:21512
  ds_read_b64_tr_b16 v[232:233], v5 offset:22528
  ds_read_b64_tr_b16 v[236:237], v5 offset:22536
  ds_read_b64_tr_b16 v[234:235], v5 offset:23552
  ds_read_b64_tr_b16 v[238:239], v5 offset:23560
  s_waitcnt lgkmcnt(0)
  s_add_u32 s36, s38, 1064960
  s_add_u32 m0, s35, 20480
  s_nop 0
  buffer_load_dwordx4 v3, s[12:15], s36 offen lds
  s_add_u32 s36, s38, 1085440
  s_add_u32 m0, s35, 21504
  s_nop 0
  buffer_load_dwordx4 v3, s[12:15], s36 offen lds
  s_add_u32 s36, s38, 1105920
  s_add_u32 m0, s35, 22528
  s_nop 0
  buffer_load_dwordx4 v3, s[12:15], s36 offen lds
  s_add_u32 s36, s38, 1126400
  s_add_u32 m0, s35, 23552
  s_nop 0
  buffer_load_dwordx4 v3, s[12:15], s36 offen lds
  s_waitcnt vmcnt(28)
  ds_read_b64_tr_b16 v[240:241], v5 offset:24576
  ds_read_b64_tr_b16 v[244:245], v5 offset:24584
  ds_read_b64_tr_b16 v[242:243], v5 offset:25600
  ds_read_b64_tr_b16 v[246:247], v5 offset:25608
  ds_read_b64_tr_b16 v[248:249], v5 offset:26624
  ds_read_b64_tr_b16 v[252:253], v5 offset:26632
  ds_read_b64_tr_b16 v[250:251], v5 offset:27648
  ds_read_b64_tr_b16 v[254:255], v5 offset:27656
  s_waitcnt lgkmcnt(0)
  s_add_u32 s36, s38, 1146880
  s_add_u32 m0, s35, 24576
  s_nop 0
  buffer_load_dwordx4 v3, s[12:15], s36 offen lds
  s_add_u32 s36, s38, 1167360
  s_add_u32 m0, s35, 25600
  s_nop 0
  buffer_load_dwordx4 v3, s[12:15], s36 offen lds
  s_add_u32 s36, s38, 1187840
  s_add_u32 m0, s35, 26624
  s_nop 0
  buffer_load_dwordx4 v3, s[12:15], s36 offen lds
  s_add_u32 s36, s38, 1208320
  s_add_u32 m0, s35, 27648
  s_nop 0
  buffer_load_dwordx4 v3, s[12:15], s36 offen lds
  s_waitcnt vmcnt(28)
  ds_read_b64_tr_b16 a[0:1], v5 offset:28672
  ds_read_b64_tr_b16 a[4:5], v5 offset:28680
  ds_read_b64_tr_b16 a[2:3], v5 offset:29696
  ds_read_b64_tr_b16 a[6:7], v5 offset:29704
  ds_read_b64_tr_b16 a[8:9], v5 offset:30720
  ds_read_b64_tr_b16 a[12:13], v5 offset:30728
  ds_read_b64_tr_b16 a[10:11], v5 offset:31744
  ds_read_b64_tr_b16 a[14:15], v5 offset:31752
  s_waitcnt lgkmcnt(0)
  s_add_u32 s36, s38, 1228800
  s_add_u32 m0, s35, 28672
  s_nop 0
  buffer_load_dwordx4 v3, s[12:15], s36 offen lds
  s_add_u32 s36, s38, 1249280
  s_add_u32 m0, s35, 29696
  s_nop 0
  buffer_load_dwordx4 v3, s[12:15], s36 offen lds
  s_add_u32 s36, s38, 1269760
  s_add_u32 m0, s35, 30720
  s_nop 0
  buffer_load_dwordx4 v3, s[12:15], s36 offen lds
  s_add_u32 s36, s38, 1290240
  s_add_u32 m0, s35, 31744
  s_nop 0
  buffer_load_dwordx4 v3, s[12:15], s36 offen lds
  s_waitcnt vmcnt(28)
  ds_read_b64_tr_b16 a[16:17], v5 offset:0
  ds_read_b64_tr_b16 a[20:21], v5 offset:8
  ds_read_b64_tr_b16 a[18:19], v5 offset:1024
  ds_read_b64_tr_b16 a[22:23], v5 offset:1032
  ds_read_b64_tr_b16 a[24:25], v5 offset:2048
  ds_read_b64_tr_b16 a[28:29], v5 offset:2056
  ds_read_b64_tr_b16 a[26:27], v5 offset:3072
  ds_read_b64_tr_b16 a[30:31], v5 offset:3080
  s_waitcnt lgkmcnt(0)
  s_add_u32 s36, s39, 0
  s_add_u32 m0, s35, 0
  s_nop 0
  buffer_load_dwordx4 v4, s[16:19], s36 offen lds
  s_add_u32 s36, s39, 10240
  s_add_u32 m0, s35, 1024
  s_nop 0
  buffer_load_dwordx4 v4, s[16:19], s36 offen lds
  s_add_u32 s36, s39, 40960
  s_add_u32 m0, s35, 2048
  s_nop 0
  buffer_load_dwordx4 v4, s[16:19], s36 offen lds
  s_add_u32 s36, s39, 51200
  s_add_u32 m0, s35, 3072
  s_nop 0
  buffer_load_dwordx4 v4, s[16:19], s36 offen lds
  s_waitcnt vmcnt(28)
  ds_read_b64_tr_b16 a[32:33], v5 offset:4096
  ds_read_b64_tr_b16 a[36:37], v5 offset:4104
  ds_read_b64_tr_b16 a[34:35], v5 offset:5120
  ds_read_b64_tr_b16 a[38:39], v5 offset:5128
  ds_read_b64_tr_b16 a[40:41], v5 offset:6144
  ds_read_b64_tr_b16 a[44:45], v5 offset:6152
  ds_read_b64_tr_b16 a[42:43], v5 offset:7168
  ds_read_b64_tr_b16 a[46:47], v5 offset:7176
  s_waitcnt lgkmcnt(0)
  s_add_u32 s36, s39, 81920
  s_add_u32 m0, s35, 4096
  s_nop 0
  buffer_load_dwordx4 v4, s[16:19], s36 offen lds
  s_add_u32 s36, s39, 92160
  s_add_u32 m0, s35, 5120
  s_nop 0
  buffer_load_dwordx4 v4, s[16:19], s36 offen lds
  s_add_u32 s36, s39, 122880
  s_add_u32 m0, s35, 6144
  s_nop 0
  buffer_load_dwordx4 v4, s[16:19], s36 offen lds
  s_add_u32 s36, s39, 133120
  s_add_u32 m0, s35, 7168
  s_nop 0
  buffer_load_dwordx4 v4, s[16:19], s36 offen lds
  s_waitcnt vmcnt(28)
  ds_read_b64_tr_b16 a[48:49], v5 offset:8192
  ds_read_b64_tr_b16 a[52:53], v5 offset:8200
  ds_read_b64_tr_b16 a[50:51], v5 offset:9216
  ds_read_b64_tr_b16 a[54:55], v5 offset:9224
  ds_read_b64_tr_b16 a[56:57], v5 offset:10240
  ds_read_b64_tr_b16 a[60:61], v5 offset:10248
  ds_read_b64_tr_b16 a[58:59], v5 offset:11264
  ds_read_b64_tr_b16 a[62:63], v5 offset:11272
  s_waitcnt lgkmcnt(0)
  s_add_u32 s36, s39, 163840
  s_add_u32 m0, s35, 8192
  s_nop 0
  buffer_load_dwordx4 v4, s[16:19], s36 offen lds
  s_add_u32 s36, s39, 174080
  s_add_u32 m0, s35, 9216
  s_nop 0
  buffer_load_dwordx4 v4, s[16:19], s36 offen lds
  s_add_u32 s36, s39, 204800
  s_add_u32 m0, s35, 10240
  s_nop 0
  buffer_load_dwordx4 v4, s[16:19], s36 offen lds
  s_add_u32 s36, s39, 215040
  s_add_u32 m0, s35, 11264
  s_nop 0
  buffer_load_dwordx4 v4, s[16:19], s36 offen lds
  s_waitcnt vmcnt(28)
  ds_read_b64_tr_b16 a[64:65], v5 offset:12288
  ds_read_b64_tr_b16 a[68:69], v5 offset:12296
  ds_read_b64_tr_b16 a[66:67], v5 offset:13312
  ds_read_b64_tr_b16 a[70:71], v5 offset:13320
  ds_read_b64_tr_b16 a[72:73], v5 offset:14336
  ds_read_b64_tr_b16 a[76:77], v5 offset:14344
  ds_read_b64_tr_b16 a[74:75], v5 offset:15360
  ds_read_b64_tr_b16 a[78:79], v5 offset:15368
  s_waitcnt lgkmcnt(0)
  s_add_u32 s36, s39, 245760
  s_add_u32 m0, s35, 12288
  s_nop 0
  buffer_load_dwordx4 v4, s[16:19], s36 offen lds
  s_add_u32 s36, s39, 256000
  s_add_u32 m0, s35, 13312
  s_nop 0
  buffer_load_dwordx4 v4, s[16:19], s36 offen lds
  s_add_u32 s36, s39, 286720
  s_add_u32 m0, s35, 14336
  s_nop 0
  buffer_load_dwordx4 v4, s[16:19], s36 offen lds
  s_add_u32 s36, s39, 296960
  s_add_u32 m0, s35, 15360
  s_nop 0
  buffer_load_dwordx4 v4, s[16:19], s36 offen lds
  s_waitcnt vmcnt(28)
  ds_read_b64_tr_b16 a[80:81], v5 offset:16384
  ds_read_b64_tr_b16 a[84:85], v5 offset:16392
  ds_read_b64_tr_b16 a[82:83], v5 offset:17408
  ds_read_b64_tr_b16 a[86:87], v5 offset:17416
  ds_read_b64_tr_b16 a[88:89], v5 offset:18432
  ds_read_b64_tr_b16 a[92:93], v5 offset:18440
  ds_read_b64_tr_b16 a[90:91], v5 offset:19456
  ds_read_b64_tr_b16 a[94:95], v5 offset:19464
  s_waitcnt lgkmcnt(0)
  s_add_u32 s36, s39, 327680
  s_add_u32 m0, s35, 16384
  s_nop 0
  buffer_load_dwordx4 v4, s[16:19], s36 offen lds
  s_add_u32 s36, s39, 337920
  s_add_u32 m0, s35, 17408
  s_nop 0
  buffer_load_dwordx4 v4, s[16:19], s36 offen lds
  s_add_u32 s36, s39, 368640
  s_add_u32 m0, s35, 18432
  s_nop 0
  buffer_load_dwordx4 v4, s[16:19], s36 offen lds
  s_add_u32 s36, s39, 378880
  s_add_u32 m0, s35, 19456
  s_nop 0
  buffer_load_dwordx4 v4, s[16:19], s36 offen lds
  s_waitcnt vmcnt(28)
  ds_read_b64_tr_b16 a[96:97], v5 offset:20480
  ds_read_b64_tr_b16 a[100:101], v5 offset:20488
  ds_read_b64_tr_b16 a[98:99], v5 offset:21504
  ds_read_b64_tr_b16 a[102:103], v5 offset:21512
  ds_read_b64_tr_b16 a[104:105], v5 offset:22528
  ds_read_b64_tr_b16 a[108:109], v5 offset:22536
  ds_read_b64_tr_b16 a[106:107], v5 offset:23552
  ds_read_b64_tr_b16 a[110:111], v5 offset:23560
  s_waitcnt lgkmcnt(0)
  s_add_u32 s36, s39, 409600
  s_add_u32 m0, s35, 20480
  s_nop 0
  buffer_load_dwordx4 v4, s[16:19], s36 offen lds
  s_add_u32 s36, s39, 419840
  s_add_u32 m0, s35, 21504
  s_nop 0
  buffer_load_dwordx4 v4, s[16:19], s36 offen lds
  s_add_u32 s36, s39, 450560
  s_add_u32 m0, s35, 22528
  s_nop 0
  buffer_load_dwordx4 v4, s[16:19], s36 offen lds
  s_add_u32 s36, s39, 460800
  s_add_u32 m0, s35, 23552
  s_nop 0
  buffer_load_dwordx4 v4, s[16:19], s36 offen lds
  s_waitcnt vmcnt(28)
  ds_read_b64_tr_b16 a[112:113], v5 offset:24576
  ds_read_b64_tr_b16 a[116:117], v5 offset:24584
  ds_read_b64_tr_b16 a[114:115], v5 offset:25600
  ds_read_b64_tr_b16 a[118:119], v5 offset:25608
  ds_read_b64_tr_b16 a[120:121], v5 offset:26624
  ds_read_b64_tr_b16 a[124:125], v5 offset:26632
  ds_read_b64_tr_b16 a[122:123], v5 offset:27648
  ds_read_b64_tr_b16 a[126:127], v5 offset:27656
  s_waitcnt lgkmcnt(0)
  s_add_u32 s36, s39, 491520
  s_add_u32 m0, s35, 24576
  s_nop 0
  buffer_load_dwordx4 v4, s[16:19], s36 offen lds
  s_add_u32 s36, s39, 501760
  s_add_u32 m0, s35, 25600
  s_nop 0
  buffer_load_dwordx4 v4, s[16:19], s36 offen lds
  s_cmp_lt_u32 s28, 2
  s_cselect_b32 s36, 532480, 0
  s_add_u32 s36, s39, s36
  s_add_u32 s36, s36, 0
  s_add_u32 m0, s35, 26624
  s_nop 0
  buffer_load_dwordx4 v4, s[16:19], s36 offen lds
  s_cmp_lt_u32 s28, 2
  s_cselect_b32 s36, 532480, 0
  s_add_u32 s36, s39, s36
  s_add_u32 s36, s36, 10240
  s_add_u32 m0, s35, 27648
  s_nop 0
  buffer_load_dwordx4 v4, s[16:19], s36 offen lds
  s_waitcnt vmcnt(28)
  ds_read_b64_tr_b16 a[128:129], v5 offset:28672
  ds_read_b64_tr_b16 a[132:133], v5 offset:28680
  ds_read_b64_tr_b16 a[130:131], v5 offset:29696
  ds_read_b64_tr_b16 a[134:135], v5 offset:29704
  ds_read_b64_tr_b16 a[136:137], v5 offset:30720
  ds_read_b64_tr_b16 a[140:141], v5 offset:30728
  ds_read_b64_tr_b16 a[138:139], v5 offset:31744
  ds_read_b64_tr_b16 a[142:143], v5 offset:31752
  s_waitcnt vmcnt(24)
  ds_read_b64_tr_b16 a[144:145], v5 offset:0
  ds_read_b64_tr_b16 a[148:149], v5 offset:8
  ds_read_b64_tr_b16 a[146:147], v5 offset:1024
  ds_read_b64_tr_b16 a[150:151], v5 offset:1032
  ds_read_b64_tr_b16 a[152:153], v5 offset:2048
  ds_read_b64_tr_b16 a[156:157], v5 offset:2056
  ds_read_b64_tr_b16 a[154:155], v5 offset:3072
  ds_read_b64_tr_b16 a[158:159], v5 offset:3080
  s_waitcnt vmcnt(20)
  ds_read_b64_tr_b16 a[160:161], v5 offset:4096
  ds_read_b64_tr_b16 a[164:165], v5 offset:4104
  ds_read_b64_tr_b16 a[162:163], v5 offset:5120
  ds_read_b64_tr_b16 a[166:167], v5 offset:5128
  ds_read_b64_tr_b16 a[168:169], v5 offset:6144
  ds_read_b64_tr_b16 a[172:173], v5 offset:6152
  ds_read_b64_tr_b16 a[170:171], v5 offset:7168
  ds_read_b64_tr_b16 a[174:175], v5 offset:7176
  s_waitcnt vmcnt(16)
  ds_read_b64_tr_b16 a[176:177], v5 offset:8192
  ds_read_b64_tr_b16 a[180:181], v5 offset:8200
  ds_read_b64_tr_b16 a[178:179], v5 offset:9216
  ds_read_b64_tr_b16 a[182:183], v5 offset:9224
  ds_read_b64_tr_b16 a[184:185], v5 offset:10240
  ds_read_b64_tr_b16 a[188:189], v5 offset:10248
  ds_read_b64_tr_b16 a[186:187], v5 offset:11264
  ds_read_b64_tr_b16 a[190:191], v5 offset:11272
  s_waitcnt vmcnt(12)
  ds_read_b64_tr_b16 a[192:193], v5 offset:12288
  ds_read_b64_tr_b16 a[196:197], v5 offset:12296
  ds_read_b64_tr_b16 a[194:195], v5 offset:13312
  ds_read_b64_tr_b16 a[198:199], v5 offset:13320
  ds_read_b64_tr_b16 a[200:201], v5 offset:14336
  ds_read_b64_tr_b16 a[204:205], v5 offset:14344
  ds_read_b64_tr_b16 a[202:203], v5 offset:15360
  ds_read_b64_tr_b16 a[206:207], v5 offset:15368
  s_waitcnt vmcnt(8)
  ds_read_b64_tr_b16 a[208:209], v5 offset:16384
  ds_read_b64_tr_b16 a[212:213], v5 offset:16392
  ds_read_b64_tr_b16 a[210:211], v5 offset:17408
  ds_read_b64_tr_b16 a[214:215], v5 offset:17416
  ds_read_b64_tr_b16 a[216:217], v5 offset:18432
  ds_read_b64_tr_b16 a[220:221], v5 offset:18440
  ds_read_b64_tr_b16 a[218:219], v5 offset:19456
  ds_read_b64_tr_b16 a[222:223], v5 offset:19464
  s_waitcnt vmcnt(4)
  ds_read_b64_tr_b16 a[224:225], v5 offset:20480
  ds_read_b64_tr_b16 a[228:229], v5 offset:20488
  ds_read_b64_tr_b16 a[226:227], v5 offset:21504
  ds_read_b64_tr_b16 a[230:231], v5 offset:21512
  ds_read_b64_tr_b16 a[232:233], v5 offset:22528
  ds_read_b64_tr_b16 a[236:237], v5 offset:22536
  ds_read_b64_tr_b16 a[234:235], v5 offset:23552
  ds_read_b64_tr_b16 a[238:239], v5 offset:23560
  s_waitcnt vmcnt(0)
  ds_read_b64_tr_b16 a[240:241], v5 offset:24576
  ds_read_b64_tr_b16 a[244:245], v5 offset:24584
  ds_read_b64_tr_b16 a[242:243], v5 offset:25600
  ds_read_b64_tr_b16 a[246:247], v5 offset:25608
  ds_read_b64_tr_b16 a[248:249], v5 offset:26624
  ds_read_b64_tr_b16 a[252:253], v5 offset:26632
  ds_read_b64_tr_b16 a[250:251], v5 offset:27648
  ds_read_b64_tr_b16 a[254:255], v5 offset:27656
  s_waitcnt lgkmcnt(0)
  s_cmp_lg_u32 s34, 0
  s_cbranch_scc1 L_verd_85
  s_cmp_eq_u32 s101, 0
  s_cbranch_scc1 L_sig_88
  s_mov_b32 s101, 0
  s_waitcnt vmcnt(0)
  s_mov_b64 exec, 1
  v_mov_b32 v0, 1
  buffer_atomic_add v0, off, s[8:11], 0 offset:32
  s_mov_b64 exec, -1
L_sig_88:
  v_lshlrev_b32 v2, 2, v1
L_ver_84:
  buffer_load_dword v3, v2, s[8:11], 0 offen sc1
  s_waitcnt vmcnt(0)
  v_readlane_b32 s3, v3, 8
  s_nop 0
  s_cmp_eq_u32 s3, 32
  s_cbranch_scc0 L_verf_87
  v_readlane_b32 s3, v3, 0
  v_readlane_b32 vcc_lo, v3, 1
  s_nop 0
  s_add_u32 s3, s3, vcc_lo
  v_readlane_b32 vcc_lo, v3, 34
  s_nop 0
  s_add_u32 s3, s3, vcc_lo
  v_readlane_b32 vcc_lo, v3, 35
  s_nop 0
  s_add_u32 s3, s3, vcc_lo
  v_readlane_b32 vcc_lo, v3, 36
  s_nop 0
  s_add_u32 s3, s3, vcc_lo
  v_readlane_b32 vcc_lo, v3, 37
  s_nop 0
  s_add_u32 s3, s3, vcc_lo
  v_readlane_b32 vcc_lo, v3, 38
  s_nop 0
  s_add_u32 s3, s3, vcc_lo
  v_readlane_b32 vcc_lo, v3, 39
  s_nop 0
  s_add_u32 s3, s3, vcc_lo
  s_cmp_eq_u32 s3, 0x100
  s_cbranch_scc1 L_verr_86
L_verf_87:
  s_sleep 2
  s_sub_u32 s29, s29, 1
  s_cbranch_scc0 L_ver_84
  s_branch L_end
L_verr_86:
  s_mov_b32 s34, 1
  v_cmp_ne_u32 vcc, 32, v3
  s_nop 4
  s_and_b32 vcc_lo, vcc_lo, 3
  s_and_b32 vcc_hi, vcc_hi, 0xfc
  s_cbranch_vccz L_verd_85
  s_mov_b32 s32, s31
  s_mov_b32 s33, 1
  v_readlane_b32 s3, v3, 0
  s_nop 0
  s_cmp_gt_u32 s30, 0
  s_cselect_b32 s3, s3, 0
  s_add_u32 s32, s32, s3
  v_readlane_b32 s3, v3, 1
  s_nop 0
  s_cmp_gt_u32 s30, 1
  s_cselect_b32 s3, s3, 0
  s_add_u32 s32, s32, s3
  v_readlane_b32 s3, v3, 34
  s_nop 0
  s_cmp_gt_u32 s30, 2
  s_cselect_b32 s3, s3, 0
  s_add_u32 s32, s32, s3
  v_readlane_b32 s3, v3, 35
  s_nop 0
  s_cmp_gt_u32 s30, 3
  s_cselect_b32 s3, s3, 0
  s_add_u32 s32, s32, s3
  v_readlane_b32 s3, v3, 36
  s_nop 0
  s_cmp_gt_u32 s30, 4
  s_cselect_b32 s3, s3, 0
  s_add_u32 s32, s32, s3
  v_readlane_b32 s3, v3, 37
  s_nop 0
  s_cmp_gt_u32 s30, 5
  s_cselect_b32 s3, s3, 0
  s_add_u32 s32, s32, s3
  v_readlane_b32 s3, v3, 38
  s_nop 0
  s_cmp_gt_u32 s30, 6
  s_cselect_b32 s3, s3, 0
  s_add_u32 s32, s32, s3
  s_branch L_restart
L_verd_85:
  s_mov_b32 s12, s88
  s_mov_b32 s13, s89
  s_mov_b32 s14, 2621440
  s_mov_b32 s15, 0x20000
  s_mov_b32 s16, s86
  s_mov_b32 s17, s87
  s_mov_b32 s18, 1280
  s_mov_b32 s19, 0x20000
  v_lshlrev_b32 v5, 4, v1
  v_lshrrev_b32 v2, 4, v1
  v_lshlrev_b32 v2, 4, v2
  buffer_load_dwordx4 v[24:27], v2, s[16:19], s49 offen
  v_and_b32 v3, 15, v1
  v_mul_u32_u24 v3, 1280, v3
  v_add_u32 v6, v3, v2
  s_lshl_b32 s3, s28, 11
  v_add_u32 v7, s3, v5
  s_waitcnt vmcnt(0)
  v_lshlrev_b32 v8, 16, v24
  v_and_b32 v9, 0xffff0000, v24
  v_lshlrev_b32 v10, 16, v25
  v_and_b32 v11, 0xffff0000, v25
  v_lshlrev_b32 v12, 16, v26
  v_and_b32 v13, 0xffff0000, v26
  v_lshlrev_b32 v14, 16, v27
  v_and_b32 v15, 0xffff0000, v27
  s_lshl_b32 s44, s40, 17
  s_lshl_b32 s3, s28, 15
  s_add_u32 s44, s44, s3
  s_add_u32 s44, s44, 58720256
  s_mul_i32 s45, s40, 55296
  s_lshl_b32 s3, s43, 10
  s_add_u32 s45, s45, s3
  s_add_u32 s45, s45, 75497472
  s_mul_i32 s46, s40, 20480
  s_add_u32 s46, s46, s49
  s_and_b32 s3, s40, 1
  s_lshl2_add_u32 s3, s3, s28
  s_lshl_b32 s3, s3, 7
  s_add_u32 s48, s3, 188672
  s_mov_b32 s42, s40
  s_mov_b32 s47, 0
  s_mov_b32 s51, 0
  s_barrier
  s_mov_b32 s24, s92
  s_mov_b32 s25, s93
  s_mov_b32 s26, 268435456
  s_mov_b32 s27, 0x20000
  s_lshr_b32 s53, s42, 1
  s_and_b32 s3, s53, 1
  s_lshl_b32 s3, s3, 5
  s_add_u32 s38, s3, 189696
  s_lshr_b32 s39, s53, 1
  s_add_u32 s39, s39, 1
  s_cmp_ge_u32 s51, s39
  s_cbranch_scc1 L_wo_hok0
  v_min_u32 v2, 6, v1
  v_mul_u32_u24 v2, 4, v2
L_wf_89:
  buffer_load_dword v3, v2, s[4:7], s38 offen sc1
  s_waitcnt vmcnt(0)
  v_cmp_gt_u32 vcc, s39, v3
  s_cbranch_vccz L_wfd_90
  s_sleep 2
  s_sub_u32 s29, s29, 1
  s_cbranch_scc0 L_wf_89
  s_branch L_end
L_wfd_90:
  v_add_u32 v3, -4, v3
  v_cmp_gt_i32 vcc, s39, v3
  s_cbranch_vccnz L_wo_hok0
  s_add_u32 s51, s39, 4
L_wo_hok0:
  s_mov_b32 s55, s45
  s_add_u32 s54, s55, 0
  buffer_load_dwordx4 v[64:67], v5, s[24:27], s54 offen offset:0 sc1
  buffer_load_dwordx4 v[68:71], v5, s[24:27], s54 offen offset:1024 sc1
  buffer_load_dwordx4 v[72:75], v5, s[24:27], s54 offen offset:2048 sc1
  buffer_load_dwordx4 v[76:79], v5, s[24:27], s54 offen offset:3072 sc1
  s_add_u32 s54, s55, 4096
  buffer_load_dwordx4 v[80:83], v5, s[24:27], s54 offen offset:0 sc1
  buffer_load_dwordx4 v[84:87], v5, s[24:27], s54 offen offset:1024 sc1
  buffer_load_dwordx4 v[88:91], v5, s[24:27], s54 offen offset:2048 sc1
  buffer_load_dwordx4 v[92:95], v5, s[24:27], s54 offen offset:3072 sc1
  s_add_u32 s54, s55, 8192
  buffer_load_dwordx4 v[96:99], v5, s[24:27], s54 offen offset:0 sc1
  buffer_load_dwordx4 v[100:103], v5, s[24:27], s54 offen offset:1024 sc1
  buffer_load_dwordx4 v[104:107], v5, s[24:27], s54 offen offset:2048 sc1
  buffer_load_dwordx4 v[108:111], v5, s[24:27], s54 offen offset:3072 sc1
  s_add_u32 s54, s55, 12288
  buffer_load_dwordx4 v[112:115], v5, s[24:27], s54 offen offset:0 sc1
  s_cmp_lt_u32 s28, 2
  s_cselect_b32 s3, 0, 1024
  s_sub_u32 s54, s54, s3
  buffer_load_dwordx4 v[116:119], v5, s[24:27], s54 offen offset:1024 sc1
L_wo_loop:
  buffer_load_dwordx4 v[24:27], v6, s[20:23], s46 offen
  s_lshr_b32 s50, s42, 1
  s_add_u32 s56, s42, 4
  s_min_u32 s56, s56, 127
  s_cmp_lt_u32 s28, 2
  s_cbranch_scc0 L_wo_h13
  s_waitcnt vmcnt(1)
  v_mfma_f32_16x16x32_bf16 v[16:19], a[248:251], v[116:119], 0
  v_mfma_f32_16x16x32_bf16 v[20:23], a[252:255], v[116:119], 0
  s_branch L_wo_h14
L_wo_h13:
  v_mov_b32 v16, 0
  v_mov_b32 v17, 0
  v_mov_b32 v18, 0
  v_mov_b32 v19, 0
  v_mov_b32 v20, 0
  v_mov_b32 v21, 0
  v_mov_b32 v22, 0
  v_mov_b32 v23, 0
  s_waitcnt vmcnt(1)
  s_nop 0
L_wo_h14:
  v_mfma_f32_16x16x32_bf16 v[16:19], a[144:147], v[64:67], v[16:19]
  v_mfma_f32_16x16x32_bf16 v[20:23], a[148:151], v[64:67], v[20:23]
  v_mfma_f32_16x16x32_bf16 v[16:19], a[152:155], v[68:71], v[16:19]
  v_mfma_f32_16x16x32_bf16 v[20:23], a[156:159], v[68:71], v[20:23]
  v_mfma_f32_16x16x32_bf16 v[16:19], a[160:163], v[72:75], v[16:19]
  v_mfma_f32_16x16x32_bf16 v[20:23], a[164:167], v[72:75], v[20:23]
  v_mfma_f32_16x16x32_bf16 v[16:19], a[168:171], v[76:79], v[16:19]
  v_mfma_f32_16x16x32_bf16 v[20:23], a[172:175], v[76:79], v[20:23]
  v_mfma_f32_16x16x32_bf16 v[16:19], a[176:179], v[80:83], v[16:19]
  v_mfma_f32_16x16x32_bf16 v[20:23], a[180:183], v[80:83], v[20:23]
  v_mfma_f32_16x16x32_bf16 v[16:19], a[184:187], v[84:87], v[16:19]
  v_mfma_f32_16x16x32_bf16 v[20:23], a[188:191], v[84:87], v[20:23]
  v_mfma_f32_16x16x32_bf16 v[16:19], a[192:195], v[88:91], v[16:19]
  v_mfma_f32_16x16x32_bf16 v[20:23], a[196:199], v[88:91], v[20:23]
  v_mfma_f32_16x16x32_bf16 v[16:19], a[200:203], v[92:95], v[16:19]
  v_mfma_f32_16x16x32_bf16 v[20:23], a[204:207], v[92:95], v[20:23]
  v_mfma_f32_16x16x32_bf16 v[16:19], a[208:211], v[96:99], v[16:19]
  v_mfma_f32_16x16x32_bf16 v[20:23], a[212:215], v[96:99], v[20:23]
  v_mfma_f32_16x16x32_bf16 v[16:19], a[216:219], v[100:103], v[16:19]
  v_mfma_f32_16x16x32_bf16 v[20:23], a[220:223], v[100:103], v[20:23]
  v_mfma_f32_16x16x32_bf16 v[16:19], a[224:227], v[104:107], v[16:19]
  v_mfma_f32_16x16x32_bf16 v[20:23], a[228:231], v[104:107], v[20:23]
  v_mfma_f32_16x16x32_bf16 v[16:19], a[232:235], v[108:111], v[16:19]
  v_mfma_f32_16x16x32_bf16 v[20:23], a[236:239], v[108:111], v[20:23]
  v_mfma_f32_16x16x32_bf16 v[16:19], a[240:243], v[112:115], v[16:19]
  v_mfma_f32_16x16x32_bf16 v[20:23], a[244:247], v[112:115], v[20:23]
  s_add_u32 s55, s45, 221184
  s_cmp_lt_u32 s42, 124
  s_cselect_b32 s26, 268435456, 0
  s_cbranch_scc0 L_wo_hok1
  s_lshr_b32 s53, s56, 1
  s_and_b32 s3, s53, 1
  s_lshl_b32 s3, s3, 5
  s_add_u32 s38, s3, 189696
  s_lshr_b32 s39, s53, 1
  s_add_u32 s39, s39, 1
  s_cmp_ge_u32 s51, s39
  s_cbranch_scc1 L_wo_hok1
  v_min_u32 v2, 6, v1
  v_mul_u32_u24 v2, 4, v2
L_wf_91:
  buffer_load_dword v3, v2, s[4:7], s38 offen sc1
  s_waitcnt vmcnt(0)
  v_cmp_gt_u32 vcc, s39, v3
  s_cbranch_vccz L_wfd_92
  s_sleep 2
  s_sub_u32 s29, s29, 1
  s_cbranch_scc0 L_wf_91
  s_branch L_end
L_wfd_92:
  v_add_u32 v3, -4, v3
  v_cmp_gt_i32 vcc, s39, v3
  s_cbranch_vccnz L_wo_hok1
  s_add_u32 s51, s39, 4
L_wo_hok1:
  s_add_u32 s39, s50, 1
  s_cmp_gt_u32 s50, 52
  s_cselect_b32 s3, s50, 0
  s_and_b32 s3, s3, 1
  s_mul_i32 s3, s3, 1792
  s_add_u32 s38, s48, s3
  v_min_u32 v2, 15, v1
  v_mul_u32_u24 v2, 4, v2
L_wf_93:
  buffer_load_dword v3, v2, s[4:7], s38 offen sc1
  s_waitcnt vmcnt(0)
  v_cmp_gt_u32 vcc, s39, v3
  s_cbranch_vccz L_wfd_94
  s_sleep 1
  s_sub_u32 s29, s29, 1
  s_cbranch_scc0 L_wf_93
  s_branch L_end
L_wfd_94:
  s_add_u32 s38, s44, 0
  buffer_load_dwordx4 v[32:35], v5, s[4:7], s38 offen offset:0 sc1
  buffer_load_dwordx4 v[36:39], v5, s[4:7], s38 offen offset:1024 sc1
  buffer_load_dwordx4 v[40:43], v5, s[4:7], s38 offen offset:2048 sc1
  buffer_load_dwordx4 v[44:47], v5, s[4:7], s38 offen offset:3072 sc1
  s_add_u32 s38, s44, 4096
  buffer_load_dwordx4 v[48:51], v5, s[4:7], s38 offen offset:0 sc1
  buffer_load_dwordx4 v[52:55], v5, s[4:7], s38 offen offset:1024 sc1
  buffer_load_dwordx4 v[56:59], v5, s[4:7], s38 offen offset:2048 sc1
  buffer_load_dwordx4 v[60:63], v5, s[4:7], s38 offen offset:3072 sc1
  s_add_u32 s38, s44, 8192
  buffer_load_dwordx4 v[64:67], v5, s[4:7], s38 offen offset:0 sc1
  buffer_load_dwordx4 v[68:71], v5, s[4:7], s38 offen offset:1024 sc1
  buffer_load_dwordx4 v[72:75], v5, s[4:7], s38 offen offset:2048 sc1
  buffer_load_dwordx4 v[76:79], v5, s[4:7], s38 offen offset:3072 sc1
  s_add_u32 s38, s44, 12288
  buffer_load_dwordx4 v[80:83], v5, s[4:7], s38 offen offset:0 sc1
  buffer_load_dwordx4 v[84:87], v5, s[4:7], s38 offen offset:1024 sc1
  buffer_load_dwordx4 v[88:91], v5, s[4:7], s38 offen offset:2048 sc1
  buffer_load_dwordx4 v[92:95], v5, s[4:7], s38 offen offset:3072 sc1
  s_add_u32 s38, s44, 16384
  buffer_load_dwordx4 v[96:99], v5, s[4:7], s38 offen offset:0 sc1
  buffer_load_dwordx4 v[100:103], v5, s[4:7], s38 offen offset:1024 sc1
  buffer_load_dwordx4 v[104:107], v5, s[4:7], s38 offen offset:2048 sc1
  buffer_load_dwordx4 v[108:111], v5, s[4:7], s38 offen offset:3072 sc1
  s_add_u32 s38, s44, 20480
  buffer_load_dwordx4 v[112:115], v5, s[4:7], s38 offen offset:0 sc1
  buffer_load_dwordx4 v[116:119], v5, s[4:7], s38 offen offset:1024 sc1
  buffer_load_dwordx4 v[120:123], v5, s[4:7], s38 offen offset:2048 sc1
  buffer_load_dwordx4 v[124:127], v5, s[4:7], s38 offen offset:3072 sc1
  s_add_u32 s38, s44, 24576
  buffer_load_dwordx4 v[128:131], v5, s[4:7], s38 offen offset:0 sc1
  buffer_load_dwordx4 v[132:135], v5, s[4:7], s38 offen offset:1024 sc1
  buffer_load_dwordx4 v[136:139], v5, s[4:7], s38 offen offset:2048 sc1
  buffer_load_dwordx4 v[140:143], v5, s[4:7], s38 offen offset:3072 sc1
  s_waitcnt vmcnt(27)
  v_mfma_f32_16x16x32_bf16 v[16:19], v[144:147], v[32:35], v[16:19]
  v_mfma_f32_16x16x32_bf16 v[20:23], v[148:151], v[32:35], v[20:23]
  s_add_u32 s38, s44, 28672
  buffer_load_dwordx4 v[32:35], v5, s[4:7], s38 offen offset:0 sc1
  s_waitcnt vmcnt(27)
  v_mfma_f32_16x16x32_bf16 v[16:19], v[152:155], v[36:39], v[16:19]
  v_mfma_f32_16x16x32_bf16 v[20:23], v[156:159], v[36:39], v[20:23]
  buffer_load_dwordx4 v[36:39], v5, s[4:7], s38 offen offset:1024 sc1
  s_waitcnt vmcnt(27)
  v_mfma_f32_16x16x32_bf16 v[16:19], v[160:163], v[40:43], v[16:19]
  v_mfma_f32_16x16x32_bf16 v[20:23], v[164:167], v[40:43], v[20:23]
  buffer_load_dwordx4 v[40:43], v5, s[4:7], s38 offen offset:2048 sc1
  s_waitcnt vmcnt(27)
  v_mfma_f32_16x16x32_bf16 v[16:19], v[168:171], v[44:47], v[16:19]
  v_mfma_f32_16x16x32_bf16 v[20:23], v[172:175], v[44:47], v[20:23]
  buffer_load_dwordx4 v[44:47], v5, s[4:7], s38 offen offset:3072 sc1
  s_waitcnt vmcnt(27)
  v_mfma_f32_16x16x32_bf16 v[16:19], v[176:179], v[48:51], v[16:19]
  v_mfma_f32_16x16x32_bf16 v[20:23], v[180:183], v[48:51], v[20:23]
  s_waitcnt vmcnt(26)
  v_mfma_f32_16x16x32_bf16 v[16:19], v[184:187], v[52:55], v[16:19]
  v_mfma_f32_16x16x32_bf16 v[20:23], v[188:191], v[52:55], v[20:23]
  s_waitcnt vmcnt(25)
  v_mfma_f32_16x16x32_bf16 v[16:19], v[192:195], v[56:59], v[16:19]
  v_mfma_f32_16x16x32_bf16 v[20:23], v[196:199], v[56:59], v[20:23]
  s_waitcnt vmcnt(24)
  v_mfma_f32_16x16x32_bf16 v[16:19], v[200:203], v[60:63], v[16:19]
  v_mfma_f32_16x16x32_bf16 v[20:23], v[204:207], v[60:63], v[20:23]
  s_waitcnt vmcnt(23)
  v_mfma_f32_16x16x32_bf16 v[16:19], v[208:211], v[64:67], v[16:19]
  v_mfma_f32_16x16x32_bf16 v[20:23], v[212:215], v[64:67], v[20:23]
  s_add_u32 s54, s55, 0
  buffer_load_dwordx4 v[64:67], v5, s[24:27], s54 offen offset:0 sc1
  s_waitcnt vmcnt(23)
  v_mfma_f32_16x16x32_bf16 v[16:19], v[216:219], v[68:71], v[16:19]
  v_mfma_f32_16x16x32_bf16 v[20:23], v[220:223], v[68:71], v[20:23]
  buffer_load_dwordx4 v[68:71], v5, s[24:27], s54 offen offset:1024 sc1
  s_waitcnt vmcnt(23)
  v_mfma_f32_16x16x32_bf16 v[16:19], v[224:227], v[72:75], v[16:19]
  v_mfma_f32_16x16x32_bf16 v[20:23], v[228:231], v[72:75], v[20:23]
  buffer_load_dwordx4 v[72:75], v5, s[24:27], s54 offen offset:2048 sc1
  s_waitcnt vmcnt(23)
  v_mfma_f32_16x16x32_bf16 v[16:19], v[232:235], v[76:79], v[16:19]
  v_mfma_f32_16x16x32_bf16 v[20:23], v[236:239], v[76:79], v[20:23]
  buffer_load_dwordx4 v[76:79], v5, s[24:27], s54 offen offset:3072 sc1
  s_waitcnt vmcnt(23)
  v_mfma_f32_16x16x32_bf16 v[16:19], v[240:243], v[80:83], v[16:19]
  v_mfma_f32_16x16x32_bf16 v[20:23], v[244:247], v[80:83], v[20:23]
  s_add_u32 s54, s55, 4096
  buffer_load_dwordx4 v[80:83], v5, s[24:27], s54 offen offset:0 sc1
  s_waitcnt vmcnt(23)
  v_mfma_f32_16x16x32_bf16 v[16:19], v[248:251], v[84:87], v[16:19]
  v_mfma_f32_16x16x32_bf16 v[20:23], v[252:255], v[84:87], v[20:23]
  buffer_load_dwordx4 v[84:87], v5, s[24:27], s54 offen offset:1024 sc1
  s_waitcnt vmcnt(23)
  v_mfma_f32_16x16x32_bf16 v[16:19], a[0:3], v[88:91], v[16:19]
  v_mfma_f32_16x16x32_bf16 v[20:23], a[4:7], v[88:91], v[20:23]
  buffer_load_dwordx4 v[88:91], v5, s[24:27], s54 offen offset:2048 sc1
  s_waitcnt vmcnt(23)
  v_mfma_f32_16x16x32_bf16 v[16:19], a[8:11], v[92:95], v[16:19]
  v_mfma_f32_16x16x32_bf16 v[20:23], a[12:15], v[92:95], v[20:23]
  buffer_load_dwordx4 v[92:95], v5, s[24:27], s54 offen offset:3072 sc1
  s_waitcnt vmcnt(23)
  v_mfma_f32_16x16x32_bf16 v[16:19], a[16:19], v[96:99], v[16:19]
  v_mfma_f32_16x16x32_bf16 v[20:23], a[20:23], v[96:99], v[20:23]
  s_add_u32 s54, s55, 8192
  buffer_load_dwordx4 v[96:99], v5, s[24:27], s54 offen offset:0 sc1
  s_waitcnt vmcnt(23)
  v_mfma_f32_16x16x32_bf16 v[16:19], a[24:27], v[100:103], v[16:19]
  v_mfma_f32_16x16x32_bf16 v[20:23], a[28:31], v[100:103], v[20:23]
  buffer_load_dwordx4 v[100:103], v5, s[24:27], s54 offen offset:1024 sc1
  s_waitcnt vmcnt(23)
  v_mfma_f32_16x16x32_bf16 v[16:19], a[32:35], v[104:107], v[16:19]
  v_mfma_f32_16x16x32_bf16 v[20:23], a[36:39], v[104:107], v[20:23]
  buffer_load_dwordx4 v[104:107], v5, s[24:27], s54 offen offset:2048 sc1
  s_waitcnt vmcnt(23)
  v_mfma_f32_16x16x32_bf16 v[16:19], a[40:43], v[108:111], v[16:19]
  v_mfma_f32_16x16x32_bf16 v[20:23], a[44:47], v[108:111], v[20:23]
  buffer_load_dwordx4 v[108:111], v5, s[24:27], s54 offen offset:3072 sc1
  s_waitcnt vmcnt(23)
  v_mfma_f32_16x16x32_bf16 v[16:19], a[48:51], v[112:115], v[16:19]
  v_mfma_f32_16x16x32_bf16 v[20:23], a[52:55], v[112:115], v[20:23]
  s_add_u32 s54, s55, 12288
  buffer_load_dwordx4 v[112:115], v5, s[24:27], s54 offen offset:0 sc1
  s_waitcnt vmcnt(23)
  v_mfma_f32_16x16x32_bf16 v[16:19], a[56:59], v[116:119], v[16:19]
  v_mfma_f32_16x16x32_bf16 v[20:23], a[60:63], v[116:119], v[20:23]
  s_cmp_lt_u32 s28, 2
  s_cselect_b32 s3, 0, 1024
  s_sub_u32 s54, s54, s3
  buffer_load_dwordx4 v[116:119], v5, s[24:27], s54 offen offset:1024 sc1
  s_waitcnt vmcnt(23)
  v_mfma_f32_16x16x32_bf16 v[16:19], a[64:67], v[120:123], v[16:19]
  v_mfma_f32_16x16x32_bf16 v[20:23], a[68:71], v[120:123], v[20:23]
  s_waitcnt vmcnt(22)
  v_mfma_f32_16x16x32_bf16 v[16:19], a[72:75], v[124:127], v[16:19]
  v_mfma_f32_16x16x32_bf16 v[20:23], a[76:79], v[124:127], v[20:23]
  s_waitcnt vmcnt(21)
  v_mfma_f32_16x16x32_bf16 v[16:19], a[80:83], v[128:131], v[16:19]
  v_mfma_f32_16x16x32_bf16 v[20:23], a[84:87], v[128:131], v[20:23]
  s_waitcnt vmcnt(20)
  v_mfma_f32_16x16x32_bf16 v[16:19], a[88:91], v[132:135], v[16:19]
  v_mfma_f32_16x16x32_bf16 v[20:23], a[92:95], v[132:135], v[20:23]
  s_waitcnt vmcnt(19)
  v_mfma_f32_16x16x32_bf16 v[16:19], a[96:99], v[136:139], v[16:19]
  v_mfma_f32_16x16x32_bf16 v[20:23], a[100:103], v[136:139], v[20:23]
  s_waitcnt vmcnt(18)
  v_mfma_f32_16x16x32_bf16 v[16:19], a[104:107], v[140:143], v[16:19]
  v_mfma_f32_16x16x32_bf16 v[20:23], a[108:111], v[140:143], v[20:23]
  s_waitcnt vmcnt(17)
  v_mfma_f32_16x16x32_bf16 v[16:19], a[112:115], v[32:35], v[16:19]
  v_mfma_f32_16x16x32_bf16 v[20:23], a[116:119], v[32:35], v[20:23]
  s_waitcnt vmcnt(16)
  v_mfma_f32_16x16x32_bf16 v[16:19], a[120:123], v[36:39], v[16:19]
  v_mfma_f32_16x16x32_bf16 v[20:23], a[124:127], v[36:39], v[20:23]
  s_waitcnt vmcnt(15)
  v_mfma_f32_16x16x32_bf16 v[16:19], a[128:131], v[40:43], v[16:19]
  v_mfma_f32_16x16x32_bf16 v[20:23], a[132:135], v[40:43], v[20:23]
  s_waitcnt vmcnt(14)
  v_mfma_f32_16x16x32_bf16 v[16:19], a[136:139], v[44:47], v[16:19]
  v_mfma_f32_16x16x32_bf16 v[20:23], a[140:143], v[44:47], v[20:23]
  v_add_u32 v2, s47, v7
  s_nop 6
  ds_write_b128 v2, v[16:19] offset:0
  ds_write_b128 v2, v[20:23] offset:1024
  s_waitcnt lgkmcnt(0)
  s_barrier
  s_cmp_lg_u32 s28, 0
  s_cbranch_scc1 L_wo_nr
  ds_read_b128 v[40:43], v2 offset:2048
  ds_read_b128 v[44:47], v2 offset:3072
  ds_read_b128 v[48:51], v2 offset:4096
  ds_read_b128 v[52:55], v2 offset:5120
  ds_read_b128 v[56:59], v2 offset:6144
  ds_read_b128 v[60:63], v2 offset:7168
  v_lshlrev_b32 v32, 16, v24
  v_and_b32 v33, 0xffff0000, v24
  v_lshlrev_b32 v34, 16, v25
  v_and_b32 v35, 0xffff0000, v25
  v_lshlrev_b32 v36, 16, v26
  v_and_b32 v37, 0xffff0000, v26
  v_lshlrev_b32 v38, 16, v27
  v_and_b32 v39, 0xffff0000, v27
  v_pk_add_f32 v[32:33], v[32:33], v[8:9]
  v_pk_add_f32 v[34:35], v[34:35], v[10:11]
  v_pk_add_f32 v[36:37], v[36:37], v[12:13]
  v_pk_add_f32 v[38:39], v[38:39], v[14:15]
  v_pk_add_f32 v[16:17], v[16:17], v[32:33]
  v_pk_add_f32 v[18:19], v[18:19], v[34:35]
  v_pk_add_f32 v[20:21], v[20:21], v[36:37]
  v_pk_add_f32 v[22:23], v[22:23], v[38:39]
  s_waitcnt lgkmcnt(4)
  v_pk_add_f32 v[16:17], v[16:17], v[40:41]
  v_pk_add_f32 v[18:19], v[18:19], v[42:43]
  v_pk_add_f32 v[20:21], v[20:21], v[44:45]
  v_pk_add_f32 v[22:23], v[22:23], v[46:47]
  s_waitcnt lgkmcnt(2)
  v_pk_add_f32 v[16:17], v[16:17], v[48:49]
  v_pk_add_f32 v[18:19], v[18:19], v[50:51]
  v_pk_add_f32 v[20:21], v[20:21], v[52:53]
  v_pk_add_f32 v[22:23], v[22:23], v[54:55]
  s_waitcnt lgkmcnt(0)
  v_pk_add_f32 v[16:17], v[16:17], v[56:57]
  v_pk_add_f32 v[18:19], v[18:19], v[58:59]
  v_pk_add_f32 v[20:21], v[20:21], v[60:61]
  v_pk_add_f32 v[22:23], v[22:23], v[62:63]
  v_cvt_pk_bf16_f32 v32, v16, v17
  v_cvt_pk_bf16_f32 v33, v18, v19
  v_cvt_pk_bf16_f32 v34, v20, v21
  v_cvt_pk_bf16_f32 v35, v22, v23
  buffer_store_dwordx4 v[32:35], v6, s[12:15], s46 offen
  s_nop 0
L_wo_nr:
  s_xor_b32 s47, s47, 8192
  s_add_u32 s44, s44, 524288
  s_add_u32 s45, s45, 221184
  s_add_u32 s46, s46, 81920
  s_add_u32 s42, s42, 4
  s_cmp_lt_u32 s42, 128
  s_cbranch_scc1 L_wo_loop
  s_branch L_fin
L_fin:
L_end:
  s_endpgm
.section .rodata,"a"
.p2align 6
.amdhsa_kernel parallel_sum__memory_aug_recurrent_mem_tr__mixer_channel_mlp__prompt_kernel
  .amdhsa_next_free_vgpr 512
  .amdhsa_next_free_sgpr 102
  .amdhsa_accum_offset 256
  .amdhsa_group_segment_fixed_size 0
  .amdhsa_kernarg_size 120
  .amdhsa_user_sgpr_count 2
  .amdhsa_user_sgpr_kernarg_segment_ptr 1
  .amdhsa_system_sgpr_workgroup_id_x 1
  .amdhsa_float_denorm_mode_32 3
  .amdhsa_float_denorm_mode_16_64 3
.end_amdhsa_kernel
```
